```python
import torch

def _softmax(x, axis=-1):
    return torch.softmax(x, dim=axis)
def _gelu(x):
    return torch.nn.functional.gelu(x, approximate="tanh")
def _silu(x):
    return torch.nn.functional.silu(x)
def _sigmoid(x):
    return torch.sigmoid(x)
def _layernorm(x, axis=-1, eps=1e-5):
    m = x.mean(dim=axis, keepdim=True)
    v = x.var(dim=axis, keepdim=True, unbiased=False)
    return (x - m) / torch.sqrt(v + eps)
def _scatter_add(tgt, idx, src, axis=0):
    return tgt.clone().index_add_(axis, idx, src)
def _segment_sum(src, seg, n):
    out = torch.zeros((n,) + src.shape[1:], dtype=src.dtype)
    return out.index_add_(0, seg, src)
def _pad(x, pw):
    flat = tuple(v for pair in reversed(pw) for v in pair)
    return torch.nn.functional.pad(x, flat)

kernel_name = 'interleave_layers__sliding_block__swiglu_ffn__prompt'

def setup_inputs():

    _w = (lambda a: (lambda t: t.to(torch.bfloat16) if t.is_floating_point() else t)(torch.as_tensor(a)))
    def _A_setup():
        B, S, D = 1, 2048, 576
        return {
            "x": _w((lambda *s: torch.randn(*s, dtype=torch.bfloat16) * 0.05)(B, S, D)),
            "wqkv": _w((lambda *s: torch.randn(*s, dtype=torch.bfloat16) * 0.05)(D, 3 * D)),
            "wo": _w((lambda *s: torch.randn(*s, dtype=torch.bfloat16) * 0.05)(D, D)),
        }
    _A_in = _A_setup()

    def _B_setup():
        B, S, D, F = 1, 2048, 576, 4608
        return {
            "x": _w((lambda *s: torch.randn(*s, dtype=torch.bfloat16) * 0.05)(B, S, D)),
            "w_gate": _w((lambda *s: torch.randn(*s, dtype=torch.bfloat16) * 0.05)(D, F)),
            "w_up": _w((lambda *s: torch.randn(*s, dtype=torch.bfloat16) * 0.05)(D, F)),
            "w_down": _w((lambda *s: torch.randn(*s, dtype=torch.bfloat16) * 0.05)(F, D)),
        }
    _B_in = _B_setup()

    return {
        "A_x": _A_in["x"],
        "A_wqkv": _A_in["wqkv"],
        "A_wo": _A_in["wo"],
        "B_x": _B_in["x"],
        "B_w_gate": _B_in["w_gate"],
        "B_w_up": _B_in["w_up"],
        "B_w_down": _B_in["w_down"],
    }

def reference(A_x, A_wqkv, A_wo, B_x, B_w_gate, B_w_up, B_w_down):
    def _A_ref(x, wqkv, wo):
        B, S, D = x.shape
        H = 32; Dh = D // H; W = 256
        qkv = (lambda x, *d: x.permute(*d))((x @ wqkv).reshape(B, S, 3, H, Dh), 2, 0, 3, 1, 4)
        q, k, v = qkv[0], qkv[1], qkv[2]
        scores = torch.einsum("bhqd,bhkd->bhqk", q, k) * (Dh ** -0.5)
        idx = torch.arange(S)
        mask = (idx[:, None] - idx[None, :] >= 0) & (idx[:, None] - idx[None, :] < W)
        scores = torch.where(mask[None, None], scores, -1e9)
        p = _softmax(scores, axis=-1)
        o = torch.einsum("bhqk,bhkd->bhqd", p, v)
        return (lambda x, *d: x.permute(*d))(o, 0, 2, 1, 3).reshape(B, S, D) @ wo

    def _B_ref(x, w_gate, w_up, w_down):
        g = _silu(x @ w_gate)
        u = x @ w_up
        return (g * u) @ w_down

    x = A_x
    x = x + _A_ref(_layernorm(x, axis=-1), A_wqkv, A_wo)
    x = x + _B_ref(_layernorm(x, axis=-1), B_w_gate, B_w_up, B_w_down)
    x = x + _A_ref(_layernorm(x, axis=-1), A_wqkv, A_wo)
    x = x + _B_ref(_layernorm(x, axis=-1), B_w_gate, B_w_up, B_w_down)
    return x
```

```asm
; @launch grid=(256,1,1) block=(256,1,1) lds=161344
.amdgcn_target "amdgcn-amd-amdhsa--gfx950"
.text
.globl interleave_layers__sliding_block__swiglu_ffn__prompt_kernel
.p2align 8
.type interleave_layers__sliding_block__swiglu_ffn__prompt_kernel,@function
interleave_layers__sliding_block__swiglu_ffn__prompt_kernel:
code_mega:
  s_load_dwordx2 s[4:5], s[0:1], 72
  s_load_dwordx4 s[8:11], s[0:1], 0
  s_load_dwordx2 s[56:57], s[0:1], 56
  s_cmp_ge_u32 s2, 256
  s_cbranch_scc1 mega_exit
  v_lshrrev_b32 v8, 6, v0
  v_and_b32 v254, 63, v0
  v_readfirstlane_b32 s18, v8
  v_lshlrev_b32 v1, 4, v254
  s_mov_b32 s54, 0
q2_main:
  s_and_b32 s6, s2, 7
  s_lshr_b32 s7, s2, 3
  s_mul_i32 s16, s7, 43
  s_lshr_b32 s16, s16, 8
  s_mul_i32 s17, s16, 6
  s_sub_u32 s17, s7, s17
  s_lshr_b32 s7, s6, 1
  s_lshl_b32 s7, s7, 2
  s_add_u32 s16, s16, s7
  s_and_b32 s6, s6, 1
  s_mul_i32 s6, s6, 6
  s_add_u32 s17, s17, s6
  s_cmp_eq_u32 s54, 0
  s_waitcnt lgkmcnt(0)
  s_cbranch_scc0 q2_l1
  s_mov_b64 s[94:95], s[8:9]
  s_mov_b64 s[12:13], s[10:11]
  s_cmp_ge_u32 s2, 192
  s_cbranch_scc1 q0_idle
q0_tile:
  s_and_b32 s9, s9, 0xffff
  s_mov_b32 s10, 2359296
  s_mov_b32 s11, 0x20000
  s_and_b32 s13, s13, 0xffff
  s_mov_b32 s14, 1990656
  s_mov_b32 s15, 0x20000
  s_lshl_b32 s19, s16, 3
  s_lshl_b32 s6, s18, 1
  s_add_u32 s19, s19, s6
  s_mul_i32 s34, s19, 18432
  s_mul_i32 s35, s17, 288
  s_lshl_b32 s38, s18, 12
  s_lshl_b32 s39, s18, 10
  s_add_u32 s39, s39, 32768
  v_lshrrev_b32 v6, 3, v254
  v_and_b32 v7, 7, v254
  v_xor_b32 v7, v7, v6
  v_mul_u32_u24 v2, 1152, v6
  v_lshl_add_u32 v2, v7, 4, v2
  v_add_u32 v3, 8192, v2
  v_add_u32 v4, 16384, v2
  v_add_u32 v5, 24576, v2
  s_mov_b32 s36, 0
  s_add_u32 m0, s38, 0
  s_nop 0
  buffer_load_dwordx4 v2, s[8:11], s34 offen offset:0 lds
  buffer_load_dwordx4 v3, s[8:11], s34 offen offset:1024 lds
  buffer_load_dwordx4 v4, s[8:11], s34 offen offset:2048 lds
  buffer_load_dwordx4 v5, s[8:11], s34 offen offset:3072 lds
  s_add_u32 s34, s34, 128
  s_add_u32 m0, s38, 36864
  s_nop 0
  buffer_load_dwordx4 v2, s[8:11], s34 offen offset:0 lds
  buffer_load_dwordx4 v3, s[8:11], s34 offen offset:1024 lds
  buffer_load_dwordx4 v4, s[8:11], s34 offen offset:2048 lds
  buffer_load_dwordx4 v5, s[8:11], s34 offen offset:3072 lds
  s_add_u32 s34, s34, 128
  s_lshl_b32 s6, s18, 8
  s_add_u32 s6, s6, 0
  v_add_u32 v6, s6, v254
  v_mul_u32_u24 v7, 3641, v6
  v_lshrrev_b32 v7, 16, v7
  v_mul_u32_u24 v8, 18, v7
  v_sub_u32 v6, v6, v8
  v_and_b32 v8, 0xfffffff3, v7
  v_bfe_u32 v9, v7, 2, 1
  v_lshl_add_u32 v8, v9, 3, v8
  v_bfe_u32 v9, v7, 3, 1
  v_lshl_add_u32 v8, v9, 2, v8
  v_mul_u32_u24 v8, 3456, v8
  v_lshl_add_u32 v9, v6, 4, v8
  s_lshl_b32 s6, s18, 8
  s_add_u32 s6, s6, 64
  v_add_u32 v6, s6, v254
  v_mul_u32_u24 v7, 3641, v6
  v_lshrrev_b32 v7, 16, v7
  v_mul_u32_u24 v8, 18, v7
  v_sub_u32 v6, v6, v8
  v_and_b32 v8, 0xfffffff3, v7
  v_bfe_u32 v10, v7, 2, 1
  v_lshl_add_u32 v8, v10, 3, v8
  v_bfe_u32 v10, v7, 3, 1
  v_lshl_add_u32 v8, v10, 2, v8
  v_mul_u32_u24 v8, 3456, v8
  v_lshl_add_u32 v10, v6, 4, v8
  v_subrev_u32 v10, 1024, v10
  s_lshl_b32 s6, s18, 8
  s_add_u32 s6, s6, 128
  v_add_u32 v6, s6, v254
  v_mul_u32_u24 v7, 3641, v6
  v_lshrrev_b32 v7, 16, v7
  v_mul_u32_u24 v8, 18, v7
  v_sub_u32 v6, v6, v8
  v_and_b32 v8, 0xfffffff3, v7
  v_bfe_u32 v11, v7, 2, 1
  v_lshl_add_u32 v8, v11, 3, v8
  v_bfe_u32 v11, v7, 3, 1
  v_lshl_add_u32 v8, v11, 2, v8
  v_mul_u32_u24 v8, 3456, v8
  v_lshl_add_u32 v11, v6, 4, v8
  v_subrev_u32 v11, 2048, v11
  s_lshl_b32 s6, s18, 8
  s_add_u32 s6, s6, 192
  v_add_u32 v6, s6, v254
  v_mul_u32_u24 v7, 3641, v6
  v_lshrrev_b32 v7, 16, v7
  v_mul_u32_u24 v8, 18, v7
  v_sub_u32 v6, v6, v8
  v_and_b32 v8, 0xfffffff3, v7
  v_bfe_u32 v12, v7, 2, 1
  v_lshl_add_u32 v8, v12, 3, v8
  v_bfe_u32 v12, v7, 3, 1
  v_lshl_add_u32 v8, v12, 2, v8
  v_mul_u32_u24 v8, 3456, v8
  v_lshl_add_u32 v12, v6, 4, v8
  v_subrev_u32 v12, 3072, v12
  s_lshl_b32 s6, s18, 6
  s_add_u32 s6, s6, 1024
  v_add_u32 v6, s6, v254
  v_mul_u32_u24 v7, 3641, v6
  v_lshrrev_b32 v7, 16, v7
  v_mul_u32_u24 v8, 18, v7
  v_sub_u32 v6, v6, v8
  v_and_b32 v8, 0xfffffff3, v7
  v_bfe_u32 v13, v7, 2, 1
  v_lshl_add_u32 v8, v13, 3, v8
  v_bfe_u32 v13, v7, 3, 1
  v_lshl_add_u32 v8, v13, 2, v8
  v_mul_u32_u24 v8, 3456, v8
  v_lshl_add_u32 v13, v6, 4, v8
  s_cmp_lt_u32 s18, 2
  s_cselect_b32 s6, 0, 0x7ff00000
  v_or_b32 v13, s6, v13
  s_add_u32 m0, s38, 16384
  s_nop 0
  buffer_load_dwordx4 v9, s[12:15], s35 offen offset:0 lds
  buffer_load_dwordx4 v10, s[12:15], s35 offen offset:1024 lds
  buffer_load_dwordx4 v11, s[12:15], s35 offen offset:2048 lds
  buffer_load_dwordx4 v12, s[12:15], s35 offen offset:3072 lds
  s_add_u32 m0, s39, 0
  s_nop 0
  buffer_load_dwordx4 v13, s[12:15], s35 offen offset:0 lds
  s_add_u32 s35, s35, 221184
  s_add_u32 m0, s38, 53248
  s_nop 0
  buffer_load_dwordx4 v9, s[12:15], s35 offen offset:0 lds
  buffer_load_dwordx4 v10, s[12:15], s35 offen offset:1024 lds
  buffer_load_dwordx4 v11, s[12:15], s35 offen offset:2048 lds
  buffer_load_dwordx4 v12, s[12:15], s35 offen offset:3072 lds
  s_add_u32 m0, s39, 36864
  s_nop 0
  buffer_load_dwordx4 v13, s[12:15], s35 offen offset:0 lds
  s_add_u32 s35, s35, 221184
  s_mov_b32 s36, 73728
  s_add_u32 s6, s4, 66887680
  s_addc_u32 s7, s5, 0
  s_load_dword s93, s[6:7], 0
  s_mov_b64 s[100:101], s[4:5]
  s_add_u32 s96, s4, 66293760
  s_addc_u32 s97, s5, 0
  s_and_b32 s97, s97, 0xffff
  s_mov_b32 s98, 593924
  s_mov_b32 s99, 0x20000
  v_mov_b32 v252, 0
  s_mov_b32 s59, 0
  v_and_b32 v7, 15, v254
  v_lshrrev_b32 v8, 4, v254
  v_and_b32 v6, 7, v7
  v_xor_b32 v6, v6, v8
  v_lshlrev_b32 v14, 7, v7
  v_lshl_add_u32 v14, v6, 4, v14
  v_add_u32 v14, s38, v14
  v_xor_b32 v15, 64, v14
  v_lshrrev_b32 v18, 5, v254
  v_lshlrev_b32 v18, 4, v18
  v_bfe_u32 v6, v254, 4, 1
  v_lshl_add_u32 v18, v6, 2, v18
  v_bfe_u32 v6, v254, 2, 2
  v_add_u32 v18, v18, v6
  v_and_b32 v19, 3, v254
  v_mul_u32_u24 v17, 288, v18
  v_add_u32 v17, 16384, v17
  v_lshl_add_u32 v16, v19, 3, v17
  v_mul_u32_u24 v6, 72, v19
  v_add_u32 v208, v17, v6
  s_lshl_b32 s40, s16, 2
  s_add_u32 s40, s40, s18
  s_mul_i32 s6, s17, 18
  s_add_u32 s6, s6, s40
  s_mul_i32 s6, s6, 9216
  s_mul_i32 s7, s17, 589824
  s_add_u32 s3, s18, 0
  s_and_b32 s3, s3, 3
  s_lshl_b32 s20, s3, 7
  s_lshl_b32 s41, s3, 11
  s_add_u32 s41, s41, s6
  s_lshl_b32 s49, s3, 17
  s_add_u32 s49, s49, s7
  s_add_u32 s60, s49, 65536
  s_mul_i32 s3, s3, 72
  v_add_u32 v204, s3, v16
  s_add_u32 s3, s18, 1
  s_and_b32 s3, s3, 3
  s_lshl_b32 s21, s3, 7
  s_lshl_b32 s42, s3, 11
  s_add_u32 s42, s42, s6
  s_lshl_b32 s50, s3, 17
  s_add_u32 s50, s50, s7
  s_add_u32 s61, s50, 65536
  s_mul_i32 s3, s3, 72
  v_add_u32 v205, s3, v16
  s_add_u32 s3, s18, 2
  s_and_b32 s3, s3, 3
  s_lshl_b32 s22, s3, 7
  s_lshl_b32 s43, s3, 11
  s_add_u32 s43, s43, s6
  s_lshl_b32 s51, s3, 17
  s_add_u32 s51, s51, s7
  s_add_u32 s62, s51, 65536
  s_mul_i32 s3, s3, 72
  v_add_u32 v206, s3, v16
  s_add_u32 s3, s18, 3
  s_and_b32 s3, s3, 3
  s_lshl_b32 s23, s3, 7
  s_lshl_b32 s44, s3, 11
  s_add_u32 s44, s44, s6
  s_lshl_b32 s52, s3, 17
  s_add_u32 s52, s52, s7
  s_add_u32 s63, s52, 65536
  s_mul_i32 s3, s3, 72
  v_add_u32 v207, s3, v16
  s_add_u32 s45, s6, 8192
  s_add_u32 s53, s7, 524288
  v_mov_b32 v120, 0
  v_mov_b32 v121, 0
  v_mov_b32 v122, 0
  v_mov_b32 v123, 0
  v_mov_b32 v124, 0
  v_mov_b32 v125, 0
  v_mov_b32 v126, 0
  v_mov_b32 v127, 0
  v_mov_b32 v128, 0
  v_mov_b32 v129, 0
  v_mov_b32 v130, 0
  v_mov_b32 v131, 0
  v_mov_b32 v132, 0
  v_mov_b32 v133, 0
  v_mov_b32 v134, 0
  v_mov_b32 v135, 0
  v_mov_b32 v136, 0
  v_mov_b32 v137, 0
  v_mov_b32 v138, 0
  v_mov_b32 v139, 0
  v_mov_b32 v140, 0
  v_mov_b32 v141, 0
  v_mov_b32 v142, 0
  v_mov_b32 v143, 0
  v_mov_b32 v144, 0
  v_mov_b32 v145, 0
  v_mov_b32 v146, 0
  v_mov_b32 v147, 0
  v_mov_b32 v148, 0
  v_mov_b32 v149, 0
  v_mov_b32 v150, 0
  v_mov_b32 v151, 0
  v_mov_b32 v152, 0
  v_mov_b32 v153, 0
  v_mov_b32 v154, 0
  v_mov_b32 v155, 0
  v_mov_b32 v156, 0
  v_mov_b32 v157, 0
  v_mov_b32 v158, 0
  v_mov_b32 v159, 0
  v_mov_b32 v160, 0
  v_mov_b32 v161, 0
  v_mov_b32 v162, 0
  v_mov_b32 v163, 0
  v_mov_b32 v164, 0
  v_mov_b32 v165, 0
  v_mov_b32 v166, 0
  v_mov_b32 v167, 0
  v_mov_b32 v168, 0
  v_mov_b32 v169, 0
  v_mov_b32 v170, 0
  v_mov_b32 v171, 0
  v_mov_b32 v172, 0
  v_mov_b32 v173, 0
  v_mov_b32 v174, 0
  v_mov_b32 v175, 0
  v_mov_b32 v176, 0
  v_mov_b32 v177, 0
  v_mov_b32 v178, 0
  v_mov_b32 v179, 0
  v_mov_b32 v180, 0
  v_mov_b32 v181, 0
  v_mov_b32 v182, 0
  v_mov_b32 v183, 0
  v_mov_b32 v184, 0
  v_mov_b32 v185, 0
  v_mov_b32 v186, 0
  v_mov_b32 v187, 0
  v_mov_b32 v188, 0
  v_mov_b32 v189, 0
  v_mov_b32 v190, 0
  v_mov_b32 v191, 0
  v_mov_b32 v192, 0
  v_mov_b32 v193, 0
  v_mov_b32 v194, 0
  v_mov_b32 v195, 0
  v_mov_b32 v196, 0
  v_mov_b32 v197, 0
  v_mov_b32 v198, 0
  v_mov_b32 v199, 0
  v_mov_b32 v200, 0
  v_mov_b32 v201, 0
  v_mov_b32 v202, 0
  v_mov_b32 v203, 0
  v_mov_b32 v228, 0
  v_mov_b32 v229, 0
  v_mov_b32 v230, 0
  v_mov_b32 v231, 0
  v_mov_b32 v232, 0
  v_mov_b32 v233, 0
  v_mov_b32 v234, 0
  v_mov_b32 v235, 0
  v_mov_b32 v236, 0
  v_mov_b32 v237, 0
  v_mov_b32 v238, 0
  v_mov_b32 v239, 0
  v_mov_b32 v240, 0
  v_mov_b32 v241, 0
  v_mov_b32 v242, 0
  v_mov_b32 v243, 0
  v_mov_b32 v244, 0x3f803f80
  v_mov_b32 v245, 0x3f803f80
  v_mov_b32 v246, 0x3f803f80
  v_mov_b32 v247, 0x3f803f80
  s_add_u32 s24, s100, 4718592
  s_addc_u32 s25, s101, 0
  s_and_b32 s25, s25, 0xffff
  s_mov_b32 s26, 7077888
  s_mov_b32 s27, 0x20000
  s_add_u32 s28, s4, 47579136
  s_addc_u32 s29, s5, 0
  s_and_b32 s29, s29, 0xffff
  s_mov_b32 s30, 1990656
  s_mov_b32 s31, 0x20000
  s_cmp_lt_u32 s17, 4
  s_cselect_b32 s46, 0x3eae1a93, 1.0
  s_lshl_b32 s47, s18, 8
  s_add_u32 s47, s47, 110592
  s_lshl_b32 s48, s19, 9
  s_lshl_b32 s58, s17, 4
  s_add_u32 s58, s58, s16
  s_lshl_b32 s58, s58, 7
  s_mov_b32 s37, 0
  s_mov_b32 s33, 0
  s_waitcnt vmcnt(5) lgkmcnt(0)
  s_cmp_ge_u32 s17, 8
  s_cbranch_scc1 q0_v
  s_barrier
  v_mov_b32 v209, v14
  v_mov_b32 v210, v204
  v_mov_b32 v211, v205
  v_mov_b32 v212, v206
  v_mov_b32 v213, v207
  v_mov_b32 v214, v208
  ds_read_b128 v[104:107], v209 offset:0
  ds_read_b128 v[108:111], v209 offset:2048
  ds_read_b64_tr_b16 v[32:33], v210 offset:0
  ds_read_b64_tr_b16 v[34:35], v210 offset:2304
  ds_read_b64_tr_b16 v[36:37], v210 offset:40
  ds_read_b64_tr_b16 v[38:39], v210 offset:2344
  ds_read_b64_tr_b16 v[40:41], v211 offset:0
  ds_read_b64_tr_b16 v[42:43], v211 offset:2304
  ds_read_b64_tr_b16 v[44:45], v211 offset:40
  ds_read_b64_tr_b16 v[46:47], v211 offset:2344
  s_waitcnt lgkmcnt(8)
q0_qk_loop:
  v_mfma_f32_16x16x32_bf16 v[228:231], v[244:247], v[104:107], v[228:231]
  s_add_u32 m0, s36, s38
  ds_read_b64_tr_b16 v[48:49], v212 offset:0
  v_mfma_f32_16x16x32_bf16 v[236:239], v[104:107], v[104:107], v[236:239]
  s_cmp_ge_u32 s33, 14
  ds_read_b64_tr_b16 v[50:51], v212 offset:2304
  v_mfma_f32_16x16x32_bf16 v[232:235], v[244:247], v[108:111], v[232:235]
  s_cselect_b32 s10, 0, s10
  buffer_load_dwordx4 v2, s[8:11], s34 offen offset:0 lds
  v_mfma_f32_16x16x32_bf16 v[240:243], v[108:111], v[108:111], v[240:243]
  s_waitcnt lgkmcnt(6)
  ds_read_b64_tr_b16 v[52:53], v212 offset:40
  v_mfma_f32_16x16x32_bf16 v[120:123], v[32:35], v[104:107], v[120:123]
  s_cselect_b32 s14, 0, s14
  ds_read_b64_tr_b16 v[54:55], v212 offset:2344
  ds_read_b64_tr_b16 v[56:57], v213 offset:0
  v_mfma_f32_16x16x32_bf16 v[156:159], v[32:35], v[108:111], v[156:159]
  ds_read_b64_tr_b16 v[58:59], v213 offset:2304
  ds_read_b64_tr_b16 v[60:61], v213 offset:40
  v_mfma_f32_16x16x32_bf16 v[192:195], v[32:35], v[244:247], v[192:195]
  ds_read_b64_tr_b16 v[62:63], v213 offset:2344
  ds_read_b64_tr_b16 v[64:65], v214 offset:32
  v_mfma_f32_16x16x32_bf16 v[124:127], v[36:39], v[104:107], v[124:127]
  buffer_load_dwordx4 v3, s[8:11], s34 offen offset:1024 lds
  v_mfma_f32_16x16x32_bf16 v[160:163], v[36:39], v[108:111], v[160:163]
  ds_read_b64_tr_b16 v[66:67], v214 offset:2336
  v_mfma_f32_16x16x32_bf16 v[196:199], v[36:39], v[244:247], v[196:199]
  s_waitcnt lgkmcnt(10)
  v_add_u32 v215, s37, v15
  v_add_u32 v216, s37, v204
  v_mfma_f32_16x16x32_bf16 v[128:131], v[40:43], v[104:107], v[128:131]
  v_add_u32 v217, s37, v205
  v_add_u32 v218, s37, v206
  v_mfma_f32_16x16x32_bf16 v[164:167], v[40:43], v[108:111], v[164:167]
  v_add_u32 v219, s37, v207
  v_add_u32 v220, s37, v208
  v_mfma_f32_16x16x32_bf16 v[132:135], v[44:47], v[104:107], v[132:135]
  v_mfma_f32_16x16x32_bf16 v[168:171], v[44:47], v[108:111], v[168:171]
  s_waitcnt lgkmcnt(6)
  buffer_load_dwordx4 v4, s[8:11], s34 offen offset:2048 lds
  v_mfma_f32_16x16x32_bf16 v[136:139], v[48:51], v[104:107], v[136:139]
  ds_read_b128 v[112:115], v215 offset:0
  v_mfma_f32_16x16x32_bf16 v[172:175], v[48:51], v[108:111], v[172:175]
  ds_read_b128 v[116:119], v215 offset:2048
  ds_read_b64_tr_b16 v[68:69], v216 offset:9216
  v_mfma_f32_16x16x32_bf16 v[140:143], v[52:55], v[104:107], v[140:143]
  ds_read_b64_tr_b16 v[70:71], v216 offset:11520
  v_mfma_f32_16x16x32_bf16 v[176:179], v[52:55], v[108:111], v[176:179]
  s_waitcnt lgkmcnt(6)
  ds_read_b64_tr_b16 v[72:73], v216 offset:9256
  ds_read_b64_tr_b16 v[74:75], v216 offset:11560
  v_mfma_f32_16x16x32_bf16 v[144:147], v[56:59], v[104:107], v[144:147]
  buffer_load_dwordx4 v5, s[8:11], s34 offen offset:3072 lds
  v_mfma_f32_16x16x32_bf16 v[180:183], v[56:59], v[108:111], v[180:183]
  ds_read_b64_tr_b16 v[76:77], v217 offset:9216
  ds_read_b64_tr_b16 v[78:79], v217 offset:11520
  v_mfma_f32_16x16x32_bf16 v[148:151], v[60:63], v[104:107], v[148:151]
  s_add_u32 m0, m0, 16384
  ds_read_b64_tr_b16 v[80:81], v217 offset:9256
  v_mfma_f32_16x16x32_bf16 v[184:187], v[60:63], v[108:111], v[184:187]
  s_waitcnt lgkmcnt(9)
  ds_read_b64_tr_b16 v[82:83], v217 offset:11560
  v_mfma_f32_16x16x32_bf16 v[152:155], v[64:67], v[104:107], v[152:155]
  s_add_u32 s34, s34, 128
  v_mfma_f32_16x16x32_bf16 v[188:191], v[64:67], v[108:111], v[188:191]
  buffer_load_dwordx4 v9, s[12:15], s35 offen offset:0 lds
  v_mfma_f32_16x16x32_bf16 v[200:203], v[64:67], v[244:247], v[200:203]
  s_waitcnt lgkmcnt(8)
  s_cmp_lg_u32 s33, s40
  s_cbranch_scc1 q0_qk_ns0
  buffer_store_dwordx4 v[32:35], v1, s[28:31], s41 offen offset:0 sc1
  buffer_store_dwordx4 v[36:39], v1, s[28:31], s41 offen offset:1024 sc1
  buffer_store_dwordx4 v[40:43], v1, s[28:31], s42 offen offset:0 sc1
  buffer_store_dwordx4 v[44:47], v1, s[28:31], s42 offen offset:1024 sc1
  buffer_store_dwordx4 v[48:51], v1, s[28:31], s43 offen offset:0 sc1
  buffer_store_dwordx4 v[52:55], v1, s[28:31], s43 offen offset:1024 sc1
  buffer_store_dwordx4 v[56:59], v1, s[28:31], s44 offen offset:0 sc1
  buffer_store_dwordx4 v[60:63], v1, s[28:31], s44 offen offset:1024 sc1
  buffer_store_dwordx4 v[64:67], v1, s[28:31], s45 offen offset:0 sc1
q0_qk_ns0:
  s_add_u32 s33, s33, 1
  v_mfma_f32_16x16x32_bf16 v[228:231], v[244:247], v[112:115], v[228:231]
  s_add_u32 s37, s37, 36864
  ds_read_b64_tr_b16 v[84:85], v218 offset:9216
  v_mfma_f32_16x16x32_bf16 v[236:239], v[112:115], v[112:115], v[236:239]
  s_cmp_eq_u32 s37, 110592
  ds_read_b64_tr_b16 v[86:87], v218 offset:11520
  v_mfma_f32_16x16x32_bf16 v[232:235], v[244:247], v[116:119], v[232:235]
  s_cselect_b32 s37, 0, s37
  ds_read_b64_tr_b16 v[88:89], v218 offset:9256
  v_mfma_f32_16x16x32_bf16 v[240:243], v[116:119], v[116:119], v[240:243]
  s_waitcnt lgkmcnt(7)
  ds_read_b64_tr_b16 v[90:91], v218 offset:11560
  v_mfma_f32_16x16x32_bf16 v[120:123], v[68:71], v[112:115], v[120:123]
  buffer_load_dwordx4 v10, s[12:15], s35 offen offset:1024 lds
  v_mfma_f32_16x16x32_bf16 v[156:159], v[68:71], v[116:119], v[156:159]
  ds_read_b64_tr_b16 v[92:93], v219 offset:9216
  ds_read_b64_tr_b16 v[94:95], v219 offset:11520
  v_mfma_f32_16x16x32_bf16 v[192:195], v[68:71], v[244:247], v[192:195]
  ds_read_b64_tr_b16 v[96:97], v219 offset:9256
  ds_read_b64_tr_b16 v[98:99], v219 offset:11560
  v_mfma_f32_16x16x32_bf16 v[124:127], v[72:75], v[112:115], v[124:127]
  ds_read_b64_tr_b16 v[100:101], v220 offset:9248
  ds_read_b64_tr_b16 v[102:103], v220 offset:11552
  v_mfma_f32_16x16x32_bf16 v[160:163], v[72:75], v[116:119], v[160:163]
  v_add_u32 v209, s37, v14
  v_add_u32 v210, s37, v204
  v_mfma_f32_16x16x32_bf16 v[196:199], v[72:75], v[244:247], v[196:199]
  s_waitcnt lgkmcnt(10)
  v_add_u32 v211, s37, v205
  v_add_u32 v212, s37, v206
  v_mfma_f32_16x16x32_bf16 v[128:131], v[76:79], v[112:115], v[128:131]
  buffer_load_dwordx4 v11, s[12:15], s35 offen offset:2048 lds
  v_mfma_f32_16x16x32_bf16 v[164:167], v[76:79], v[116:119], v[164:167]
  v_add_u32 v213, s37, v207
  v_add_u32 v214, s37, v208
  v_mfma_f32_16x16x32_bf16 v[132:135], v[80:83], v[112:115], v[132:135]
  s_waitcnt vmcnt(7) lgkmcnt(0)
  v_mfma_f32_16x16x32_bf16 v[168:171], v[80:83], v[116:119], v[168:171]
  s_barrier
  v_mfma_f32_16x16x32_bf16 v[136:139], v[84:87], v[112:115], v[136:139]
  ds_read_b128 v[104:107], v209 offset:0
  v_mfma_f32_16x16x32_bf16 v[172:175], v[84:87], v[116:119], v[172:175]
  ds_read_b128 v[108:111], v209 offset:2048
  ds_read_b64_tr_b16 v[32:33], v210 offset:0
  v_mfma_f32_16x16x32_bf16 v[140:143], v[88:91], v[112:115], v[140:143]
  buffer_load_dwordx4 v12, s[12:15], s35 offen offset:3072 lds
  v_mfma_f32_16x16x32_bf16 v[176:179], v[88:91], v[116:119], v[176:179]
  ds_read_b64_tr_b16 v[34:35], v210 offset:2304
  ds_read_b64_tr_b16 v[36:37], v210 offset:40
  v_mfma_f32_16x16x32_bf16 v[144:147], v[92:95], v[112:115], v[144:147]
  s_add_u32 m0, s36, s39
  ds_read_b64_tr_b16 v[38:39], v210 offset:2344
  v_mfma_f32_16x16x32_bf16 v[180:183], v[92:95], v[116:119], v[180:183]
  s_add_u32 s36, s36, 36864
  ds_read_b64_tr_b16 v[40:41], v211 offset:0
  ds_read_b64_tr_b16 v[42:43], v211 offset:2304
  v_mfma_f32_16x16x32_bf16 v[148:151], v[96:99], v[112:115], v[148:151]
  s_cmp_eq_u32 s36, 110592
  ds_read_b64_tr_b16 v[44:45], v211 offset:40
  v_mfma_f32_16x16x32_bf16 v[184:187], v[96:99], v[116:119], v[184:187]
  s_cselect_b32 s36, 0, s36
  ds_read_b64_tr_b16 v[46:47], v211 offset:2344
  v_mfma_f32_16x16x32_bf16 v[152:155], v[100:103], v[112:115], v[152:155]
  buffer_load_dwordx4 v13, s[12:15], s35 offen offset:0 lds
  v_mfma_f32_16x16x32_bf16 v[188:191], v[100:103], v[116:119], v[188:191]
  s_add_u32 s35, s35, 221184
  v_mfma_f32_16x16x32_bf16 v[200:203], v[100:103], v[244:247], v[200:203]
  s_waitcnt lgkmcnt(8)
  s_cmp_lg_u32 s33, s40
  s_cbranch_scc1 q0_qk_ns1
  buffer_store_dwordx4 v[68:71], v1, s[28:31], s41 offen offset:0 sc1
  buffer_store_dwordx4 v[72:75], v1, s[28:31], s41 offen offset:1024 sc1
  buffer_store_dwordx4 v[76:79], v1, s[28:31], s42 offen offset:0 sc1
  buffer_store_dwordx4 v[80:83], v1, s[28:31], s42 offen offset:1024 sc1
  buffer_store_dwordx4 v[84:87], v1, s[28:31], s43 offen offset:0 sc1
  buffer_store_dwordx4 v[88:91], v1, s[28:31], s43 offen offset:1024 sc1
  buffer_store_dwordx4 v[92:95], v1, s[28:31], s44 offen offset:0 sc1
  buffer_store_dwordx4 v[96:99], v1, s[28:31], s44 offen offset:1024 sc1
  buffer_store_dwordx4 v[100:103], v1, s[28:31], s45 offen offset:0 sc1
q0_qk_ns1:
  s_add_u32 s33, s33, 1
  s_cmp_lt_u32 s33, 18
  s_cbranch_scc1 q0_qk_loop
  v_lshlrev_b32 v10, 4, v8
  v_add_u32 v10, 111616, v10
  v_add_u32 v204, s20, v10
  v_add_u32 v205, s21, v10
  v_add_u32 v206, s22, v10
  v_add_u32 v207, s23, v10
  v_and_b32 v6, 3, v7
  v_lshrrev_b32 v9, 2, v7
  s_waitcnt lgkmcnt(0)
  ds_write_b128 v204, v[192:195] offset:0
  ds_write_b128 v204, v[196:199] offset:64
  ds_write_b128 v10, v[200:203] offset:512
  v_cmp_eq_u32 vcc, 1, v6
  s_nop 1
  v_cndmask_b32 v236, v236, v237, vcc
  v_cndmask_b32 v240, v240, v241, vcc
  v_cmp_eq_u32 vcc, 2, v6
  s_nop 1
  v_cndmask_b32 v236, v236, v238, vcc
  v_cndmask_b32 v240, v240, v242, vcc
  v_cmp_eq_u32 vcc, 3, v6
  s_nop 1
  v_cndmask_b32 v236, v236, v239, vcc
  v_cndmask_b32 v240, v240, v243, vcc
  v_cmp_eq_u32 vcc, v9, v8
  s_nop 1
  v_cndmask_b32 v236, 0, v236, vcc
  v_cndmask_b32 v240, 0, v240, vcc
  s_waitcnt lgkmcnt(0)
  s_barrier
  ds_read_b128 v[68:71], v204 offset:0
  ds_read_b128 v[72:75], v204 offset:64
  ds_read_b128 v[76:79], v205 offset:0
  ds_read_b128 v[80:83], v205 offset:64
  ds_read_b128 v[84:87], v206 offset:0
  ds_read_b128 v[88:91], v206 offset:64
  ds_read_b128 v[92:95], v207 offset:0
  ds_read_b128 v[96:99], v207 offset:64
  ds_read_b128 v[100:103], v10 offset:512
  v_mov_b32 v237, v236
  v_mov_b32 v241, v240
  s_nop 0
  v_permlane16_swap_b32 v236, v237
  v_permlane16_swap_b32 v240, v241
  v_add_f32 v236, v236, v237
  v_add_f32 v240, v240, v241
  v_mov_b32 v237, v236
  v_mov_b32 v241, v240
  s_nop 0
  v_permlane32_swap_b32 v236, v237
  v_permlane32_swap_b32 v240, v241
  v_add_f32 v236, v236, v237
  v_add_f32 v240, v240, v241
  v_mul_f32 v228, 0x3ae38e39, v228
  v_mul_f32 v232, 0x3ae38e39, v232
  v_mul_f32 v236, 0x3ae38e39, v236
  v_mul_f32 v240, 0x3ae38e39, v240
  v_fma_f32 v236, -v228, v228, v236
  v_fma_f32 v240, -v232, v232, v240
  v_max_f32 v236, 0, v236
  v_max_f32 v240, 0, v240
  v_add_f32 v236, 0x3727c5ac, v236
  v_add_f32 v240, 0x3727c5ac, v240
  v_rsq_f32 v13, v236
  v_rsq_f32 v15, v240
  v_sub_f32 v12, 0, v228
  v_sub_f32 v14, 0, v232
  v_mul_f32 v13, s46, v13
  v_mul_f32 v15, s46, v15
  v_and_b32 v18, 1, v8
  v_lshlrev_b32 v18, 9, v18
  v_lshrrev_b32 v19, 1, v8
  v_lshl_add_u32 v18, v19, 8, v18
  v_lshl_add_u32 v18, v7, 4, v18
  v_add_u32 v18, s48, v18
  s_waitcnt lgkmcnt(0)
  v_pk_fma_f32 v[120:121], v[12:13], v[68:69], v[120:121] op_sel_hi:[0,1,1]
  v_pk_fma_f32 v[122:123], v[12:13], v[70:71], v[122:123] op_sel_hi:[0,1,1]
  v_pk_mul_f32 v[120:121], v[120:121], v[12:13] op_sel:[0,1] op_sel_hi:[1,1]
  v_pk_mul_f32 v[122:123], v[122:123], v[12:13] op_sel:[0,1] op_sel_hi:[1,1]
  v_cvt_pk_bf16_f32 v32, v120, v121
  v_cvt_pk_bf16_f32 v33, v122, v123
  v_pk_fma_f32 v[156:157], v[14:15], v[68:69], v[156:157] op_sel_hi:[0,1,1]
  v_pk_fma_f32 v[158:159], v[14:15], v[70:71], v[158:159] op_sel_hi:[0,1,1]
  v_pk_mul_f32 v[156:157], v[156:157], v[14:15] op_sel:[0,1] op_sel_hi:[1,1]
  v_pk_mul_f32 v[158:159], v[158:159], v[14:15] op_sel:[0,1] op_sel_hi:[1,1]
  v_cvt_pk_bf16_f32 v34, v156, v157
  v_cvt_pk_bf16_f32 v35, v158, v159
  v_pk_fma_f32 v[124:125], v[12:13], v[72:73], v[124:125] op_sel_hi:[0,1,1]
  v_pk_fma_f32 v[126:127], v[12:13], v[74:75], v[126:127] op_sel_hi:[0,1,1]
  v_pk_mul_f32 v[124:125], v[124:125], v[12:13] op_sel:[0,1] op_sel_hi:[1,1]
  v_pk_mul_f32 v[126:127], v[126:127], v[12:13] op_sel:[0,1] op_sel_hi:[1,1]
  v_cvt_pk_bf16_f32 v36, v124, v125
  v_cvt_pk_bf16_f32 v37, v126, v127
  v_pk_fma_f32 v[160:161], v[14:15], v[72:73], v[160:161] op_sel_hi:[0,1,1]
  v_pk_fma_f32 v[162:163], v[14:15], v[74:75], v[162:163] op_sel_hi:[0,1,1]
  v_pk_mul_f32 v[160:161], v[160:161], v[14:15] op_sel:[0,1] op_sel_hi:[1,1]
  v_pk_mul_f32 v[162:163], v[162:163], v[14:15] op_sel:[0,1] op_sel_hi:[1,1]
  v_cvt_pk_bf16_f32 v38, v160, v161
  v_cvt_pk_bf16_f32 v39, v162, v163
  v_permlane16_swap_b32 v32, v34
  v_permlane16_swap_b32 v33, v35
  buffer_store_dwordx4 v[32:35], v18, s[24:27], s49 offen sc1
  v_pk_fma_f32 v[128:129], v[12:13], v[76:77], v[128:129] op_sel_hi:[0,1,1]
  v_pk_fma_f32 v[130:131], v[12:13], v[78:79], v[130:131] op_sel_hi:[0,1,1]
  v_pk_mul_f32 v[128:129], v[128:129], v[12:13] op_sel:[0,1] op_sel_hi:[1,1]
  v_pk_mul_f32 v[130:131], v[130:131], v[12:13] op_sel:[0,1] op_sel_hi:[1,1]
  v_cvt_pk_bf16_f32 v40, v128, v129
  v_cvt_pk_bf16_f32 v41, v130, v131
  v_pk_fma_f32 v[164:165], v[14:15], v[76:77], v[164:165] op_sel_hi:[0,1,1]
  v_pk_fma_f32 v[166:167], v[14:15], v[78:79], v[166:167] op_sel_hi:[0,1,1]
  v_pk_mul_f32 v[164:165], v[164:165], v[14:15] op_sel:[0,1] op_sel_hi:[1,1]
  v_pk_mul_f32 v[166:167], v[166:167], v[14:15] op_sel:[0,1] op_sel_hi:[1,1]
  v_cvt_pk_bf16_f32 v42, v164, v165
  v_cvt_pk_bf16_f32 v43, v166, v167
  v_permlane16_swap_b32 v36, v38
  v_permlane16_swap_b32 v37, v39
  buffer_store_dwordx4 v[36:39], v18, s[24:27], s60 offen sc1
  v_pk_fma_f32 v[132:133], v[12:13], v[80:81], v[132:133] op_sel_hi:[0,1,1]
  v_pk_fma_f32 v[134:135], v[12:13], v[82:83], v[134:135] op_sel_hi:[0,1,1]
  v_pk_mul_f32 v[132:133], v[132:133], v[12:13] op_sel:[0,1] op_sel_hi:[1,1]
  v_pk_mul_f32 v[134:135], v[134:135], v[12:13] op_sel:[0,1] op_sel_hi:[1,1]
  v_cvt_pk_bf16_f32 v44, v132, v133
  v_cvt_pk_bf16_f32 v45, v134, v135
  v_pk_fma_f32 v[168:169], v[14:15], v[80:81], v[168:169] op_sel_hi:[0,1,1]
  v_pk_fma_f32 v[170:171], v[14:15], v[82:83], v[170:171] op_sel_hi:[0,1,1]
  v_pk_mul_f32 v[168:169], v[168:169], v[14:15] op_sel:[0,1] op_sel_hi:[1,1]
  v_pk_mul_f32 v[170:171], v[170:171], v[14:15] op_sel:[0,1] op_sel_hi:[1,1]
  v_cvt_pk_bf16_f32 v46, v168, v169
  v_cvt_pk_bf16_f32 v47, v170, v171
  v_permlane16_swap_b32 v40, v42
  v_permlane16_swap_b32 v41, v43
  buffer_store_dwordx4 v[40:43], v18, s[24:27], s50 offen sc1
  v_pk_fma_f32 v[136:137], v[12:13], v[84:85], v[136:137] op_sel_hi:[0,1,1]
  v_pk_fma_f32 v[138:139], v[12:13], v[86:87], v[138:139] op_sel_hi:[0,1,1]
  v_pk_mul_f32 v[136:137], v[136:137], v[12:13] op_sel:[0,1] op_sel_hi:[1,1]
  v_pk_mul_f32 v[138:139], v[138:139], v[12:13] op_sel:[0,1] op_sel_hi:[1,1]
  v_cvt_pk_bf16_f32 v48, v136, v137
  v_cvt_pk_bf16_f32 v49, v138, v139
  v_pk_fma_f32 v[172:173], v[14:15], v[84:85], v[172:173] op_sel_hi:[0,1,1]
  v_pk_fma_f32 v[174:175], v[14:15], v[86:87], v[174:175] op_sel_hi:[0,1,1]
  v_pk_mul_f32 v[172:173], v[172:173], v[14:15] op_sel:[0,1] op_sel_hi:[1,1]
  v_pk_mul_f32 v[174:175], v[174:175], v[14:15] op_sel:[0,1] op_sel_hi:[1,1]
  v_cvt_pk_bf16_f32 v50, v172, v173
  v_cvt_pk_bf16_f32 v51, v174, v175
  v_permlane16_swap_b32 v44, v46
  v_permlane16_swap_b32 v45, v47
  buffer_store_dwordx4 v[44:47], v18, s[24:27], s61 offen sc1
  v_pk_fma_f32 v[140:141], v[12:13], v[88:89], v[140:141] op_sel_hi:[0,1,1]
  v_pk_fma_f32 v[142:143], v[12:13], v[90:91], v[142:143] op_sel_hi:[0,1,1]
  v_pk_mul_f32 v[140:141], v[140:141], v[12:13] op_sel:[0,1] op_sel_hi:[1,1]
  v_pk_mul_f32 v[142:143], v[142:143], v[12:13] op_sel:[0,1] op_sel_hi:[1,1]
  v_cvt_pk_bf16_f32 v52, v140, v141
  v_cvt_pk_bf16_f32 v53, v142, v143
  v_pk_fma_f32 v[176:177], v[14:15], v[88:89], v[176:177] op_sel_hi:[0,1,1]
  v_pk_fma_f32 v[178:179], v[14:15], v[90:91], v[178:179] op_sel_hi:[0,1,1]
  v_pk_mul_f32 v[176:177], v[176:177], v[14:15] op_sel:[0,1] op_sel_hi:[1,1]
  v_pk_mul_f32 v[178:179], v[178:179], v[14:15] op_sel:[0,1] op_sel_hi:[1,1]
  v_cvt_pk_bf16_f32 v54, v176, v177
  v_cvt_pk_bf16_f32 v55, v178, v179
  v_permlane16_swap_b32 v48, v50
  v_permlane16_swap_b32 v49, v51
  buffer_store_dwordx4 v[48:51], v18, s[24:27], s51 offen sc1
  v_pk_fma_f32 v[144:145], v[12:13], v[92:93], v[144:145] op_sel_hi:[0,1,1]
  v_pk_fma_f32 v[146:147], v[12:13], v[94:95], v[146:147] op_sel_hi:[0,1,1]
  v_pk_mul_f32 v[144:145], v[144:145], v[12:13] op_sel:[0,1] op_sel_hi:[1,1]
  v_pk_mul_f32 v[146:147], v[146:147], v[12:13] op_sel:[0,1] op_sel_hi:[1,1]
  v_cvt_pk_bf16_f32 v56, v144, v145
  v_cvt_pk_bf16_f32 v57, v146, v147
  v_pk_fma_f32 v[180:181], v[14:15], v[92:93], v[180:181] op_sel_hi:[0,1,1]
  v_pk_fma_f32 v[182:183], v[14:15], v[94:95], v[182:183] op_sel_hi:[0,1,1]
  v_pk_mul_f32 v[180:181], v[180:181], v[14:15] op_sel:[0,1] op_sel_hi:[1,1]
  v_pk_mul_f32 v[182:183], v[182:183], v[14:15] op_sel:[0,1] op_sel_hi:[1,1]
  v_cvt_pk_bf16_f32 v58, v180, v181
  v_cvt_pk_bf16_f32 v59, v182, v183
  v_permlane16_swap_b32 v52, v54
  v_permlane16_swap_b32 v53, v55
  buffer_store_dwordx4 v[52:55], v18, s[24:27], s62 offen sc1
  v_pk_fma_f32 v[148:149], v[12:13], v[96:97], v[148:149] op_sel_hi:[0,1,1]
  v_pk_fma_f32 v[150:151], v[12:13], v[98:99], v[150:151] op_sel_hi:[0,1,1]
  v_pk_mul_f32 v[148:149], v[148:149], v[12:13] op_sel:[0,1] op_sel_hi:[1,1]
  v_pk_mul_f32 v[150:151], v[150:151], v[12:13] op_sel:[0,1] op_sel_hi:[1,1]
  v_cvt_pk_bf16_f32 v60, v148, v149
  v_cvt_pk_bf16_f32 v61, v150, v151
  v_pk_fma_f32 v[184:185], v[14:15], v[96:97], v[184:185] op_sel_hi:[0,1,1]
  v_pk_fma_f32 v[186:187], v[14:15], v[98:99], v[186:187] op_sel_hi:[0,1,1]
  v_pk_mul_f32 v[184:185], v[184:185], v[14:15] op_sel:[0,1] op_sel_hi:[1,1]
  v_pk_mul_f32 v[186:187], v[186:187], v[14:15] op_sel:[0,1] op_sel_hi:[1,1]
  v_cvt_pk_bf16_f32 v62, v184, v185
  v_cvt_pk_bf16_f32 v63, v186, v187
  v_permlane16_swap_b32 v56, v58
  v_permlane16_swap_b32 v57, v59
  buffer_store_dwordx4 v[56:59], v18, s[24:27], s52 offen sc1
  v_pk_fma_f32 v[152:153], v[12:13], v[100:101], v[152:153] op_sel_hi:[0,1,1]
  v_pk_fma_f32 v[154:155], v[12:13], v[102:103], v[154:155] op_sel_hi:[0,1,1]
  v_pk_mul_f32 v[152:153], v[152:153], v[12:13] op_sel:[0,1] op_sel_hi:[1,1]
  v_pk_mul_f32 v[154:155], v[154:155], v[12:13] op_sel:[0,1] op_sel_hi:[1,1]
  v_cvt_pk_bf16_f32 v64, v152, v153
  v_cvt_pk_bf16_f32 v65, v154, v155
  v_pk_fma_f32 v[188:189], v[14:15], v[100:101], v[188:189] op_sel_hi:[0,1,1]
  v_pk_fma_f32 v[190:191], v[14:15], v[102:103], v[190:191] op_sel_hi:[0,1,1]
  v_pk_mul_f32 v[188:189], v[188:189], v[14:15] op_sel:[0,1] op_sel_hi:[1,1]
  v_pk_mul_f32 v[190:191], v[190:191], v[14:15] op_sel:[0,1] op_sel_hi:[1,1]
  v_cvt_pk_bf16_f32 v66, v188, v189
  v_cvt_pk_bf16_f32 v67, v190, v191
  v_permlane16_swap_b32 v60, v62
  v_permlane16_swap_b32 v61, v63
  buffer_store_dwordx4 v[60:63], v18, s[24:27], s63 offen sc1
  v_permlane16_swap_b32 v64, v66
  v_permlane16_swap_b32 v65, v67
  buffer_store_dwordx4 v[64:67], v18, s[24:27], s53 offen sc1
  s_branch q0_cs
q0_v:
  s_barrier
  v_mov_b32 v209, v14
  v_mov_b32 v210, v204
  v_mov_b32 v211, v205
  v_mov_b32 v212, v206
  v_mov_b32 v213, v207
  v_mov_b32 v214, v208
  ds_read_b128 v[104:107], v209 offset:0
  ds_read_b128 v[108:111], v209 offset:2048
  ds_read_b64_tr_b16 v[32:33], v210 offset:0
  ds_read_b64_tr_b16 v[34:35], v210 offset:2304
  ds_read_b64_tr_b16 v[36:37], v210 offset:40
  ds_read_b64_tr_b16 v[38:39], v210 offset:2344
  ds_read_b64_tr_b16 v[40:41], v211 offset:0
  ds_read_b64_tr_b16 v[42:43], v211 offset:2304
  ds_read_b64_tr_b16 v[44:45], v211 offset:40
  ds_read_b64_tr_b16 v[46:47], v211 offset:2344
  s_waitcnt lgkmcnt(8)
q0_v_loop:
  v_mfma_f32_16x16x32_bf16 v[228:231], v[244:247], v[104:107], v[228:231]
  s_add_u32 m0, s36, s38
  ds_read_b64_tr_b16 v[48:49], v212 offset:0
  v_mfma_f32_16x16x32_bf16 v[236:239], v[104:107], v[104:107], v[236:239]
  s_cmp_ge_u32 s33, 14
  ds_read_b64_tr_b16 v[50:51], v212 offset:2304
  v_mfma_f32_16x16x32_bf16 v[232:235], v[244:247], v[108:111], v[232:235]
  s_cselect_b32 s10, 0, s10
  buffer_load_dwordx4 v2, s[8:11], s34 offen offset:0 lds
  v_mfma_f32_16x16x32_bf16 v[240:243], v[108:111], v[108:111], v[240:243]
  s_waitcnt lgkmcnt(6)
  ds_read_b64_tr_b16 v[52:53], v212 offset:40
  v_mfma_f32_16x16x32_bf16 v[120:123], v[104:107], v[32:35], v[120:123]
  s_cselect_b32 s14, 0, s14
  ds_read_b64_tr_b16 v[54:55], v212 offset:2344
  ds_read_b64_tr_b16 v[56:57], v213 offset:0
  v_mfma_f32_16x16x32_bf16 v[156:159], v[108:111], v[32:35], v[156:159]
  ds_read_b64_tr_b16 v[58:59], v213 offset:2304
  ds_read_b64_tr_b16 v[60:61], v213 offset:40
  v_mfma_f32_16x16x32_bf16 v[192:195], v[244:247], v[32:35], v[192:195]
  ds_read_b64_tr_b16 v[62:63], v213 offset:2344
  ds_read_b64_tr_b16 v[64:65], v214 offset:32
  v_mfma_f32_16x16x32_bf16 v[124:127], v[104:107], v[36:39], v[124:127]
  buffer_load_dwordx4 v3, s[8:11], s34 offen offset:1024 lds
  v_mfma_f32_16x16x32_bf16 v[160:163], v[108:111], v[36:39], v[160:163]
  ds_read_b64_tr_b16 v[66:67], v214 offset:2336
  v_mfma_f32_16x16x32_bf16 v[196:199], v[244:247], v[36:39], v[196:199]
  s_waitcnt lgkmcnt(10)
  v_add_u32 v215, s37, v15
  v_add_u32 v216, s37, v204
  v_mfma_f32_16x16x32_bf16 v[128:131], v[104:107], v[40:43], v[128:131]
  v_add_u32 v217, s37, v205
  v_add_u32 v218, s37, v206
  v_mfma_f32_16x16x32_bf16 v[164:167], v[108:111], v[40:43], v[164:167]
  v_add_u32 v219, s37, v207
  v_add_u32 v220, s37, v208
  v_mfma_f32_16x16x32_bf16 v[132:135], v[104:107], v[44:47], v[132:135]
  v_mfma_f32_16x16x32_bf16 v[168:171], v[108:111], v[44:47], v[168:171]
  s_waitcnt lgkmcnt(6)
  buffer_load_dwordx4 v4, s[8:11], s34 offen offset:2048 lds
  v_mfma_f32_16x16x32_bf16 v[136:139], v[104:107], v[48:51], v[136:139]
  ds_read_b128 v[112:115], v215 offset:0
  v_mfma_f32_16x16x32_bf16 v[172:175], v[108:111], v[48:51], v[172:175]
  ds_read_b128 v[116:119], v215 offset:2048
  ds_read_b64_tr_b16 v[68:69], v216 offset:9216
  v_mfma_f32_16x16x32_bf16 v[140:143], v[104:107], v[52:55], v[140:143]
  ds_read_b64_tr_b16 v[70:71], v216 offset:11520
  v_mfma_f32_16x16x32_bf16 v[176:179], v[108:111], v[52:55], v[176:179]
  s_waitcnt lgkmcnt(6)
  ds_read_b64_tr_b16 v[72:73], v216 offset:9256
  ds_read_b64_tr_b16 v[74:75], v216 offset:11560
  v_mfma_f32_16x16x32_bf16 v[144:147], v[104:107], v[56:59], v[144:147]
  buffer_load_dwordx4 v5, s[8:11], s34 offen offset:3072 lds
  v_mfma_f32_16x16x32_bf16 v[180:183], v[108:111], v[56:59], v[180:183]
  ds_read_b64_tr_b16 v[76:77], v217 offset:9216
  ds_read_b64_tr_b16 v[78:79], v217 offset:11520
  v_mfma_f32_16x16x32_bf16 v[148:151], v[104:107], v[60:63], v[148:151]
  s_add_u32 m0, m0, 16384
  ds_read_b64_tr_b16 v[80:81], v217 offset:9256
  v_mfma_f32_16x16x32_bf16 v[184:187], v[108:111], v[60:63], v[184:187]
  s_waitcnt lgkmcnt(9)
  ds_read_b64_tr_b16 v[82:83], v217 offset:11560
  v_mfma_f32_16x16x32_bf16 v[152:155], v[104:107], v[64:67], v[152:155]
  s_add_u32 s34, s34, 128
  v_mfma_f32_16x16x32_bf16 v[188:191], v[108:111], v[64:67], v[188:191]
  buffer_load_dwordx4 v9, s[12:15], s35 offen offset:0 lds
  v_mfma_f32_16x16x32_bf16 v[200:203], v[244:247], v[64:67], v[200:203]
  s_waitcnt lgkmcnt(8)
  s_cmp_lg_u32 s33, s40
  s_cbranch_scc1 q0_v_ns0
  buffer_store_dwordx4 v[32:35], v1, s[28:31], s41 offen offset:0 sc1
  buffer_store_dwordx4 v[36:39], v1, s[28:31], s41 offen offset:1024 sc1
  buffer_store_dwordx4 v[40:43], v1, s[28:31], s42 offen offset:0 sc1
  buffer_store_dwordx4 v[44:47], v1, s[28:31], s42 offen offset:1024 sc1
  buffer_store_dwordx4 v[48:51], v1, s[28:31], s43 offen offset:0 sc1
  buffer_store_dwordx4 v[52:55], v1, s[28:31], s43 offen offset:1024 sc1
  buffer_store_dwordx4 v[56:59], v1, s[28:31], s44 offen offset:0 sc1
  buffer_store_dwordx4 v[60:63], v1, s[28:31], s44 offen offset:1024 sc1
  buffer_store_dwordx4 v[64:67], v1, s[28:31], s45 offen offset:0 sc1
q0_v_ns0:
  s_add_u32 s33, s33, 1
  v_mfma_f32_16x16x32_bf16 v[228:231], v[244:247], v[112:115], v[228:231]
  s_add_u32 s37, s37, 36864
  ds_read_b64_tr_b16 v[84:85], v218 offset:9216
  v_mfma_f32_16x16x32_bf16 v[236:239], v[112:115], v[112:115], v[236:239]
  s_cmp_eq_u32 s37, 110592
  ds_read_b64_tr_b16 v[86:87], v218 offset:11520
  v_mfma_f32_16x16x32_bf16 v[232:235], v[244:247], v[116:119], v[232:235]
  s_cselect_b32 s37, 0, s37
  ds_read_b64_tr_b16 v[88:89], v218 offset:9256
  v_mfma_f32_16x16x32_bf16 v[240:243], v[116:119], v[116:119], v[240:243]
  s_waitcnt lgkmcnt(7)
  ds_read_b64_tr_b16 v[90:91], v218 offset:11560
  v_mfma_f32_16x16x32_bf16 v[120:123], v[112:115], v[68:71], v[120:123]
  buffer_load_dwordx4 v10, s[12:15], s35 offen offset:1024 lds
  v_mfma_f32_16x16x32_bf16 v[156:159], v[116:119], v[68:71], v[156:159]
  ds_read_b64_tr_b16 v[92:93], v219 offset:9216
  ds_read_b64_tr_b16 v[94:95], v219 offset:11520
  v_mfma_f32_16x16x32_bf16 v[192:195], v[244:247], v[68:71], v[192:195]
  ds_read_b64_tr_b16 v[96:97], v219 offset:9256
  ds_read_b64_tr_b16 v[98:99], v219 offset:11560
  v_mfma_f32_16x16x32_bf16 v[124:127], v[112:115], v[72:75], v[124:127]
  ds_read_b64_tr_b16 v[100:101], v220 offset:9248
  ds_read_b64_tr_b16 v[102:103], v220 offset:11552
  v_mfma_f32_16x16x32_bf16 v[160:163], v[116:119], v[72:75], v[160:163]
  v_add_u32 v209, s37, v14
  v_add_u32 v210, s37, v204
  v_mfma_f32_16x16x32_bf16 v[196:199], v[244:247], v[72:75], v[196:199]
  s_waitcnt lgkmcnt(10)
  v_add_u32 v211, s37, v205
  v_add_u32 v212, s37, v206
  v_mfma_f32_16x16x32_bf16 v[128:131], v[112:115], v[76:79], v[128:131]
  buffer_load_dwordx4 v11, s[12:15], s35 offen offset:2048 lds
  v_mfma_f32_16x16x32_bf16 v[164:167], v[116:119], v[76:79], v[164:167]
  v_add_u32 v213, s37, v207
  v_add_u32 v214, s37, v208
  v_mfma_f32_16x16x32_bf16 v[132:135], v[112:115], v[80:83], v[132:135]
  s_waitcnt vmcnt(7) lgkmcnt(0)
  v_mfma_f32_16x16x32_bf16 v[168:171], v[116:119], v[80:83], v[168:171]
  s_barrier
  v_mfma_f32_16x16x32_bf16 v[136:139], v[112:115], v[84:87], v[136:139]
  ds_read_b128 v[104:107], v209 offset:0
  v_mfma_f32_16x16x32_bf16 v[172:175], v[116:119], v[84:87], v[172:175]
  ds_read_b128 v[108:111], v209 offset:2048
  ds_read_b64_tr_b16 v[32:33], v210 offset:0
  v_mfma_f32_16x16x32_bf16 v[140:143], v[112:115], v[88:91], v[140:143]
  buffer_load_dwordx4 v12, s[12:15], s35 offen offset:3072 lds
  v_mfma_f32_16x16x32_bf16 v[176:179], v[116:119], v[88:91], v[176:179]
  ds_read_b64_tr_b16 v[34:35], v210 offset:2304
  ds_read_b64_tr_b16 v[36:37], v210 offset:40
  v_mfma_f32_16x16x32_bf16 v[144:147], v[112:115], v[92:95], v[144:147]
  s_add_u32 m0, s36, s39
  ds_read_b64_tr_b16 v[38:39], v210 offset:2344
  v_mfma_f32_16x16x32_bf16 v[180:183], v[116:119], v[92:95], v[180:183]
  s_add_u32 s36, s36, 36864
  ds_read_b64_tr_b16 v[40:41], v211 offset:0
  ds_read_b64_tr_b16 v[42:43], v211 offset:2304
  v_mfma_f32_16x16x32_bf16 v[148:151], v[112:115], v[96:99], v[148:151]
  s_cmp_eq_u32 s36, 110592
  ds_read_b64_tr_b16 v[44:45], v211 offset:40
  v_mfma_f32_16x16x32_bf16 v[184:187], v[116:119], v[96:99], v[184:187]
  s_cselect_b32 s36, 0, s36
  ds_read_b64_tr_b16 v[46:47], v211 offset:2344
  v_mfma_f32_16x16x32_bf16 v[152:155], v[112:115], v[100:103], v[152:155]
  buffer_load_dwordx4 v13, s[12:15], s35 offen offset:0 lds
  v_mfma_f32_16x16x32_bf16 v[188:191], v[116:119], v[100:103], v[188:191]
  s_add_u32 s35, s35, 221184
  v_mfma_f32_16x16x32_bf16 v[200:203], v[244:247], v[100:103], v[200:203]
  s_waitcnt lgkmcnt(8)
  s_cmp_lg_u32 s33, s40
  s_cbranch_scc1 q0_v_ns1
  buffer_store_dwordx4 v[68:71], v1, s[28:31], s41 offen offset:0 sc1
  buffer_store_dwordx4 v[72:75], v1, s[28:31], s41 offen offset:1024 sc1
  buffer_store_dwordx4 v[76:79], v1, s[28:31], s42 offen offset:0 sc1
  buffer_store_dwordx4 v[80:83], v1, s[28:31], s42 offen offset:1024 sc1
  buffer_store_dwordx4 v[84:87], v1, s[28:31], s43 offen offset:0 sc1
  buffer_store_dwordx4 v[88:91], v1, s[28:31], s43 offen offset:1024 sc1
  buffer_store_dwordx4 v[92:95], v1, s[28:31], s44 offen offset:0 sc1
  buffer_store_dwordx4 v[96:99], v1, s[28:31], s44 offen offset:1024 sc1
  buffer_store_dwordx4 v[100:103], v1, s[28:31], s45 offen offset:0 sc1
q0_v_ns1:
  s_add_u32 s33, s33, 1
  s_cmp_lt_u32 s33, 18
  s_cbranch_scc1 q0_v_loop
  v_lshlrev_b32 v10, 2, v7
  v_add_u32 v10, 111616, v10
  v_add_u32 v204, s20, v10
  v_add_u32 v205, s21, v10
  v_add_u32 v206, s22, v10
  v_add_u32 v207, s23, v10
  v_and_b32 v6, 3, v7
  v_lshrrev_b32 v9, 2, v7
  s_waitcnt lgkmcnt(0)
  ds_write_b32 v204, v192 offset:0
  ds_write_b32 v204, v196 offset:64
  ds_write_b32 v10, v200 offset:512
  v_cmp_eq_u32 vcc, 1, v6
  s_nop 1
  v_cndmask_b32 v236, v236, v237, vcc
  v_cndmask_b32 v240, v240, v241, vcc
  v_cmp_eq_u32 vcc, 2, v6
  s_nop 1
  v_cndmask_b32 v236, v236, v238, vcc
  v_cndmask_b32 v240, v240, v242, vcc
  v_cmp_eq_u32 vcc, 3, v6
  s_nop 1
  v_cndmask_b32 v236, v236, v239, vcc
  v_cndmask_b32 v240, v240, v243, vcc
  v_cmp_eq_u32 vcc, v9, v8
  s_nop 1
  v_cndmask_b32 v236, 0, v236, vcc
  v_cndmask_b32 v240, 0, v240, vcc
  s_waitcnt lgkmcnt(0)
  s_barrier
  ds_read_b32 v68, v204 offset:0
  ds_read_b32 v70, v204 offset:64
  ds_read_b32 v72, v205 offset:0
  ds_read_b32 v74, v205 offset:64
  ds_read_b32 v76, v206 offset:0
  ds_read_b32 v78, v206 offset:64
  ds_read_b32 v80, v207 offset:0
  ds_read_b32 v82, v207 offset:64
  ds_read_b32 v84, v10 offset:512
  v_mov_b32 v237, v236
  v_mov_b32 v241, v240
  s_nop 0
  v_permlane16_swap_b32 v236, v237
  v_permlane16_swap_b32 v240, v241
  v_add_f32 v236, v236, v237
  v_add_f32 v240, v240, v241
  v_mov_b32 v237, v236
  v_mov_b32 v241, v240
  s_nop 0
  v_permlane32_swap_b32 v236, v237
  v_permlane32_swap_b32 v240, v241
  v_add_f32 v236, v236, v237
  v_add_f32 v240, v240, v241
  v_mul_f32 v228, 0x3ae38e39, v228
  v_mul_f32 v232, 0x3ae38e39, v232
  v_mul_f32 v236, 0x3ae38e39, v236
  v_mul_f32 v240, 0x3ae38e39, v240
  v_fma_f32 v236, -v228, v228, v236
  v_fma_f32 v240, -v232, v232, v240
  v_max_f32 v236, 0, v236
  v_max_f32 v240, 0, v240
  v_add_f32 v236, 0x3727c5ac, v236
  v_add_f32 v240, 0x3727c5ac, v240
  v_rsq_f32 v13, v236
  v_rsq_f32 v15, v240
  v_sub_f32 v12, 0, v228
  v_sub_f32 v14, 0, v232
  v_lshl_add_u32 v11, v7, 2, s47
  s_waitcnt lgkmcnt(0)
  ds_write_b32 v11, v12 offset:0
  ds_write_b32 v11, v13 offset:64
  ds_write_b32 v11, v14 offset:128
  ds_write_b32 v11, v15 offset:192
  v_lshl_add_u32 v11, v8, 4, s47
  ds_read_b128 v[104:107], v11 offset:0
  ds_read_b128 v[108:111], v11 offset:64
  ds_read_b128 v[112:115], v11 offset:128
  ds_read_b128 v[116:119], v11 offset:192
  v_add_u32 v18, s48, v1
  s_waitcnt lgkmcnt(0)
  v_pk_fma_f32 v[120:121], v[104:105], v[68:69], v[120:121] op_sel_hi:[1,0,1]
  v_pk_fma_f32 v[122:123], v[106:107], v[68:69], v[122:123] op_sel_hi:[1,0,1]
  v_pk_mul_f32 v[120:121], v[120:121], v[108:109]
  v_pk_mul_f32 v[122:123], v[122:123], v[110:111]
  v_cvt_pk_bf16_f32 v32, v120, v121
  v_cvt_pk_bf16_f32 v33, v122, v123
  v_pk_fma_f32 v[156:157], v[112:113], v[68:69], v[156:157] op_sel_hi:[1,0,1]
  v_pk_fma_f32 v[158:159], v[114:115], v[68:69], v[158:159] op_sel_hi:[1,0,1]
  v_pk_mul_f32 v[156:157], v[156:157], v[116:117]
  v_pk_mul_f32 v[158:159], v[158:159], v[118:119]
  v_cvt_pk_bf16_f32 v34, v156, v157
  v_cvt_pk_bf16_f32 v35, v158, v159
  v_pk_fma_f32 v[124:125], v[104:105], v[70:71], v[124:125] op_sel_hi:[1,0,1]
  v_pk_fma_f32 v[126:127], v[106:107], v[70:71], v[126:127] op_sel_hi:[1,0,1]
  v_pk_mul_f32 v[124:125], v[124:125], v[108:109]
  v_pk_mul_f32 v[126:127], v[126:127], v[110:111]
  v_cvt_pk_bf16_f32 v36, v124, v125
  v_cvt_pk_bf16_f32 v37, v126, v127
  v_pk_fma_f32 v[160:161], v[112:113], v[70:71], v[160:161] op_sel_hi:[1,0,1]
  v_pk_fma_f32 v[162:163], v[114:115], v[70:71], v[162:163] op_sel_hi:[1,0,1]
  v_pk_mul_f32 v[160:161], v[160:161], v[116:117]
  v_pk_mul_f32 v[162:163], v[162:163], v[118:119]
  v_cvt_pk_bf16_f32 v38, v160, v161
  v_cvt_pk_bf16_f32 v39, v162, v163
  buffer_store_dwordx4 v[32:35], v18, s[24:27], s49 offen sc1
  v_pk_fma_f32 v[128:129], v[104:105], v[72:73], v[128:129] op_sel_hi:[1,0,1]
  v_pk_fma_f32 v[130:131], v[106:107], v[72:73], v[130:131] op_sel_hi:[1,0,1]
  v_pk_mul_f32 v[128:129], v[128:129], v[108:109]
  v_pk_mul_f32 v[130:131], v[130:131], v[110:111]
  v_cvt_pk_bf16_f32 v40, v128, v129
  v_cvt_pk_bf16_f32 v41, v130, v131
  v_pk_fma_f32 v[164:165], v[112:113], v[72:73], v[164:165] op_sel_hi:[1,0,1]
  v_pk_fma_f32 v[166:167], v[114:115], v[72:73], v[166:167] op_sel_hi:[1,0,1]
  v_pk_mul_f32 v[164:165], v[164:165], v[116:117]
  v_pk_mul_f32 v[166:167], v[166:167], v[118:119]
  v_cvt_pk_bf16_f32 v42, v164, v165
  v_cvt_pk_bf16_f32 v43, v166, v167
  buffer_store_dwordx4 v[36:39], v18, s[24:27], s60 offen sc1
  v_pk_fma_f32 v[132:133], v[104:105], v[74:75], v[132:133] op_sel_hi:[1,0,1]
  v_pk_fma_f32 v[134:135], v[106:107], v[74:75], v[134:135] op_sel_hi:[1,0,1]
  v_pk_mul_f32 v[132:133], v[132:133], v[108:109]
  v_pk_mul_f32 v[134:135], v[134:135], v[110:111]
  v_cvt_pk_bf16_f32 v44, v132, v133
  v_cvt_pk_bf16_f32 v45, v134, v135
  v_pk_fma_f32 v[168:169], v[112:113], v[74:75], v[168:169] op_sel_hi:[1,0,1]
  v_pk_fma_f32 v[170:171], v[114:115], v[74:75], v[170:171] op_sel_hi:[1,0,1]
  v_pk_mul_f32 v[168:169], v[168:169], v[116:117]
  v_pk_mul_f32 v[170:171], v[170:171], v[118:119]
  v_cvt_pk_bf16_f32 v46, v168, v169
  v_cvt_pk_bf16_f32 v47, v170, v171
  buffer_store_dwordx4 v[40:43], v18, s[24:27], s50 offen sc1
  v_pk_fma_f32 v[136:137], v[104:105], v[76:77], v[136:137] op_sel_hi:[1,0,1]
  v_pk_fma_f32 v[138:139], v[106:107], v[76:77], v[138:139] op_sel_hi:[1,0,1]
  v_pk_mul_f32 v[136:137], v[136:137], v[108:109]
  v_pk_mul_f32 v[138:139], v[138:139], v[110:111]
  v_cvt_pk_bf16_f32 v48, v136, v137
  v_cvt_pk_bf16_f32 v49, v138, v139
  v_pk_fma_f32 v[172:173], v[112:113], v[76:77], v[172:173] op_sel_hi:[1,0,1]
  v_pk_fma_f32 v[174:175], v[114:115], v[76:77], v[174:175] op_sel_hi:[1,0,1]
  v_pk_mul_f32 v[172:173], v[172:173], v[116:117]
  v_pk_mul_f32 v[174:175], v[174:175], v[118:119]
  v_cvt_pk_bf16_f32 v50, v172, v173
  v_cvt_pk_bf16_f32 v51, v174, v175
  buffer_store_dwordx4 v[44:47], v18, s[24:27], s61 offen sc1
  v_pk_fma_f32 v[140:141], v[104:105], v[78:79], v[140:141] op_sel_hi:[1,0,1]
  v_pk_fma_f32 v[142:143], v[106:107], v[78:79], v[142:143] op_sel_hi:[1,0,1]
  v_pk_mul_f32 v[140:141], v[140:141], v[108:109]
  v_pk_mul_f32 v[142:143], v[142:143], v[110:111]
  v_cvt_pk_bf16_f32 v52, v140, v141
  v_cvt_pk_bf16_f32 v53, v142, v143
  v_pk_fma_f32 v[176:177], v[112:113], v[78:79], v[176:177] op_sel_hi:[1,0,1]
  v_pk_fma_f32 v[178:179], v[114:115], v[78:79], v[178:179] op_sel_hi:[1,0,1]
  v_pk_mul_f32 v[176:177], v[176:177], v[116:117]
  v_pk_mul_f32 v[178:179], v[178:179], v[118:119]
  v_cvt_pk_bf16_f32 v54, v176, v177
  v_cvt_pk_bf16_f32 v55, v178, v179
  buffer_store_dwordx4 v[48:51], v18, s[24:27], s51 offen sc1
  v_pk_fma_f32 v[144:145], v[104:105], v[80:81], v[144:145] op_sel_hi:[1,0,1]
  v_pk_fma_f32 v[146:147], v[106:107], v[80:81], v[146:147] op_sel_hi:[1,0,1]
  v_pk_mul_f32 v[144:145], v[144:145], v[108:109]
  v_pk_mul_f32 v[146:147], v[146:147], v[110:111]
  v_cvt_pk_bf16_f32 v56, v144, v145
  v_cvt_pk_bf16_f32 v57, v146, v147
  v_pk_fma_f32 v[180:181], v[112:113], v[80:81], v[180:181] op_sel_hi:[1,0,1]
  v_pk_fma_f32 v[182:183], v[114:115], v[80:81], v[182:183] op_sel_hi:[1,0,1]
  v_pk_mul_f32 v[180:181], v[180:181], v[116:117]
  v_pk_mul_f32 v[182:183], v[182:183], v[118:119]
  v_cvt_pk_bf16_f32 v58, v180, v181
  v_cvt_pk_bf16_f32 v59, v182, v183
  buffer_store_dwordx4 v[52:55], v18, s[24:27], s62 offen sc1
  v_pk_fma_f32 v[148:149], v[104:105], v[82:83], v[148:149] op_sel_hi:[1,0,1]
  v_pk_fma_f32 v[150:151], v[106:107], v[82:83], v[150:151] op_sel_hi:[1,0,1]
  v_pk_mul_f32 v[148:149], v[148:149], v[108:109]
  v_pk_mul_f32 v[150:151], v[150:151], v[110:111]
  v_cvt_pk_bf16_f32 v60, v148, v149
  v_cvt_pk_bf16_f32 v61, v150, v151
  v_pk_fma_f32 v[184:185], v[112:113], v[82:83], v[184:185] op_sel_hi:[1,0,1]
  v_pk_fma_f32 v[186:187], v[114:115], v[82:83], v[186:187] op_sel_hi:[1,0,1]
  v_pk_mul_f32 v[184:185], v[184:185], v[116:117]
  v_pk_mul_f32 v[186:187], v[186:187], v[118:119]
  v_cvt_pk_bf16_f32 v62, v184, v185
  v_cvt_pk_bf16_f32 v63, v186, v187
  buffer_store_dwordx4 v[56:59], v18, s[24:27], s52 offen sc1
  v_pk_fma_f32 v[152:153], v[104:105], v[84:85], v[152:153] op_sel_hi:[1,0,1]
  v_pk_fma_f32 v[154:155], v[106:107], v[84:85], v[154:155] op_sel_hi:[1,0,1]
  v_pk_mul_f32 v[152:153], v[152:153], v[108:109]
  v_pk_mul_f32 v[154:155], v[154:155], v[110:111]
  v_cvt_pk_bf16_f32 v64, v152, v153
  v_cvt_pk_bf16_f32 v65, v154, v155
  v_pk_fma_f32 v[188:189], v[112:113], v[84:85], v[188:189] op_sel_hi:[1,0,1]
  v_pk_fma_f32 v[190:191], v[114:115], v[84:85], v[190:191] op_sel_hi:[1,0,1]
  v_pk_mul_f32 v[188:189], v[188:189], v[116:117]
  v_pk_mul_f32 v[190:191], v[190:191], v[118:119]
  v_cvt_pk_bf16_f32 v66, v188, v189
  v_cvt_pk_bf16_f32 v67, v190, v191
  buffer_store_dwordx4 v[60:63], v18, s[24:27], s63 offen sc1
  buffer_store_dwordx4 v[64:67], v18, s[24:27], s53 offen sc1
q0_cs:
  s_cmp_lg_u32 s40, 63
  s_cbranch_scc1 at_main
  s_add_u32 s28, s4, 66158592
  s_addc_u32 s29, s5, 0
  s_and_b32 s29, s29, 0xffff
  s_mov_b32 s30, 6912
  s_mov_b32 s31, 0x20000
  s_mul_i32 s41, s17, 576
  v_min_u32 v6, 35, v254
  v_lshlrev_b32 v6, 4, v6
  v_add_u32 v9, 111616, v6
  ds_read_b128 v[96:99], v9
  s_waitcnt lgkmcnt(0)
  buffer_store_dwordx4 v[96:99], v6, s[28:31], s41 offen sc1
  s_branch at_main
q0_idle:
  s_sub_u32 s6, s2, 192
  s_lshr_b32 s6, s6, 3
  s_lshl_b32 s6, s6, 2
  s_add_u32 s6, s6, s18
  s_sub_u32 s7, s2, 192
  s_lshl_b32 s7, s7, 2
  s_add_u32 s7, s7, s18
  s_and_b32 s9, s9, 0xffff
  s_mov_b32 s10, 2359296
  s_mov_b32 s11, 0x20000
  s_and_b32 s13, s13, 0xffff
  s_mov_b32 s14, 1990656
  s_mov_b32 s15, 0x20000
  v_lshlrev_b32 v2, 15, v254
  s_lshl_b32 s3, s7, 7
  s_add_u32 s3, s3, 442368
  buffer_load_dword v245, v2, s[12:15], s3 offen
  v_and_b32 v2, 7, v254
  v_mul_u32_u24 v2, 1152, v2
  v_lshrrev_b32 v3, 3, v254
  v_min_u32 v3, 6, v3
  v_lshl_add_u32 v2, v3, 7, v2
  s_mul_i32 s3, s7, 9216
  buffer_load_dword v239, v2, s[8:11], s3 offen offset:256
  s_getpc_b64 s[20:21]
cpf1:
  s_sub_u32 s20, s20, cpf1-code_mega
  s_subb_u32 s21, s21, 0
  v_mul_u32_u24 v246, 32, v254
  v_add_u32 v246, s6, v246
  v_lshlrev_b32 v246, 7, v246
  v_min_u32 v246, code_end-code_mega-4, v246
  global_load_dword v246, v246, s[20:21]
  s_add_u32 s6, s4, 66887680
  s_addc_u32 s7, s5, 0
  s_load_dword s93, s[6:7], 0
  s_mov_b64 s[100:101], s[4:5]
  s_add_u32 s96, s4, 66293760
  s_addc_u32 s97, s5, 0
  s_and_b32 s97, s97, 0xffff
  s_mov_b32 s98, 593924
  s_mov_b32 s99, 0x20000
  v_mov_b32 v252, 0
  s_mov_b32 s59, 0
  s_waitcnt lgkmcnt(0)
  s_mul_i32 s3, s93, 0x9E3779B1
  s_add_u32 s3, s3, 0x7F4A7C15
  v_mov_b32 v253, s3
  s_sub_u32 s50, s2, 256
  s_mov_b32 s35, 0
  s_cmp_ge_u32 s2, 224
  s_cselect_b32 s34, 2, 2
  s_mov_b32 s40, s4
  s_and_b32 s41, s5, 0xffff
  s_mov_b32 s42, 66891776
  s_mov_b32 s43, 0x20000
  s_branch pi_next
pi_top:
  s_waitcnt vmcnt(9)
  s_cmp_gt_u32 s35, 2
  s_cbranch_scc1 pi_t1
  s_cmp_eq_u32 s35, 1
  s_cbranch_scc1 pi_t0
  s_cmp_ge_u32 s2, 201
  s_cbranch_scc1 pi_t1
  s_waitcnt vmcnt(0)
  s_barrier
  s_cmp_lg_u32 s18, 0
  s_cbranch_scc1 pi_t1
  s_lshl_b32 s3, s2, 7
  s_add_u32 s3, s3, 499712
  s_mov_b64 exec, 1
  buffer_store_dword v253, v252, s[96:99], s3 offen sc1
  s_mov_b64 exec, -1
  s_branch pi_t1
pi_t0:
  s_waitcnt vmcnt(0)
pi_t1:
  s_barrier
  s_mov_b32 s40, s4
  s_and_b32 s41, s5, 0xffff
  s_mov_b32 s42, 66891776
  s_mov_b32 s43, 0x20000
  v_lshrrev_b32 v234, 5, v254
  v_lshlrev_b32 v234, 4, v234
  v_bfe_u32 v232, v254, 4, 1
  v_lshl_add_u32 v234, v232, 2, v234
  v_bfe_u32 v232, v254, 2, 2
  v_add_u32 v234, v234, v232
  v_and_b32 v235, 3, v254
  s_cmp_eq_u32 s46, 72
  s_cselect_b32 s39, 1, 0
  s_and_b32 s3, s44, 2
  s_mul_i32 s39, s39, s3
  s_add_u32 s39, s39, s44
  s_cmp_eq_u32 s44, 2
  s_cbranch_scc1 pi_fr
  v_lshrrev_b32 v232, 4, v0
  v_and_b32 v233, 0xfffffff3, v232
  v_bfe_u32 v236, v232, 2, 1
  v_lshl_add_u32 v233, v236, 3, v233
  v_bfe_u32 v236, v232, 3, 1
  v_lshl_add_u32 v233, v236, 2, v233
  v_and_b32 v232, 15, v0
  v_mul_u32_u24 v233, 288, v233
  v_lshl_add_u32 v233, v232, 4, v233
  v_add_u32 v233, 53248, v233
  ds_write_b128 v233, a[184:187] offset:0
  ds_write_b128 v233, a[188:191] offset:4608
  ds_write_b128 v233, a[192:195] offset:9216
  ds_write_b128 v233, a[196:199] offset:13824
  ds_write_b128 v233, a[200:203] offset:18432
  ds_write_b128 v233, a[204:207] offset:23040
  ds_write_b128 v233, a[208:211] offset:27648
  ds_write_b128 v233, a[212:215] offset:32256
  ds_write_b128 v233, a[216:219] offset:36864
  ds_write_b128 v233, a[220:223] offset:41472
  ds_write_b128 v233, a[224:227] offset:46080
  ds_write_b128 v233, a[228:231] offset:50688
  v_mul_u32_u24 v234, 288, v234
  s_lshl_b32 s3, s18, 6
  s_add_u32 s3, s3, 53248
  v_add_u32 v234, s3, v234
  v_lshl_add_u32 v234, v235, 3, v234
  s_lshl_b32 s30, s45, 3
  s_lshl_b32 s3, s18, 1
  s_add_u32 s31, s30, s3
  s_mul_i32 s38, s46, 36864
  s_lshl_b32 s3, s31, 7
  s_add_u32 s38, s38, s3
  s_lshl_b32 s3, s44, 6
  s_add_u32 s38, s38, s3
  s_add_u32 s38, s38, 66183168
  s_mul_i32 s30, s31, 18
  s_mul_i32 s3, s46, 6
  s_add_u32 s30, s30, s3
  s_lshl_b32 s30, s30, 11
  s_lshl_b32 s3, s44, 10
  s_add_u32 s30, s30, s3
  s_add_u32 s30, s30, 50233344
  s_add_u32 s33, s30, 36864
  v_mov_b32 v232, 0x3f803f80
  v_accvgpr_write_b32 a72, v232
  v_accvgpr_write_b32 a73, v232
  v_accvgpr_write_b32 a74, v232
  v_accvgpr_write_b32 a75, v232
  s_branch pi_fm
pi_fr:
  v_lshrrev_b32 v232, 3, v0
  v_and_b32 v233, 0xfffffff3, v232
  v_bfe_u32 v236, v232, 2, 1
  v_lshl_add_u32 v233, v236, 3, v233
  v_bfe_u32 v236, v232, 3, 1
  v_lshl_add_u32 v233, v236, 2, v233
  v_and_b32 v232, 7, v0
  v_mul_u32_u24 v233, 1184, v233
  v_lshl_add_u32 v233, v232, 4, v233
  v_add_u32 v233, 53248, v233
  ds_write_b128 v233, a[184:187] offset:0
  ds_write_b128 v233, a[188:191] offset:128
  ds_write_b128 v233, a[192:195] offset:256
  ds_write_b128 v233, a[196:199] offset:384
  ds_write_b128 v233, a[200:203] offset:512
  ds_write_b128 v233, a[204:207] offset:640
  ds_write_b128 v233, a[208:211] offset:768
  ds_write_b128 v233, a[212:215] offset:896
  ds_write_b128 v233, a[216:219] offset:1024
  s_cmp_eq_u32 s46, 72
  s_cbranch_scc1 pi_fw
  s_waitcnt lgkmcnt(4)
  ds_write_b128 v233, a[220:223] offset:37888
  ds_write_b128 v233, a[224:227] offset:38016
  ds_write_b128 v233, a[228:231] offset:38144
  ds_write_b128 v233, a[232:235] offset:38272
  ds_write_b128 v233, a[236:239] offset:38400
  ds_write_b128 v233, a[240:243] offset:38528
  ds_write_b128 v233, a[244:247] offset:38656
  ds_write_b128 v233, a[248:251] offset:38784
  ds_write_b128 v233, a[252:255] offset:38912
pi_fw:
  v_mul_u32_u24 v234, 1184, v234
  s_mul_i32 s3, s18, 288
  s_add_u32 s3, s3, 53248
  v_add_u32 v234, s3, v234
  v_and_b32 v232, 1, v235
  v_lshl_add_u32 v236, v232, 3, v234
  v_lshrrev_b32 v232, 1, v235
  v_mul_u32_u24 v232, 37888, v232
  v_add_u32 v236, v236, v232
  v_lshl_add_u32 v234, v235, 3, v234
  s_mul_i32 s33, s46, 9216
  s_mul_i32 s30, s45, 9216
  s_lshl_b32 s3, s18, 1
  s_mul_i32 s3, s3, s33
  s_add_u32 s30, s30, s3
  s_add_u32 s30, s30, 49569792
  s_add_u32 s33, s33, s30
  s_cmp_eq_u32 s46, 9
  s_cbranch_scc1 pi_fm
  s_mul_i32 s30, s18, 144
  s_add_u32 s30, s30, s45
  s_mul_i32 s30, s30, 9216
  s_add_u32 s30, s30, 60850176
  s_add_u32 s33, s30, 9216
pi_fm:
  s_add_u32 s31, s30, 4096
  s_add_u32 s32, s30, 8192
  s_add_u32 s36, s33, 4096
  s_add_u32 s37, s33, 8192
  s_waitcnt lgkmcnt(0)
  s_barrier
pi_next:
  s_cmp_gt_u32 s35, 2
  s_cselect_b32 s3, 32, 64
  s_cmp_eq_u32 s35, 2
  s_cselect_b32 s3, 32, s3
  s_add_u32 s50, s50, s3
  s_add_u32 s35, s35, 1
  s_cmp_gt_u32 s35, s34
  s_cbranch_scc1 pi_last
  s_load_dwordx4 s[60:63], s[0:1], 32
  s_load_dwordx2 s[48:49], s[0:1], 16
  s_load_dwordx2 s[52:53], s[0:1], 48
  s_sub_u32 s47, s50, 9
  s_cmp_lt_u32 s47, 216
  s_cbranch_scc0 pi_rp
  s_cmp_ge_u32 s47, 108
  s_cselect_b32 s44, 1, 0
  s_mul_i32 s45, s44, 108
  s_sub_u32 s47, s47, s45
  s_mul_i32 s45, s47, 43691
  s_lshr_b32 s45, s45, 17
  s_mul_i32 s46, s45, 3
  s_sub_u32 s46, s47, s46
  v_lshrrev_b32 v248, 4, v0
  v_and_b32 v247, 15, v0
  v_mul_u32_u24 v248, 9216, v248
  v_lshl_add_u32 v248, v247, 4, v248
  s_mul_i32 s47, s46, 1769472
  s_lshl_b32 s51, s45, 8
  s_add_u32 s47, s47, s51
  s_cmp_eq_u32 s44, 0
  s_waitcnt lgkmcnt(0)
  s_cselect_b32 s60, s60, s62
  s_cselect_b32 s61, s61, s63
  s_mov_b32 s62, 5308416
  s_branch pi_sd
pi_rp:
  s_mov_b32 s44, 2
  s_sub_u32 s45, s50, 225
  s_cmp_lt_u32 s50, 9
  s_cselect_b32 s45, s50, s45
  s_cselect_b32 s46, 9, 72
  s_cselect_b32 s3, 6, 5
  s_lshl_b32 s47, s45, s3
  s_mul_i32 s51, s45, 1821
  s_lshr_b32 s51, s51, 16
  s_mul_i32 s3, s51, 36
  s_sub_u32 s3, s45, s3
  s_lshr_b32 s3, s3, 2
  s_lshl_b32 s3, s3, 4
  s_mul_i32 s51, s51, 1152
  s_add_u32 s51, s51, s3
  s_cmp_lt_u32 s50, 9
  v_lshrrev_b32 v240, 3, v0
  v_add_u32 v240, s47, v240
  v_lshrrev_b32 v241, 4, v240
  v_mul_u32_u24 v242, 18, v241
  v_and_b32 v243, 15, v240
  v_add_u32 v242, v242, v243
  v_and_b32 v243, 1, v241
  v_lshl_add_u32 v242, v243, 1, v242
  v_bfe_u32 v241, v240, 1, 5
  v_mul_u32_u24 v243, 18, v241
  v_and_b32 v244, 1, v240
  v_add_u32 v243, v243, v244
  v_and_b32 v244, 1, v241
  v_xor_b32 v244, 1, v244
  v_lshl_add_u32 v243, v244, 4, v243
  v_cmp_gt_u32 vcc, 512, v240
  s_nop 1
  v_cndmask_b32 v242, v243, v242, vcc
  v_bfe_u32 v241, v240, 4, 3
  v_mul_u32_u24 v241, 144, v241
  v_and_b32 v243, 15, v240
  v_add3_u32 v240, v241, v243, s51
  s_cselect_b64 vcc, -1, 0
  v_cndmask_b32 v240, v240, v242, vcc
  v_mul_u32_u24 v240, 1152, v240
  v_and_b32 v241, 7, v0
  v_lshl_add_u32 v247, v241, 4, v240
  v_lshrrev_b32 v240, 3, v0
  v_add_u32 v240, s47, v240
  v_add_u32 v240, 32, v240
  v_lshrrev_b32 v241, 4, v240
  v_mul_u32_u24 v242, 18, v241
  v_and_b32 v243, 15, v240
  v_add_u32 v242, v242, v243
  v_and_b32 v243, 1, v241
  v_lshl_add_u32 v242, v243, 1, v242
  v_bfe_u32 v241, v240, 1, 5
  v_mul_u32_u24 v243, 18, v241
  v_and_b32 v244, 1, v240
  v_add_u32 v243, v243, v244
  v_and_b32 v244, 1, v241
  v_xor_b32 v244, 1, v244
  v_lshl_add_u32 v243, v244, 4, v243
  v_cmp_gt_u32 vcc, 512, v240
  s_nop 1
  v_cndmask_b32 v242, v243, v242, vcc
  v_bfe_u32 v241, v240, 4, 3
  v_mul_u32_u24 v241, 144, v241
  v_and_b32 v243, 15, v240
  v_add3_u32 v240, v241, v243, s51
  s_cselect_b64 vcc, -1, 0
  v_cndmask_b32 v240, v240, v242, vcc
  v_mul_u32_u24 v240, 1152, v240
  v_and_b32 v241, 7, v0
  v_lshl_add_u32 v248, v241, 4, v240
  s_waitcnt lgkmcnt(0)
  s_cselect_b32 s60, s48, s52
  s_cselect_b32 s61, s49, s53
  s_mov_b32 s62, 5308416
  s_cselect_b32 s62, 663552, s62
pi_sd:
  s_and_b32 s61, s61, 0xffff
  s_mov_b32 s63, 0x20000
  s_cmp_eq_u32 s44, 2
  s_cbranch_scc1 pi_lr0
  buffer_load_dwordx4 a[184:187], v248, s[60:63], s47 offen nt
  s_add_u32 s47, s47, 147456
  buffer_load_dwordx4 a[188:191], v248, s[60:63], s47 offen nt
  s_add_u32 s47, s47, 147456
  buffer_load_dwordx4 a[192:195], v248, s[60:63], s47 offen nt
  s_add_u32 s47, s47, 147456
  buffer_load_dwordx4 a[196:199], v248, s[60:63], s47 offen nt
  s_add_u32 s47, s47, 147456
  buffer_load_dwordx4 a[200:203], v248, s[60:63], s47 offen nt
  s_add_u32 s47, s47, 147456
  buffer_load_dwordx4 a[204:207], v248, s[60:63], s47 offen nt
  s_add_u32 s47, s47, 147456
  buffer_load_dwordx4 a[208:211], v248, s[60:63], s47 offen nt
  s_add_u32 s47, s47, 147456
  buffer_load_dwordx4 a[212:215], v248, s[60:63], s47 offen nt
  s_add_u32 s47, s47, 147456
  buffer_load_dwordx4 a[216:219], v248, s[60:63], s47 offen nt
  s_add_u32 s47, s47, 147456
  s_branch pi_ld0
pi_lr0:
  buffer_load_dwordx4 a[184:187], v247, s[60:63], 0 offen offset:0 nt
  buffer_load_dwordx4 a[188:191], v247, s[60:63], 0 offen offset:128 nt
  buffer_load_dwordx4 a[192:195], v247, s[60:63], 0 offen offset:256 nt
  buffer_load_dwordx4 a[196:199], v247, s[60:63], 0 offen offset:384 nt
  buffer_load_dwordx4 a[200:203], v247, s[60:63], 0 offen offset:512 nt
  buffer_load_dwordx4 a[204:207], v247, s[60:63], 0 offen offset:640 nt
  buffer_load_dwordx4 a[208:211], v247, s[60:63], 0 offen offset:768 nt
  buffer_load_dwordx4 a[212:215], v247, s[60:63], 0 offen offset:896 nt
  buffer_load_dwordx4 a[216:219], v247, s[60:63], 0 offen offset:1024 nt
pi_ld0:
  s_cmp_eq_u32 s44, 2
  s_cbranch_scc1 pi_lr1
  buffer_load_dwordx4 a[220:223], v248, s[60:63], s47 offen nt
  s_add_u32 s47, s47, 147456
  buffer_load_dwordx4 a[224:227], v248, s[60:63], s47 offen nt
  s_add_u32 s47, s47, 147456
  buffer_load_dwordx4 a[228:231], v248, s[60:63], s47 offen nt
  s_branch pi_ld1
pi_lr1:
  s_cmp_eq_u32 s46, 72
  s_cbranch_scc1 pi_ld1
  buffer_load_dwordx4 a[220:223], v248, s[60:63], 0 offen offset:0 nt
  buffer_load_dwordx4 a[224:227], v248, s[60:63], 0 offen offset:128 nt
  buffer_load_dwordx4 a[228:231], v248, s[60:63], 0 offen offset:256 nt
  buffer_load_dwordx4 a[232:235], v248, s[60:63], 0 offen offset:384 nt
  buffer_load_dwordx4 a[236:239], v248, s[60:63], 0 offen offset:512 nt
  buffer_load_dwordx4 a[240:243], v248, s[60:63], 0 offen offset:640 nt
  buffer_load_dwordx4 a[244:247], v248, s[60:63], 0 offen offset:768 nt
  buffer_load_dwordx4 a[248:251], v248, s[60:63], 0 offen offset:896 nt
  buffer_load_dwordx4 a[252:255], v248, s[60:63], 0 offen offset:1024 nt
pi_ld1:
  s_cmp_eq_u32 s35, 1
  s_cbranch_scc1 pi_top
pi_last:
  s_cmp_eq_u32 s39, 2
  s_cbranch_scc1 pi_fr2
  s_cmp_eq_u32 s39, 4
  s_cbranch_scc1 pi_fr3
  ds_read_b64_tr_b16 a[0:1], v234 offset:0
  ds_read_b64_tr_b16 a[2:3], v234 offset:2304
  ds_read_b64_tr_b16 a[4:5], v234 offset:9216
  ds_read_b64_tr_b16 a[6:7], v234 offset:11520
  ds_read_b64_tr_b16 a[8:9], v234 offset:18432
  ds_read_b64_tr_b16 a[10:11], v234 offset:20736
  ds_read_b64_tr_b16 a[12:13], v234 offset:27648
  ds_read_b64_tr_b16 a[14:15], v234 offset:29952
  s_waitcnt lgkmcnt(6)
  buffer_store_dwordx4 a[0:3], v1, s[40:43], s30 offen offset:0 sc1
  v_mfma_f32_16x16x32_bf16 v[224:227], a[0:3], a[72:75], 0
  ds_read_b64_tr_b16 a[16:17], v234 offset:36864
  ds_read_b64_tr_b16 a[18:19], v234 offset:39168
  s_waitcnt lgkmcnt(6)
  buffer_store_dwordx4 a[4:7], v1, s[40:43], s30 offen offset:2048 sc1
  v_mfma_f32_16x16x32_bf16 v[224:227], a[4:7], a[72:75], v[224:227]
  ds_read_b64_tr_b16 a[20:21], v234 offset:46080
  ds_read_b64_tr_b16 a[22:23], v234 offset:48384
  s_waitcnt lgkmcnt(6)
  buffer_store_dwordx4 a[8:11], v1, s[40:43], s31 offen offset:0 sc1
  v_mfma_f32_16x16x32_bf16 v[224:227], a[8:11], a[72:75], v[224:227]
  ds_read_b64_tr_b16 a[24:25], v234 offset:32
  ds_read_b64_tr_b16 a[26:27], v234 offset:2336
  s_waitcnt lgkmcnt(6)
  buffer_store_dwordx4 a[12:15], v1, s[40:43], s31 offen offset:2048 sc1
  v_mfma_f32_16x16x32_bf16 v[224:227], a[12:15], a[72:75], v[224:227]
  ds_read_b64_tr_b16 a[28:29], v234 offset:9248
  ds_read_b64_tr_b16 a[30:31], v234 offset:11552
  s_waitcnt lgkmcnt(6)
  buffer_store_dwordx4 a[16:19], v1, s[40:43], s32 offen offset:0 sc1
  v_mfma_f32_16x16x32_bf16 v[224:227], a[16:19], a[72:75], v[224:227]
  ds_read_b64_tr_b16 a[32:33], v234 offset:18464
  ds_read_b64_tr_b16 a[34:35], v234 offset:20768
  s_waitcnt lgkmcnt(6)
  buffer_store_dwordx4 a[20:23], v1, s[40:43], s32 offen offset:2048 sc1
  v_mfma_f32_16x16x32_bf16 v[224:227], a[20:23], a[72:75], v[224:227]
  ds_read_b64_tr_b16 a[36:37], v234 offset:27680
  ds_read_b64_tr_b16 a[38:39], v234 offset:29984
  s_waitcnt lgkmcnt(6)
  buffer_store_dwordx4 a[24:27], v1, s[40:43], s33 offen offset:0 sc1
  v_mfma_f32_16x16x32_bf16 v[228:231], a[24:27], a[72:75], 0
  ds_read_b64_tr_b16 a[40:41], v234 offset:36896
  ds_read_b64_tr_b16 a[42:43], v234 offset:39200
  s_waitcnt lgkmcnt(6)
  buffer_store_dwordx4 a[28:31], v1, s[40:43], s33 offen offset:2048 sc1
  v_mfma_f32_16x16x32_bf16 v[228:231], a[28:31], a[72:75], v[228:231]
  ds_read_b64_tr_b16 a[44:45], v234 offset:46112
  ds_read_b64_tr_b16 a[46:47], v234 offset:48416
  s_waitcnt lgkmcnt(6)
  buffer_store_dwordx4 a[32:35], v1, s[40:43], s36 offen offset:0 sc1
  v_mfma_f32_16x16x32_bf16 v[228:231], a[32:35], a[72:75], v[228:231]
  s_waitcnt lgkmcnt(4)
  buffer_store_dwordx4 a[36:39], v1, s[40:43], s36 offen offset:2048 sc1
  v_mfma_f32_16x16x32_bf16 v[228:231], a[36:39], a[72:75], v[228:231]
  s_waitcnt lgkmcnt(2)
  buffer_store_dwordx4 a[40:43], v1, s[40:43], s37 offen offset:0 sc1
  v_mfma_f32_16x16x32_bf16 v[228:231], a[40:43], a[72:75], v[228:231]
  s_waitcnt lgkmcnt(0)
  buffer_store_dwordx4 a[44:47], v1, s[40:43], s37 offen offset:2048 sc1
  v_mfma_f32_16x16x32_bf16 v[228:231], a[44:47], a[72:75], v[228:231]
  v_lshrrev_b32 v232, 4, v254
  v_lshlrev_b32 v232, 4, v232
  s_mov_b32 exec_lo, 0x00010001
  s_mov_b32 exec_hi, 0x00010001
  buffer_store_dwordx4 v[224:227], v232, s[40:43], s38 offen sc1
  s_nop 2
  buffer_store_dwordx4 v[228:231], v232, s[40:43], s38 offen offset:128 sc1
  s_mov_b64 exec, -1
  s_branch pi_fd
pi_fr2:
  ds_read_b64_tr_b16 a[0:1], v234 offset:0
  ds_read_b64_tr_b16 a[2:3], v234 offset:9472
  ds_read_b64_tr_b16 a[4:5], v234 offset:32
  ds_read_b64_tr_b16 a[6:7], v234 offset:9504
  ds_read_b64_tr_b16 a[8:9], v234 offset:64
  ds_read_b64_tr_b16 a[10:11], v234 offset:9536
  ds_read_b64_tr_b16 a[12:13], v234 offset:96
  ds_read_b64_tr_b16 a[14:15], v234 offset:9568
  s_waitcnt lgkmcnt(6)
  buffer_store_dwordx4 a[0:3], v1, s[40:43], s30 offen offset:0 sc1
  ds_read_b64_tr_b16 a[16:17], v234 offset:37888
  ds_read_b64_tr_b16 a[18:19], v234 offset:47360
  s_waitcnt lgkmcnt(6)
  buffer_store_dwordx4 a[4:7], v1, s[40:43], s30 offen offset:1024 sc1
  ds_read_b64_tr_b16 a[20:21], v234 offset:37920
  ds_read_b64_tr_b16 a[22:23], v234 offset:47392
  s_waitcnt lgkmcnt(6)
  buffer_store_dwordx4 a[8:11], v1, s[40:43], s30 offen offset:2048 sc1
  ds_read_b64_tr_b16 a[24:25], v234 offset:37952
  ds_read_b64_tr_b16 a[26:27], v234 offset:47424
  s_waitcnt lgkmcnt(6)
  buffer_store_dwordx4 a[12:15], v1, s[40:43], s30 offen offset:3072 sc1
  ds_read_b64_tr_b16 a[28:29], v234 offset:37984
  ds_read_b64_tr_b16 a[30:31], v234 offset:47456
  s_waitcnt lgkmcnt(6)
  buffer_store_dwordx4 a[16:19], v1, s[40:43], s31 offen offset:0 sc1
  ds_read_b64_tr_b16 a[32:33], v236 offset:128
  ds_read_b64_tr_b16 a[34:35], v236 offset:9600
  s_waitcnt lgkmcnt(6)
  buffer_store_dwordx4 a[20:23], v1, s[40:43], s31 offen offset:1024 sc1
  ds_read_b64_tr_b16 a[36:37], v234 offset:144
  ds_read_b64_tr_b16 a[38:39], v234 offset:9616
  s_waitcnt lgkmcnt(6)
  buffer_store_dwordx4 a[24:27], v1, s[40:43], s31 offen offset:2048 sc1
  ds_read_b64_tr_b16 a[40:41], v234 offset:176
  ds_read_b64_tr_b16 a[42:43], v234 offset:9648
  s_waitcnt lgkmcnt(6)
  buffer_store_dwordx4 a[28:31], v1, s[40:43], s31 offen offset:3072 sc1
  ds_read_b64_tr_b16 a[44:45], v234 offset:208
  ds_read_b64_tr_b16 a[46:47], v234 offset:9680
  s_waitcnt lgkmcnt(6)
  buffer_store_dwordx4 a[32:35], v1, s[40:43], s32 offen offset:0 sc1
  ds_read_b64_tr_b16 a[48:49], v234 offset:240
  ds_read_b64_tr_b16 a[50:51], v234 offset:9712
  s_waitcnt lgkmcnt(6)
  buffer_store_dwordx4 a[36:39], v1, s[40:43], s33 offen offset:0 sc1
  ds_read_b64_tr_b16 a[52:53], v234 offset:38032
  ds_read_b64_tr_b16 a[54:55], v234 offset:47504
  s_waitcnt lgkmcnt(6)
  buffer_store_dwordx4 a[40:43], v1, s[40:43], s33 offen offset:1024 sc1
  ds_read_b64_tr_b16 a[56:57], v234 offset:38064
  ds_read_b64_tr_b16 a[58:59], v234 offset:47536
  s_waitcnt lgkmcnt(6)
  buffer_store_dwordx4 a[44:47], v1, s[40:43], s33 offen offset:2048 sc1
  ds_read_b64_tr_b16 a[60:61], v234 offset:38096
  ds_read_b64_tr_b16 a[62:63], v234 offset:47568
  s_waitcnt lgkmcnt(6)
  buffer_store_dwordx4 a[48:51], v1, s[40:43], s33 offen offset:3072 sc1
  ds_read_b64_tr_b16 a[64:65], v234 offset:38128
  ds_read_b64_tr_b16 a[66:67], v234 offset:47600
  s_waitcnt lgkmcnt(6)
  buffer_store_dwordx4 a[52:55], v1, s[40:43], s36 offen offset:0 sc1
  ds_read_b64_tr_b16 a[68:69], v236 offset:272
  ds_read_b64_tr_b16 a[70:71], v236 offset:9744
  s_waitcnt lgkmcnt(6)
  buffer_store_dwordx4 a[56:59], v1, s[40:43], s36 offen offset:1024 sc1
  s_waitcnt lgkmcnt(4)
  buffer_store_dwordx4 a[60:63], v1, s[40:43], s36 offen offset:2048 sc1
  s_waitcnt lgkmcnt(2)
  buffer_store_dwordx4 a[64:67], v1, s[40:43], s36 offen offset:3072 sc1
  s_waitcnt lgkmcnt(0)
  buffer_store_dwordx4 a[68:71], v1, s[40:43], s37 offen offset:0 sc1
  s_branch pi_fd
pi_fr3:
  ds_read_b64_tr_b16 a[0:1], v234 offset:0
  ds_read_b64_tr_b16 a[2:3], v234 offset:9472
  ds_read_b64_tr_b16 a[4:5], v234 offset:32
  ds_read_b64_tr_b16 a[6:7], v234 offset:9504
  ds_read_b64_tr_b16 a[8:9], v234 offset:64
  ds_read_b64_tr_b16 a[10:11], v234 offset:9536
  ds_read_b64_tr_b16 a[12:13], v234 offset:96
  ds_read_b64_tr_b16 a[14:15], v234 offset:9568
  s_waitcnt lgkmcnt(6)
  buffer_store_dwordx4 a[0:3], v1, s[40:43], s30 offen offset:0 sc1
  ds_read_b64_tr_b16 a[16:17], v234 offset:128
  ds_read_b64_tr_b16 a[18:19], v234 offset:9600
  s_waitcnt lgkmcnt(6)
  buffer_store_dwordx4 a[4:7], v1, s[40:43], s30 offen offset:1024 sc1
  ds_read_b64_tr_b16 a[20:21], v234 offset:160
  ds_read_b64_tr_b16 a[22:23], v234 offset:9632
  s_waitcnt lgkmcnt(6)
  buffer_store_dwordx4 a[8:11], v1, s[40:43], s30 offen offset:2048 sc1
  ds_read_b64_tr_b16 a[24:25], v234 offset:192
  ds_read_b64_tr_b16 a[26:27], v234 offset:9664
  s_waitcnt lgkmcnt(6)
  buffer_store_dwordx4 a[12:15], v1, s[40:43], s30 offen offset:3072 sc1
  ds_read_b64_tr_b16 a[28:29], v234 offset:224
  ds_read_b64_tr_b16 a[30:31], v234 offset:9696
  s_waitcnt lgkmcnt(6)
  buffer_store_dwordx4 a[16:19], v1, s[40:43], s31 offen offset:0 sc1
  ds_read_b64_tr_b16 a[32:33], v234 offset:256
  ds_read_b64_tr_b16 a[34:35], v234 offset:9728
  s_waitcnt lgkmcnt(6)
  buffer_store_dwordx4 a[20:23], v1, s[40:43], s31 offen offset:1024 sc1
  s_waitcnt lgkmcnt(4)
  buffer_store_dwordx4 a[24:27], v1, s[40:43], s31 offen offset:2048 sc1
  s_waitcnt lgkmcnt(2)
  buffer_store_dwordx4 a[28:31], v1, s[40:43], s31 offen offset:3072 sc1
  s_waitcnt lgkmcnt(0)
  buffer_store_dwordx4 a[32:35], v1, s[40:43], s32 offen offset:0 sc1
pi_fd:
  s_cmp_le_u32 s35, s34
  s_cbranch_scc1 pi_top
  s_barrier
  s_branch at_main
q2_l1:
  s_mul_i32 s6, s17, 165888
  s_add_u32 s6, s6, 47579136
  s_add_u32 s12, s4, s6
  s_addc_u32 s13, s5, 0
  s_and_b32 s13, s13, 0xffff
  s_mov_b32 s14, 165888
  s_mov_b32 s15, 0x20000
  s_waitcnt vmcnt(0)
  s_barrier
  s_cmp_lg_u32 s18, 0
  s_cbranch_scc1 dn_sg
  s_mov_b64 exec, 1
  buffer_store_dword v253, v252, s[96:99], s58 offen sc1
  s_mov_b64 exec, -1
dn_sg:
  s_cmp_ge_u32 s2, 192
  s_cbranch_scc1 at_main
  s_lshl_b32 s49, s16, 11
  s_add_u32 s49, s49, 163840
  s_lshl_b32 s38, s18, 10
  s_add_u32 m0, s38, 57344
  s_nop 0
  buffer_load_dwordx4 v1, s[12:15], m0 offen sc1 lds
  s_add_u32 m0, s38, 61440
  s_nop 0
  buffer_load_dwordx4 v1, s[12:15], m0 offen sc1 lds
  s_add_u32 m0, s38, 65536
  s_nop 0
  buffer_load_dwordx4 v1, s[12:15], m0 offen sc1 lds
  s_add_u32 m0, s38, 69632
  s_nop 0
  buffer_load_dwordx4 v1, s[12:15], m0 offen sc1 lds
  s_add_u32 m0, s38, 73728
  s_nop 0
  buffer_load_dwordx4 v1, s[12:15], m0 offen sc1 lds
  s_add_u32 m0, s38, 77824
  s_nop 0
  buffer_load_dwordx4 v1, s[12:15], m0 offen sc1 lds
  s_add_u32 m0, s38, 81920
  s_nop 0
  buffer_load_dwordx4 v1, s[12:15], m0 offen sc1 lds
  s_add_u32 m0, s38, 86016
  s_nop 0
  buffer_load_dwordx4 v1, s[12:15], m0 offen sc1 lds
  s_add_u32 m0, s38, 90112
  s_nop 0
  buffer_load_dwordx4 v1, s[12:15], m0 offen sc1 lds
  s_add_u32 m0, s38, 94208
  s_nop 0
  buffer_load_dwordx4 v1, s[12:15], m0 offen sc1 lds
  s_add_u32 m0, s38, 98304
  s_nop 0
  buffer_load_dwordx4 v1, s[12:15], m0 offen sc1 lds
  s_add_u32 m0, s38, 102400
  s_nop 0
  buffer_load_dwordx4 v1, s[12:15], m0 offen sc1 lds
  s_add_u32 m0, s38, 106496
  s_nop 0
  buffer_load_dwordx4 v1, s[12:15], m0 offen sc1 lds
  s_lshl_b32 s19, s16, 3
  s_lshl_b32 s6, s18, 1
  s_add_u32 s19, s19, s6
  s_mul_i32 s6, s19, 18432
  v_add_u32 v2, s6, v1
  v_add_u32 v3, 18432, v2
  s_mov_b32 s33, 4096
  s_mov_b32 s34, 8192
  s_mov_b32 s35, 12288
  s_mov_b32 s36, 16384
  v_add_u32 v6, 156672, v1
  v_and_b32 v7, 15, v254
  v_lshrrev_b32 v8, 4, v254
  s_lshl_b32 s6, s19, 11
  v_add_u32 v9, s6, v1
  v_min_u32 v10, 35, v254
  v_lshlrev_b32 v10, 4, v10
  s_mul_i32 s42, s17, 576
  s_mov_b32 s8, s100
  s_and_b32 s9, s101, 0xffff
  s_mov_b32 s10, 2359296
  s_mov_b32 s11, 0x20000
  s_add_u32 s20, s100, 14155776
  s_addc_u32 s21, s101, 0
  s_and_b32 s21, s21, 0xffff
  s_mov_b32 s22, 262144
  s_mov_b32 s23, 0x20000
  s_add_u32 s28, s4, 66158592
  s_addc_u32 s29, s5, 0
  s_and_b32 s29, s29, 0xffff
  s_mov_b32 s30, 6912
  s_mov_b32 s31, 0x20000
  s_add_u32 s24, s100, 40501248
  s_addc_u32 s25, s101, 0
  s_and_b32 s25, s25, 0xffff
  s_mov_b32 s26, 7077888
  s_mov_b32 s27, 0x20000
  v_add_u32 v16, 65536, v1
  v_add_u32 v17, 131072, v1
  s_cmp_lt_u32 s17, 4
  s_cselect_b32 s46, 0x3eae1a93, 1.0
  s_lshl_b32 s47, s18, 8
  s_add_u32 s47, s47, 159744
  s_mul_i32 s45, s17, 589824
  s_lshl_b32 s48, s19, 9
  s_lshl_b32 s58, s17, 4
  s_add_u32 s58, s58, s16
  s_lshl_b32 s58, s58, 7
  s_add_u32 s58, s58, s59
  buffer_load_dwordx4 v[184:187], v10, s[28:31], s42 offen sc1
  s_cmp_lg_u32 s18, 0
  s_cbranch_scc1 q2_wn
  v_min_u32 v255, 15, v254
  v_lshlrev_b32 v255, 7, v255
  s_mov_b32 s3, 150000
q2_wl:
  buffer_load_dword v249, v255, s[96:99], s49 offen sc1
  s_waitcnt vmcnt(0)
  v_cmp_ne_u32 vcc, v253, v249
  s_nop 1
  s_cmp_eq_u64 vcc, 0
  s_cbranch_scc1 q2_wd
  s_sub_u32 s3, s3, 1
  s_cmp_lg_u32 s3, 0
  s_cbranch_scc1 q2_wl
q2_wn:
  s_waitcnt vmcnt(0)
q2_wd:
  s_barrier
  buffer_load_dwordx4 a[0:3], v2, s[8:11], 0 offen offset:0 sc1
  buffer_load_dwordx4 a[4:7], v3, s[8:11], 0 offen offset:0 sc1
  buffer_load_dwordx4 a[8:11], v2, s[8:11], 0 offen offset:1024 sc1
  buffer_load_dwordx4 a[12:15], v3, s[8:11], 0 offen offset:1024 sc1
  buffer_load_dwordx4 a[16:19], v2, s[8:11], 0 offen offset:2048 sc1
  buffer_load_dwordx4 a[20:23], v3, s[8:11], 0 offen offset:2048 sc1
  buffer_load_dwordx4 a[24:27], v2, s[8:11], 0 offen offset:3072 sc1
  buffer_load_dwordx4 a[28:31], v3, s[8:11], 0 offen offset:3072 sc1
  buffer_load_dwordx4 a[32:35], v2, s[8:11], s33 offen offset:0 sc1
  buffer_load_dwordx4 a[36:39], v3, s[8:11], s33 offen offset:0 sc1
  buffer_load_dwordx4 v[176:179], v9, s[20:23], 0 offen offset:0 sc1
  buffer_load_dwordx4 v[240:243], v9, s[20:23], 0 offen offset:1024 sc1
  buffer_load_dwordx4 v[180:183], v9, s[20:23], 0 offen offset:2048 sc1
  buffer_load_dwordx4 v[244:247], v9, s[20:23], 0 offen offset:3072 sc1
  s_cmp_ge_u32 s17, 8
  s_cbranch_scc1 q2_v
  ds_read_b128 v[32:35], v1 offset:0
  ds_read_b128 v[36:39], v1 offset:1024
  ds_read_b128 v[40:43], v1 offset:2048
  ds_read_b128 v[44:47], v1 offset:3072
  ds_read_b128 v[48:51], v1 offset:4096
  ds_read_b128 v[52:55], v1 offset:5120
  ds_read_b128 v[56:59], v1 offset:6144
  ds_read_b128 v[60:63], v1 offset:7168
  ds_read_b128 v[64:67], v1 offset:8192
  s_waitcnt lgkmcnt(6)
  s_waitcnt vmcnt(12)
  v_mfma_f32_16x16x32_bf16 v[104:107], v[32:35], a[0:3], 0
  ds_read_b128 v[68:71], v1 offset:9216
  v_mfma_f32_16x16x32_bf16 v[108:111], v[36:39], a[0:3], 0
  buffer_load_dwordx4 a[40:43], v2, s[8:11], s33 offen offset:1024 sc1
  v_mfma_f32_16x16x32_bf16 v[112:115], v[40:43], a[0:3], 0
  s_waitcnt lgkmcnt(4)
  ds_read_b128 v[72:75], v1 offset:10240
  v_mfma_f32_16x16x32_bf16 v[116:119], v[44:47], a[0:3], 0
  buffer_load_dwordx4 a[44:47], v3, s[8:11], s33 offen offset:1024 sc1
  v_mfma_f32_16x16x32_bf16 v[120:123], v[48:51], a[0:3], 0
  ds_read_b128 v[76:79], v1 offset:11264
  v_mfma_f32_16x16x32_bf16 v[124:127], v[52:55], a[0:3], 0
  s_waitcnt lgkmcnt(3)
  v_mfma_f32_16x16x32_bf16 v[128:131], v[56:59], a[0:3], 0
  ds_read_b128 v[80:83], v1 offset:12288
  v_mfma_f32_16x16x32_bf16 v[132:135], v[60:63], a[0:3], 0
  s_add_u32 m0, s38, 110592
  s_nop 0
  buffer_load_dwordx4 v1, s[12:15], m0 offen sc1 lds
  v_mfma_f32_16x16x32_bf16 v[136:139], v[64:67], a[0:3], 0
  ds_read_b128 v[84:87], v1 offset:13312
  v_mfma_f32_16x16x32_bf16 v[172:175], v[64:67], a[4:7], 0
  s_add_u32 m0, s38, 114688
  s_nop 0
  buffer_load_dwordx4 v1, s[12:15], m0 offen sc1 lds
  v_mfma_f32_16x16x32_bf16 v[168:171], v[60:63], a[4:7], 0
  ds_read_b128 v[88:91], v1 offset:14336
  v_mfma_f32_16x16x32_bf16 v[164:167], v[56:59], a[4:7], 0
  v_mfma_f32_16x16x32_bf16 v[160:163], v[52:55], a[4:7], 0
  ds_read_b128 v[92:95], v1 offset:15360
  v_mfma_f32_16x16x32_bf16 v[156:159], v[48:51], a[4:7], 0
  s_add_u32 m0, s38, 118784
  s_nop 0
  buffer_load_dwordx4 v1, s[12:15], m0 offen sc1 lds
  v_mfma_f32_16x16x32_bf16 v[152:155], v[44:47], a[4:7], 0
  ds_read_b128 v[96:99], v1 offset:16384
  v_mfma_f32_16x16x32_bf16 v[148:151], v[40:43], a[4:7], 0
  v_mfma_f32_16x16x32_bf16 v[144:147], v[36:39], a[4:7], 0
  s_waitcnt vmcnt(15)
  ds_read_b128 v[100:103], v1 offset:17408
  v_mfma_f32_16x16x32_bf16 v[140:143], v[32:35], a[4:7], 0
  s_waitcnt lgkmcnt(6)
  v_mfma_f32_16x16x32_bf16 v[104:107], v[68:71], a[8:11], v[104:107]
  ds_read_b128 v[32:35], v1 offset:18432
  v_mfma_f32_16x16x32_bf16 v[108:111], v[72:75], a[8:11], v[108:111]
  buffer_load_dwordx4 a[48:51], v2, s[8:11], s33 offen offset:2048 sc1
  v_mfma_f32_16x16x32_bf16 v[112:115], v[76:79], a[8:11], v[112:115]
  s_waitcnt lgkmcnt(4)
  ds_read_b128 v[36:39], v1 offset:19456
  v_mfma_f32_16x16x32_bf16 v[116:119], v[80:83], a[8:11], v[116:119]
  buffer_load_dwordx4 a[52:55], v3, s[8:11], s33 offen offset:2048 sc1
  v_mfma_f32_16x16x32_bf16 v[120:123], v[84:87], a[8:11], v[120:123]
  ds_read_b128 v[40:43], v1 offset:20480
  v_mfma_f32_16x16x32_bf16 v[124:127], v[88:91], a[8:11], v[124:127]
  s_waitcnt lgkmcnt(3)
  v_mfma_f32_16x16x32_bf16 v[128:131], v[92:95], a[8:11], v[128:131]
  ds_read_b128 v[44:47], v1 offset:21504
  v_mfma_f32_16x16x32_bf16 v[132:135], v[96:99], a[8:11], v[132:135]
  s_add_u32 m0, s38, 122880
  s_nop 0
  buffer_load_dwordx4 v1, s[12:15], m0 offen sc1 lds
  v_mfma_f32_16x16x32_bf16 v[136:139], v[100:103], a[8:11], v[136:139]
  ds_read_b128 v[48:51], v1 offset:22528
  v_mfma_f32_16x16x32_bf16 v[172:175], v[100:103], a[12:15], v[172:175]
  s_add_u32 m0, s38, 126976
  s_nop 0
  buffer_load_dwordx4 v1, s[12:15], m0 offen sc1 lds
  v_mfma_f32_16x16x32_bf16 v[168:171], v[96:99], a[12:15], v[168:171]
  ds_read_b128 v[52:55], v1 offset:23552
  v_mfma_f32_16x16x32_bf16 v[164:167], v[92:95], a[12:15], v[164:167]
  v_mfma_f32_16x16x32_bf16 v[160:163], v[88:91], a[12:15], v[160:163]
  ds_read_b128 v[56:59], v1 offset:24576
  v_mfma_f32_16x16x32_bf16 v[156:159], v[84:87], a[12:15], v[156:159]
  s_add_u32 m0, s38, 131072
  s_nop 0
  buffer_load_dwordx4 v1, s[12:15], m0 offen sc1 lds
  v_mfma_f32_16x16x32_bf16 v[152:155], v[80:83], a[12:15], v[152:155]
  ds_read_b128 v[60:63], v1 offset:25600
  v_mfma_f32_16x16x32_bf16 v[148:151], v[76:79], a[12:15], v[148:151]
  v_mfma_f32_16x16x32_bf16 v[144:147], v[72:75], a[12:15], v[144:147]
  s_waitcnt vmcnt(18)
  ds_read_b128 v[64:67], v1 offset:26624
  v_mfma_f32_16x16x32_bf16 v[140:143], v[68:71], a[12:15], v[140:143]
  s_waitcnt lgkmcnt(6)
  v_mfma_f32_16x16x32_bf16 v[104:107], v[32:35], a[16:19], v[104:107]
  ds_read_b128 v[68:71], v1 offset:27648
  v_mfma_f32_16x16x32_bf16 v[108:111], v[36:39], a[16:19], v[108:111]
  buffer_load_dwordx4 a[56:59], v2, s[8:11], s33 offen offset:3072 sc1
  v_mfma_f32_16x16x32_bf16 v[112:115], v[40:43], a[16:19], v[112:115]
  s_waitcnt lgkmcnt(4)
  ds_read_b128 v[72:75], v1 offset:28672
  v_mfma_f32_16x16x32_bf16 v[116:119], v[44:47], a[16:19], v[116:119]
  buffer_load_dwordx4 a[60:63], v3, s[8:11], s33 offen offset:3072 sc1
  v_mfma_f32_16x16x32_bf16 v[120:123], v[48:51], a[16:19], v[120:123]
  ds_read_b128 v[76:79], v1 offset:29696
  v_mfma_f32_16x16x32_bf16 v[124:127], v[52:55], a[16:19], v[124:127]
  s_waitcnt lgkmcnt(3)
  v_mfma_f32_16x16x32_bf16 v[128:131], v[56:59], a[16:19], v[128:131]
  ds_read_b128 v[80:83], v1 offset:30720
  v_mfma_f32_16x16x32_bf16 v[132:135], v[60:63], a[16:19], v[132:135]
  s_add_u32 m0, s38, 135168
  s_nop 0
  buffer_load_dwordx4 v1, s[12:15], m0 offen sc1 lds
  v_mfma_f32_16x16x32_bf16 v[136:139], v[64:67], a[16:19], v[136:139]
  ds_read_b128 v[84:87], v1 offset:31744
  v_mfma_f32_16x16x32_bf16 v[172:175], v[64:67], a[20:23], v[172:175]
  s_add_u32 m0, s38, 139264
  s_nop 0
  buffer_load_dwordx4 v1, s[12:15], m0 offen sc1 lds
  v_mfma_f32_16x16x32_bf16 v[168:171], v[60:63], a[20:23], v[168:171]
  ds_read_b128 v[88:91], v1 offset:32768
  v_mfma_f32_16x16x32_bf16 v[164:167], v[56:59], a[20:23], v[164:167]
  v_mfma_f32_16x16x32_bf16 v[160:163], v[52:55], a[20:23], v[160:163]
  ds_read_b128 v[92:95], v1 offset:33792
  v_mfma_f32_16x16x32_bf16 v[156:159], v[48:51], a[20:23], v[156:159]
  s_add_u32 m0, s38, 143360
  s_nop 0
  buffer_load_dwordx4 v1, s[12:15], m0 offen sc1 lds
  v_mfma_f32_16x16x32_bf16 v[152:155], v[44:47], a[20:23], v[152:155]
  ds_read_b128 v[96:99], v1 offset:34816
  v_mfma_f32_16x16x32_bf16 v[148:151], v[40:43], a[20:23], v[148:151]
  v_mfma_f32_16x16x32_bf16 v[144:147], v[36:39], a[20:23], v[144:147]
  s_waitcnt vmcnt(21)
  ds_read_b128 v[100:103], v1 offset:35840
  v_mfma_f32_16x16x32_bf16 v[140:143], v[32:35], a[20:23], v[140:143]
  s_waitcnt lgkmcnt(6)
  v_mfma_f32_16x16x32_bf16 v[104:107], v[68:71], a[24:27], v[104:107]
  ds_read_b128 v[32:35], v1 offset:36864
  v_mfma_f32_16x16x32_bf16 v[108:111], v[72:75], a[24:27], v[108:111]
  buffer_load_dwordx4 a[64:67], v2, s[8:11], s34 offen offset:0 sc1
  v_mfma_f32_16x16x32_bf16 v[112:115], v[76:79], a[24:27], v[112:115]
  s_waitcnt lgkmcnt(4)
  ds_read_b128 v[36:39], v1 offset:37888
  v_mfma_f32_16x16x32_bf16 v[116:119], v[80:83], a[24:27], v[116:119]
  buffer_load_dwordx4 a[68:71], v3, s[8:11], s34 offen offset:0 sc1
  v_mfma_f32_16x16x32_bf16 v[120:123], v[84:87], a[24:27], v[120:123]
  ds_read_b128 v[40:43], v1 offset:38912
  v_mfma_f32_16x16x32_bf16 v[124:127], v[88:91], a[24:27], v[124:127]
  s_waitcnt lgkmcnt(3)
  v_mfma_f32_16x16x32_bf16 v[128:131], v[92:95], a[24:27], v[128:131]
  ds_read_b128 v[44:47], v1 offset:39936
  v_mfma_f32_16x16x32_bf16 v[132:135], v[96:99], a[24:27], v[132:135]
  s_add_u32 m0, s38, 147456
  s_nop 0
  buffer_load_dwordx4 v1, s[12:15], m0 offen sc1 lds
  v_mfma_f32_16x16x32_bf16 v[136:139], v[100:103], a[24:27], v[136:139]
  ds_read_b128 v[48:51], v1 offset:40960
  v_mfma_f32_16x16x32_bf16 v[172:175], v[100:103], a[28:31], v[172:175]
  s_add_u32 m0, s38, 151552
  s_nop 0
  buffer_load_dwordx4 v1, s[12:15], m0 offen sc1 lds
  v_mfma_f32_16x16x32_bf16 v[168:171], v[96:99], a[28:31], v[168:171]
  ds_read_b128 v[52:55], v1 offset:41984
  v_mfma_f32_16x16x32_bf16 v[164:167], v[92:95], a[28:31], v[164:167]
  v_mfma_f32_16x16x32_bf16 v[160:163], v[88:91], a[28:31], v[160:163]
  ds_read_b128 v[56:59], v1 offset:43008
  v_mfma_f32_16x16x32_bf16 v[156:159], v[84:87], a[28:31], v[156:159]
  s_add_u32 m0, s38, 155648
  s_nop 0
  buffer_load_dwordx4 v1, s[12:15], m0 offen sc1 lds
  v_mfma_f32_16x16x32_bf16 v[152:155], v[80:83], a[28:31], v[152:155]
  ds_read_b128 v[60:63], v1 offset:44032
  v_mfma_f32_16x16x32_bf16 v[148:151], v[76:79], a[28:31], v[148:151]
  v_mfma_f32_16x16x32_bf16 v[144:147], v[72:75], a[28:31], v[144:147]
  s_waitcnt vmcnt(24)
  ds_read_b128 v[64:67], v1 offset:45056
  v_mfma_f32_16x16x32_bf16 v[140:143], v[68:71], a[28:31], v[140:143]
  s_waitcnt lgkmcnt(6)
  v_mfma_f32_16x16x32_bf16 v[104:107], v[32:35], a[32:35], v[104:107]
  ds_read_b128 v[68:71], v1 offset:46080
  v_add_u32 v10, 160768, v10
  v_mfma_f32_16x16x32_bf16 v[108:111], v[36:39], a[32:35], v[108:111]
  buffer_load_dwordx4 a[72:75], v2, s[8:11], s34 offen offset:1024 sc1
  v_mfma_f32_16x16x32_bf16 v[112:115], v[40:43], a[32:35], v[112:115]
  s_waitcnt lgkmcnt(4)
  ds_read_b128 v[72:75], v1 offset:47104
  ds_write_b128 v10, v[184:187]
  v_mfma_f32_16x16x32_bf16 v[116:119], v[44:47], a[32:35], v[116:119]
  s_waitcnt vmcnt(21)
  v_add_f32 v176, v176, v240
  v_add_f32 v177, v177, v241
  v_mfma_f32_16x16x32_bf16 v[120:123], v[48:51], a[32:35], v[120:123]
  ds_read_b128 v[76:79], v1 offset:48128
  v_add_f32 v178, v178, v242
  v_mfma_f32_16x16x32_bf16 v[124:127], v[52:55], a[32:35], v[124:127]
  s_waitcnt lgkmcnt(4)
  v_add_f32 v179, v179, v243
  v_add_f32 v180, v180, v244
  v_mfma_f32_16x16x32_bf16 v[128:131], v[56:59], a[32:35], v[128:131]
  ds_read_b128 v[80:83], v1 offset:49152
  v_add_f32 v181, v181, v245
  v_mfma_f32_16x16x32_bf16 v[132:135], v[60:63], a[32:35], v[132:135]
  v_add_f32 v182, v182, v246
  v_add_f32 v183, v183, v247
  v_mfma_f32_16x16x32_bf16 v[136:139], v[64:67], a[32:35], v[136:139]
  ds_read_b128 v[84:87], v1 offset:50176
  v_add_f32 v176, v176, v178
  v_mfma_f32_16x16x32_bf16 v[172:175], v[64:67], a[36:39], v[172:175]
  buffer_load_dwordx4 a[76:79], v3, s[8:11], s34 offen offset:1024 sc1
  v_mfma_f32_16x16x32_bf16 v[168:171], v[60:63], a[36:39], v[168:171]
  ds_read_b128 v[88:91], v1 offset:51200
  v_add_f32 v177, v177, v179
  v_mfma_f32_16x16x32_bf16 v[164:167], v[56:59], a[36:39], v[164:167]
  v_add_f32 v180, v180, v182
  v_add_f32 v181, v181, v183
  v_mfma_f32_16x16x32_bf16 v[160:163], v[52:55], a[36:39], v[160:163]
  ds_read_b128 v[92:95], v1 offset:52224
  v_mov_b32 v178, v176
  v_mfma_f32_16x16x32_bf16 v[156:159], v[48:51], a[36:39], v[156:159]
  v_mov_b32 v179, v177
  v_mov_b32 v182, v180
  v_mfma_f32_16x16x32_bf16 v[152:155], v[44:47], a[36:39], v[152:155]
  ds_read_b128 v[96:99], v1 offset:53248
  v_mov_b32 v183, v181
  v_mfma_f32_16x16x32_bf16 v[148:151], v[40:43], a[36:39], v[148:151]
  v_permlane16_swap_b32 v176, v178
  v_mfma_f32_16x16x32_bf16 v[144:147], v[36:39], a[36:39], v[144:147]
  s_waitcnt vmcnt(20)
  ds_read_b128 v[100:103], v1 offset:54272
  v_add_f32 v176, v176, v178
  v_mfma_f32_16x16x32_bf16 v[140:143], v[32:35], a[36:39], v[140:143]
  s_waitcnt lgkmcnt(6)
  v_permlane16_swap_b32 v177, v179
  v_mfma_f32_16x16x32_bf16 v[104:107], v[68:71], a[40:43], v[104:107]
  ds_read_b128 v[32:35], v1 offset:55296
  v_add_f32 v177, v177, v179
  v_mfma_f32_16x16x32_bf16 v[108:111], v[72:75], a[40:43], v[108:111]
  buffer_load_dwordx4 a[80:83], v2, s[8:11], s34 offen offset:2048 sc1
  v_mfma_f32_16x16x32_bf16 v[112:115], v[76:79], a[40:43], v[112:115]
  s_waitcnt lgkmcnt(4)
  ds_read_b128 v[36:39], v1 offset:56320
  v_mov_b32 v178, v176
  v_mfma_f32_16x16x32_bf16 v[116:119], v[80:83], a[40:43], v[116:119]
  v_permlane16_swap_b32 v180, v182
  v_mfma_f32_16x16x32_bf16 v[120:123], v[84:87], a[40:43], v[120:123]
  ds_read_b128 v[40:43], v1 offset:57344
  v_add_f32 v180, v180, v182
  v_mfma_f32_16x16x32_bf16 v[124:127], v[88:91], a[40:43], v[124:127]
  s_waitcnt lgkmcnt(3)
  v_permlane16_swap_b32 v181, v183
  v_mfma_f32_16x16x32_bf16 v[128:131], v[92:95], a[40:43], v[128:131]
  ds_read_b128 v[44:47], v1 offset:58368
  v_add_f32 v181, v181, v183
  v_mfma_f32_16x16x32_bf16 v[132:135], v[96:99], a[40:43], v[132:135]
  v_mov_b32 v179, v177
  v_mov_b32 v182, v180
  v_mfma_f32_16x16x32_bf16 v[136:139], v[100:103], a[40:43], v[136:139]
  ds_read_b128 v[48:51], v1 offset:59392
  v_mov_b32 v183, v181
  v_mfma_f32_16x16x32_bf16 v[172:175], v[100:103], a[44:47], v[172:175]
  buffer_load_dwordx4 a[84:87], v3, s[8:11], s34 offen offset:2048 sc1
  v_mfma_f32_16x16x32_bf16 v[168:171], v[96:99], a[44:47], v[168:171]
  ds_read_b128 v[52:55], v1 offset:60416
  v_mfma_f32_16x16x32_bf16 v[164:167], v[92:95], a[44:47], v[164:167]
  v_permlane32_swap_b32 v176, v178
  v_mfma_f32_16x16x32_bf16 v[160:163], v[88:91], a[44:47], v[160:163]
  ds_read_b128 v[56:59], v1 offset:61440
  v_add_f32 v176, v176, v178
  v_mfma_f32_16x16x32_bf16 v[156:159], v[84:87], a[44:47], v[156:159]
  v_permlane32_swap_b32 v177, v179
  v_mfma_f32_16x16x32_bf16 v[152:155], v[80:83], a[44:47], v[152:155]
  ds_read_b128 v[60:63], v1 offset:62464
  v_add_f32 v177, v177, v179
  v_mfma_f32_16x16x32_bf16 v[148:151], v[76:79], a[44:47], v[148:151]
  v_permlane32_swap_b32 v180, v182
  v_mfma_f32_16x16x32_bf16 v[144:147], v[72:75], a[44:47], v[144:147]
  s_waitcnt vmcnt(17)
  ds_read_b128 v[64:67], v1 offset:63488
  v_add_f32 v180, v180, v182
  v_mfma_f32_16x16x32_bf16 v[140:143], v[68:71], a[44:47], v[140:143]
  s_waitcnt lgkmcnt(6)
  v_permlane32_swap_b32 v181, v183
  v_mfma_f32_16x16x32_bf16 v[104:107], v[32:35], a[48:51], v[104:107]
  ds_read_b128 v[68:71], v1 offset:64512
  v_add_f32 v181, v181, v183
  v_mfma_f32_16x16x32_bf16 v[108:111], v[36:39], a[48:51], v[108:111]
  buffer_load_dwordx4 a[88:91], v2, s[8:11], s34 offen offset:3072 sc1
  v_mfma_f32_16x16x32_bf16 v[112:115], v[40:43], a[48:51], v[112:115]
  s_waitcnt lgkmcnt(4)
  ds_read_b128 v[72:75], v16 offset:0
  v_mul_f32 v176, 0x3ae38e39, v176
  v_mfma_f32_16x16x32_bf16 v[116:119], v[44:47], a[48:51], v[116:119]
  v_mul_f32 v177, 0x3ae38e39, v177
  v_fma_f32 v177, -v176, v176, v177
  v_mfma_f32_16x16x32_bf16 v[120:123], v[48:51], a[48:51], v[120:123]
  ds_read_b128 v[76:79], v16 offset:1024
  v_max_f32 v177, 0, v177
  v_mfma_f32_16x16x32_bf16 v[124:127], v[52:55], a[48:51], v[124:127]
  s_waitcnt lgkmcnt(3)
  v_add_f32 v177, 0x3727c5ac, v177
  v_mul_f32 v180, 0x3ae38e39, v180
  v_mfma_f32_16x16x32_bf16 v[128:131], v[56:59], a[48:51], v[128:131]
  ds_read_b128 v[80:83], v16 offset:2048
  v_mul_f32 v181, 0x3ae38e39, v181
  v_mfma_f32_16x16x32_bf16 v[132:135], v[60:63], a[48:51], v[132:135]
  v_fma_f32 v181, -v180, v180, v181
  v_max_f32 v181, 0, v181
  v_mfma_f32_16x16x32_bf16 v[136:139], v[64:67], a[48:51], v[136:139]
  ds_read_b128 v[84:87], v16 offset:3072
  v_add_f32 v181, 0x3727c5ac, v181
  v_mfma_f32_16x16x32_bf16 v[172:175], v[64:67], a[52:55], v[172:175]
  buffer_load_dwordx4 a[92:95], v3, s[8:11], s34 offen offset:3072 sc1
  v_mfma_f32_16x16x32_bf16 v[168:171], v[60:63], a[52:55], v[168:171]
  ds_read_b128 v[88:91], v16 offset:4096
  v_sub_f32 v12, 0, v176
  v_mfma_f32_16x16x32_bf16 v[164:167], v[56:59], a[52:55], v[164:167]
  v_rsq_f32 v13, v177
  v_mfma_f32_16x16x32_bf16 v[160:163], v[52:55], a[52:55], v[160:163]
  ds_read_b128 v[92:95], v16 offset:5120
  v_sub_f32 v14, 0, v180
  v_mfma_f32_16x16x32_bf16 v[156:159], v[48:51], a[52:55], v[156:159]
  v_rsq_f32 v15, v181
  v_mfma_f32_16x16x32_bf16 v[152:155], v[44:47], a[52:55], v[152:155]
  ds_read_b128 v[96:99], v16 offset:6144
  v_mul_f32 v13, s46, v13
  v_mfma_f32_16x16x32_bf16 v[148:151], v[40:43], a[52:55], v[148:151]
  v_mul_f32 v15, s46, v15
  v_lshlrev_b32 v10, 4, v8
  v_mfma_f32_16x16x32_bf16 v[144:147], v[36:39], a[52:55], v[144:147]
  s_waitcnt vmcnt(14)
  ds_read_b128 v[100:103], v16 offset:7168
  v_and_b32 v18, 1, v8
  v_mfma_f32_16x16x32_bf16 v[140:143], v[32:35], a[52:55], v[140:143]
  s_waitcnt lgkmcnt(6)
  v_lshlrev_b32 v18, 9, v18
  v_lshrrev_b32 v19, 1, v8
  v_mfma_f32_16x16x32_bf16 v[104:107], v[68:71], a[56:59], v[104:107]
  ds_read_b128 v[32:35], v16 offset:8192
  v_lshl_add_u32 v18, v19, 8, v18
  v_mfma_f32_16x16x32_bf16 v[108:111], v[72:75], a[56:59], v[108:111]
  buffer_load_dwordx4 a[96:99], v2, s[8:11], s35 offen offset:0 sc1
  v_mfma_f32_16x16x32_bf16 v[112:115], v[76:79], a[56:59], v[112:115]
  s_waitcnt lgkmcnt(4)
  ds_read_b128 v[36:39], v16 offset:9216
  v_lshl_add_u32 v18, v7, 4, v18
  v_mfma_f32_16x16x32_bf16 v[116:119], v[80:83], a[56:59], v[116:119]
  buffer_load_dwordx4 a[100:103], v3, s[8:11], s35 offen offset:0 sc1
  v_mfma_f32_16x16x32_bf16 v[120:123], v[84:87], a[56:59], v[120:123]
  ds_read_b128 v[40:43], v16 offset:10240
  v_add_u32 v18, s48, v18
  v_mfma_f32_16x16x32_bf16 v[124:127], v[88:91], a[56:59], v[124:127]
  s_waitcnt lgkmcnt(3)
  v_add_u32 v10, 160768, v10
  v_mfma_f32_16x16x32_bf16 v[128:131], v[92:95], a[56:59], v[128:131]
  ds_read_b128 v[44:47], v16 offset:11264
  v_mfma_f32_16x16x32_bf16 v[132:135], v[96:99], a[56:59], v[132:135]
  buffer_load_dwordx4 a[144:147], v6, s[12:15], 0 offen offset:0 sc1
  v_mfma_f32_16x16x32_bf16 v[136:139], v[100:103], a[56:59], v[136:139]
  ds_read_b128 v[48:51], v16 offset:12288
  v_mfma_f32_16x16x32_bf16 v[172:175], v[100:103], a[60:63], v[172:175]
  buffer_load_dwordx4 a[148:151], v6, s[12:15], 0 offen offset:1024 sc1
  v_mfma_f32_16x16x32_bf16 v[168:171], v[96:99], a[60:63], v[168:171]
  ds_read_b128 v[52:55], v16 offset:13312
  v_mfma_f32_16x16x32_bf16 v[164:167], v[92:95], a[60:63], v[164:167]
  v_mfma_f32_16x16x32_bf16 v[160:163], v[88:91], a[60:63], v[160:163]
  ds_read_b128 v[56:59], v16 offset:14336
  v_mfma_f32_16x16x32_bf16 v[156:159], v[84:87], a[60:63], v[156:159]
  buffer_load_dwordx4 a[152:155], v6, s[12:15], 0 offen offset:2048 sc1
  v_mfma_f32_16x16x32_bf16 v[152:155], v[80:83], a[60:63], v[152:155]
  ds_read_b128 v[60:63], v16 offset:15360
  v_mfma_f32_16x16x32_bf16 v[148:151], v[76:79], a[60:63], v[148:151]
  v_mfma_f32_16x16x32_bf16 v[144:147], v[72:75], a[60:63], v[144:147]
  s_waitcnt vmcnt(14)
  ds_read_b128 v[64:67], v16 offset:16384
  v_mfma_f32_16x16x32_bf16 v[140:143], v[68:71], a[60:63], v[140:143]
  s_waitcnt lgkmcnt(6)
  v_mfma_f32_16x16x32_bf16 v[104:107], v[32:35], a[64:67], v[104:107]
  ds_read_b128 v[68:71], v16 offset:17408
  v_mfma_f32_16x16x32_bf16 v[108:111], v[36:39], a[64:67], v[108:111]
  buffer_load_dwordx4 a[104:107], v2, s[8:11], s35 offen offset:1024 sc1
  v_mfma_f32_16x16x32_bf16 v[112:115], v[40:43], a[64:67], v[112:115]
  s_waitcnt lgkmcnt(4)
  ds_read_b128 v[72:75], v16 offset:18432
  v_mfma_f32_16x16x32_bf16 v[116:119], v[44:47], a[64:67], v[116:119]
  buffer_load_dwordx4 a[108:111], v3, s[8:11], s35 offen offset:1024 sc1
  v_mfma_f32_16x16x32_bf16 v[120:123], v[48:51], a[64:67], v[120:123]
  ds_read_b128 v[76:79], v16 offset:19456
  v_mfma_f32_16x16x32_bf16 v[124:127], v[52:55], a[64:67], v[124:127]
  s_waitcnt lgkmcnt(3)
  v_mfma_f32_16x16x32_bf16 v[128:131], v[56:59], a[64:67], v[128:131]
  ds_read_b128 v[80:83], v16 offset:20480
  v_mfma_f32_16x16x32_bf16 v[132:135], v[60:63], a[64:67], v[132:135]
  buffer_load_dwordx4 a[156:159], v6, s[12:15], 0 offen offset:3072 sc1
  v_mfma_f32_16x16x32_bf16 v[136:139], v[64:67], a[64:67], v[136:139]
  ds_read_b128 v[84:87], v16 offset:21504
  v_mfma_f32_16x16x32_bf16 v[172:175], v[64:67], a[68:71], v[172:175]
  buffer_load_dwordx4 a[160:163], v6, s[12:15], s33 offen offset:0 sc1
  v_mfma_f32_16x16x32_bf16 v[168:171], v[60:63], a[68:71], v[168:171]
  ds_read_b128 v[88:91], v16 offset:22528
  v_mfma_f32_16x16x32_bf16 v[164:167], v[56:59], a[68:71], v[164:167]
  v_mfma_f32_16x16x32_bf16 v[160:163], v[52:55], a[68:71], v[160:163]
  ds_read_b128 v[92:95], v16 offset:23552
  v_mfma_f32_16x16x32_bf16 v[156:159], v[48:51], a[68:71], v[156:159]
  buffer_load_dwordx4 a[164:167], v6, s[12:15], s33 offen offset:1024 sc1
  v_mfma_f32_16x16x32_bf16 v[152:155], v[44:47], a[68:71], v[152:155]
  ds_read_b128 v[96:99], v16 offset:24576
  v_mfma_f32_16x16x32_bf16 v[148:151], v[40:43], a[68:71], v[148:151]
  v_mfma_f32_16x16x32_bf16 v[144:147], v[36:39], a[68:71], v[144:147]
  s_waitcnt vmcnt(14)
  ds_read_b128 v[100:103], v16 offset:25600
  v_mfma_f32_16x16x32_bf16 v[140:143], v[32:35], a[68:71], v[140:143]
  s_waitcnt lgkmcnt(6)
  v_mfma_f32_16x16x32_bf16 v[104:107], v[68:71], a[72:75], v[104:107]
  ds_read_b128 v[32:35], v16 offset:26624
  ds_read_b128 v[196:199], v10 offset:0
  v_mfma_f32_16x16x32_bf16 v[108:111], v[72:75], a[72:75], v[108:111]
  buffer_load_dwordx4 a[112:115], v2, s[8:11], s35 offen offset:2048 sc1
  v_mfma_f32_16x16x32_bf16 v[112:115], v[76:79], a[72:75], v[112:115]
  s_waitcnt lgkmcnt(5)
  ds_read_b128 v[36:39], v16 offset:27648
  v_mfma_f32_16x16x32_bf16 v[116:119], v[80:83], a[72:75], v[116:119]
  buffer_load_dwordx4 a[116:119], v3, s[8:11], s35 offen offset:2048 sc1
  v_mfma_f32_16x16x32_bf16 v[120:123], v[84:87], a[72:75], v[120:123]
  ds_read_b128 v[40:43], v16 offset:28672
  v_mfma_f32_16x16x32_bf16 v[124:127], v[88:91], a[72:75], v[124:127]
  s_waitcnt lgkmcnt(4)
  v_mfma_f32_16x16x32_bf16 v[128:131], v[92:95], a[72:75], v[128:131]
  ds_read_b128 v[44:47], v16 offset:29696
  v_mfma_f32_16x16x32_bf16 v[132:135], v[96:99], a[72:75], v[132:135]
  buffer_load_dwordx4 a[168:171], v6, s[12:15], s33 offen offset:2048 sc1
  v_mfma_f32_16x16x32_bf16 v[136:139], v[100:103], a[72:75], v[136:139]
  ds_read_b128 v[48:51], v16 offset:30720
  ds_read_b128 v[200:203], v10 offset:64
  v_mfma_f32_16x16x32_bf16 v[172:175], v[100:103], a[76:79], v[172:175]
  buffer_load_dwordx4 a[172:175], v6, s[12:15], s33 offen offset:3072 sc1
  v_mfma_f32_16x16x32_bf16 v[168:171], v[96:99], a[76:79], v[168:171]
  ds_read_b128 v[52:55], v16 offset:31744
  v_mfma_f32_16x16x32_bf16 v[164:167], v[92:95], a[76:79], v[164:167]
  v_mfma_f32_16x16x32_bf16 v[160:163], v[88:91], a[76:79], v[160:163]
  ds_read_b128 v[56:59], v16 offset:32768
  v_mfma_f32_16x16x32_bf16 v[156:159], v[84:87], a[76:79], v[156:159]
  buffer_load_dwordx4 a[176:179], v6, s[12:15], s34 offen offset:0 sc1
  v_mfma_f32_16x16x32_bf16 v[152:155], v[80:83], a[76:79], v[152:155]
  ds_read_b128 v[60:63], v16 offset:33792
  v_mfma_f32_16x16x32_bf16 v[148:151], v[76:79], a[76:79], v[148:151]
  v_mfma_f32_16x16x32_bf16 v[144:147], v[72:75], a[76:79], v[144:147]
  s_waitcnt vmcnt(17)
  ds_read_b128 v[64:67], v16 offset:34816
  ds_read_b128 v[204:207], v10 offset:128
  v_mfma_f32_16x16x32_bf16 v[140:143], v[68:71], a[76:79], v[140:143]
  s_waitcnt lgkmcnt(8)
  v_mfma_f32_16x16x32_bf16 v[104:107], v[32:35], a[80:83], v[104:107]
  ds_read_b128 v[68:71], v16 offset:35840
  v_mfma_f32_16x16x32_bf16 v[108:111], v[36:39], a[80:83], v[108:111]
  buffer_load_dwordx4 a[120:123], v2, s[8:11], s35 offen offset:3072 sc1
  v_mfma_f32_16x16x32_bf16 v[112:115], v[40:43], a[80:83], v[112:115]
  s_waitcnt lgkmcnt(5)
  ds_read_b128 v[72:75], v16 offset:36864
  v_mfma_f32_16x16x32_bf16 v[116:119], v[44:47], a[80:83], v[116:119]
  v_mfma_f32_16x16x32_bf16 v[120:123], v[48:51], a[80:83], v[120:123]
  ds_read_b128 v[76:79], v16 offset:37888
  v_mfma_f32_16x16x32_bf16 v[124:127], v[52:55], a[80:83], v[124:127]
  s_waitcnt lgkmcnt(4)
  v_mfma_f32_16x16x32_bf16 v[128:131], v[56:59], a[80:83], v[128:131]
  ds_read_b128 v[80:83], v16 offset:38912
  ds_read_b128 v[208:211], v10 offset:192
  v_mfma_f32_16x16x32_bf16 v[132:135], v[60:63], a[80:83], v[132:135]
  v_mfma_f32_16x16x32_bf16 v[136:139], v[64:67], a[80:83], v[136:139]
  ds_read_b128 v[84:87], v16 offset:39936
  v_mfma_f32_16x16x32_bf16 v[172:175], v[64:67], a[84:87], v[172:175]
  buffer_load_dwordx4 a[124:127], v3, s[8:11], s35 offen offset:3072 sc1
  v_mfma_f32_16x16x32_bf16 v[168:171], v[60:63], a[84:87], v[168:171]
  ds_read_b128 v[88:91], v16 offset:40960
  v_mfma_f32_16x16x32_bf16 v[164:167], v[56:59], a[84:87], v[164:167]
  v_mfma_f32_16x16x32_bf16 v[160:163], v[52:55], a[84:87], v[160:163]
  ds_read_b128 v[92:95], v16 offset:41984
  v_mfma_f32_16x16x32_bf16 v[156:159], v[48:51], a[84:87], v[156:159]
  v_mfma_f32_16x16x32_bf16 v[152:155], v[44:47], a[84:87], v[152:155]
  s_waitcnt vmcnt(23)
  ds_read_b128 v[96:99], v16 offset:43008
  ds_read_b128 v[212:215], v10 offset:256
  v_mfma_f32_16x16x32_bf16 v[148:151], v[40:43], a[84:87], v[148:151]
  s_barrier
  v_mfma_f32_16x16x32_bf16 v[144:147], v[36:39], a[84:87], v[144:147]
  s_waitcnt vmcnt(17)
  ds_read_b128 v[100:103], v16 offset:44032
  v_mfma_f32_16x16x32_bf16 v[140:143], v[32:35], a[84:87], v[140:143]
  s_waitcnt lgkmcnt(8)
  v_mfma_f32_16x16x32_bf16 v[104:107], v[68:71], a[88:91], v[104:107]
  ds_read_b128 v[32:35], v16 offset:45056
  v_mfma_f32_16x16x32_bf16 v[108:111], v[72:75], a[88:91], v[108:111]
  buffer_load_dwordx4 a[128:131], v2, s[8:11], s36 offen offset:0 sc1
  v_mfma_f32_16x16x32_bf16 v[112:115], v[76:79], a[88:91], v[112:115]
  s_waitcnt lgkmcnt(5)
  ds_read_b128 v[36:39], v16 offset:46080
  v_mfma_f32_16x16x32_bf16 v[116:119], v[80:83], a[88:91], v[116:119]
  v_mfma_f32_16x16x32_bf16 v[120:123], v[84:87], a[88:91], v[120:123]
  ds_read_b128 v[40:43], v16 offset:47104
  ds_read_b128 v[216:219], v10 offset:320
  v_mfma_f32_16x16x32_bf16 v[124:127], v[88:91], a[88:91], v[124:127]
  s_waitcnt lgkmcnt(4)
  v_mfma_f32_16x16x32_bf16 v[128:131], v[92:95], a[88:91], v[128:131]
  ds_read_b128 v[44:47], v16 offset:48128
  v_mfma_f32_16x16x32_bf16 v[132:135], v[96:99], a[88:91], v[132:135]
  v_mfma_f32_16x16x32_bf16 v[136:139], v[100:103], a[88:91], v[136:139]
  ds_read_b128 v[48:51], v16 offset:49152
  v_mfma_f32_16x16x32_bf16 v[172:175], v[100:103], a[92:95], v[172:175]
  buffer_load_dwordx4 a[132:135], v3, s[8:11], s36 offen offset:0 sc1
  v_mfma_f32_16x16x32_bf16 v[168:171], v[96:99], a[92:95], v[168:171]
  ds_read_b128 v[52:55], v16 offset:50176
  v_mfma_f32_16x16x32_bf16 v[164:167], v[92:95], a[92:95], v[164:167]
  v_mfma_f32_16x16x32_bf16 v[160:163], v[88:91], a[92:95], v[160:163]
  ds_read_b128 v[56:59], v16 offset:51200
  ds_read_b128 v[220:223], v10 offset:384
  v_mfma_f32_16x16x32_bf16 v[156:159], v[84:87], a[92:95], v[156:159]
  v_mfma_f32_16x16x32_bf16 v[152:155], v[80:83], a[92:95], v[152:155]
  ds_read_b128 v[60:63], v16 offset:52224
  v_mfma_f32_16x16x32_bf16 v[148:151], v[76:79], a[92:95], v[148:151]
  v_mfma_f32_16x16x32_bf16 v[144:147], v[72:75], a[92:95], v[144:147]
  s_waitcnt vmcnt(17)
  ds_read_b128 v[64:67], v16 offset:53248
  v_mfma_f32_16x16x32_bf16 v[140:143], v[68:71], a[92:95], v[140:143]
  s_waitcnt lgkmcnt(8)
  v_mfma_f32_16x16x32_bf16 v[104:107], v[32:35], a[96:99], v[104:107]
  ds_read_b128 v[68:71], v16 offset:54272
  v_mfma_f32_16x16x32_bf16 v[108:111], v[36:39], a[96:99], v[108:111]
  buffer_load_dwordx4 a[136:139], v2, s[8:11], s36 offen offset:1024 sc1
  v_mfma_f32_16x16x32_bf16 v[112:115], v[40:43], a[96:99], v[112:115]
  s_waitcnt lgkmcnt(5)
  ds_read_b128 v[72:75], v16 offset:55296
  ds_read_b128 v[224:227], v10 offset:448
  v_mfma_f32_16x16x32_bf16 v[116:119], v[44:47], a[96:99], v[116:119]
  v_mfma_f32_16x16x32_bf16 v[120:123], v[48:51], a[96:99], v[120:123]
  ds_read_b128 v[76:79], v16 offset:56320
  v_mfma_f32_16x16x32_bf16 v[124:127], v[52:55], a[96:99], v[124:127]
  s_waitcnt lgkmcnt(4)
  v_mfma_f32_16x16x32_bf16 v[128:131], v[56:59], a[96:99], v[128:131]
  ds_read_b128 v[80:83], v16 offset:57344
  v_mfma_f32_16x16x32_bf16 v[132:135], v[60:63], a[96:99], v[132:135]
  v_mfma_f32_16x16x32_bf16 v[136:139], v[64:67], a[96:99], v[136:139]
  ds_read_b128 v[84:87], v16 offset:58368
  v_mfma_f32_16x16x32_bf16 v[172:175], v[64:67], a[100:103], v[172:175]
  buffer_load_dwordx4 a[140:143], v3, s[8:11], s36 offen offset:1024 sc1
  v_mfma_f32_16x16x32_bf16 v[168:171], v[60:63], a[100:103], v[168:171]
  ds_read_b128 v[88:91], v16 offset:59392
  ds_read_b128 v[228:231], v10 offset:512
  v_mfma_f32_16x16x32_bf16 v[164:167], v[56:59], a[100:103], v[164:167]
  v_mfma_f32_16x16x32_bf16 v[160:163], v[52:55], a[100:103], v[160:163]
  ds_read_b128 v[92:95], v16 offset:60416
  v_mfma_f32_16x16x32_bf16 v[156:159], v[48:51], a[100:103], v[156:159]
  v_mfma_f32_16x16x32_bf16 v[152:155], v[44:47], a[100:103], v[152:155]
  ds_read_b128 v[96:99], v16 offset:61440
  v_mfma_f32_16x16x32_bf16 v[148:151], v[40:43], a[100:103], v[148:151]
  v_mfma_f32_16x16x32_bf16 v[144:147], v[36:39], a[100:103], v[144:147]
  s_waitcnt vmcnt(14)
  ds_read_b128 v[100:103], v16 offset:62464
  v_mfma_f32_16x16x32_bf16 v[140:143], v[32:35], a[100:103], v[140:143]
  s_waitcnt lgkmcnt(7)
  v_mfma_f32_16x16x32_bf16 v[104:107], v[68:71], a[104:107], v[104:107]
  ds_read_b128 v[32:35], v16 offset:63488
  v_mfma_f32_16x16x32_bf16 v[108:111], v[72:75], a[104:107], v[108:111]
  v_mfma_f32_16x16x32_bf16 v[112:115], v[76:79], a[104:107], v[112:115]
  s_waitcnt lgkmcnt(5)
  ds_read_b128 v[36:39], v16 offset:64512
  v_mfma_f32_16x16x32_bf16 v[116:119], v[80:83], a[104:107], v[116:119]
  v_mfma_f32_16x16x32_bf16 v[120:123], v[84:87], a[104:107], v[120:123]
  ds_read_b128 v[40:43], v17 offset:0
  v_mfma_f32_16x16x32_bf16 v[124:127], v[88:91], a[104:107], v[124:127]
  s_waitcnt lgkmcnt(3)
  v_mfma_f32_16x16x32_bf16 v[128:131], v[92:95], a[104:107], v[128:131]
  ds_read_b128 v[44:47], v17 offset:1024
  v_mfma_f32_16x16x32_bf16 v[132:135], v[96:99], a[104:107], v[132:135]
  v_mfma_f32_16x16x32_bf16 v[136:139], v[100:103], a[104:107], v[136:139]
  ds_read_b128 v[48:51], v17 offset:2048
  v_mfma_f32_16x16x32_bf16 v[172:175], v[100:103], a[108:111], v[172:175]
  v_mfma_f32_16x16x32_bf16 v[168:171], v[96:99], a[108:111], v[168:171]
  ds_read_b128 v[52:55], v17 offset:3072
  v_mfma_f32_16x16x32_bf16 v[164:167], v[92:95], a[108:111], v[164:167]
  v_mfma_f32_16x16x32_bf16 v[160:163], v[88:91], a[108:111], v[160:163]
  ds_read_b128 v[56:59], v17 offset:4096
  v_mfma_f32_16x16x32_bf16 v[156:159], v[84:87], a[108:111], v[156:159]
  v_mfma_f32_16x16x32_bf16 v[152:155], v[80:83], a[108:111], v[152:155]
  ds_read_b128 v[60:63], v17 offset:5120
  v_mfma_f32_16x16x32_bf16 v[148:151], v[76:79], a[108:111], v[148:151]
  v_mfma_f32_16x16x32_bf16 v[144:147], v[72:75], a[108:111], v[144:147]
  s_waitcnt vmcnt(9)
  ds_read_b128 v[64:67], v17 offset:6144
  v_mfma_f32_16x16x32_bf16 v[140:143], v[68:71], a[108:111], v[140:143]
  s_waitcnt lgkmcnt(6)
  v_mfma_f32_16x16x32_bf16 v[104:107], v[32:35], a[112:115], v[104:107]
  ds_read_b128 v[68:71], v17 offset:7168
  v_mfma_f32_16x16x32_bf16 v[108:111], v[36:39], a[112:115], v[108:111]
  v_mfma_f32_16x16x32_bf16 v[112:115], v[40:43], a[112:115], v[112:115]
  s_waitcnt lgkmcnt(4)
  ds_read_b128 v[72:75], v17 offset:8192
  v_mfma_f32_16x16x32_bf16 v[116:119], v[44:47], a[112:115], v[116:119]
  v_mfma_f32_16x16x32_bf16 v[120:123], v[48:51], a[112:115], v[120:123]
  ds_read_b128 v[76:79], v17 offset:9216
  v_mfma_f32_16x16x32_bf16 v[124:127], v[52:55], a[112:115], v[124:127]
  s_waitcnt lgkmcnt(3)
  v_mfma_f32_16x16x32_bf16 v[128:131], v[56:59], a[112:115], v[128:131]
  ds_read_b128 v[80:83], v17 offset:10240
  v_mfma_f32_16x16x32_bf16 v[132:135], v[60:63], a[112:115], v[132:135]
  v_mfma_f32_16x16x32_bf16 v[136:139], v[64:67], a[112:115], v[136:139]
  ds_read_b128 v[84:87], v17 offset:11264
  v_mfma_f32_16x16x32_bf16 v[172:175], v[64:67], a[116:119], v[172:175]
  v_mfma_f32_16x16x32_bf16 v[168:171], v[60:63], a[116:119], v[168:171]
  ds_read_b128 v[88:91], v17 offset:12288
  v_mfma_f32_16x16x32_bf16 v[164:167], v[56:59], a[116:119], v[164:167]
  v_mfma_f32_16x16x32_bf16 v[160:163], v[52:55], a[116:119], v[160:163]
  ds_read_b128 v[92:95], v17 offset:13312
  v_mfma_f32_16x16x32_bf16 v[156:159], v[48:51], a[116:119], v[156:159]
  v_mfma_f32_16x16x32_bf16 v[152:155], v[44:47], a[116:119], v[152:155]
  ds_read_b128 v[96:99], v17 offset:14336
  v_mfma_f32_16x16x32_bf16 v[148:151], v[40:43], a[116:119], v[148:151]
  v_mfma_f32_16x16x32_bf16 v[144:147], v[36:39], a[116:119], v[144:147]
  s_waitcnt vmcnt(4)
  ds_read_b128 v[100:103], v17 offset:15360
  v_mfma_f32_16x16x32_bf16 v[140:143], v[32:35], a[116:119], v[140:143]
  s_waitcnt lgkmcnt(6)
  v_mfma_f32_16x16x32_bf16 v[104:107], v[68:71], a[120:123], v[104:107]
  ds_read_b128 v[32:35], v17 offset:16384
  v_mfma_f32_16x16x32_bf16 v[108:111], v[72:75], a[120:123], v[108:111]
  v_mfma_f32_16x16x32_bf16 v[112:115], v[76:79], a[120:123], v[112:115]
  s_waitcnt lgkmcnt(4)
  ds_read_b128 v[36:39], v17 offset:17408
  v_mfma_f32_16x16x32_bf16 v[116:119], v[80:83], a[120:123], v[116:119]
  v_mfma_f32_16x16x32_bf16 v[120:123], v[84:87], a[120:123], v[120:123]
  ds_read_b128 v[40:43], v17 offset:18432
  v_mfma_f32_16x16x32_bf16 v[124:127], v[88:91], a[120:123], v[124:127]
  s_waitcnt lgkmcnt(3)
  v_mfma_f32_16x16x32_bf16 v[128:131], v[92:95], a[120:123], v[128:131]
  ds_read_b128 v[44:47], v17 offset:19456
  v_mfma_f32_16x16x32_bf16 v[132:135], v[96:99], a[120:123], v[132:135]
  v_mfma_f32_16x16x32_bf16 v[136:139], v[100:103], a[120:123], v[136:139]
  ds_read_b128 v[48:51], v17 offset:20480
  v_mfma_f32_16x16x32_bf16 v[172:175], v[100:103], a[124:127], v[172:175]
  v_mfma_f32_16x16x32_bf16 v[168:171], v[96:99], a[124:127], v[168:171]
  ds_read_b128 v[52:55], v17 offset:21504
  v_mfma_f32_16x16x32_bf16 v[164:167], v[92:95], a[124:127], v[164:167]
  v_mfma_f32_16x16x32_bf16 v[160:163], v[88:91], a[124:127], v[160:163]
  ds_read_b128 v[56:59], v17 offset:22528
  v_mfma_f32_16x16x32_bf16 v[156:159], v[84:87], a[124:127], v[156:159]
  v_mfma_f32_16x16x32_bf16 v[152:155], v[80:83], a[124:127], v[152:155]
  ds_read_b128 v[60:63], v17 offset:23552
  v_mfma_f32_16x16x32_bf16 v[148:151], v[76:79], a[124:127], v[148:151]
  v_mfma_f32_16x16x32_bf16 v[144:147], v[72:75], a[124:127], v[144:147]
  s_waitcnt vmcnt(0)
  ds_read_b128 v[64:67], v17 offset:24576
  v_mfma_f32_16x16x32_bf16 v[140:143], v[68:71], a[124:127], v[140:143]
  s_waitcnt lgkmcnt(6)
  v_mfma_f32_16x16x32_bf16 v[104:107], v[32:35], a[128:131], v[104:107]
  v_mfma_f32_16x16x32_bf16 v[140:143], v[32:35], a[132:135], v[140:143]
  v_mfma_f32_16x16x32_bf16 v[104:107], a[144:147], a[136:139], v[104:107]
  v_mfma_f32_16x16x32_bf16 v[140:143], a[144:147], a[140:143], v[140:143]
  v_mfma_f32_16x16x32_bf16 v[108:111], v[36:39], a[128:131], v[108:111]
  v_mfma_f32_16x16x32_bf16 v[144:147], v[36:39], a[132:135], v[144:147]
  v_mfma_f32_16x16x32_bf16 v[108:111], a[148:151], a[136:139], v[108:111]
  v_mfma_f32_16x16x32_bf16 v[144:147], a[148:151], a[140:143], v[144:147]
  v_mfma_f32_16x16x32_bf16 v[112:115], v[40:43], a[128:131], v[112:115]
  v_mfma_f32_16x16x32_bf16 v[148:151], v[40:43], a[132:135], v[148:151]
  v_mfma_f32_16x16x32_bf16 v[112:115], a[152:155], a[136:139], v[112:115]
  v_fmac_f32 v104, v12, v196
  v_fmac_f32 v105, v12, v197
  v_mfma_f32_16x16x32_bf16 v[148:151], a[152:155], a[140:143], v[148:151]
  s_waitcnt lgkmcnt(3)
  v_fmac_f32 v106, v12, v198
  v_fmac_f32 v107, v12, v199
  v_mfma_f32_16x16x32_bf16 v[116:119], v[44:47], a[128:131], v[116:119]
  v_mul_f32 v104, v104, v13
  v_mul_f32 v105, v105, v13
  v_mfma_f32_16x16x32_bf16 v[152:155], v[44:47], a[132:135], v[152:155]
  v_mul_f32 v106, v106, v13
  v_mul_f32 v107, v107, v13
  v_mfma_f32_16x16x32_bf16 v[116:119], a[156:159], a[136:139], v[116:119]
  v_cvt_pk_bf16_f32 v233, v106, v107
  v_cvt_pk_bf16_f32 v232, v104, v105
  v_mfma_f32_16x16x32_bf16 v[152:155], a[156:159], a[140:143], v[152:155]
  v_fmac_f32 v140, v14, v196
  v_fmac_f32 v141, v14, v197
  v_mfma_f32_16x16x32_bf16 v[120:123], v[48:51], a[128:131], v[120:123]
  v_fmac_f32 v142, v14, v198
  v_fmac_f32 v143, v14, v199
  v_mfma_f32_16x16x32_bf16 v[156:159], v[48:51], a[132:135], v[156:159]
  v_mul_f32 v140, v140, v15
  v_mul_f32 v141, v141, v15
  v_mfma_f32_16x16x32_bf16 v[120:123], a[160:163], a[136:139], v[120:123]
  v_mul_f32 v142, v142, v15
  v_mul_f32 v143, v143, v15
  v_mfma_f32_16x16x32_bf16 v[156:159], a[160:163], a[140:143], v[156:159]
  v_cvt_pk_bf16_f32 v235, v142, v143
  v_cvt_pk_bf16_f32 v234, v140, v141
  v_mfma_f32_16x16x32_bf16 v[124:127], v[52:55], a[128:131], v[124:127]
  v_permlane16_swap_b32 v233, v235
  v_mfma_f32_16x16x32_bf16 v[160:163], v[52:55], a[132:135], v[160:163]
  v_permlane16_swap_b32 v232, v234
  buffer_store_dwordx4 v[232:235], v18, s[24:27], s45 offen sc1
  v_mfma_f32_16x16x32_bf16 v[124:127], a[164:167], a[136:139], v[124:127]
  s_add_u32 s45, s45, 65536
  v_fmac_f32 v108, v12, v200
  v_fmac_f32 v109, v12, v201
  v_mfma_f32_16x16x32_bf16 v[160:163], a[164:167], a[140:143], v[160:163]
  s_waitcnt lgkmcnt(0)
  v_fmac_f32 v110, v12, v202
  v_fmac_f32 v111, v12, v203
  v_mfma_f32_16x16x32_bf16 v[128:131], v[56:59], a[128:131], v[128:131]
  v_mul_f32 v108, v108, v13
  v_mul_f32 v109, v109, v13
  v_mfma_f32_16x16x32_bf16 v[164:167], v[56:59], a[132:135], v[164:167]
  v_mul_f32 v110, v110, v13
  v_mul_f32 v111, v111, v13
  v_mfma_f32_16x16x32_bf16 v[128:131], a[168:171], a[136:139], v[128:131]
  v_cvt_pk_bf16_f32 v237, v110, v111
  v_cvt_pk_bf16_f32 v236, v108, v109
  v_mfma_f32_16x16x32_bf16 v[164:167], a[168:171], a[140:143], v[164:167]
  v_fmac_f32 v144, v14, v200
  v_fmac_f32 v145, v14, v201
  v_mfma_f32_16x16x32_bf16 v[132:135], v[60:63], a[128:131], v[132:135]
  v_fmac_f32 v146, v14, v202
  v_fmac_f32 v147, v14, v203
  v_mfma_f32_16x16x32_bf16 v[168:171], v[60:63], a[132:135], v[168:171]
  v_mul_f32 v144, v144, v15
  v_mul_f32 v145, v145, v15
  v_mfma_f32_16x16x32_bf16 v[132:135], a[172:175], a[136:139], v[132:135]
  v_mul_f32 v146, v146, v15
  v_mul_f32 v147, v147, v15
  v_mfma_f32_16x16x32_bf16 v[168:171], a[172:175], a[140:143], v[168:171]
  v_cvt_pk_bf16_f32 v239, v146, v147
  v_cvt_pk_bf16_f32 v238, v144, v145
  v_mfma_f32_16x16x32_bf16 v[136:139], v[64:67], a[128:131], v[136:139]
  v_permlane16_swap_b32 v237, v239
  v_mfma_f32_16x16x32_bf16 v[172:175], v[64:67], a[132:135], v[172:175]
  v_permlane16_swap_b32 v236, v238
  buffer_store_dwordx4 v[236:239], v18, s[24:27], s45 offen sc1
  v_mfma_f32_16x16x32_bf16 v[136:139], a[176:179], a[136:139], v[136:139]
  s_add_u32 s45, s45, 65536
  v_fmac_f32 v112, v12, v204
  v_fmac_f32 v113, v12, v205
  v_mfma_f32_16x16x32_bf16 v[172:175], a[176:179], a[140:143], v[172:175]
  v_fmac_f32 v114, v12, v206
  v_fmac_f32 v115, v12, v207
  v_mul_f32 v112, v112, v13
  v_mul_f32 v113, v113, v13
  v_mul_f32 v114, v114, v13
  v_mul_f32 v115, v115, v13
  v_cvt_pk_bf16_f32 v232, v112, v113
  v_cvt_pk_bf16_f32 v233, v114, v115
  v_fmac_f32 v148, v14, v204
  v_fmac_f32 v149, v14, v205
  v_fmac_f32 v150, v14, v206
  v_fmac_f32 v151, v14, v207
  v_mul_f32 v148, v148, v15
  v_mul_f32 v149, v149, v15
  v_mul_f32 v150, v150, v15
  v_mul_f32 v151, v151, v15
  v_cvt_pk_bf16_f32 v234, v148, v149
  v_cvt_pk_bf16_f32 v235, v150, v151
  s_nop 0
  v_permlane16_swap_b32 v232, v234
  v_permlane16_swap_b32 v233, v235
  buffer_store_dwordx4 v[232:235], v18, s[24:27], s45 offen sc1
  s_add_u32 s45, s45, 65536
  v_fmac_f32 v116, v12, v208
  v_fmac_f32 v117, v12, v209
  v_fmac_f32 v118, v12, v210
  v_fmac_f32 v119, v12, v211
  v_mul_f32 v116, v116, v13
  v_mul_f32 v117, v117, v13
  v_mul_f32 v118, v118, v13
  v_mul_f32 v119, v119, v13
  v_cvt_pk_bf16_f32 v236, v116, v117
  v_cvt_pk_bf16_f32 v237, v118, v119
  v_fmac_f32 v152, v14, v208
  v_fmac_f32 v153, v14, v209
  v_fmac_f32 v154, v14, v210
  v_fmac_f32 v155, v14, v211
  v_mul_f32 v152, v152, v15
  v_mul_f32 v153, v153, v15
  v_mul_f32 v154, v154, v15
  v_mul_f32 v155, v155, v15
  v_cvt_pk_bf16_f32 v238, v152, v153
  v_cvt_pk_bf16_f32 v239, v154, v155
  s_nop 0
  v_permlane16_swap_b32 v236, v238
  v_permlane16_swap_b32 v237, v239
  buffer_store_dwordx4 v[236:239], v18, s[24:27], s45 offen sc1
  s_add_u32 s45, s45, 65536
  v_fmac_f32 v120, v12, v212
  v_fmac_f32 v121, v12, v213
  v_fmac_f32 v122, v12, v214
  v_fmac_f32 v123, v12, v215
  v_mul_f32 v120, v120, v13
  v_mul_f32 v121, v121, v13
  v_mul_f32 v122, v122, v13
  v_mul_f32 v123, v123, v13
  v_cvt_pk_bf16_f32 v232, v120, v121
  v_cvt_pk_bf16_f32 v233, v122, v123
  v_fmac_f32 v156, v14, v212
  v_fmac_f32 v157, v14, v213
  v_fmac_f32 v158, v14, v214
  v_fmac_f32 v159, v14, v215
  v_mul_f32 v156, v156, v15
  v_mul_f32 v157, v157, v15
  v_mul_f32 v158, v158, v15
  v_mul_f32 v159, v159, v15
  v_cvt_pk_bf16_f32 v234, v156, v157
  v_cvt_pk_bf16_f32 v235, v158, v159
  s_nop 0
  v_permlane16_swap_b32 v232, v234
  v_permlane16_swap_b32 v233, v235
  buffer_store_dwordx4 v[232:235], v18, s[24:27], s45 offen sc1
  s_add_u32 s45, s45, 65536
  v_fmac_f32 v124, v12, v216
  v_fmac_f32 v125, v12, v217
  v_fmac_f32 v126, v12, v218
  v_fmac_f32 v127, v12, v219
  v_mul_f32 v124, v124, v13
  v_mul_f32 v125, v125, v13
  v_mul_f32 v126, v126, v13
  v_mul_f32 v127, v127, v13
  v_cvt_pk_bf16_f32 v236, v124, v125
  v_cvt_pk_bf16_f32 v237, v126, v127
  v_fmac_f32 v160, v14, v216
  v_fmac_f32 v161, v14, v217
  v_fmac_f32 v162, v14, v218
  v_fmac_f32 v163, v14, v219
  v_mul_f32 v160, v160, v15
  v_mul_f32 v161, v161, v15
  v_mul_f32 v162, v162, v15
  v_mul_f32 v163, v163, v15
  v_cvt_pk_bf16_f32 v238, v160, v161
  v_cvt_pk_bf16_f32 v239, v162, v163
  s_nop 0
  v_permlane16_swap_b32 v236, v238
  v_permlane16_swap_b32 v237, v239
  buffer_store_dwordx4 v[236:239], v18, s[24:27], s45 offen sc1
  s_add_u32 s45, s45, 65536
  v_fmac_f32 v128, v12, v220
  v_fmac_f32 v129, v12, v221
  v_fmac_f32 v130, v12, v222
  v_fmac_f32 v131, v12, v223
  v_mul_f32 v128, v128, v13
  v_mul_f32 v129, v129, v13
  v_mul_f32 v130, v130, v13
  v_mul_f32 v131, v131, v13
  v_cvt_pk_bf16_f32 v232, v128, v129
  v_cvt_pk_bf16_f32 v233, v130, v131
  v_fmac_f32 v164, v14, v220
  v_fmac_f32 v165, v14, v221
  v_fmac_f32 v166, v14, v222
  v_fmac_f32 v167, v14, v223
  v_mul_f32 v164, v164, v15
  v_mul_f32 v165, v165, v15
  v_mul_f32 v166, v166, v15
  v_mul_f32 v167, v167, v15
  v_cvt_pk_bf16_f32 v234, v164, v165
  v_cvt_pk_bf16_f32 v235, v166, v167
  s_nop 0
  v_permlane16_swap_b32 v232, v234
  v_permlane16_swap_b32 v233, v235
  buffer_store_dwordx4 v[232:235], v18, s[24:27], s45 offen sc1
  s_add_u32 s45, s45, 65536
  v_fmac_f32 v132, v12, v224
  v_fmac_f32 v133, v12, v225
  v_fmac_f32 v134, v12, v226
  v_fmac_f32 v135, v12, v227
  v_mul_f32 v132, v132, v13
  v_mul_f32 v133, v133, v13
  v_mul_f32 v134, v134, v13
  v_mul_f32 v135, v135, v13
  v_cvt_pk_bf16_f32 v236, v132, v133
  v_cvt_pk_bf16_f32 v237, v134, v135
  v_fmac_f32 v168, v14, v224
  v_fmac_f32 v169, v14, v225
  v_fmac_f32 v170, v14, v226
  v_fmac_f32 v171, v14, v227
  v_mul_f32 v168, v168, v15
  v_mul_f32 v169, v169, v15
  v_mul_f32 v170, v170, v15
  v_mul_f32 v171, v171, v15
  v_cvt_pk_bf16_f32 v238, v168, v169
  v_cvt_pk_bf16_f32 v239, v170, v171
  s_nop 0
  v_permlane16_swap_b32 v236, v238
  v_permlane16_swap_b32 v237, v239
  buffer_store_dwordx4 v[236:239], v18, s[24:27], s45 offen sc1
  s_add_u32 s45, s45, 65536
  v_fmac_f32 v136, v12, v228
  v_fmac_f32 v137, v12, v229
  v_fmac_f32 v138, v12, v230
  v_fmac_f32 v139, v12, v231
  v_mul_f32 v136, v136, v13
  v_mul_f32 v137, v137, v13
  v_mul_f32 v138, v138, v13
  v_mul_f32 v139, v139, v13
  v_cvt_pk_bf16_f32 v232, v136, v137
  v_cvt_pk_bf16_f32 v233, v138, v139
  v_fmac_f32 v172, v14, v228
  v_fmac_f32 v173, v14, v229
  v_fmac_f32 v174, v14, v230
  v_fmac_f32 v175, v14, v231
  v_mul_f32 v172, v172, v15
  v_mul_f32 v173, v173, v15
  v_mul_f32 v174, v174, v15
  v_mul_f32 v175, v175, v15
  v_cvt_pk_bf16_f32 v234, v172, v173
  v_cvt_pk_bf16_f32 v235, v174, v175
  s_nop 0
  v_permlane16_swap_b32 v232, v234
  v_permlane16_swap_b32 v233, v235
  buffer_store_dwordx4 v[232:235], v18, s[24:27], s45 offen sc1
  s_branch at_main
q2_v:
  ds_read_b128 v[32:35], v1 offset:0
  ds_read_b128 v[36:39], v1 offset:1024
  ds_read_b128 v[40:43], v1 offset:2048
  ds_read_b128 v[44:47], v1 offset:3072
  ds_read_b128 v[48:51], v1 offset:4096
  ds_read_b128 v[52:55], v1 offset:5120
  ds_read_b128 v[56:59], v1 offset:6144
  ds_read_b128 v[60:63], v1 offset:7168
  ds_read_b128 v[64:67], v1 offset:8192
  s_waitcnt lgkmcnt(6)
  s_waitcnt vmcnt(12)
  v_mfma_f32_16x16x32_bf16 v[104:107], a[0:3], v[32:35], 0
  ds_read_b128 v[68:71], v1 offset:9216
  v_mfma_f32_16x16x32_bf16 v[108:111], a[0:3], v[36:39], 0
  buffer_load_dwordx4 a[40:43], v2, s[8:11], s33 offen offset:1024 sc1
  v_mfma_f32_16x16x32_bf16 v[112:115], a[0:3], v[40:43], 0
  s_waitcnt lgkmcnt(4)
  ds_read_b128 v[72:75], v1 offset:10240
  v_mfma_f32_16x16x32_bf16 v[116:119], a[0:3], v[44:47], 0
  buffer_load_dwordx4 a[44:47], v3, s[8:11], s33 offen offset:1024 sc1
  v_mfma_f32_16x16x32_bf16 v[120:123], a[0:3], v[48:51], 0
  ds_read_b128 v[76:79], v1 offset:11264
  v_mfma_f32_16x16x32_bf16 v[124:127], a[0:3], v[52:55], 0
  s_waitcnt lgkmcnt(3)
  v_mfma_f32_16x16x32_bf16 v[128:131], a[0:3], v[56:59], 0
  ds_read_b128 v[80:83], v1 offset:12288
  v_mfma_f32_16x16x32_bf16 v[132:135], a[0:3], v[60:63], 0
  s_add_u32 m0, s38, 110592
  s_nop 0
  buffer_load_dwordx4 v1, s[12:15], m0 offen sc1 lds
  v_mfma_f32_16x16x32_bf16 v[136:139], a[0:3], v[64:67], 0
  ds_read_b128 v[84:87], v1 offset:13312
  v_mfma_f32_16x16x32_bf16 v[172:175], a[4:7], v[64:67], 0
  s_add_u32 m0, s38, 114688
  s_nop 0
  buffer_load_dwordx4 v1, s[12:15], m0 offen sc1 lds
  v_mfma_f32_16x16x32_bf16 v[168:171], a[4:7], v[60:63], 0
  ds_read_b128 v[88:91], v1 offset:14336
  v_mfma_f32_16x16x32_bf16 v[164:167], a[4:7], v[56:59], 0
  v_mfma_f32_16x16x32_bf16 v[160:163], a[4:7], v[52:55], 0
  ds_read_b128 v[92:95], v1 offset:15360
  v_mfma_f32_16x16x32_bf16 v[156:159], a[4:7], v[48:51], 0
  s_add_u32 m0, s38, 118784
  s_nop 0
  buffer_load_dwordx4 v1, s[12:15], m0 offen sc1 lds
  v_mfma_f32_16x16x32_bf16 v[152:155], a[4:7], v[44:47], 0
  ds_read_b128 v[96:99], v1 offset:16384
  v_mfma_f32_16x16x32_bf16 v[148:151], a[4:7], v[40:43], 0
  v_mfma_f32_16x16x32_bf16 v[144:147], a[4:7], v[36:39], 0
  s_waitcnt vmcnt(15)
  ds_read_b128 v[100:103], v1 offset:17408
  v_mfma_f32_16x16x32_bf16 v[140:143], a[4:7], v[32:35], 0
  s_waitcnt lgkmcnt(6)
  v_mfma_f32_16x16x32_bf16 v[104:107], a[8:11], v[68:71], v[104:107]
  ds_read_b128 v[32:35], v1 offset:18432
  v_mfma_f32_16x16x32_bf16 v[108:111], a[8:11], v[72:75], v[108:111]
  buffer_load_dwordx4 a[48:51], v2, s[8:11], s33 offen offset:2048 sc1
  v_mfma_f32_16x16x32_bf16 v[112:115], a[8:11], v[76:79], v[112:115]
  s_waitcnt lgkmcnt(4)
  ds_read_b128 v[36:39], v1 offset:19456
  v_mfma_f32_16x16x32_bf16 v[116:119], a[8:11], v[80:83], v[116:119]
  buffer_load_dwordx4 a[52:55], v3, s[8:11], s33 offen offset:2048 sc1
  v_mfma_f32_16x16x32_bf16 v[120:123], a[8:11], v[84:87], v[120:123]
  ds_read_b128 v[40:43], v1 offset:20480
  v_mfma_f32_16x16x32_bf16 v[124:127], a[8:11], v[88:91], v[124:127]
  s_waitcnt lgkmcnt(3)
  v_mfma_f32_16x16x32_bf16 v[128:131], a[8:11], v[92:95], v[128:131]
  ds_read_b128 v[44:47], v1 offset:21504
  v_mfma_f32_16x16x32_bf16 v[132:135], a[8:11], v[96:99], v[132:135]
  s_add_u32 m0, s38, 122880
  s_nop 0
  buffer_load_dwordx4 v1, s[12:15], m0 offen sc1 lds
  v_mfma_f32_16x16x32_bf16 v[136:139], a[8:11], v[100:103], v[136:139]
  ds_read_b128 v[48:51], v1 offset:22528
  v_mfma_f32_16x16x32_bf16 v[172:175], a[12:15], v[100:103], v[172:175]
  s_add_u32 m0, s38, 126976
  s_nop 0
  buffer_load_dwordx4 v1, s[12:15], m0 offen sc1 lds
  v_mfma_f32_16x16x32_bf16 v[168:171], a[12:15], v[96:99], v[168:171]
  ds_read_b128 v[52:55], v1 offset:23552
  v_mfma_f32_16x16x32_bf16 v[164:167], a[12:15], v[92:95], v[164:167]
  v_mfma_f32_16x16x32_bf16 v[160:163], a[12:15], v[88:91], v[160:163]
  ds_read_b128 v[56:59], v1 offset:24576
  v_mfma_f32_16x16x32_bf16 v[156:159], a[12:15], v[84:87], v[156:159]
  s_add_u32 m0, s38, 131072
  s_nop 0
  buffer_load_dwordx4 v1, s[12:15], m0 offen sc1 lds
  v_mfma_f32_16x16x32_bf16 v[152:155], a[12:15], v[80:83], v[152:155]
  ds_read_b128 v[60:63], v1 offset:25600
  v_mfma_f32_16x16x32_bf16 v[148:151], a[12:15], v[76:79], v[148:151]
  v_mfma_f32_16x16x32_bf16 v[144:147], a[12:15], v[72:75], v[144:147]
  s_waitcnt vmcnt(18)
  ds_read_b128 v[64:67], v1 offset:26624
  v_mfma_f32_16x16x32_bf16 v[140:143], a[12:15], v[68:71], v[140:143]
  s_waitcnt lgkmcnt(6)
  v_mfma_f32_16x16x32_bf16 v[104:107], a[16:19], v[32:35], v[104:107]
  ds_read_b128 v[68:71], v1 offset:27648
  v_mfma_f32_16x16x32_bf16 v[108:111], a[16:19], v[36:39], v[108:111]
  buffer_load_dwordx4 a[56:59], v2, s[8:11], s33 offen offset:3072 sc1
  v_mfma_f32_16x16x32_bf16 v[112:115], a[16:19], v[40:43], v[112:115]
  s_waitcnt lgkmcnt(4)
  ds_read_b128 v[72:75], v1 offset:28672
  v_mfma_f32_16x16x32_bf16 v[116:119], a[16:19], v[44:47], v[116:119]
  buffer_load_dwordx4 a[60:63], v3, s[8:11], s33 offen offset:3072 sc1
  v_mfma_f32_16x16x32_bf16 v[120:123], a[16:19], v[48:51], v[120:123]
  ds_read_b128 v[76:79], v1 offset:29696
  v_mfma_f32_16x16x32_bf16 v[124:127], a[16:19], v[52:55], v[124:127]
  s_waitcnt lgkmcnt(3)
  v_mfma_f32_16x16x32_bf16 v[128:131], a[16:19], v[56:59], v[128:131]
  ds_read_b128 v[80:83], v1 offset:30720
  v_mfma_f32_16x16x32_bf16 v[132:135], a[16:19], v[60:63], v[132:135]
  s_add_u32 m0, s38, 135168
  s_nop 0
  buffer_load_dwordx4 v1, s[12:15], m0 offen sc1 lds
  v_mfma_f32_16x16x32_bf16 v[136:139], a[16:19], v[64:67], v[136:139]
  ds_read_b128 v[84:87], v1 offset:31744
  v_mfma_f32_16x16x32_bf16 v[172:175], a[20:23], v[64:67], v[172:175]
  s_add_u32 m0, s38, 139264
  s_nop 0
  buffer_load_dwordx4 v1, s[12:15], m0 offen sc1 lds
  v_mfma_f32_16x16x32_bf16 v[168:171], a[20:23], v[60:63], v[168:171]
  ds_read_b128 v[88:91], v1 offset:32768
  v_mfma_f32_16x16x32_bf16 v[164:167], a[20:23], v[56:59], v[164:167]
  v_mfma_f32_16x16x32_bf16 v[160:163], a[20:23], v[52:55], v[160:163]
  ds_read_b128 v[92:95], v1 offset:33792
  v_mfma_f32_16x16x32_bf16 v[156:159], a[20:23], v[48:51], v[156:159]
  s_add_u32 m0, s38, 143360
  s_nop 0
  buffer_load_dwordx4 v1, s[12:15], m0 offen sc1 lds
  v_mfma_f32_16x16x32_bf16 v[152:155], a[20:23], v[44:47], v[152:155]
  ds_read_b128 v[96:99], v1 offset:34816
  v_mfma_f32_16x16x32_bf16 v[148:151], a[20:23], v[40:43], v[148:151]
  v_mfma_f32_16x16x32_bf16 v[144:147], a[20:23], v[36:39], v[144:147]
  s_waitcnt vmcnt(21)
  ds_read_b128 v[100:103], v1 offset:35840
  v_mfma_f32_16x16x32_bf16 v[140:143], a[20:23], v[32:35], v[140:143]
  s_waitcnt lgkmcnt(6)
  v_mfma_f32_16x16x32_bf16 v[104:107], a[24:27], v[68:71], v[104:107]
  ds_read_b128 v[32:35], v1 offset:36864
  v_mfma_f32_16x16x32_bf16 v[108:111], a[24:27], v[72:75], v[108:111]
  buffer_load_dwordx4 a[64:67], v2, s[8:11], s34 offen offset:0 sc1
  v_mfma_f32_16x16x32_bf16 v[112:115], a[24:27], v[76:79], v[112:115]
  s_waitcnt lgkmcnt(4)
  ds_read_b128 v[36:39], v1 offset:37888
  v_mfma_f32_16x16x32_bf16 v[116:119], a[24:27], v[80:83], v[116:119]
  buffer_load_dwordx4 a[68:71], v3, s[8:11], s34 offen offset:0 sc1
  v_mfma_f32_16x16x32_bf16 v[120:123], a[24:27], v[84:87], v[120:123]
  ds_read_b128 v[40:43], v1 offset:38912
  v_mfma_f32_16x16x32_bf16 v[124:127], a[24:27], v[88:91], v[124:127]
  s_waitcnt lgkmcnt(3)
  v_mfma_f32_16x16x32_bf16 v[128:131], a[24:27], v[92:95], v[128:131]
  ds_read_b128 v[44:47], v1 offset:39936
  v_mfma_f32_16x16x32_bf16 v[132:135], a[24:27], v[96:99], v[132:135]
  s_add_u32 m0, s38, 147456
  s_nop 0
  buffer_load_dwordx4 v1, s[12:15], m0 offen sc1 lds
  v_mfma_f32_16x16x32_bf16 v[136:139], a[24:27], v[100:103], v[136:139]
  ds_read_b128 v[48:51], v1 offset:40960
  v_mfma_f32_16x16x32_bf16 v[172:175], a[28:31], v[100:103], v[172:175]
  s_add_u32 m0, s38, 151552
  s_nop 0
  buffer_load_dwordx4 v1, s[12:15], m0 offen sc1 lds
  v_mfma_f32_16x16x32_bf16 v[168:171], a[28:31], v[96:99], v[168:171]
  ds_read_b128 v[52:55], v1 offset:41984
  v_mfma_f32_16x16x32_bf16 v[164:167], a[28:31], v[92:95], v[164:167]
  v_mfma_f32_16x16x32_bf16 v[160:163], a[28:31], v[88:91], v[160:163]
  ds_read_b128 v[56:59], v1 offset:43008
  v_mfma_f32_16x16x32_bf16 v[156:159], a[28:31], v[84:87], v[156:159]
  s_add_u32 m0, s38, 155648
  s_nop 0
  buffer_load_dwordx4 v1, s[12:15], m0 offen sc1 lds
  v_mfma_f32_16x16x32_bf16 v[152:155], a[28:31], v[80:83], v[152:155]
  ds_read_b128 v[60:63], v1 offset:44032
  v_mfma_f32_16x16x32_bf16 v[148:151], a[28:31], v[76:79], v[148:151]
  v_mfma_f32_16x16x32_bf16 v[144:147], a[28:31], v[72:75], v[144:147]
  s_waitcnt vmcnt(24)
  ds_read_b128 v[64:67], v1 offset:45056
  v_mfma_f32_16x16x32_bf16 v[140:143], a[28:31], v[68:71], v[140:143]
  s_waitcnt lgkmcnt(6)
  v_mfma_f32_16x16x32_bf16 v[104:107], a[32:35], v[32:35], v[104:107]
  ds_read_b128 v[68:71], v1 offset:46080
  v_add_u32 v10, 160768, v10
  v_mfma_f32_16x16x32_bf16 v[108:111], a[32:35], v[36:39], v[108:111]
  buffer_load_dwordx4 a[72:75], v2, s[8:11], s34 offen offset:1024 sc1
  v_mfma_f32_16x16x32_bf16 v[112:115], a[32:35], v[40:43], v[112:115]
  s_waitcnt lgkmcnt(4)
  ds_read_b128 v[72:75], v1 offset:47104
  ds_write_b128 v10, v[184:187]
  v_mfma_f32_16x16x32_bf16 v[116:119], a[32:35], v[44:47], v[116:119]
  s_waitcnt vmcnt(21)
  v_add_f32 v176, v176, v240
  v_add_f32 v177, v177, v241
  v_mfma_f32_16x16x32_bf16 v[120:123], a[32:35], v[48:51], v[120:123]
  ds_read_b128 v[76:79], v1 offset:48128
  v_add_f32 v178, v178, v242
  v_mfma_f32_16x16x32_bf16 v[124:127], a[32:35], v[52:55], v[124:127]
  s_waitcnt lgkmcnt(4)
  v_add_f32 v179, v179, v243
  v_add_f32 v180, v180, v244
  v_mfma_f32_16x16x32_bf16 v[128:131], a[32:35], v[56:59], v[128:131]
  ds_read_b128 v[80:83], v1 offset:49152
  v_add_f32 v181, v181, v245
  v_mfma_f32_16x16x32_bf16 v[132:135], a[32:35], v[60:63], v[132:135]
  v_add_f32 v182, v182, v246
  v_add_f32 v183, v183, v247
  v_mfma_f32_16x16x32_bf16 v[136:139], a[32:35], v[64:67], v[136:139]
  ds_read_b128 v[84:87], v1 offset:50176
  v_add_f32 v176, v176, v178
  v_mfma_f32_16x16x32_bf16 v[172:175], a[36:39], v[64:67], v[172:175]
  buffer_load_dwordx4 a[76:79], v3, s[8:11], s34 offen offset:1024 sc1
  v_mfma_f32_16x16x32_bf16 v[168:171], a[36:39], v[60:63], v[168:171]
  ds_read_b128 v[88:91], v1 offset:51200
  v_add_f32 v177, v177, v179
  v_mfma_f32_16x16x32_bf16 v[164:167], a[36:39], v[56:59], v[164:167]
  v_add_f32 v180, v180, v182
  v_add_f32 v181, v181, v183
  v_mfma_f32_16x16x32_bf16 v[160:163], a[36:39], v[52:55], v[160:163]
  ds_read_b128 v[92:95], v1 offset:52224
  v_mov_b32 v178, v176
  v_mfma_f32_16x16x32_bf16 v[156:159], a[36:39], v[48:51], v[156:159]
  v_mov_b32 v179, v177
  v_mov_b32 v182, v180
  v_mfma_f32_16x16x32_bf16 v[152:155], a[36:39], v[44:47], v[152:155]
  ds_read_b128 v[96:99], v1 offset:53248
  v_mov_b32 v183, v181
  v_mfma_f32_16x16x32_bf16 v[148:151], a[36:39], v[40:43], v[148:151]
  v_permlane16_swap_b32 v176, v178
  v_mfma_f32_16x16x32_bf16 v[144:147], a[36:39], v[36:39], v[144:147]
  s_waitcnt vmcnt(20)
  ds_read_b128 v[100:103], v1 offset:54272
  v_add_f32 v176, v176, v178
  v_mfma_f32_16x16x32_bf16 v[140:143], a[36:39], v[32:35], v[140:143]
  s_waitcnt lgkmcnt(6)
  v_permlane16_swap_b32 v177, v179
  v_mfma_f32_16x16x32_bf16 v[104:107], a[40:43], v[68:71], v[104:107]
  ds_read_b128 v[32:35], v1 offset:55296
  v_add_f32 v177, v177, v179
  v_mfma_f32_16x16x32_bf16 v[108:111], a[40:43], v[72:75], v[108:111]
  buffer_load_dwordx4 a[80:83], v2, s[8:11], s34 offen offset:2048 sc1
  v_mfma_f32_16x16x32_bf16 v[112:115], a[40:43], v[76:79], v[112:115]
  s_waitcnt lgkmcnt(4)
  ds_read_b128 v[36:39], v1 offset:56320
  v_mov_b32 v178, v176
  v_mfma_f32_16x16x32_bf16 v[116:119], a[40:43], v[80:83], v[116:119]
  v_permlane16_swap_b32 v180, v182
  v_mfma_f32_16x16x32_bf16 v[120:123], a[40:43], v[84:87], v[120:123]
  ds_read_b128 v[40:43], v1 offset:57344
  v_add_f32 v180, v180, v182
  v_mfma_f32_16x16x32_bf16 v[124:127], a[40:43], v[88:91], v[124:127]
  s_waitcnt lgkmcnt(3)
  v_permlane16_swap_b32 v181, v183
  v_mfma_f32_16x16x32_bf16 v[128:131], a[40:43], v[92:95], v[128:131]
  ds_read_b128 v[44:47], v1 offset:58368
  v_add_f32 v181, v181, v183
  v_mfma_f32_16x16x32_bf16 v[132:135], a[40:43], v[96:99], v[132:135]
  v_mov_b32 v179, v177
  v_mov_b32 v182, v180
  v_mfma_f32_16x16x32_bf16 v[136:139], a[40:43], v[100:103], v[136:139]
  ds_read_b128 v[48:51], v1 offset:59392
  v_mov_b32 v183, v181
  v_mfma_f32_16x16x32_bf16 v[172:175], a[44:47], v[100:103], v[172:175]
  buffer_load_dwordx4 a[84:87], v3, s[8:11], s34 offen offset:2048 sc1
  v_mfma_f32_16x16x32_bf16 v[168:171], a[44:47], v[96:99], v[168:171]
  ds_read_b128 v[52:55], v1 offset:60416
  v_lshl_add_u32 v11, v7, 3, s47
  v_mfma_f32_16x16x32_bf16 v[164:167], a[44:47], v[92:95], v[164:167]
  v_permlane32_swap_b32 v176, v178
  v_mfma_f32_16x16x32_bf16 v[160:163], a[44:47], v[88:91], v[160:163]
  ds_read_b128 v[56:59], v1 offset:61440
  v_add_f32 v176, v176, v178
  v_mfma_f32_16x16x32_bf16 v[156:159], a[44:47], v[84:87], v[156:159]
  v_permlane32_swap_b32 v177, v179
  v_mfma_f32_16x16x32_bf16 v[152:155], a[44:47], v[80:83], v[152:155]
  ds_read_b128 v[60:63], v1 offset:62464
  v_add_f32 v177, v177, v179
  v_mfma_f32_16x16x32_bf16 v[148:151], a[44:47], v[76:79], v[148:151]
  v_permlane32_swap_b32 v180, v182
  v_mfma_f32_16x16x32_bf16 v[144:147], a[44:47], v[72:75], v[144:147]
  s_waitcnt vmcnt(17)
  ds_read_b128 v[64:67], v1 offset:63488
  v_add_f32 v180, v180, v182
  v_mfma_f32_16x16x32_bf16 v[140:143], a[44:47], v[68:71], v[140:143]
  s_waitcnt lgkmcnt(6)
  v_permlane32_swap_b32 v181, v183
  v_mfma_f32_16x16x32_bf16 v[104:107], a[48:51], v[32:35], v[104:107]
  ds_read_b128 v[68:71], v1 offset:64512
  v_add_f32 v181, v181, v183
  v_mfma_f32_16x16x32_bf16 v[108:111], a[48:51], v[36:39], v[108:111]
  buffer_load_dwordx4 a[88:91], v2, s[8:11], s34 offen offset:3072 sc1
  v_mfma_f32_16x16x32_bf16 v[112:115], a[48:51], v[40:43], v[112:115]
  s_waitcnt lgkmcnt(4)
  ds_read_b128 v[72:75], v16 offset:0
  v_mul_f32 v176, 0x3ae38e39, v176
  v_mfma_f32_16x16x32_bf16 v[116:119], a[48:51], v[44:47], v[116:119]
  v_mul_f32 v177, 0x3ae38e39, v177
  v_fma_f32 v177, -v176, v176, v177
  v_mfma_f32_16x16x32_bf16 v[120:123], a[48:51], v[48:51], v[120:123]
  ds_read_b128 v[76:79], v16 offset:1024
  v_max_f32 v177, 0, v177
  v_mfma_f32_16x16x32_bf16 v[124:127], a[48:51], v[52:55], v[124:127]
  s_waitcnt lgkmcnt(3)
  v_add_f32 v177, 0x3727c5ac, v177
  v_mul_f32 v180, 0x3ae38e39, v180
  v_mfma_f32_16x16x32_bf16 v[128:131], a[48:51], v[56:59], v[128:131]
  ds_read_b128 v[80:83], v16 offset:2048
  v_mul_f32 v181, 0x3ae38e39, v181
  v_mfma_f32_16x16x32_bf16 v[132:135], a[48:51], v[60:63], v[132:135]
  v_fma_f32 v181, -v180, v180, v181
  v_max_f32 v181, 0, v181
  v_mfma_f32_16x16x32_bf16 v[136:139], a[48:51], v[64:67], v[136:139]
  ds_read_b128 v[84:87], v16 offset:3072
  v_add_f32 v181, 0x3727c5ac, v181
  v_mfma_f32_16x16x32_bf16 v[172:175], a[52:55], v[64:67], v[172:175]
  buffer_load_dwordx4 a[92:95], v3, s[8:11], s34 offen offset:3072 sc1
  v_mfma_f32_16x16x32_bf16 v[168:171], a[52:55], v[60:63], v[168:171]
  ds_read_b128 v[88:91], v16 offset:4096
  v_sub_f32 v12, 0, v176
  v_mfma_f32_16x16x32_bf16 v[164:167], a[52:55], v[56:59], v[164:167]
  v_rsq_f32 v13, v177
  v_mfma_f32_16x16x32_bf16 v[160:163], a[52:55], v[52:55], v[160:163]
  ds_read_b128 v[92:95], v16 offset:5120
  v_sub_f32 v14, 0, v180
  v_mfma_f32_16x16x32_bf16 v[156:159], a[52:55], v[48:51], v[156:159]
  v_rsq_f32 v15, v181
  v_mfma_f32_16x16x32_bf16 v[152:155], a[52:55], v[44:47], v[152:155]
  ds_read_b128 v[96:99], v16 offset:6144
  ds_write_b64 v11, v[12:13]
  v_mfma_f32_16x16x32_bf16 v[148:151], a[52:55], v[40:43], v[148:151]
  ds_write_b64 v11, v[14:15] offset:128
  v_lshl_add_u32 v11, v8, 5, s47
  v_mfma_f32_16x16x32_bf16 v[144:147], a[52:55], v[36:39], v[144:147]
  s_waitcnt vmcnt(14)
  ds_read_b128 v[100:103], v16 offset:7168
  ds_read_b128 v[176:179], v11 offset:0
  v_mfma_f32_16x16x32_bf16 v[140:143], a[52:55], v[32:35], v[140:143]
  s_waitcnt lgkmcnt(9)
  ds_read_b128 v[180:183], v11 offset:16
  ds_read_b128 v[184:187], v11 offset:128
  v_mfma_f32_16x16x32_bf16 v[104:107], a[56:59], v[68:71], v[104:107]
  ds_read_b128 v[32:35], v16 offset:8192
  ds_read_b128 v[188:191], v11 offset:144
  v_mfma_f32_16x16x32_bf16 v[108:111], a[56:59], v[72:75], v[108:111]
  buffer_load_dwordx4 a[96:99], v2, s[8:11], s35 offen offset:0 sc1
  v_mfma_f32_16x16x32_bf16 v[112:115], a[56:59], v[76:79], v[112:115]
  s_waitcnt lgkmcnt(10)
  ds_read_b128 v[36:39], v16 offset:9216
  v_lshlrev_b32 v10, 2, v7
  v_mfma_f32_16x16x32_bf16 v[116:119], a[56:59], v[80:83], v[116:119]
  buffer_load_dwordx4 a[100:103], v3, s[8:11], s35 offen offset:0 sc1
  v_mfma_f32_16x16x32_bf16 v[120:123], a[56:59], v[84:87], v[120:123]
  ds_read_b128 v[40:43], v16 offset:10240
  v_add_u32 v18, s48, v1
  v_mfma_f32_16x16x32_bf16 v[124:127], a[56:59], v[88:91], v[124:127]
  s_waitcnt lgkmcnt(7)
  v_add_u32 v10, 160768, v10
  v_mfma_f32_16x16x32_bf16 v[128:131], a[56:59], v[92:95], v[128:131]
  ds_read_b128 v[44:47], v16 offset:11264
  v_mfma_f32_16x16x32_bf16 v[132:135], a[56:59], v[96:99], v[132:135]
  buffer_load_dwordx4 a[144:147], v6, s[12:15], 0 offen offset:0 sc1
  v_mfma_f32_16x16x32_bf16 v[136:139], a[56:59], v[100:103], v[136:139]
  ds_read_b128 v[48:51], v16 offset:12288
  v_mfma_f32_16x16x32_bf16 v[172:175], a[60:63], v[100:103], v[172:175]
  buffer_load_dwordx4 a[148:151], v6, s[12:15], 0 offen offset:1024 sc1
  v_mfma_f32_16x16x32_bf16 v[168:171], a[60:63], v[96:99], v[168:171]
  ds_read_b128 v[52:55], v16 offset:13312
  v_mfma_f32_16x16x32_bf16 v[164:167], a[60:63], v[92:95], v[164:167]
  v_mfma_f32_16x16x32_bf16 v[160:163], a[60:63], v[88:91], v[160:163]
  ds_read_b128 v[56:59], v16 offset:14336
  v_mfma_f32_16x16x32_bf16 v[156:159], a[60:63], v[84:87], v[156:159]
  buffer_load_dwordx4 a[152:155], v6, s[12:15], 0 offen offset:2048 sc1
  v_mfma_f32_16x16x32_bf16 v[152:155], a[60:63], v[80:83], v[152:155]
  ds_read_b128 v[60:63], v16 offset:15360
  v_mfma_f32_16x16x32_bf16 v[148:151], a[60:63], v[76:79], v[148:151]
  v_mfma_f32_16x16x32_bf16 v[144:147], a[60:63], v[72:75], v[144:147]
  s_waitcnt vmcnt(14)
  ds_read_b128 v[64:67], v16 offset:16384
  v_mfma_f32_16x16x32_bf16 v[140:143], a[60:63], v[68:71], v[140:143]
  s_waitcnt lgkmcnt(6)
  v_mfma_f32_16x16x32_bf16 v[104:107], a[64:67], v[32:35], v[104:107]
  ds_read_b128 v[68:71], v16 offset:17408
  v_mfma_f32_16x16x32_bf16 v[108:111], a[64:67], v[36:39], v[108:111]
  buffer_load_dwordx4 a[104:107], v2, s[8:11], s35 offen offset:1024 sc1
  v_mfma_f32_16x16x32_bf16 v[112:115], a[64:67], v[40:43], v[112:115]
  s_waitcnt lgkmcnt(4)
  ds_read_b128 v[72:75], v16 offset:18432
  v_mfma_f32_16x16x32_bf16 v[116:119], a[64:67], v[44:47], v[116:119]
  buffer_load_dwordx4 a[108:111], v3, s[8:11], s35 offen offset:1024 sc1
  v_mfma_f32_16x16x32_bf16 v[120:123], a[64:67], v[48:51], v[120:123]
  ds_read_b128 v[76:79], v16 offset:19456
  v_mfma_f32_16x16x32_bf16 v[124:127], a[64:67], v[52:55], v[124:127]
  s_waitcnt lgkmcnt(3)
  v_mfma_f32_16x16x32_bf16 v[128:131], a[64:67], v[56:59], v[128:131]
  ds_read_b128 v[80:83], v16 offset:20480
  v_mfma_f32_16x16x32_bf16 v[132:135], a[64:67], v[60:63], v[132:135]
  buffer_load_dwordx4 a[156:159], v6, s[12:15], 0 offen offset:3072 sc1
  v_mfma_f32_16x16x32_bf16 v[136:139], a[64:67], v[64:67], v[136:139]
  ds_read_b128 v[84:87], v16 offset:21504
  v_mfma_f32_16x16x32_bf16 v[172:175], a[68:71], v[64:67], v[172:175]
  buffer_load_dwordx4 a[160:163], v6, s[12:15], s33 offen offset:0 sc1
  v_mfma_f32_16x16x32_bf16 v[168:171], a[68:71], v[60:63], v[168:171]
  ds_read_b128 v[88:91], v16 offset:22528
  v_mfma_f32_16x16x32_bf16 v[164:167], a[68:71], v[56:59], v[164:167]
  v_mfma_f32_16x16x32_bf16 v[160:163], a[68:71], v[52:55], v[160:163]
  ds_read_b128 v[92:95], v16 offset:23552
  v_mfma_f32_16x16x32_bf16 v[156:159], a[68:71], v[48:51], v[156:159]
  buffer_load_dwordx4 a[164:167], v6, s[12:15], s33 offen offset:1024 sc1
  v_mfma_f32_16x16x32_bf16 v[152:155], a[68:71], v[44:47], v[152:155]
  ds_read_b128 v[96:99], v16 offset:24576
  v_mfma_f32_16x16x32_bf16 v[148:151], a[68:71], v[40:43], v[148:151]
  v_mfma_f32_16x16x32_bf16 v[144:147], a[68:71], v[36:39], v[144:147]
  s_waitcnt vmcnt(14)
  ds_read_b128 v[100:103], v16 offset:25600
  v_mfma_f32_16x16x32_bf16 v[140:143], a[68:71], v[32:35], v[140:143]
  s_waitcnt lgkmcnt(6)
  v_mfma_f32_16x16x32_bf16 v[104:107], a[72:75], v[68:71], v[104:107]
  ds_read_b128 v[32:35], v16 offset:26624
  ds_read_b32 v196, v10 offset:0
  v_mfma_f32_16x16x32_bf16 v[108:111], a[72:75], v[72:75], v[108:111]
  buffer_load_dwordx4 a[112:115], v2, s[8:11], s35 offen offset:2048 sc1
  v_mfma_f32_16x16x32_bf16 v[112:115], a[72:75], v[76:79], v[112:115]
  s_waitcnt lgkmcnt(5)
  ds_read_b128 v[36:39], v16 offset:27648
  v_mfma_f32_16x16x32_bf16 v[116:119], a[72:75], v[80:83], v[116:119]
  buffer_load_dwordx4 a[116:119], v3, s[8:11], s35 offen offset:2048 sc1
  v_mfma_f32_16x16x32_bf16 v[120:123], a[72:75], v[84:87], v[120:123]
  ds_read_b128 v[40:43], v16 offset:28672
  v_mfma_f32_16x16x32_bf16 v[124:127], a[72:75], v[88:91], v[124:127]
  s_waitcnt lgkmcnt(4)
  v_mfma_f32_16x16x32_bf16 v[128:131], a[72:75], v[92:95], v[128:131]
  ds_read_b128 v[44:47], v16 offset:29696
  v_mfma_f32_16x16x32_bf16 v[132:135], a[72:75], v[96:99], v[132:135]
  buffer_load_dwordx4 a[168:171], v6, s[12:15], s33 offen offset:2048 sc1
  v_mfma_f32_16x16x32_bf16 v[136:139], a[72:75], v[100:103], v[136:139]
  ds_read_b128 v[48:51], v16 offset:30720
  ds_read_b32 v197, v10 offset:64
  v_mfma_f32_16x16x32_bf16 v[172:175], a[76:79], v[100:103], v[172:175]
  buffer_load_dwordx4 a[172:175], v6, s[12:15], s33 offen offset:3072 sc1
  v_mfma_f32_16x16x32_bf16 v[168:171], a[76:79], v[96:99], v[168:171]
  ds_read_b128 v[52:55], v16 offset:31744
  v_mfma_f32_16x16x32_bf16 v[164:167], a[76:79], v[92:95], v[164:167]
  v_mfma_f32_16x16x32_bf16 v[160:163], a[76:79], v[88:91], v[160:163]
  ds_read_b128 v[56:59], v16 offset:32768
  v_mfma_f32_16x16x32_bf16 v[156:159], a[76:79], v[84:87], v[156:159]
  buffer_load_dwordx4 a[176:179], v6, s[12:15], s34 offen offset:0 sc1
  v_mfma_f32_16x16x32_bf16 v[152:155], a[76:79], v[80:83], v[152:155]
  ds_read_b128 v[60:63], v16 offset:33792
  v_mfma_f32_16x16x32_bf16 v[148:151], a[76:79], v[76:79], v[148:151]
  v_mfma_f32_16x16x32_bf16 v[144:147], a[76:79], v[72:75], v[144:147]
  s_waitcnt vmcnt(17)
  ds_read_b128 v[64:67], v16 offset:34816
  ds_read_b32 v198, v10 offset:128
  v_mfma_f32_16x16x32_bf16 v[140:143], a[76:79], v[68:71], v[140:143]
  s_waitcnt lgkmcnt(8)
  v_mfma_f32_16x16x32_bf16 v[104:107], a[80:83], v[32:35], v[104:107]
  ds_read_b128 v[68:71], v16 offset:35840
  v_mfma_f32_16x16x32_bf16 v[108:111], a[80:83], v[36:39], v[108:111]
  buffer_load_dwordx4 a[120:123], v2, s[8:11], s35 offen offset:3072 sc1
  v_mfma_f32_16x16x32_bf16 v[112:115], a[80:83], v[40:43], v[112:115]
  s_waitcnt lgkmcnt(5)
  ds_read_b128 v[72:75], v16 offset:36864
  v_mfma_f32_16x16x32_bf16 v[116:119], a[80:83], v[44:47], v[116:119]
  v_mfma_f32_16x16x32_bf16 v[120:123], a[80:83], v[48:51], v[120:123]
  ds_read_b128 v[76:79], v16 offset:37888
  v_mfma_f32_16x16x32_bf16 v[124:127], a[80:83], v[52:55], v[124:127]
  s_waitcnt lgkmcnt(4)
  v_mfma_f32_16x16x32_bf16 v[128:131], a[80:83], v[56:59], v[128:131]
  ds_read_b128 v[80:83], v16 offset:38912
  ds_read_b32 v199, v10 offset:192
  v_mfma_f32_16x16x32_bf16 v[132:135], a[80:83], v[60:63], v[132:135]
  v_mfma_f32_16x16x32_bf16 v[136:139], a[80:83], v[64:67], v[136:139]
  ds_read_b128 v[84:87], v16 offset:39936
  v_mfma_f32_16x16x32_bf16 v[172:175], a[84:87], v[64:67], v[172:175]
  buffer_load_dwordx4 a[124:127], v3, s[8:11], s35 offen offset:3072 sc1
  v_mfma_f32_16x16x32_bf16 v[168:171], a[84:87], v[60:63], v[168:171]
  ds_read_b128 v[88:91], v16 offset:40960
  v_mfma_f32_16x16x32_bf16 v[164:167], a[84:87], v[56:59], v[164:167]
  v_mfma_f32_16x16x32_bf16 v[160:163], a[84:87], v[52:55], v[160:163]
  ds_read_b128 v[92:95], v16 offset:41984
  v_mfma_f32_16x16x32_bf16 v[156:159], a[84:87], v[48:51], v[156:159]
  v_mfma_f32_16x16x32_bf16 v[152:155], a[84:87], v[44:47], v[152:155]
  s_waitcnt vmcnt(23)
  ds_read_b128 v[96:99], v16 offset:43008
  ds_read_b32 v200, v10 offset:256
  v_mfma_f32_16x16x32_bf16 v[148:151], a[84:87], v[40:43], v[148:151]
  s_barrier
  v_mfma_f32_16x16x32_bf16 v[144:147], a[84:87], v[36:39], v[144:147]
  s_waitcnt vmcnt(17)
  ds_read_b128 v[100:103], v16 offset:44032
  v_mfma_f32_16x16x32_bf16 v[140:143], a[84:87], v[32:35], v[140:143]
  s_waitcnt lgkmcnt(8)
  v_mfma_f32_16x16x32_bf16 v[104:107], a[88:91], v[68:71], v[104:107]
  ds_read_b128 v[32:35], v16 offset:45056
  v_mfma_f32_16x16x32_bf16 v[108:111], a[88:91], v[72:75], v[108:111]
  buffer_load_dwordx4 a[128:131], v2, s[8:11], s36 offen offset:0 sc1
  v_mfma_f32_16x16x32_bf16 v[112:115], a[88:91], v[76:79], v[112:115]
  s_waitcnt lgkmcnt(5)
  ds_read_b128 v[36:39], v16 offset:46080
  v_mfma_f32_16x16x32_bf16 v[116:119], a[88:91], v[80:83], v[116:119]
  v_mfma_f32_16x16x32_bf16 v[120:123], a[88:91], v[84:87], v[120:123]
  ds_read_b128 v[40:43], v16 offset:47104
  ds_read_b32 v201, v10 offset:320
  v_mfma_f32_16x16x32_bf16 v[124:127], a[88:91], v[88:91], v[124:127]
  s_waitcnt lgkmcnt(4)
  v_mfma_f32_16x16x32_bf16 v[128:131], a[88:91], v[92:95], v[128:131]
  ds_read_b128 v[44:47], v16 offset:48128
  v_mfma_f32_16x16x32_bf16 v[132:135], a[88:91], v[96:99], v[132:135]
  v_mfma_f32_16x16x32_bf16 v[136:139], a[88:91], v[100:103], v[136:139]
  ds_read_b128 v[48:51], v16 offset:49152
  v_mfma_f32_16x16x32_bf16 v[172:175], a[92:95], v[100:103], v[172:175]
  buffer_load_dwordx4 a[132:135], v3, s[8:11], s36 offen offset:0 sc1
  v_mfma_f32_16x16x32_bf16 v[168:171], a[92:95], v[96:99], v[168:171]
  ds_read_b128 v[52:55], v16 offset:50176
  v_mfma_f32_16x16x32_bf16 v[164:167], a[92:95], v[92:95], v[164:167]
  v_mfma_f32_16x16x32_bf16 v[160:163], a[92:95], v[88:91], v[160:163]
  ds_read_b128 v[56:59], v16 offset:51200
  ds_read_b32 v202, v10 offset:384
  v_mfma_f32_16x16x32_bf16 v[156:159], a[92:95], v[84:87], v[156:159]
  v_mfma_f32_16x16x32_bf16 v[152:155], a[92:95], v[80:83], v[152:155]
  ds_read_b128 v[60:63], v16 offset:52224
  v_mfma_f32_16x16x32_bf16 v[148:151], a[92:95], v[76:79], v[148:151]
  v_mfma_f32_16x16x32_bf16 v[144:147], a[92:95], v[72:75], v[144:147]
  s_waitcnt vmcnt(17)
  ds_read_b128 v[64:67], v16 offset:53248
  v_mfma_f32_16x16x32_bf16 v[140:143], a[92:95], v[68:71], v[140:143]
  s_waitcnt lgkmcnt(8)
  v_mfma_f32_16x16x32_bf16 v[104:107], a[96:99], v[32:35], v[104:107]
  ds_read_b128 v[68:71], v16 offset:54272
  v_mfma_f32_16x16x32_bf16 v[108:111], a[96:99], v[36:39], v[108:111]
  buffer_load_dwordx4 a[136:139], v2, s[8:11], s36 offen offset:1024 sc1
  v_mfma_f32_16x16x32_bf16 v[112:115], a[96:99], v[40:43], v[112:115]
  s_waitcnt lgkmcnt(5)
  ds_read_b128 v[72:75], v16 offset:55296
  ds_read_b32 v203, v10 offset:448
  v_mfma_f32_16x16x32_bf16 v[116:119], a[96:99], v[44:47], v[116:119]
  v_mfma_f32_16x16x32_bf16 v[120:123], a[96:99], v[48:51], v[120:123]
  ds_read_b128 v[76:79], v16 offset:56320
  v_mfma_f32_16x16x32_bf16 v[124:127], a[96:99], v[52:55], v[124:127]
  s_waitcnt lgkmcnt(4)
  v_mfma_f32_16x16x32_bf16 v[128:131], a[96:99], v[56:59], v[128:131]
  ds_read_b128 v[80:83], v16 offset:57344
  v_mfma_f32_16x16x32_bf16 v[132:135], a[96:99], v[60:63], v[132:135]
  v_mfma_f32_16x16x32_bf16 v[136:139], a[96:99], v[64:67], v[136:139]
  ds_read_b128 v[84:87], v16 offset:58368
  v_mfma_f32_16x16x32_bf16 v[172:175], a[100:103], v[64:67], v[172:175]
  buffer_load_dwordx4 a[140:143], v3, s[8:11], s36 offen offset:1024 sc1
  v_mfma_f32_16x16x32_bf16 v[168:171], a[100:103], v[60:63], v[168:171]
  ds_read_b128 v[88:91], v16 offset:59392
  ds_read_b32 v204, v10 offset:512
  v_mfma_f32_16x16x32_bf16 v[164:167], a[100:103], v[56:59], v[164:167]
  v_mfma_f32_16x16x32_bf16 v[160:163], a[100:103], v[52:55], v[160:163]
  ds_read_b128 v[92:95], v16 offset:60416
  v_mfma_f32_16x16x32_bf16 v[156:159], a[100:103], v[48:51], v[156:159]
  v_mfma_f32_16x16x32_bf16 v[152:155], a[100:103], v[44:47], v[152:155]
  ds_read_b128 v[96:99], v16 offset:61440
  v_mfma_f32_16x16x32_bf16 v[148:151], a[100:103], v[40:43], v[148:151]
  v_mfma_f32_16x16x32_bf16 v[144:147], a[100:103], v[36:39], v[144:147]
  s_waitcnt vmcnt(14)
  ds_read_b128 v[100:103], v16 offset:62464
  v_mfma_f32_16x16x32_bf16 v[140:143], a[100:103], v[32:35], v[140:143]
  s_waitcnt lgkmcnt(7)
  v_mfma_f32_16x16x32_bf16 v[104:107], a[104:107], v[68:71], v[104:107]
  ds_read_b128 v[32:35], v16 offset:63488
  v_mfma_f32_16x16x32_bf16 v[108:111], a[104:107], v[72:75], v[108:111]
  v_mfma_f32_16x16x32_bf16 v[112:115], a[104:107], v[76:79], v[112:115]
  s_waitcnt lgkmcnt(5)
  ds_read_b128 v[36:39], v16 offset:64512
  v_mfma_f32_16x16x32_bf16 v[116:119], a[104:107], v[80:83], v[116:119]
  v_mfma_f32_16x16x32_bf16 v[120:123], a[104:107], v[84:87], v[120:123]
  ds_read_b128 v[40:43], v17 offset:0
  v_mfma_f32_16x16x32_bf16 v[124:127], a[104:107], v[88:91], v[124:127]
  s_waitcnt lgkmcnt(3)
  v_mfma_f32_16x16x32_bf16 v[128:131], a[104:107], v[92:95], v[128:131]
  ds_read_b128 v[44:47], v17 offset:1024
  v_mfma_f32_16x16x32_bf16 v[132:135], a[104:107], v[96:99], v[132:135]
  v_mfma_f32_16x16x32_bf16 v[136:139], a[104:107], v[100:103], v[136:139]
  ds_read_b128 v[48:51], v17 offset:2048
  v_mfma_f32_16x16x32_bf16 v[172:175], a[108:111], v[100:103], v[172:175]
  v_mfma_f32_16x16x32_bf16 v[168:171], a[108:111], v[96:99], v[168:171]
  ds_read_b128 v[52:55], v17 offset:3072
  v_mfma_f32_16x16x32_bf16 v[164:167], a[108:111], v[92:95], v[164:167]
  v_mfma_f32_16x16x32_bf16 v[160:163], a[108:111], v[88:91], v[160:163]
  ds_read_b128 v[56:59], v17 offset:4096
  v_mfma_f32_16x16x32_bf16 v[156:159], a[108:111], v[84:87], v[156:159]
  v_mfma_f32_16x16x32_bf16 v[152:155], a[108:111], v[80:83], v[152:155]
  ds_read_b128 v[60:63], v17 offset:5120
  v_mfma_f32_16x16x32_bf16 v[148:151], a[108:111], v[76:79], v[148:151]
  v_mfma_f32_16x16x32_bf16 v[144:147], a[108:111], v[72:75], v[144:147]
  s_waitcnt vmcnt(9)
  ds_read_b128 v[64:67], v17 offset:6144
  v_mfma_f32_16x16x32_bf16 v[140:143], a[108:111], v[68:71], v[140:143]
  s_waitcnt lgkmcnt(6)
  v_mfma_f32_16x16x32_bf16 v[104:107], a[112:115], v[32:35], v[104:107]
  ds_read_b128 v[68:71], v17 offset:7168
  v_mfma_f32_16x16x32_bf16 v[108:111], a[112:115], v[36:39], v[108:111]
  v_mfma_f32_16x16x32_bf16 v[112:115], a[112:115], v[40:43], v[112:115]
  s_waitcnt lgkmcnt(4)
  ds_read_b128 v[72:75], v17 offset:8192
  v_mfma_f32_16x16x32_bf16 v[116:119], a[112:115], v[44:47], v[116:119]
  v_mfma_f32_16x16x32_bf16 v[120:123], a[112:115], v[48:51], v[120:123]
  ds_read_b128 v[76:79], v17 offset:9216
  v_mfma_f32_16x16x32_bf16 v[124:127], a[112:115], v[52:55], v[124:127]
  s_waitcnt lgkmcnt(3)
  v_mfma_f32_16x16x32_bf16 v[128:131], a[112:115], v[56:59], v[128:131]
  ds_read_b128 v[80:83], v17 offset:10240
  v_mfma_f32_16x16x32_bf16 v[132:135], a[112:115], v[60:63], v[132:135]
  v_mfma_f32_16x16x32_bf16 v[136:139], a[112:115], v[64:67], v[136:139]
  ds_read_b128 v[84:87], v17 offset:11264
  v_mfma_f32_16x16x32_bf16 v[172:175], a[116:119], v[64:67], v[172:175]
  v_mfma_f32_16x16x32_bf16 v[168:171], a[116:119], v[60:63], v[168:171]
  ds_read_b128 v[88:91], v17 offset:12288
  v_mfma_f32_16x16x32_bf16 v[164:167], a[116:119], v[56:59], v[164:167]
  v_mfma_f32_16x16x32_bf16 v[160:163], a[116:119], v[52:55], v[160:163]
  ds_read_b128 v[92:95], v17 offset:13312
  v_mfma_f32_16x16x32_bf16 v[156:159], a[116:119], v[48:51], v[156:159]
  v_mfma_f32_16x16x32_bf16 v[152:155], a[116:119], v[44:47], v[152:155]
  ds_read_b128 v[96:99], v17 offset:14336
  v_mfma_f32_16x16x32_bf16 v[148:151], a[116:119], v[40:43], v[148:151]
  v_mfma_f32_16x16x32_bf16 v[144:147], a[116:119], v[36:39], v[144:147]
  s_waitcnt vmcnt(4)
  ds_read_b128 v[100:103], v17 offset:15360
  v_mfma_f32_16x16x32_bf16 v[140:143], a[116:119], v[32:35], v[140:143]
  s_waitcnt lgkmcnt(6)
  v_mfma_f32_16x16x32_bf16 v[104:107], a[120:123], v[68:71], v[104:107]
  ds_read_b128 v[32:35], v17 offset:16384
  v_mfma_f32_16x16x32_bf16 v[108:111], a[120:123], v[72:75], v[108:111]
  v_mfma_f32_16x16x32_bf16 v[112:115], a[120:123], v[76:79], v[112:115]
  s_waitcnt lgkmcnt(4)
  ds_read_b128 v[36:39], v17 offset:17408
  v_mfma_f32_16x16x32_bf16 v[116:119], a[120:123], v[80:83], v[116:119]
  v_mfma_f32_16x16x32_bf16 v[120:123], a[120:123], v[84:87], v[120:123]
  ds_read_b128 v[40:43], v17 offset:18432
  v_mfma_f32_16x16x32_bf16 v[124:127], a[120:123], v[88:91], v[124:127]
  s_waitcnt lgkmcnt(3)
  v_mfma_f32_16x16x32_bf16 v[128:131], a[120:123], v[92:95], v[128:131]
  ds_read_b128 v[44:47], v17 offset:19456
  v_mfma_f32_16x16x32_bf16 v[132:135], a[120:123], v[96:99], v[132:135]
  v_mfma_f32_16x16x32_bf16 v[136:139], a[120:123], v[100:103], v[136:139]
  ds_read_b128 v[48:51], v17 offset:20480
  v_mfma_f32_16x16x32_bf16 v[172:175], a[124:127], v[100:103], v[172:175]
  v_mfma_f32_16x16x32_bf16 v[168:171], a[124:127], v[96:99], v[168:171]
  ds_read_b128 v[52:55], v17 offset:21504
  v_mfma_f32_16x16x32_bf16 v[164:167], a[124:127], v[92:95], v[164:167]
  v_mfma_f32_16x16x32_bf16 v[160:163], a[124:127], v[88:91], v[160:163]
  ds_read_b128 v[56:59], v17 offset:22528
  v_mfma_f32_16x16x32_bf16 v[156:159], a[124:127], v[84:87], v[156:159]
  v_mfma_f32_16x16x32_bf16 v[152:155], a[124:127], v[80:83], v[152:155]
  ds_read_b128 v[60:63], v17 offset:23552
  v_mfma_f32_16x16x32_bf16 v[148:151], a[124:127], v[76:79], v[148:151]
  v_mfma_f32_16x16x32_bf16 v[144:147], a[124:127], v[72:75], v[144:147]
  s_waitcnt vmcnt(0)
  ds_read_b128 v[64:67], v17 offset:24576
  v_mfma_f32_16x16x32_bf16 v[140:143], a[124:127], v[68:71], v[140:143]
  s_waitcnt lgkmcnt(6)
  v_mfma_f32_16x16x32_bf16 v[104:107], a[128:131], v[32:35], v[104:107]
  v_mfma_f32_16x16x32_bf16 v[140:143], a[132:135], v[32:35], v[140:143]
  v_mfma_f32_16x16x32_bf16 v[104:107], a[136:139], a[144:147], v[104:107]
  v_mfma_f32_16x16x32_bf16 v[140:143], a[140:143], a[144:147], v[140:143]
  v_mfma_f32_16x16x32_bf16 v[108:111], a[128:131], v[36:39], v[108:111]
  v_mfma_f32_16x16x32_bf16 v[144:147], a[132:135], v[36:39], v[144:147]
  v_mfma_f32_16x16x32_bf16 v[108:111], a[136:139], a[148:151], v[108:111]
  v_mfma_f32_16x16x32_bf16 v[144:147], a[140:143], a[148:151], v[144:147]
  v_mfma_f32_16x16x32_bf16 v[112:115], a[128:131], v[40:43], v[112:115]
  v_mfma_f32_16x16x32_bf16 v[148:151], a[132:135], v[40:43], v[148:151]
  v_mfma_f32_16x16x32_bf16 v[112:115], a[136:139], a[152:155], v[112:115]
  v_fmac_f32 v104, v176, v196
  v_fmac_f32 v105, v178, v196
  v_mfma_f32_16x16x32_bf16 v[148:151], a[140:143], a[152:155], v[148:151]
  s_waitcnt lgkmcnt(3)
  v_fmac_f32 v106, v180, v196
  v_fmac_f32 v107, v182, v196
  v_mfma_f32_16x16x32_bf16 v[116:119], a[128:131], v[44:47], v[116:119]
  v_mul_f32 v104, v104, v177
  v_mul_f32 v105, v105, v179
  v_mfma_f32_16x16x32_bf16 v[152:155], a[132:135], v[44:47], v[152:155]
  v_mul_f32 v106, v106, v181
  v_mul_f32 v107, v107, v183
  v_mfma_f32_16x16x32_bf16 v[116:119], a[136:139], a[156:159], v[116:119]
  v_cvt_pk_bf16_f32 v233, v106, v107
  v_cvt_pk_bf16_f32 v232, v104, v105
  v_mfma_f32_16x16x32_bf16 v[152:155], a[140:143], a[156:159], v[152:155]
  v_fmac_f32 v140, v184, v196
  v_fmac_f32 v141, v186, v196
  v_mfma_f32_16x16x32_bf16 v[120:123], a[128:131], v[48:51], v[120:123]
  v_fmac_f32 v142, v188, v196
  v_fmac_f32 v143, v190, v196
  v_mfma_f32_16x16x32_bf16 v[156:159], a[132:135], v[48:51], v[156:159]
  v_mul_f32 v140, v140, v185
  v_mul_f32 v141, v141, v187
  v_mfma_f32_16x16x32_bf16 v[120:123], a[136:139], a[160:163], v[120:123]
  v_mul_f32 v142, v142, v189
  v_mul_f32 v143, v143, v191
  v_mfma_f32_16x16x32_bf16 v[156:159], a[140:143], a[160:163], v[156:159]
  v_cvt_pk_bf16_f32 v234, v140, v141
  v_cvt_pk_bf16_f32 v235, v142, v143
  buffer_store_dwordx4 v[232:235], v18, s[24:27], s45 offen sc1
  v_mfma_f32_16x16x32_bf16 v[124:127], a[128:131], v[52:55], v[124:127]
  s_add_u32 s45, s45, 65536
  v_fmac_f32 v108, v176, v197
  v_fmac_f32 v109, v178, v197
  v_mfma_f32_16x16x32_bf16 v[160:163], a[132:135], v[52:55], v[160:163]
  v_fmac_f32 v110, v180, v197
  v_fmac_f32 v111, v182, v197
  v_mfma_f32_16x16x32_bf16 v[124:127], a[136:139], a[164:167], v[124:127]
  v_mul_f32 v108, v108, v177
  v_mul_f32 v109, v109, v179
  v_mfma_f32_16x16x32_bf16 v[160:163], a[140:143], a[164:167], v[160:163]
  s_waitcnt lgkmcnt(0)
  v_mul_f32 v110, v110, v181
  v_mul_f32 v111, v111, v183
  v_mfma_f32_16x16x32_bf16 v[128:131], a[128:131], v[56:59], v[128:131]
  v_cvt_pk_bf16_f32 v237, v110, v111
  v_cvt_pk_bf16_f32 v236, v108, v109
  v_mfma_f32_16x16x32_bf16 v[164:167], a[132:135], v[56:59], v[164:167]
  v_fmac_f32 v144, v184, v197
  v_fmac_f32 v145, v186, v197
  v_mfma_f32_16x16x32_bf16 v[128:131], a[136:139], a[168:171], v[128:131]
  v_fmac_f32 v146, v188, v197
  v_fmac_f32 v147, v190, v197
  v_mfma_f32_16x16x32_bf16 v[164:167], a[140:143], a[168:171], v[164:167]
  v_mul_f32 v144, v144, v185
  v_mul_f32 v145, v145, v187
  v_mfma_f32_16x16x32_bf16 v[132:135], a[128:131], v[60:63], v[132:135]
  v_mul_f32 v146, v146, v189
  v_mul_f32 v147, v147, v191
  v_mfma_f32_16x16x32_bf16 v[168:171], a[132:135], v[60:63], v[168:171]
  v_cvt_pk_bf16_f32 v238, v144, v145
  v_cvt_pk_bf16_f32 v239, v146, v147
  buffer_store_dwordx4 v[236:239], v18, s[24:27], s45 offen sc1
  v_mfma_f32_16x16x32_bf16 v[132:135], a[136:139], a[172:175], v[132:135]
  s_add_u32 s45, s45, 65536
  v_fmac_f32 v112, v176, v198
  v_fmac_f32 v113, v178, v198
  v_mfma_f32_16x16x32_bf16 v[168:171], a[140:143], a[172:175], v[168:171]
  v_fmac_f32 v114, v180, v198
  v_fmac_f32 v115, v182, v198
  v_mfma_f32_16x16x32_bf16 v[136:139], a[128:131], v[64:67], v[136:139]
  v_mul_f32 v112, v112, v177
  v_mul_f32 v113, v113, v179
  v_mfma_f32_16x16x32_bf16 v[172:175], a[132:135], v[64:67], v[172:175]
  v_mul_f32 v114, v114, v181
  v_mul_f32 v115, v115, v183
  v_mfma_f32_16x16x32_bf16 v[136:139], a[136:139], a[176:179], v[136:139]
  v_cvt_pk_bf16_f32 v233, v114, v115
  v_cvt_pk_bf16_f32 v232, v112, v113
  v_mfma_f32_16x16x32_bf16 v[172:175], a[140:143], a[176:179], v[172:175]
  v_fmac_f32 v148, v184, v198
  v_fmac_f32 v149, v186, v198
  v_fmac_f32 v150, v188, v198
  v_fmac_f32 v151, v190, v198
  v_mul_f32 v148, v148, v185
  v_mul_f32 v149, v149, v187
  v_mul_f32 v150, v150, v189
  v_mul_f32 v151, v151, v191
  v_cvt_pk_bf16_f32 v234, v148, v149
  v_cvt_pk_bf16_f32 v235, v150, v151
  buffer_store_dwordx4 v[232:235], v18, s[24:27], s45 offen sc1
  s_add_u32 s45, s45, 65536
  v_fmac_f32 v116, v176, v199
  v_fmac_f32 v117, v178, v199
  v_fmac_f32 v118, v180, v199
  v_fmac_f32 v119, v182, v199
  v_mul_f32 v116, v116, v177
  v_mul_f32 v117, v117, v179
  v_mul_f32 v118, v118, v181
  v_mul_f32 v119, v119, v183
  v_cvt_pk_bf16_f32 v236, v116, v117
  v_cvt_pk_bf16_f32 v237, v118, v119
  v_fmac_f32 v152, v184, v199
  v_fmac_f32 v153, v186, v199
  v_fmac_f32 v154, v188, v199
  v_fmac_f32 v155, v190, v199
  v_mul_f32 v152, v152, v185
  v_mul_f32 v153, v153, v187
  v_mul_f32 v154, v154, v189
  v_mul_f32 v155, v155, v191
  v_cvt_pk_bf16_f32 v238, v152, v153
  v_cvt_pk_bf16_f32 v239, v154, v155
  buffer_store_dwordx4 v[236:239], v18, s[24:27], s45 offen sc1
  s_add_u32 s45, s45, 65536
  v_fmac_f32 v120, v176, v200
  v_fmac_f32 v121, v178, v200
  v_fmac_f32 v122, v180, v200
  v_fmac_f32 v123, v182, v200
  v_mul_f32 v120, v120, v177
  v_mul_f32 v121, v121, v179
  v_mul_f32 v122, v122, v181
  v_mul_f32 v123, v123, v183
  v_cvt_pk_bf16_f32 v232, v120, v121
  v_cvt_pk_bf16_f32 v233, v122, v123
  v_fmac_f32 v156, v184, v200
  v_fmac_f32 v157, v186, v200
  v_fmac_f32 v158, v188, v200
  v_fmac_f32 v159, v190, v200
  v_mul_f32 v156, v156, v185
  v_mul_f32 v157, v157, v187
  v_mul_f32 v158, v158, v189
  v_mul_f32 v159, v159, v191
  v_cvt_pk_bf16_f32 v234, v156, v157
  v_cvt_pk_bf16_f32 v235, v158, v159
  buffer_store_dwordx4 v[232:235], v18, s[24:27], s45 offen sc1
  s_add_u32 s45, s45, 65536
  v_fmac_f32 v124, v176, v201
  v_fmac_f32 v125, v178, v201
  v_fmac_f32 v126, v180, v201
  v_fmac_f32 v127, v182, v201
  v_mul_f32 v124, v124, v177
  v_mul_f32 v125, v125, v179
  v_mul_f32 v126, v126, v181
  v_mul_f32 v127, v127, v183
  v_cvt_pk_bf16_f32 v236, v124, v125
  v_cvt_pk_bf16_f32 v237, v126, v127
  v_fmac_f32 v160, v184, v201
  v_fmac_f32 v161, v186, v201
  v_fmac_f32 v162, v188, v201
  v_fmac_f32 v163, v190, v201
  v_mul_f32 v160, v160, v185
  v_mul_f32 v161, v161, v187
  v_mul_f32 v162, v162, v189
  v_mul_f32 v163, v163, v191
  v_cvt_pk_bf16_f32 v238, v160, v161
  v_cvt_pk_bf16_f32 v239, v162, v163
  buffer_store_dwordx4 v[236:239], v18, s[24:27], s45 offen sc1
  s_add_u32 s45, s45, 65536
  v_fmac_f32 v128, v176, v202
  v_fmac_f32 v129, v178, v202
  v_fmac_f32 v130, v180, v202
  v_fmac_f32 v131, v182, v202
  v_mul_f32 v128, v128, v177
  v_mul_f32 v129, v129, v179
  v_mul_f32 v130, v130, v181
  v_mul_f32 v131, v131, v183
  v_cvt_pk_bf16_f32 v232, v128, v129
  v_cvt_pk_bf16_f32 v233, v130, v131
  v_fmac_f32 v164, v184, v202
  v_fmac_f32 v165, v186, v202
  v_fmac_f32 v166, v188, v202
  v_fmac_f32 v167, v190, v202
  v_mul_f32 v164, v164, v185
  v_mul_f32 v165, v165, v187
  v_mul_f32 v166, v166, v189
  v_mul_f32 v167, v167, v191
  v_cvt_pk_bf16_f32 v234, v164, v165
  v_cvt_pk_bf16_f32 v235, v166, v167
  buffer_store_dwordx4 v[232:235], v18, s[24:27], s45 offen sc1
  s_add_u32 s45, s45, 65536
  v_fmac_f32 v132, v176, v203
  v_fmac_f32 v133, v178, v203
  v_fmac_f32 v134, v180, v203
  v_fmac_f32 v135, v182, v203
  v_mul_f32 v132, v132, v177
  v_mul_f32 v133, v133, v179
  v_mul_f32 v134, v134, v181
  v_mul_f32 v135, v135, v183
  v_cvt_pk_bf16_f32 v236, v132, v133
  v_cvt_pk_bf16_f32 v237, v134, v135
  v_fmac_f32 v168, v184, v203
  v_fmac_f32 v169, v186, v203
  v_fmac_f32 v170, v188, v203
  v_fmac_f32 v171, v190, v203
  v_mul_f32 v168, v168, v185
  v_mul_f32 v169, v169, v187
  v_mul_f32 v170, v170, v189
  v_mul_f32 v171, v171, v191
  v_cvt_pk_bf16_f32 v238, v168, v169
  v_cvt_pk_bf16_f32 v239, v170, v171
  buffer_store_dwordx4 v[236:239], v18, s[24:27], s45 offen sc1
  s_add_u32 s45, s45, 65536
  v_fmac_f32 v136, v176, v204
  v_fmac_f32 v137, v178, v204
  v_fmac_f32 v138, v180, v204
  v_fmac_f32 v139, v182, v204
  v_mul_f32 v136, v136, v177
  v_mul_f32 v137, v137, v179
  v_mul_f32 v138, v138, v181
  v_mul_f32 v139, v139, v183
  v_cvt_pk_bf16_f32 v232, v136, v137
  v_cvt_pk_bf16_f32 v233, v138, v139
  v_fmac_f32 v172, v184, v204
  v_fmac_f32 v173, v186, v204
  v_fmac_f32 v174, v188, v204
  v_fmac_f32 v175, v190, v204
  v_mul_f32 v172, v172, v185
  v_mul_f32 v173, v173, v187
  v_mul_f32 v174, v174, v189
  v_mul_f32 v175, v175, v191
  v_cvt_pk_bf16_f32 v234, v172, v173
  v_cvt_pk_bf16_f32 v235, v174, v175
  buffer_store_dwordx4 v[232:235], v18, s[24:27], s45 offen sc1
at_main:
  v_and_b32 v7, 15, v254
  v_lshrrev_b32 v8, 4, v254
  s_and_b32 s6, s2, 7
  s_lshr_b32 s7, s2, 3
  s_lshr_b32 s17, s7, 2
  s_sub_u32 s17, 7, s17
  s_and_b32 s7, s7, 3
  s_lshl_b32 s16, s6, 2
  s_add_u32 s16, s16, s7
  s_lshr_b32 s33, s16, 3
  s_mul_i32 s19, s33, 9
  s_and_b32 s20, s16, 7
  s_add_u32 s21, s19, s20
  s_lshl_b32 s21, s21, 16
  s_add_u32 s22, s19, 8
  s_lshl_b32 s22, s22, 16
  s_and_b32 s23, s6, 1
  s_lshl_b32 s23, s23, 8
  s_add_u32 s23, s23, s22
  s_waitcnt lgkmcnt(0)
  s_mul_i32 s3, s93, 0x9E3779B1
  s_add_u32 s3, s3, 0x7F4A7C15
  v_mov_b32 v253, s3
  s_cmp_ge_u32 s2, 192
  s_cbranch_scc1 at_nosig
  s_waitcnt vmcnt(0)
  s_barrier
  s_cmp_lg_u32 s18, 0
  s_cbranch_scc1 qk_sg
  s_mov_b64 exec, 1
  buffer_store_dword v253, v252, s[96:99], s58 offen sc1
  s_mov_b64 exec, -1
qk_sg:
at_nosig:
  v_min_u32 v255, 11, v254
  v_lshrrev_b32 v9, 2, v255
  v_lshl_add_u32 v9, v9, 2, s33
  v_and_b32 v255, 3, v255
  s_lshl_b32 s24, s17, 1
  s_sub_u32 s24, s24, 2
  v_add_u32 v255, s24, v255
  v_max_i32 v255, 0, v255
  v_lshl_add_u32 v255, v9, 4, v255
  v_lshlrev_b32 v255, 7, v255
  v_add_u32 v9, s21, v1
  v_lshl_add_u32 v10, v7, 4, s23
  v_cmp_gt_u32 vcc, 32, v254
  s_nop 1
  v_cndmask_b32 v9, v10, v9, vcc
  v_bfe_u32 v10, v254, 1, 2
  v_lshlrev_b32 v10, 8, v10
  v_and_b32 v11, 1, v254
  v_lshl_add_u32 v10, v11, 4, v10
  v_bfe_u32 v11, v254, 3, 2
  v_lshl_add_u32 v10, v11, 10, v10
  s_lshl_b32 s24, s20, 5
  s_add_u32 s24, s24, s22
  v_add_u32 v10, s24, v10
  s_lshl_b32 s24, s17, 4
  s_lshl_b32 s25, s18, 2
  s_add_u32 s26, s24, s25
  s_lshl_b32 s27, s26, 9
  s_add_u32 s24, s26, s25
  s_lshl_b32 s24, s24, 9
  s_add_u32 s28, s24, 2351104
  s_add_u32 s29, s24, 4710400
  s_add_u32 s30, s29, s21
  s_mul_i32 s31, s18, 12288
  s_mul_i32 s24, s54, 35782656
  s_add_u32 s24, s24, 4718592
  s_add_u32 s8, s100, s24
  s_addc_u32 s9, s101, 0
  s_and_b32 s9, s9, 0xffff
  s_mov_b32 s10, 7077888
  s_mov_b32 s11, 0x20000
  s_add_u32 s12, s100, 11796480
  s_addc_u32 s13, s101, 0
  s_and_b32 s13, s13, 0xffff
  s_mov_b32 s14, 2359296
  s_mov_b32 s15, 0x20000
  v_mov_b32 v80, 0x3f803f80
  v_mov_b32 v81, 0x3f803f80
  v_mov_b32 v82, 0x3f803f80
  v_mov_b32 v83, 0x3f803f80
  v_mov_b32 v11, 51200
  ds_write_b128 v11, v[80:83]
  v_lshlrev_b32 v11, 2, v8
  v_mov_b32 v12, 0xf149f2ca
  v_add_u32 v13, 0, v11
  v_cmp_gt_u32 vcc, v13, v7
  s_nop 1
  v_cndmask_b32_e64 v160, v12, 0, vcc
  v_cndmask_b32 v164, 0, v12, vcc
  v_add_u32 v13, 1, v11
  v_cmp_gt_u32 vcc, v13, v7
  s_nop 1
  v_cndmask_b32_e64 v161, v12, 0, vcc
  v_cndmask_b32 v165, 0, v12, vcc
  v_add_u32 v13, 2, v11
  v_cmp_gt_u32 vcc, v13, v7
  s_nop 1
  v_cndmask_b32_e64 v162, v12, 0, vcc
  v_cndmask_b32 v166, 0, v12, vcc
  v_add_u32 v13, 3, v11
  v_cmp_gt_u32 vcc, v13, v7
  s_nop 1
  v_cndmask_b32_e64 v163, v12, 0, vcc
  v_cndmask_b32 v167, 0, v12, vcc
  v_mov_b32 v112, 0
  v_mov_b32 v113, 0
  v_mov_b32 v114, 0
  v_mov_b32 v115, 0
  v_mov_b32 v116, 0
  v_mov_b32 v117, 0
  v_mov_b32 v118, 0
  v_mov_b32 v119, 0
  v_mov_b32 v120, 0
  v_mov_b32 v121, 0
  v_mov_b32 v122, 0
  v_mov_b32 v123, 0
  v_mov_b32 v124, 0
  v_mov_b32 v125, 0
  v_mov_b32 v126, 0
  v_mov_b32 v127, 0
  v_mov_b32 v128, 0
  v_mov_b32 v129, 0
  v_mov_b32 v130, 0
  v_mov_b32 v131, 0
  v_mov_b32 v132, 0
  v_mov_b32 v133, 0
  v_mov_b32 v134, 0
  v_mov_b32 v135, 0
  v_mov_b32 v136, 0
  v_mov_b32 v137, 0
  v_mov_b32 v138, 0
  v_mov_b32 v139, 0
  v_mov_b32 v140, 0
  v_mov_b32 v141, 0
  v_mov_b32 v142, 0
  v_mov_b32 v143, 0
  v_mov_b32 v144, 0
  v_mov_b32 v145, 0
  v_mov_b32 v146, 0
  v_mov_b32 v147, 0
  v_mov_b32 v148, 0
  v_mov_b32 v149, 0
  v_mov_b32 v150, 0
  v_mov_b32 v151, 0
  v_mov_b32 v152, 0
  v_mov_b32 v153, 0
  v_mov_b32 v154, 0
  v_mov_b32 v155, 0
  v_mov_b32 v156, 0
  v_mov_b32 v157, 0
  v_mov_b32 v158, 0
  v_mov_b32 v159, 0
  v_mov_b32 v168, 0
  v_mov_b32 v184, v160
  v_mov_b32 v200, v164
  v_mov_b32 v169, 0
  v_mov_b32 v185, v161
  v_mov_b32 v201, v165
  v_mov_b32 v170, 0
  v_mov_b32 v186, v162
  v_mov_b32 v202, v166
  v_mov_b32 v171, 0
  v_mov_b32 v187, v163
  v_mov_b32 v203, v167
  v_mov_b32 v172, 0
  v_mov_b32 v188, v160
  v_mov_b32 v204, v164
  v_mov_b32 v173, 0
  v_mov_b32 v189, v161
  v_mov_b32 v205, v165
  v_mov_b32 v174, 0
  v_mov_b32 v190, v162
  v_mov_b32 v206, v166
  v_mov_b32 v175, 0
  v_mov_b32 v191, v163
  v_mov_b32 v207, v167
  v_mov_b32 v176, 0
  v_mov_b32 v192, v160
  v_mov_b32 v208, v164
  v_mov_b32 v177, 0
  v_mov_b32 v193, v161
  v_mov_b32 v209, v165
  v_mov_b32 v178, 0
  v_mov_b32 v194, v162
  v_mov_b32 v210, v166
  v_mov_b32 v179, 0
  v_mov_b32 v195, v163
  v_mov_b32 v211, v167
  v_mov_b32 v180, 0
  v_mov_b32 v196, v160
  v_mov_b32 v212, v164
  v_mov_b32 v181, 0
  v_mov_b32 v197, v161
  v_mov_b32 v213, v165
  v_mov_b32 v182, 0
  v_mov_b32 v198, v162
  v_mov_b32 v214, v166
  v_mov_b32 v183, 0
  v_mov_b32 v199, v163
  v_mov_b32 v215, v167
  s_lshl_b32 s32, s18, 1
  s_cmp_gt_u32 s17, 0
  s_cselect_b32 s32, s32, 8
  s_mul_i32 s33, s32, 3072
  v_add_u32 v6, s33, v1
  s_lshl_b32 s33, s32, 7
  s_add_u32 s33, s33, 49152
  v_lshl_add_u32 v3, v8, 1, v7
  v_lshl_add_u32 v3, v3, 4, s33
  v_mov_b32 v11, 51200
  v_mov_b32 v4, 128
  v_cmp_gt_u32 vcc, 2, v7
  s_nop 1
  v_cndmask_b32 v5, v11, v3, vcc
  v_cndmask_b32 v4, 0, v4, vcc
  s_lshl_b32 s58, s17, 5
  s_add_u32 s58, s58, s16
  s_lshl_b32 s58, s58, 7
  s_add_u32 s58, s58, s59
  s_add_u32 s58, s58, 32768
  s_add_u32 s50, s2, 128
  s_cmp_lg_u32 s54, 0
  s_cselect_b32 s50, 369, s50
  s_waitcnt lgkmcnt(0)
  s_load_dwordx4 s[60:63], s[0:1], 32
  s_load_dwordx2 s[48:49], s[0:1], 16
  s_load_dwordx2 s[52:53], s[0:1], 48
  s_sub_u32 s47, s50, 9
  s_cmp_lt_u32 s47, 216
  s_cbranch_scc0 pa_rp
  s_cmp_ge_u32 s47, 108
  s_cselect_b32 s44, 1, 0
  s_mul_i32 s45, s44, 108
  s_sub_u32 s47, s47, s45
  s_mul_i32 s45, s47, 43691
  s_lshr_b32 s45, s45, 17
  s_mul_i32 s46, s45, 3
  s_sub_u32 s46, s47, s46
  v_lshrrev_b32 v248, 4, v0
  v_and_b32 v247, 15, v0
  v_mul_u32_u24 v248, 9216, v248
  v_lshl_add_u32 v248, v247, 4, v248
  s_mul_i32 s47, s46, 1769472
  s_lshl_b32 s51, s45, 8
  s_add_u32 s47, s47, s51
  s_cmp_eq_u32 s44, 0
  s_waitcnt lgkmcnt(0)
  s_cselect_b32 s60, s60, s62
  s_cselect_b32 s61, s61, s63
  s_mov_b32 s62, 5308416
  s_branch pa_sd
pa_rp:
  s_mov_b32 s44, 2
  s_sub_u32 s45, s50, 225
  s_cmp_lt_u32 s50, 9
  s_cselect_b32 s45, s50, s45
  s_cselect_b32 s46, 9, 72
  s_cselect_b32 s3, 6, 5
  s_lshl_b32 s47, s45, s3
  s_mul_i32 s51, s45, 1821
  s_lshr_b32 s51, s51, 16
  s_mul_i32 s3, s51, 36
  s_sub_u32 s3, s45, s3
  s_lshr_b32 s3, s3, 2
  s_lshl_b32 s3, s3, 4
  s_mul_i32 s51, s51, 1152
  s_add_u32 s51, s51, s3
  s_cmp_lt_u32 s50, 9
  v_lshrrev_b32 v240, 3, v0
  v_add_u32 v240, s47, v240
  v_lshrrev_b32 v241, 4, v240
  v_mul_u32_u24 v242, 18, v241
  v_and_b32 v243, 15, v240
  v_add_u32 v242, v242, v243
  v_and_b32 v243, 1, v241
  v_lshl_add_u32 v242, v243, 1, v242
  v_bfe_u32 v241, v240, 1, 5
  v_mul_u32_u24 v243, 18, v241
  v_and_b32 v244, 1, v240
  v_add_u32 v243, v243, v244
  v_and_b32 v244, 1, v241
  v_xor_b32 v244, 1, v244
  v_lshl_add_u32 v243, v244, 4, v243
  v_cmp_gt_u32 vcc, 512, v240
  s_nop 1
  v_cndmask_b32 v242, v243, v242, vcc
  v_bfe_u32 v241, v240, 4, 3
  v_mul_u32_u24 v241, 144, v241
  v_and_b32 v243, 15, v240
  v_add3_u32 v240, v241, v243, s51
  s_cselect_b64 vcc, -1, 0
  v_cndmask_b32 v240, v240, v242, vcc
  v_mul_u32_u24 v240, 1152, v240
  v_and_b32 v241, 7, v0
  v_lshl_add_u32 v247, v241, 4, v240
  v_lshrrev_b32 v240, 3, v0
  v_add_u32 v240, s47, v240
  v_add_u32 v240, 32, v240
  v_lshrrev_b32 v241, 4, v240
  v_mul_u32_u24 v242, 18, v241
  v_and_b32 v243, 15, v240
  v_add_u32 v242, v242, v243
  v_and_b32 v243, 1, v241
  v_lshl_add_u32 v242, v243, 1, v242
  v_bfe_u32 v241, v240, 1, 5
  v_mul_u32_u24 v243, 18, v241
  v_and_b32 v244, 1, v240
  v_add_u32 v243, v243, v244
  v_and_b32 v244, 1, v241
  v_xor_b32 v244, 1, v244
  v_lshl_add_u32 v243, v244, 4, v243
  v_cmp_gt_u32 vcc, 512, v240
  s_nop 1
  v_cndmask_b32 v242, v243, v242, vcc
  v_bfe_u32 v241, v240, 4, 3
  v_mul_u32_u24 v241, 144, v241
  v_and_b32 v243, 15, v240
  v_add3_u32 v240, v241, v243, s51
  s_cselect_b64 vcc, -1, 0
  v_cndmask_b32 v240, v240, v242, vcc
  v_mul_u32_u24 v240, 1152, v240
  v_and_b32 v241, 7, v0
  v_lshl_add_u32 v248, v241, 4, v240
  s_waitcnt lgkmcnt(0)
  s_cselect_b32 s60, s48, s52
  s_cselect_b32 s61, s49, s53
  s_mov_b32 s62, 5308416
  s_cselect_b32 s62, 663552, s62
pa_sd:
  s_and_b32 s61, s61, 0xffff
  s_mov_b32 s63, 0x20000
  s_cmp_lg_u32 s18, 0
  s_cbranch_scc1 at_wn
  s_mov_b32 s3, 150000
at_wl:
  buffer_load_dword v249, v255, s[96:99], s59 offen sc1
  s_waitcnt vmcnt(0)
  v_cmp_ne_u32 vcc, v253, v249
  s_nop 1
  s_cmp_eq_u64 vcc, 0
  s_cbranch_scc1 at_wd
  s_sub_u32 s3, s3, 1
  s_cmp_lg_u32 s3, 0
  s_cbranch_scc1 at_wl
at_wn:
  s_waitcnt vmcnt(0)
at_wd:
  s_barrier
  s_add_u32 m0, s31, 0
  s_add_u32 s24, s28, 0
  buffer_load_dwordx4 v9, s[8:11], s24 offen sc1 lds
  s_add_u32 m0, s31, 1024
  s_add_u32 s24, s28, 512
  buffer_load_dwordx4 v9, s[8:11], s24 offen sc1 lds
  s_add_u32 m0, s31, 3072
  s_add_u32 s24, s28, 1024
  buffer_load_dwordx4 v9, s[8:11], s24 offen sc1 lds
  s_add_u32 m0, s31, 4096
  s_add_u32 s24, s28, 1536
  buffer_load_dwordx4 v9, s[8:11], s24 offen sc1 lds
  s_add_u32 m0, s31, 6144
  s_add_u32 s24, s28, 2048
  buffer_load_dwordx4 v9, s[8:11], s24 offen sc1 lds
  s_add_u32 m0, s31, 7168
  s_add_u32 s24, s28, 2560
  buffer_load_dwordx4 v9, s[8:11], s24 offen sc1 lds
  s_add_u32 m0, s31, 9216
  s_add_u32 s24, s28, 3072
  buffer_load_dwordx4 v9, s[8:11], s24 offen sc1 lds
  s_add_u32 m0, s31, 10240
  s_add_u32 s24, s28, 3584
  buffer_load_dwordx4 v9, s[8:11], s24 offen sc1 lds
  buffer_load_dwordx4 v[16:19], v9, s[8:11], s27 offen offset:0 sc1
  buffer_load_dwordx4 v[20:23], v9, s[8:11], s27 offen offset:512 sc1
  buffer_load_dwordx4 v[24:27], v9, s[8:11], s27 offen offset:1024 sc1
  buffer_load_dwordx4 v[28:31], v9, s[8:11], s27 offen offset:1536 sc1
  s_add_u32 m0, s31, 2048
  s_add_u32 s24, s30, 0
  buffer_load_dwordx4 v1, s[8:11], s24 offen sc1 lds
  s_add_u32 m0, s31, 5120
  s_add_u32 s24, s30, 1024
  buffer_load_dwordx4 v1, s[8:11], s24 offen sc1 lds
  s_add_u32 m0, s31, 8192
  s_add_u32 s24, s30, 2048
  buffer_load_dwordx4 v1, s[8:11], s24 offen sc1 lds
  s_add_u32 m0, s31, 11264
  s_add_u32 s24, s30, 3072
  buffer_load_dwordx4 v1, s[8:11], s24 offen sc1 lds
  s_lshl_b32 s24, s18, 9
  s_add_u32 m0, s24, 49152
  s_mov_b32 exec_hi, 0
  buffer_load_dwordx4 v10, s[8:11], s29 offen sc1 lds
  s_mov_b32 exec_hi, -1
  v_min_u32 v255, 8, v254
  v_lshlrev_b32 v255, 7, v255
  s_mov_b32 s35, 524288
  buffer_load_dword v246, v255, s[96:99], s35 offen sc1
  s_cmp_ge_u32 s50, 369
  s_cbranch_scc1 at_nojob
  s_cmp_eq_u32 s44, 2
  s_cbranch_scc1 pa_lr0
  buffer_load_dwordx4 a[184:187], v248, s[60:63], s47 offen nt
  s_add_u32 s47, s47, 147456
  buffer_load_dwordx4 a[188:191], v248, s[60:63], s47 offen nt
  s_add_u32 s47, s47, 147456
  buffer_load_dwordx4 a[192:195], v248, s[60:63], s47 offen nt
  s_add_u32 s47, s47, 147456
  buffer_load_dwordx4 a[196:199], v248, s[60:63], s47 offen nt
  s_add_u32 s47, s47, 147456
  buffer_load_dwordx4 a[200:203], v248, s[60:63], s47 offen nt
  s_add_u32 s47, s47, 147456
  buffer_load_dwordx4 a[204:207], v248, s[60:63], s47 offen nt
  s_add_u32 s47, s47, 147456
  buffer_load_dwordx4 a[208:211], v248, s[60:63], s47 offen nt
  s_add_u32 s47, s47, 147456
  buffer_load_dwordx4 a[212:215], v248, s[60:63], s47 offen nt
  s_add_u32 s47, s47, 147456
  buffer_load_dwordx4 a[216:219], v248, s[60:63], s47 offen nt
  s_add_u32 s47, s47, 147456
  s_branch pa_ld0
pa_lr0:
  buffer_load_dwordx4 a[184:187], v247, s[60:63], 0 offen offset:0 nt
  buffer_load_dwordx4 a[188:191], v247, s[60:63], 0 offen offset:128 nt
  buffer_load_dwordx4 a[192:195], v247, s[60:63], 0 offen offset:256 nt
  buffer_load_dwordx4 a[196:199], v247, s[60:63], 0 offen offset:384 nt
  buffer_load_dwordx4 a[200:203], v247, s[60:63], 0 offen offset:512 nt
  buffer_load_dwordx4 a[204:207], v247, s[60:63], 0 offen offset:640 nt
  buffer_load_dwordx4 a[208:211], v247, s[60:63], 0 offen offset:768 nt
  buffer_load_dwordx4 a[212:215], v247, s[60:63], 0 offen offset:896 nt
  buffer_load_dwordx4 a[216:219], v247, s[60:63], 0 offen offset:1024 nt
pa_ld0:
  s_waitcnt vmcnt(15)
  s_branch at_job
at_nojob:
  s_waitcnt vmcnt(6)
at_job:
  s_cmp_eq_u32 s7, 0
  s_cselect_b32 s24, 48, 32
  v_cmp_gt_u32 vcc, s24, v254
  s_nop 1
  v_cndmask_b32 v16, 0, v16, vcc
  v_cndmask_b32 v20, 0, v20, vcc
  v_cndmask_b32 v24, 0, v24, vcc
  v_cndmask_b32 v28, 0, v28, vcc
  s_cmp_eq_u32 s7, 1
  s_cselect_b32 s24, 48, 32
  v_cmp_gt_u32 vcc, s24, v254
  s_nop 1
  v_cndmask_b32 v17, 0, v17, vcc
  v_cndmask_b32 v21, 0, v21, vcc
  v_cndmask_b32 v25, 0, v25, vcc
  v_cndmask_b32 v29, 0, v29, vcc
  s_cmp_eq_u32 s7, 2
  s_cselect_b32 s24, 48, 32
  v_cmp_gt_u32 vcc, s24, v254
  s_nop 1
  v_cndmask_b32 v18, 0, v18, vcc
  v_cndmask_b32 v22, 0, v22, vcc
  v_cndmask_b32 v26, 0, v26, vcc
  v_cndmask_b32 v30, 0, v30, vcc
  s_cmp_eq_u32 s7, 3
  s_cselect_b32 s24, 48, 32
  v_cmp_gt_u32 vcc, s24, v254
  s_nop 1
  v_cndmask_b32 v19, 0, v19, vcc
  v_cndmask_b32 v23, 0, v23, vcc
  v_cndmask_b32 v27, 0, v27, vcc
  v_cndmask_b32 v31, 0, v31, vcc
  s_mov_b32 s29, 0
  s_waitcnt lgkmcnt(0)
  s_barrier
at_p2:
  v_mov_b32 v2, v6
  v_mov_b32 v3, v5
  s_cmp_eq_u32 s17, 0
  s_cbranch_scc1 at_p2_q0
  ds_read_b128 v[32:35], v2
  ds_read_b128 v[36:39], v2 offset:1024
  s_waitcnt lgkmcnt(0)
  v_mfma_f32_16x16x32_bf16 v[48:51], v[32:35], v[16:19], v[184:187]
  v_mfma_f32_16x16x32_bf16 v[64:67], v[36:39], v[16:19], v[168:171]
  v_mfma_f32_16x16x32_bf16 v[68:71], v[36:39], v[20:23], v[188:191]
  ds_read_b128 v[32:35], v2 offset:3072
  ds_read_b128 v[36:39], v2 offset:4096
  ds_read_b128 v[40:43], v2 offset:2048
  ds_read_b128 v[44:47], v3
  s_nop 5
  v_exp_f32 v80, v48
  v_exp_f32 v81, v49
  v_exp_f32 v82, v50
  v_exp_f32 v83, v51
  s_waitcnt lgkmcnt(3)
  v_mfma_f32_16x16x32_bf16 v[48:51], v[32:35], v[16:19], v[168:171]
  s_waitcnt lgkmcnt(0)
  v_mfma_f32_16x16x32_bf16 v[52:55], v[32:35], v[20:23], v[172:175]
  v_mfma_f32_16x16x32_bf16 v[56:59], v[32:35], v[24:27], v[192:195]
  ds_read_b128 v[32:35], v2 offset:6144
  v_exp_f32 v96, v64
  v_exp_f32 v97, v65
  v_exp_f32 v98, v66
  v_exp_f32 v99, v67
  v_mfma_f32_16x16x32_bf16 v[64:67], v[36:39], v[16:19], v[168:171]
  v_exp_f32 v100, v68
  v_exp_f32 v101, v69
  v_exp_f32 v102, v70
  v_exp_f32 v103, v71
  v_mfma_f32_16x16x32_bf16 v[68:71], v[36:39], v[20:23], v[172:175]
  v_mfma_f32_16x16x32_bf16 v[72:75], v[36:39], v[24:27], v[176:179]
  v_mfma_f32_16x16x32_bf16 v[76:79], v[36:39], v[28:31], v[196:199]
  ds_read_b128 v[36:39], v2 offset:7168
  v_cvt_pk_bf16_f32 v112, v80, v81
  v_cvt_pk_bf16_f32 v113, v82, v83
  s_cmp_lg_u32 s29, 0
  s_cbranch_scc1 at_v1
  s_mov_b32 s3, 150000
  s_waitcnt vmcnt(9)
  s_cmp_lt_u32 s50, 369
  s_cbranch_scc1 at_h1_chk
at_h1_wl:
  s_waitcnt vmcnt(0)
at_h1_chk:
  v_cmp_ne_u32 vcc, v253, v246
  s_nop 1
  s_cmp_eq_u64 vcc, 0
  s_cbranch_scc1 at_h1_wd
  buffer_load_dword v246, v255, s[96:99], s35 offen sc1
  s_sub_u32 s3, s3, 1
  s_cmp_lg_u32 s3, 0
  s_cbranch_scc1 at_h1_wl
  s_waitcnt vmcnt(0)
at_h1_wd:
  s_cmp_ge_u32 s50, 369
  s_cbranch_scc1 at_h1_nj
  s_cmp_eq_u32 s44, 2
  s_cbranch_scc1 at_h1_lr1
  buffer_load_dwordx4 a[220:223], v248, s[60:63], s47 offen nt
  s_add_u32 s47, s47, 147456
  buffer_load_dwordx4 a[224:227], v248, s[60:63], s47 offen nt
  s_add_u32 s47, s47, 147456
  buffer_load_dwordx4 a[228:231], v248, s[60:63], s47 offen nt
  s_branch at_h1_ld1
at_h1_lr1:
  s_cmp_eq_u32 s46, 72
  s_cbranch_scc1 at_h1_ld1
  buffer_load_dwordx4 a[220:223], v248, s[60:63], 0 offen offset:0 nt
  buffer_load_dwordx4 a[224:227], v248, s[60:63], 0 offen offset:128 nt
  buffer_load_dwordx4 a[228:231], v248, s[60:63], 0 offen offset:256 nt
  buffer_load_dwordx4 a[232:235], v248, s[60:63], 0 offen offset:384 nt
  buffer_load_dwordx4 a[236:239], v248, s[60:63], 0 offen offset:512 nt
  buffer_load_dwordx4 a[240:243], v248, s[60:63], 0 offen offset:640 nt
  buffer_load_dwordx4 a[244:247], v248, s[60:63], 0 offen offset:768 nt
  buffer_load_dwordx4 a[248:251], v248, s[60:63], 0 offen offset:896 nt
  buffer_load_dwordx4 a[252:255], v248, s[60:63], 0 offen offset:1024 nt
at_h1_ld1:
at_h1_nj:
  s_barrier
at_v1:
  ds_read_b128 v[40:43], v2 offset:2048
  ds_read_b128 v[44:47], v3
  v_cvt_pk_bf16_f32 v114, v96, v97
  v_cvt_pk_bf16_f32 v115, v98, v99
  v_mov_b32 v116, 0
  v_mov_b32 v117, 0
  v_cvt_pk_bf16_f32 v118, v100, v101
  v_cvt_pk_bf16_f32 v119, v102, v103
  v_add_u32 v3, v3, v4
  v_add_u32 v2, 3072, v2
  v_exp_f32 v80, v48
  v_exp_f32 v81, v49
  v_exp_f32 v82, v50
  v_exp_f32 v83, v51
  s_waitcnt lgkmcnt(3)
  v_mfma_f32_16x16x32_bf16 v[48:51], v[32:35], v[16:19], v[168:171]
  v_exp_f32 v84, v52
  v_exp_f32 v85, v53
  s_waitcnt lgkmcnt(0)
  v_mfma_f32_16x16x32_bf16 v[128:131], v[40:43], v[112:115], v[128:131]
  v_exp_f32 v86, v54
  v_exp_f32 v87, v55
  v_mfma_f32_16x16x32_bf16 v[52:55], v[32:35], v[20:23], v[172:175]
  v_exp_f32 v88, v56
  v_exp_f32 v89, v57
  v_mfma_f32_16x16x32_bf16 v[144:147], v[44:47], v[112:115], v[144:147]
  v_exp_f32 v90, v58
  v_exp_f32 v91, v59
  v_mfma_f32_16x16x32_bf16 v[56:59], v[32:35], v[24:27], v[176:179]
  v_mfma_f32_16x16x32_bf16 v[132:135], v[40:43], v[116:119], v[132:135]
  v_mfma_f32_16x16x32_bf16 v[60:63], v[32:35], v[28:31], v[180:183]
  ds_read_b128 v[32:35], v2 offset:6144
  v_exp_f32 v96, v64
  v_exp_f32 v97, v65
  v_mfma_f32_16x16x32_bf16 v[148:151], v[44:47], v[116:119], v[148:151]
  v_exp_f32 v98, v66
  v_exp_f32 v99, v67
  v_mfma_f32_16x16x32_bf16 v[64:67], v[36:39], v[16:19], v[168:171]
  v_exp_f32 v100, v68
  v_exp_f32 v101, v69
  v_exp_f32 v102, v70
  v_exp_f32 v103, v71
  v_mfma_f32_16x16x32_bf16 v[68:71], v[36:39], v[20:23], v[172:175]
  v_exp_f32 v104, v72
  v_exp_f32 v105, v73
  v_exp_f32 v106, v74
  v_exp_f32 v107, v75
  v_mfma_f32_16x16x32_bf16 v[72:75], v[36:39], v[24:27], v[176:179]
  v_exp_f32 v108, v76
  v_exp_f32 v109, v77
  v_exp_f32 v110, v78
  v_exp_f32 v111, v79
  v_mfma_f32_16x16x32_bf16 v[76:79], v[36:39], v[28:31], v[180:183]
  ds_read_b128 v[36:39], v2 offset:7168
  v_cvt_pk_bf16_f32 v112, v80, v81
  v_cvt_pk_bf16_f32 v113, v82, v83
  ds_read_b128 v[40:43], v2 offset:2048
  ds_read_b128 v[44:47], v3
  v_cvt_pk_bf16_f32 v114, v96, v97
  v_cvt_pk_bf16_f32 v115, v98, v99
  v_cvt_pk_bf16_f32 v116, v84, v85
  v_cvt_pk_bf16_f32 v117, v86, v87
  v_cvt_pk_bf16_f32 v118, v100, v101
  v_cvt_pk_bf16_f32 v119, v102, v103
  v_cvt_pk_bf16_f32 v120, v88, v89
  v_cvt_pk_bf16_f32 v121, v90, v91
  v_cvt_pk_bf16_f32 v122, v104, v105
  v_cvt_pk_bf16_f32 v123, v106, v107
  v_mov_b32 v124, 0
  v_mov_b32 v125, 0
  v_cvt_pk_bf16_f32 v126, v108, v109
  v_cvt_pk_bf16_f32 v127, v110, v111
  v_add_u32 v3, v3, v4
  v_add_u32 v2, 3072, v2
  s_mov_b32 s34, 5
  s_branch at_p2_loop
at_p2_q0:
  s_cmp_eq_u32 s18, 0
  s_cbranch_scc0 at_p2_q0b
  ds_read_b128 v[32:35], v2
  ds_read_b128 v[36:39], v2 offset:1024
  s_waitcnt lgkmcnt(0)
  v_mfma_f32_16x16x32_bf16 v[48:51], v[32:35], v[16:19], v[200:203]
  v_mfma_f32_16x16x32_bf16 v[52:55], v[32:35], v[20:23], v[172:175]
  v_mfma_f32_16x16x32_bf16 v[56:59], v[32:35], v[24:27], v[176:179]
  v_mfma_f32_16x16x32_bf16 v[60:63], v[32:35], v[28:31], v[180:183]
  v_mfma_f32_16x16x32_bf16 v[68:71], v[36:39], v[20:23], v[204:207]
  v_mfma_f32_16x16x32_bf16 v[72:75], v[36:39], v[24:27], v[176:179]
  v_mfma_f32_16x16x32_bf16 v[76:79], v[36:39], v[28:31], v[180:183]
  ds_read_b128 v[32:35], v2 offset:3072
  ds_read_b128 v[36:39], v2 offset:4096
  s_cmp_lg_u32 s29, 0
  s_cbranch_scc1 at_v2
  s_mov_b32 s3, 150000
  s_waitcnt vmcnt(9)
  s_cmp_lt_u32 s50, 369
  s_cbranch_scc1 at_h2_chk
at_h2_wl:
  s_waitcnt vmcnt(0)
at_h2_chk:
  v_cmp_ne_u32 vcc, v253, v246
  s_nop 1
  s_cmp_eq_u64 vcc, 0
  s_cbranch_scc1 at_h2_wd
  buffer_load_dword v246, v255, s[96:99], s35 offen sc1
  s_sub_u32 s3, s3, 1
  s_cmp_lg_u32 s3, 0
  s_cbranch_scc1 at_h2_wl
  s_waitcnt vmcnt(0)
at_h2_wd:
  s_cmp_ge_u32 s50, 369
  s_cbranch_scc1 at_h2_nj
  s_cmp_eq_u32 s44, 2
  s_cbranch_scc1 at_h2_lr1
  buffer_load_dwordx4 a[220:223], v248, s[60:63], s47 offen nt
  s_add_u32 s47, s47, 147456
  buffer_load_dwordx4 a[224:227], v248, s[60:63], s47 offen nt
  s_add_u32 s47, s47, 147456
  buffer_load_dwordx4 a[228:231], v248, s[60:63], s47 offen nt
  s_branch at_h2_ld1
at_h2_lr1:
  s_cmp_eq_u32 s46, 72
  s_cbranch_scc1 at_h2_ld1
  buffer_load_dwordx4 a[220:223], v248, s[60:63], 0 offen offset:0 nt
  buffer_load_dwordx4 a[224:227], v248, s[60:63], 0 offen offset:128 nt
  buffer_load_dwordx4 a[228:231], v248, s[60:63], 0 offen offset:256 nt
  buffer_load_dwordx4 a[232:235], v248, s[60:63], 0 offen offset:384 nt
  buffer_load_dwordx4 a[236:239], v248, s[60:63], 0 offen offset:512 nt
  buffer_load_dwordx4 a[240:243], v248, s[60:63], 0 offen offset:640 nt
  buffer_load_dwordx4 a[244:247], v248, s[60:63], 0 offen offset:768 nt
  buffer_load_dwordx4 a[248:251], v248, s[60:63], 0 offen offset:896 nt
  buffer_load_dwordx4 a[252:255], v248, s[60:63], 0 offen offset:1024 nt
at_h2_ld1:
at_h2_nj:
  s_barrier
at_v2:
  ds_read_b128 v[40:43], v2 offset:2048
  ds_read_b128 v[44:47], v3
  s_nop 5
  s_branch at_p2_8
at_p2_q0b:
  ds_read_b128 v[32:35], v2
  ds_read_b128 v[36:39], v2 offset:1024
  s_waitcnt lgkmcnt(0)
  v_mfma_f32_16x16x32_bf16 v[48:51], v[32:35], v[16:19], v[168:171]
  v_mfma_f32_16x16x32_bf16 v[52:55], v[32:35], v[20:23], v[172:175]
  v_mfma_f32_16x16x32_bf16 v[56:59], v[32:35], v[24:27], v[176:179]
  v_mfma_f32_16x16x32_bf16 v[60:63], v[32:35], v[28:31], v[180:183]
  v_mfma_f32_16x16x32_bf16 v[64:67], v[36:39], v[16:19], v[168:171]
  v_mfma_f32_16x16x32_bf16 v[68:71], v[36:39], v[20:23], v[172:175]
  v_mfma_f32_16x16x32_bf16 v[72:75], v[36:39], v[24:27], v[176:179]
  v_mfma_f32_16x16x32_bf16 v[76:79], v[36:39], v[28:31], v[180:183]
  ds_read_b128 v[32:35], v2 offset:3072
  ds_read_b128 v[36:39], v2 offset:4096
  s_cmp_lg_u32 s29, 0
  s_cbranch_scc1 at_v3
  s_mov_b32 s3, 150000
  s_waitcnt vmcnt(9)
  s_cmp_lt_u32 s50, 369
  s_cbranch_scc1 at_h3_chk
at_h3_wl:
  s_waitcnt vmcnt(0)
at_h3_chk:
  v_cmp_ne_u32 vcc, v253, v246
  s_nop 1
  s_cmp_eq_u64 vcc, 0
  s_cbranch_scc1 at_h3_wd
  buffer_load_dword v246, v255, s[96:99], s35 offen sc1
  s_sub_u32 s3, s3, 1
  s_cmp_lg_u32 s3, 0
  s_cbranch_scc1 at_h3_wl
  s_waitcnt vmcnt(0)
at_h3_wd:
  s_cmp_ge_u32 s50, 369
  s_cbranch_scc1 at_h3_nj
  s_cmp_eq_u32 s44, 2
  s_cbranch_scc1 at_h3_lr1
  buffer_load_dwordx4 a[220:223], v248, s[60:63], s47 offen nt
  s_add_u32 s47, s47, 147456
  buffer_load_dwordx4 a[224:227], v248, s[60:63], s47 offen nt
  s_add_u32 s47, s47, 147456
  buffer_load_dwordx4 a[228:231], v248, s[60:63], s47 offen nt
  s_branch at_h3_ld1
at_h3_lr1:
  s_cmp_eq_u32 s46, 72
  s_cbranch_scc1 at_h3_ld1
  buffer_load_dwordx4 a[220:223], v248, s[60:63], 0 offen offset:0 nt
  buffer_load_dwordx4 a[224:227], v248, s[60:63], 0 offen offset:128 nt
  buffer_load_dwordx4 a[228:231], v248, s[60:63], 0 offen offset:256 nt
  buffer_load_dwordx4 a[232:235], v248, s[60:63], 0 offen offset:384 nt
  buffer_load_dwordx4 a[236:239], v248, s[60:63], 0 offen offset:512 nt
  buffer_load_dwordx4 a[240:243], v248, s[60:63], 0 offen offset:640 nt
  buffer_load_dwordx4 a[244:247], v248, s[60:63], 0 offen offset:768 nt
  buffer_load_dwordx4 a[248:251], v248, s[60:63], 0 offen offset:896 nt
  buffer_load_dwordx4 a[252:255], v248, s[60:63], 0 offen offset:1024 nt
at_h3_ld1:
at_h3_nj:
  s_barrier
at_v3:
  ds_read_b128 v[40:43], v2 offset:2048
  ds_read_b128 v[44:47], v3
  s_nop 5
  s_lshl_b32 s34, s18, 1
  s_sub_u32 s34, s34, 1
at_p2_loop:
  v_exp_f32 v80, v48
  v_exp_f32 v81, v49
  v_exp_f32 v82, v50
  v_exp_f32 v83, v51
  s_waitcnt lgkmcnt(3)
  v_mfma_f32_16x16x32_bf16 v[48:51], v[32:35], v[16:19], v[168:171]
  v_exp_f32 v84, v52
  v_exp_f32 v85, v53
  s_waitcnt lgkmcnt(0)
  v_mfma_f32_16x16x32_bf16 v[128:131], v[40:43], v[112:115], v[128:131]
  v_exp_f32 v86, v54
  v_exp_f32 v87, v55
  v_mfma_f32_16x16x32_bf16 v[52:55], v[32:35], v[20:23], v[172:175]
  v_exp_f32 v88, v56
  v_exp_f32 v89, v57
  v_mfma_f32_16x16x32_bf16 v[144:147], v[44:47], v[112:115], v[144:147]
  v_exp_f32 v90, v58
  v_exp_f32 v91, v59
  v_mfma_f32_16x16x32_bf16 v[56:59], v[32:35], v[24:27], v[176:179]
  v_exp_f32 v92, v60
  v_exp_f32 v93, v61
  v_mfma_f32_16x16x32_bf16 v[132:135], v[40:43], v[116:119], v[132:135]
  v_exp_f32 v94, v62
  v_exp_f32 v95, v63
  v_mfma_f32_16x16x32_bf16 v[60:63], v[32:35], v[28:31], v[180:183]
  ds_read_b128 v[32:35], v2 offset:6144
  v_exp_f32 v96, v64
  v_exp_f32 v97, v65
  v_mfma_f32_16x16x32_bf16 v[148:151], v[44:47], v[116:119], v[148:151]
  v_exp_f32 v98, v66
  v_exp_f32 v99, v67
  v_mfma_f32_16x16x32_bf16 v[64:67], v[36:39], v[16:19], v[168:171]
  v_exp_f32 v100, v68
  v_exp_f32 v101, v69
  v_mfma_f32_16x16x32_bf16 v[136:139], v[40:43], v[120:123], v[136:139]
  v_exp_f32 v102, v70
  v_exp_f32 v103, v71
  v_mfma_f32_16x16x32_bf16 v[68:71], v[36:39], v[20:23], v[172:175]
  v_exp_f32 v104, v72
  v_exp_f32 v105, v73
  v_mfma_f32_16x16x32_bf16 v[152:155], v[44:47], v[120:123], v[152:155]
  v_exp_f32 v106, v74
  v_exp_f32 v107, v75
  v_mfma_f32_16x16x32_bf16 v[72:75], v[36:39], v[24:27], v[176:179]
  v_exp_f32 v108, v76
  v_exp_f32 v109, v77
  v_mfma_f32_16x16x32_bf16 v[140:143], v[40:43], v[124:127], v[140:143]
  v_exp_f32 v110, v78
  v_exp_f32 v111, v79
  v_mfma_f32_16x16x32_bf16 v[76:79], v[36:39], v[28:31], v[180:183]
  ds_read_b128 v[36:39], v2 offset:7168
  v_cvt_pk_bf16_f32 v112, v80, v81
  v_cvt_pk_bf16_f32 v113, v82, v83
  v_mfma_f32_16x16x32_bf16 v[156:159], v[44:47], v[124:127], v[156:159]
  ds_read_b128 v[40:43], v2 offset:2048
  ds_read_b128 v[44:47], v3
  v_cvt_pk_bf16_f32 v114, v96, v97
  v_cvt_pk_bf16_f32 v115, v98, v99
  v_cvt_pk_bf16_f32 v116, v84, v85
  v_cvt_pk_bf16_f32 v117, v86, v87
  v_cvt_pk_bf16_f32 v118, v100, v101
  v_cvt_pk_bf16_f32 v119, v102, v103
  v_cvt_pk_bf16_f32 v120, v88, v89
  v_cvt_pk_bf16_f32 v121, v90, v91
  v_cvt_pk_bf16_f32 v122, v104, v105
  v_cvt_pk_bf16_f32 v123, v106, v107
  v_cvt_pk_bf16_f32 v124, v92, v93
  v_cvt_pk_bf16_f32 v125, v94, v95
  v_cvt_pk_bf16_f32 v126, v108, v109
  v_cvt_pk_bf16_f32 v127, v110, v111
  v_add_u32 v3, v3, v4
  v_add_u32 v2, 3072, v2
  s_sub_u32 s34, s34, 1
  s_cmp_lg_u32 s34, 0
  s_cbranch_scc1 at_p2_loop
  v_exp_f32 v80, v48
  v_exp_f32 v81, v49
  v_exp_f32 v82, v50
  v_exp_f32 v83, v51
  s_waitcnt lgkmcnt(3)
  v_mfma_f32_16x16x32_bf16 v[48:51], v[32:35], v[16:19], v[200:203]
  v_exp_f32 v84, v52
  v_exp_f32 v85, v53
  s_waitcnt lgkmcnt(0)
  v_mfma_f32_16x16x32_bf16 v[128:131], v[40:43], v[112:115], v[128:131]
  v_exp_f32 v86, v54
  v_exp_f32 v87, v55
  v_mfma_f32_16x16x32_bf16 v[52:55], v[32:35], v[20:23], v[172:175]
  v_exp_f32 v88, v56
  v_exp_f32 v89, v57
  v_mfma_f32_16x16x32_bf16 v[144:147], v[44:47], v[112:115], v[144:147]
  v_exp_f32 v90, v58
  v_exp_f32 v91, v59
  v_mfma_f32_16x16x32_bf16 v[56:59], v[32:35], v[24:27], v[176:179]
  v_exp_f32 v92, v60
  v_exp_f32 v93, v61
  v_mfma_f32_16x16x32_bf16 v[132:135], v[40:43], v[116:119], v[132:135]
  v_exp_f32 v94, v62
  v_exp_f32 v95, v63
  v_mfma_f32_16x16x32_bf16 v[60:63], v[32:35], v[28:31], v[180:183]
  ds_read_b128 v[32:35], v2 offset:6144
  v_exp_f32 v96, v64
  v_exp_f32 v97, v65
  v_mfma_f32_16x16x32_bf16 v[148:151], v[44:47], v[116:119], v[148:151]
  v_exp_f32 v98, v66
  v_exp_f32 v99, v67
  v_exp_f32 v100, v68
  v_exp_f32 v101, v69
  v_mfma_f32_16x16x32_bf16 v[136:139], v[40:43], v[120:123], v[136:139]
  v_exp_f32 v102, v70
  v_exp_f32 v103, v71
  v_mfma_f32_16x16x32_bf16 v[68:71], v[36:39], v[20:23], v[204:207]
  v_exp_f32 v104, v72
  v_exp_f32 v105, v73
  v_mfma_f32_16x16x32_bf16 v[152:155], v[44:47], v[120:123], v[152:155]
  v_exp_f32 v106, v74
  v_exp_f32 v107, v75
  v_mfma_f32_16x16x32_bf16 v[72:75], v[36:39], v[24:27], v[176:179]
  v_exp_f32 v108, v76
  v_exp_f32 v109, v77
  v_mfma_f32_16x16x32_bf16 v[140:143], v[40:43], v[124:127], v[140:143]
  v_exp_f32 v110, v78
  v_exp_f32 v111, v79
  v_mfma_f32_16x16x32_bf16 v[76:79], v[36:39], v[28:31], v[180:183]
  ds_read_b128 v[36:39], v2 offset:7168
  v_cvt_pk_bf16_f32 v112, v80, v81
  v_cvt_pk_bf16_f32 v113, v82, v83
  v_mfma_f32_16x16x32_bf16 v[156:159], v[44:47], v[124:127], v[156:159]
  ds_read_b128 v[40:43], v2 offset:2048
  ds_read_b128 v[44:47], v3
  v_cvt_pk_bf16_f32 v114, v96, v97
  v_cvt_pk_bf16_f32 v115, v98, v99
  v_cvt_pk_bf16_f32 v116, v84, v85
  v_cvt_pk_bf16_f32 v117, v86, v87
  v_cvt_pk_bf16_f32 v118, v100, v101
  v_cvt_pk_bf16_f32 v119, v102, v103
  v_cvt_pk_bf16_f32 v120, v88, v89
  v_cvt_pk_bf16_f32 v121, v90, v91
  v_cvt_pk_bf16_f32 v122, v104, v105
  v_cvt_pk_bf16_f32 v123, v106, v107
  v_cvt_pk_bf16_f32 v124, v92, v93
  v_cvt_pk_bf16_f32 v125, v94, v95
  v_cvt_pk_bf16_f32 v126, v108, v109
  v_cvt_pk_bf16_f32 v127, v110, v111
  v_add_u32 v3, v3, v4
  v_add_u32 v2, 3072, v2
at_p2_8:
  s_cmp_ge_u32 s50, 369
  s_cbranch_scc1 at_nojob4
  s_mov_b32 s50, 369
  s_waitcnt vmcnt(0) lgkmcnt(0)
  s_mov_b32 s40, s4
  s_and_b32 s41, s5, 0xffff
  s_mov_b32 s42, 66891776
  s_mov_b32 s43, 0x20000
  v_lshrrev_b32 v234, 5, v254
  v_lshlrev_b32 v234, 4, v234
  v_bfe_u32 v232, v254, 4, 1
  v_lshl_add_u32 v234, v232, 2, v234
  v_bfe_u32 v232, v254, 2, 2
  v_add_u32 v234, v234, v232
  v_and_b32 v235, 3, v254
  s_cmp_eq_u32 s46, 72
  s_cselect_b32 s39, 1, 0
  s_and_b32 s3, s44, 2
  s_mul_i32 s39, s39, s3
  s_add_u32 s39, s39, s44
  s_cmp_eq_u32 s44, 2
  s_cbranch_scc1 pa_fr
  v_lshrrev_b32 v232, 4, v0
  v_and_b32 v233, 0xfffffff3, v232
  v_bfe_u32 v236, v232, 2, 1
  v_lshl_add_u32 v233, v236, 3, v233
  v_bfe_u32 v236, v232, 3, 1
  v_lshl_add_u32 v233, v236, 2, v233
  v_and_b32 v232, 15, v0
  v_mul_u32_u24 v233, 288, v233
  v_lshl_add_u32 v233, v232, 4, v233
  v_add_u32 v233, 53248, v233
  ds_write_b128 v233, a[184:187] offset:0
  ds_write_b128 v233, a[188:191] offset:4608
  ds_write_b128 v233, a[192:195] offset:9216
  ds_write_b128 v233, a[196:199] offset:13824
  ds_write_b128 v233, a[200:203] offset:18432
  ds_write_b128 v233, a[204:207] offset:23040
  ds_write_b128 v233, a[208:211] offset:27648
  ds_write_b128 v233, a[212:215] offset:32256
  ds_write_b128 v233, a[216:219] offset:36864
  ds_write_b128 v233, a[220:223] offset:41472
  ds_write_b128 v233, a[224:227] offset:46080
  ds_write_b128 v233, a[228:231] offset:50688
  v_mul_u32_u24 v234, 288, v234
  s_lshl_b32 s3, s18, 6
  s_add_u32 s3, s3, 53248
  v_add_u32 v234, s3, v234
  v_lshl_add_u32 v234, v235, 3, v234
  s_lshl_b32 s30, s45, 3
  s_lshl_b32 s3, s18, 1
  s_add_u32 s31, s30, s3
  s_mul_i32 s38, s46, 36864
  s_lshl_b32 s3, s31, 7
  s_add_u32 s38, s38, s3
  s_lshl_b32 s3, s44, 6
  s_add_u32 s38, s38, s3
  s_add_u32 s38, s38, 66183168
  s_mul_i32 s30, s31, 18
  s_mul_i32 s3, s46, 6
  s_add_u32 s30, s30, s3
  s_lshl_b32 s30, s30, 11
  s_lshl_b32 s3, s44, 10
  s_add_u32 s30, s30, s3
  s_add_u32 s30, s30, 50233344
  s_add_u32 s33, s30, 36864
  v_mov_b32 v232, 0x3f803f80
  v_accvgpr_write_b32 a72, v232
  v_accvgpr_write_b32 a73, v232
  v_accvgpr_write_b32 a74, v232
  v_accvgpr_write_b32 a75, v232
  s_branch pa_fm
pa_fr:
  v_lshrrev_b32 v232, 3, v0
  v_and_b32 v233, 0xfffffff3, v232
  v_bfe_u32 v236, v232, 2, 1
  v_lshl_add_u32 v233, v236, 3, v233
  v_bfe_u32 v236, v232, 3, 1
  v_lshl_add_u32 v233, v236, 2, v233
  v_and_b32 v232, 7, v0
  v_mul_u32_u24 v233, 1184, v233
  v_lshl_add_u32 v233, v232, 4, v233
  v_add_u32 v233, 53248, v233
  ds_write_b128 v233, a[184:187] offset:0
  ds_write_b128 v233, a[188:191] offset:128
  ds_write_b128 v233, a[192:195] offset:256
  ds_write_b128 v233, a[196:199] offset:384
  ds_write_b128 v233, a[200:203] offset:512
  ds_write_b128 v233, a[204:207] offset:640
  ds_write_b128 v233, a[208:211] offset:768
  ds_write_b128 v233, a[212:215] offset:896
  ds_write_b128 v233, a[216:219] offset:1024
  s_cmp_eq_u32 s46, 72
  s_cbranch_scc1 pa_fw
  s_waitcnt lgkmcnt(4)
  ds_write_b128 v233, a[220:223] offset:37888
  ds_write_b128 v233, a[224:227] offset:38016
  ds_write_b128 v233, a[228:231] offset:38144
  ds_write_b128 v233, a[232:235] offset:38272
  ds_write_b128 v233, a[236:239] offset:38400
  ds_write_b128 v233, a[240:243] offset:38528
  ds_write_b128 v233, a[244:247] offset:38656
  ds_write_b128 v233, a[248:251] offset:38784
  ds_write_b128 v233, a[252:255] offset:38912
pa_fw:
  v_mul_u32_u24 v234, 1184, v234
  s_mul_i32 s3, s18, 288
  s_add_u32 s3, s3, 53248
  v_add_u32 v234, s3, v234
  v_and_b32 v232, 1, v235
  v_lshl_add_u32 v236, v232, 3, v234
  v_lshrrev_b32 v232, 1, v235
  v_mul_u32_u24 v232, 37888, v232
  v_add_u32 v236, v236, v232
  v_lshl_add_u32 v234, v235, 3, v234
  s_mul_i32 s33, s46, 9216
  s_mul_i32 s30, s45, 9216
  s_lshl_b32 s3, s18, 1
  s_mul_i32 s3, s3, s33
  s_add_u32 s30, s30, s3
  s_add_u32 s30, s30, 49569792
  s_add_u32 s33, s33, s30
  s_cmp_eq_u32 s46, 9
  s_cbranch_scc1 pa_fm
  s_mul_i32 s30, s18, 144
  s_add_u32 s30, s30, s45
  s_mul_i32 s30, s30, 9216
  s_add_u32 s30, s30, 60850176
  s_add_u32 s33, s30, 9216
pa_fm:
  s_add_u32 s31, s30, 4096
  s_add_u32 s32, s30, 8192
  s_add_u32 s36, s33, 4096
  s_add_u32 s37, s33, 8192
  s_waitcnt lgkmcnt(0)
  s_barrier
  s_cmp_eq_u32 s39, 2
  s_cbranch_scc1 pa_fr2
  s_cmp_eq_u32 s39, 4
  s_cbranch_scc1 pa_fr3
  ds_read_b64_tr_b16 a[0:1], v234 offset:0
  ds_read_b64_tr_b16 a[2:3], v234 offset:2304
  ds_read_b64_tr_b16 a[4:5], v234 offset:9216
  ds_read_b64_tr_b16 a[6:7], v234 offset:11520
  ds_read_b64_tr_b16 a[8:9], v234 offset:18432
  ds_read_b64_tr_b16 a[10:11], v234 offset:20736
  ds_read_b64_tr_b16 a[12:13], v234 offset:27648
  ds_read_b64_tr_b16 a[14:15], v234 offset:29952
  s_waitcnt lgkmcnt(6)
  buffer_store_dwordx4 a[0:3], v1, s[40:43], s30 offen offset:0 sc1
  v_mfma_f32_16x16x32_bf16 v[224:227], a[0:3], a[72:75], 0
  ds_read_b64_tr_b16 a[16:17], v234 offset:36864
  ds_read_b64_tr_b16 a[18:19], v234 offset:39168
  s_waitcnt lgkmcnt(6)
  buffer_store_dwordx4 a[4:7], v1, s[40:43], s30 offen offset:2048 sc1
  v_mfma_f32_16x16x32_bf16 v[224:227], a[4:7], a[72:75], v[224:227]
  ds_read_b64_tr_b16 a[20:21], v234 offset:46080
  ds_read_b64_tr_b16 a[22:23], v234 offset:48384
  s_waitcnt lgkmcnt(6)
  buffer_store_dwordx4 a[8:11], v1, s[40:43], s31 offen offset:0 sc1
  v_mfma_f32_16x16x32_bf16 v[224:227], a[8:11], a[72:75], v[224:227]
  ds_read_b64_tr_b16 a[24:25], v234 offset:32
  ds_read_b64_tr_b16 a[26:27], v234 offset:2336
  s_waitcnt lgkmcnt(6)
  buffer_store_dwordx4 a[12:15], v1, s[40:43], s31 offen offset:2048 sc1
  v_mfma_f32_16x16x32_bf16 v[224:227], a[12:15], a[72:75], v[224:227]
  ds_read_b64_tr_b16 a[28:29], v234 offset:9248
  ds_read_b64_tr_b16 a[30:31], v234 offset:11552
  s_waitcnt lgkmcnt(6)
  buffer_store_dwordx4 a[16:19], v1, s[40:43], s32 offen offset:0 sc1
  v_mfma_f32_16x16x32_bf16 v[224:227], a[16:19], a[72:75], v[224:227]
  ds_read_b64_tr_b16 a[32:33], v234 offset:18464
  ds_read_b64_tr_b16 a[34:35], v234 offset:20768
  s_waitcnt lgkmcnt(6)
  buffer_store_dwordx4 a[20:23], v1, s[40:43], s32 offen offset:2048 sc1
  v_mfma_f32_16x16x32_bf16 v[224:227], a[20:23], a[72:75], v[224:227]
  ds_read_b64_tr_b16 a[36:37], v234 offset:27680
  ds_read_b64_tr_b16 a[38:39], v234 offset:29984
  s_waitcnt lgkmcnt(6)
  buffer_store_dwordx4 a[24:27], v1, s[40:43], s33 offen offset:0 sc1
  v_mfma_f32_16x16x32_bf16 v[228:231], a[24:27], a[72:75], 0
  ds_read_b64_tr_b16 a[40:41], v234 offset:36896
  ds_read_b64_tr_b16 a[42:43], v234 offset:39200
  s_waitcnt lgkmcnt(6)
  buffer_store_dwordx4 a[28:31], v1, s[40:43], s33 offen offset:2048 sc1
  v_mfma_f32_16x16x32_bf16 v[228:231], a[28:31], a[72:75], v[228:231]
  ds_read_b64_tr_b16 a[44:45], v234 offset:46112
  ds_read_b64_tr_b16 a[46:47], v234 offset:48416
  s_waitcnt lgkmcnt(6)
  buffer_store_dwordx4 a[32:35], v1, s[40:43], s36 offen offset:0 sc1
  v_mfma_f32_16x16x32_bf16 v[228:231], a[32:35], a[72:75], v[228:231]
  s_waitcnt lgkmcnt(4)
  buffer_store_dwordx4 a[36:39], v1, s[40:43], s36 offen offset:2048 sc1
  v_mfma_f32_16x16x32_bf16 v[228:231], a[36:39], a[72:75], v[228:231]
  s_waitcnt lgkmcnt(2)
  buffer_store_dwordx4 a[40:43], v1, s[40:43], s37 offen offset:0 sc1
  v_mfma_f32_16x16x32_bf16 v[228:231], a[40:43], a[72:75], v[228:231]
  s_waitcnt lgkmcnt(0)
  buffer_store_dwordx4 a[44:47], v1, s[40:43], s37 offen offset:2048 sc1
  v_mfma_f32_16x16x32_bf16 v[228:231], a[44:47], a[72:75], v[228:231]
  v_lshrrev_b32 v232, 4, v254
  v_lshlrev_b32 v232, 4, v232
  s_mov_b32 exec_lo, 0x00010001
  s_mov_b32 exec_hi, 0x00010001
  buffer_store_dwordx4 v[224:227], v232, s[40:43], s38 offen sc1
  s_nop 2
  buffer_store_dwordx4 v[228:231], v232, s[40:43], s38 offen offset:128 sc1
  s_mov_b64 exec, -1
  s_branch pa_fd
pa_fr2:
  ds_read_b64_tr_b16 a[0:1], v234 offset:0
  ds_read_b64_tr_b16 a[2:3], v234 offset:9472
  ds_read_b64_tr_b16 a[4:5], v234 offset:32
  ds_read_b64_tr_b16 a[6:7], v234 offset:9504
  ds_read_b64_tr_b16 a[8:9], v234 offset:64
  ds_read_b64_tr_b16 a[10:11], v234 offset:9536
  ds_read_b64_tr_b16 a[12:13], v234 offset:96
  ds_read_b64_tr_b16 a[14:15], v234 offset:9568
  s_waitcnt lgkmcnt(6)
  buffer_store_dwordx4 a[0:3], v1, s[40:43], s30 offen offset:0 sc1
  ds_read_b64_tr_b16 a[16:17], v234 offset:37888
  ds_read_b64_tr_b16 a[18:19], v234 offset:47360
  s_waitcnt lgkmcnt(6)
  buffer_store_dwordx4 a[4:7], v1, s[40:43], s30 offen offset:1024 sc1
  ds_read_b64_tr_b16 a[20:21], v234 offset:37920
  ds_read_b64_tr_b16 a[22:23], v234 offset:47392
  s_waitcnt lgkmcnt(6)
  buffer_store_dwordx4 a[8:11], v1, s[40:43], s30 offen offset:2048 sc1
  ds_read_b64_tr_b16 a[24:25], v234 offset:37952
  ds_read_b64_tr_b16 a[26:27], v234 offset:47424
  s_waitcnt lgkmcnt(6)
  buffer_store_dwordx4 a[12:15], v1, s[40:43], s30 offen offset:3072 sc1
  ds_read_b64_tr_b16 a[28:29], v234 offset:37984
  ds_read_b64_tr_b16 a[30:31], v234 offset:47456
  s_waitcnt lgkmcnt(6)
  buffer_store_dwordx4 a[16:19], v1, s[40:43], s31 offen offset:0 sc1
  ds_read_b64_tr_b16 a[32:33], v236 offset:128
  ds_read_b64_tr_b16 a[34:35], v236 offset:9600
  s_waitcnt lgkmcnt(6)
  buffer_store_dwordx4 a[20:23], v1, s[40:43], s31 offen offset:1024 sc1
  ds_read_b64_tr_b16 a[36:37], v234 offset:144
  ds_read_b64_tr_b16 a[38:39], v234 offset:9616
  s_waitcnt lgkmcnt(6)
  buffer_store_dwordx4 a[24:27], v1, s[40:43], s31 offen offset:2048 sc1
  ds_read_b64_tr_b16 a[40:41], v234 offset:176
  ds_read_b64_tr_b16 a[42:43], v234 offset:9648
  s_waitcnt lgkmcnt(6)
  buffer_store_dwordx4 a[28:31], v1, s[40:43], s31 offen offset:3072 sc1
  ds_read_b64_tr_b16 a[44:45], v234 offset:208
  ds_read_b64_tr_b16 a[46:47], v234 offset:9680
  s_waitcnt lgkmcnt(6)
  buffer_store_dwordx4 a[32:35], v1, s[40:43], s32 offen offset:0 sc1
  ds_read_b64_tr_b16 a[48:49], v234 offset:240
  ds_read_b64_tr_b16 a[50:51], v234 offset:9712
  s_waitcnt lgkmcnt(6)
  buffer_store_dwordx4 a[36:39], v1, s[40:43], s33 offen offset:0 sc1
  ds_read_b64_tr_b16 a[52:53], v234 offset:38032
  ds_read_b64_tr_b16 a[54:55], v234 offset:47504
  s_waitcnt lgkmcnt(6)
  buffer_store_dwordx4 a[40:43], v1, s[40:43], s33 offen offset:1024 sc1
  ds_read_b64_tr_b16 a[56:57], v234 offset:38064
  ds_read_b64_tr_b16 a[58:59], v234 offset:47536
  s_waitcnt lgkmcnt(6)
  buffer_store_dwordx4 a[44:47], v1, s[40:43], s33 offen offset:2048 sc1
  ds_read_b64_tr_b16 a[60:61], v234 offset:38096
  ds_read_b64_tr_b16 a[62:63], v234 offset:47568
  s_waitcnt lgkmcnt(6)
  buffer_store_dwordx4 a[48:51], v1, s[40:43], s33 offen offset:3072 sc1
  ds_read_b64_tr_b16 a[64:65], v234 offset:38128
  ds_read_b64_tr_b16 a[66:67], v234 offset:47600
  s_waitcnt lgkmcnt(6)
  buffer_store_dwordx4 a[52:55], v1, s[40:43], s36 offen offset:0 sc1
  ds_read_b64_tr_b16 a[68:69], v236 offset:272
  ds_read_b64_tr_b16 a[70:71], v236 offset:9744
  s_waitcnt lgkmcnt(6)
  buffer_store_dwordx4 a[56:59], v1, s[40:43], s36 offen offset:1024 sc1
  s_waitcnt lgkmcnt(4)
  buffer_store_dwordx4 a[60:63], v1, s[40:43], s36 offen offset:2048 sc1
  s_waitcnt lgkmcnt(2)
  buffer_store_dwordx4 a[64:67], v1, s[40:43], s36 offen offset:3072 sc1
  s_waitcnt lgkmcnt(0)
  buffer_store_dwordx4 a[68:71], v1, s[40:43], s37 offen offset:0 sc1
  s_branch pa_fd
pa_fr3:
  ds_read_b64_tr_b16 a[0:1], v234 offset:0
  ds_read_b64_tr_b16 a[2:3], v234 offset:9472
  ds_read_b64_tr_b16 a[4:5], v234 offset:32
  ds_read_b64_tr_b16 a[6:7], v234 offset:9504
  ds_read_b64_tr_b16 a[8:9], v234 offset:64
  ds_read_b64_tr_b16 a[10:11], v234 offset:9536
  ds_read_b64_tr_b16 a[12:13], v234 offset:96
  ds_read_b64_tr_b16 a[14:15], v234 offset:9568
  s_waitcnt lgkmcnt(6)
  buffer_store_dwordx4 a[0:3], v1, s[40:43], s30 offen offset:0 sc1
  ds_read_b64_tr_b16 a[16:17], v234 offset:128
  ds_read_b64_tr_b16 a[18:19], v234 offset:9600
  s_waitcnt lgkmcnt(6)
  buffer_store_dwordx4 a[4:7], v1, s[40:43], s30 offen offset:1024 sc1
  ds_read_b64_tr_b16 a[20:21], v234 offset:160
  ds_read_b64_tr_b16 a[22:23], v234 offset:9632
  s_waitcnt lgkmcnt(6)
  buffer_store_dwordx4 a[8:11], v1, s[40:43], s30 offen offset:2048 sc1
  ds_read_b64_tr_b16 a[24:25], v234 offset:192
  ds_read_b64_tr_b16 a[26:27], v234 offset:9664
  s_waitcnt lgkmcnt(6)
  buffer_store_dwordx4 a[12:15], v1, s[40:43], s30 offen offset:3072 sc1
  ds_read_b64_tr_b16 a[28:29], v234 offset:224
  ds_read_b64_tr_b16 a[30:31], v234 offset:9696
  s_waitcnt lgkmcnt(6)
  buffer_store_dwordx4 a[16:19], v1, s[40:43], s31 offen offset:0 sc1
  ds_read_b64_tr_b16 a[32:33], v234 offset:256
  ds_read_b64_tr_b16 a[34:35], v234 offset:9728
  s_waitcnt lgkmcnt(6)
  buffer_store_dwordx4 a[20:23], v1, s[40:43], s31 offen offset:1024 sc1
  s_waitcnt lgkmcnt(4)
  buffer_store_dwordx4 a[24:27], v1, s[40:43], s31 offen offset:2048 sc1
  s_waitcnt lgkmcnt(2)
  buffer_store_dwordx4 a[28:31], v1, s[40:43], s31 offen offset:3072 sc1
  s_waitcnt lgkmcnt(0)
  buffer_store_dwordx4 a[32:35], v1, s[40:43], s32 offen offset:0 sc1
pa_fd:
at_nojob4:
  v_exp_f32 v80, v48
  v_exp_f32 v81, v49
  v_exp_f32 v82, v50
  v_exp_f32 v83, v51
  s_waitcnt lgkmcnt(3)
  v_exp_f32 v84, v52
  v_exp_f32 v85, v53
  s_waitcnt lgkmcnt(0)
  v_mfma_f32_16x16x32_bf16 v[128:131], v[40:43], v[112:115], v[128:131]
  v_exp_f32 v86, v54
  v_exp_f32 v87, v55
  v_exp_f32 v88, v56
  v_exp_f32 v89, v57
  v_mfma_f32_16x16x32_bf16 v[144:147], v[44:47], v[112:115], v[144:147]
  v_exp_f32 v90, v58
  v_exp_f32 v91, v59
  v_mfma_f32_16x16x32_bf16 v[56:59], v[32:35], v[24:27], v[208:211]
  v_exp_f32 v92, v60
  v_exp_f32 v93, v61
  v_mfma_f32_16x16x32_bf16 v[132:135], v[40:43], v[116:119], v[132:135]
  v_exp_f32 v94, v62
  v_exp_f32 v95, v63
  v_mfma_f32_16x16x32_bf16 v[60:63], v[32:35], v[28:31], v[180:183]
  ds_read_b128 v[32:35], v2 offset:6144
  v_mfma_f32_16x16x32_bf16 v[148:151], v[44:47], v[116:119], v[148:151]
  v_exp_f32 v100, v68
  v_exp_f32 v101, v69
  v_mfma_f32_16x16x32_bf16 v[136:139], v[40:43], v[120:123], v[136:139]
  v_exp_f32 v102, v70
  v_exp_f32 v103, v71
  v_exp_f32 v104, v72
  v_exp_f32 v105, v73
  v_mfma_f32_16x16x32_bf16 v[152:155], v[44:47], v[120:123], v[152:155]
  v_exp_f32 v106, v74
  v_exp_f32 v107, v75
  v_exp_f32 v108, v76
  v_exp_f32 v109, v77
  v_mfma_f32_16x16x32_bf16 v[140:143], v[40:43], v[124:127], v[140:143]
  v_exp_f32 v110, v78
  v_exp_f32 v111, v79
  v_mfma_f32_16x16x32_bf16 v[76:79], v[36:39], v[28:31], v[212:215]
  ds_read_b128 v[36:39], v2 offset:7168
  v_cvt_pk_bf16_f32 v112, v80, v81
  v_cvt_pk_bf16_f32 v113, v82, v83
  v_mfma_f32_16x16x32_bf16 v[156:159], v[44:47], v[124:127], v[156:159]
  ds_read_b128 v[40:43], v2 offset:2048
  ds_read_b128 v[44:47], v3
  v_mov_b32 v114, 0
  v_mov_b32 v115, 0
  v_cvt_pk_bf16_f32 v116, v84, v85
  v_cvt_pk_bf16_f32 v117, v86, v87
  v_cvt_pk_bf16_f32 v118, v100, v101
  v_cvt_pk_bf16_f32 v119, v102, v103
  v_cvt_pk_bf16_f32 v120, v88, v89
  v_cvt_pk_bf16_f32 v121, v90, v91
  v_cvt_pk_bf16_f32 v122, v104, v105
  v_cvt_pk_bf16_f32 v123, v106, v107
  v_cvt_pk_bf16_f32 v124, v92, v93
  v_cvt_pk_bf16_f32 v125, v94, v95
  v_cvt_pk_bf16_f32 v126, v108, v109
  v_cvt_pk_bf16_f32 v127, v110, v111
  v_add_u32 v3, v3, v4
  v_add_u32 v2, 3072, v2
  s_waitcnt lgkmcnt(0)
  v_mfma_f32_16x16x32_bf16 v[128:131], v[40:43], v[112:115], v[128:131]
  v_exp_f32 v88, v56
  v_exp_f32 v89, v57
  v_mfma_f32_16x16x32_bf16 v[144:147], v[44:47], v[112:115], v[144:147]
  v_exp_f32 v90, v58
  v_exp_f32 v91, v59
  v_exp_f32 v92, v60
  v_exp_f32 v93, v61
  v_mfma_f32_16x16x32_bf16 v[132:135], v[40:43], v[116:119], v[132:135]
  v_exp_f32 v94, v62
  v_exp_f32 v95, v63
  v_mfma_f32_16x16x32_bf16 v[148:151], v[44:47], v[116:119], v[148:151]
  v_mfma_f32_16x16x32_bf16 v[136:139], v[40:43], v[120:123], v[136:139]
  v_mfma_f32_16x16x32_bf16 v[152:155], v[44:47], v[120:123], v[152:155]
  v_exp_f32 v108, v76
  v_exp_f32 v109, v77
  v_mfma_f32_16x16x32_bf16 v[140:143], v[40:43], v[124:127], v[140:143]
  v_exp_f32 v110, v78
  v_exp_f32 v111, v79
  v_mfma_f32_16x16x32_bf16 v[156:159], v[44:47], v[124:127], v[156:159]
  ds_read_b128 v[40:43], v2 offset:2048
  ds_read_b128 v[44:47], v3
  v_cvt_pk_bf16_f32 v120, v88, v89
  v_cvt_pk_bf16_f32 v121, v90, v91
  v_mov_b32 v122, 0
  v_mov_b32 v123, 0
  v_cvt_pk_bf16_f32 v124, v92, v93
  v_cvt_pk_bf16_f32 v125, v94, v95
  v_cvt_pk_bf16_f32 v126, v108, v109
  v_cvt_pk_bf16_f32 v127, v110, v111
  v_add_u32 v3, v3, v4
  s_waitcnt lgkmcnt(0)
  v_mfma_f32_16x16x32_bf16 v[136:139], v[40:43], v[120:123], v[136:139]
  v_mfma_f32_16x16x32_bf16 v[152:155], v[44:47], v[120:123], v[152:155]
  v_mfma_f32_16x16x32_bf16 v[140:143], v[40:43], v[124:127], v[140:143]
  v_mfma_f32_16x16x32_bf16 v[156:159], v[44:47], v[124:127], v[156:159]
  s_cmp_lg_u32 s29, 0
  s_cbranch_scc1 at_fine
  s_mov_b32 s24, 0x2b800000
  s_mov_b32 s25, 0x53800000
  s_nop 1
  v_min3_f32 v80, v146, v150, v154
  s_nop 0
  v_min_f32 v80, v80, v158
  v_add_f32 v81, v146, v150
  v_add_f32 v82, v154, v158
  v_add_f32 v81, v81, v82
  v_cmp_lt_f32 vcc, s24, v80
  v_cmp_gt_f32 s[24:25], s25, v81
  s_nop 1
  s_and_b64 vcc, vcc, s[24:25]
  s_cmp_eq_u64 vcc, -1
  s_cbranch_scc0 at_redo
at_fine:
  v_mul_u32_u24 v13, 18432, v8
  v_lshl_add_u32 v13, v7, 4, v13
  s_mul_i32 s24, s26, 18432
  s_lshr_b32 s27, s16, 2
  s_lshl_b32 s27, s27, 8
  s_lshl_b32 s28, s7, 2
  s_add_u32 s27, s27, s28
  s_add_u32 s27, s27, s24
  s_add_u32 s27, s27, 16384
  v_rcp_f32 v80, v146
  v_rcp_f32 v82, v150
  v_rcp_f32 v84, v154
  v_rcp_f32 v86, v158
  v_pk_mul_f32 v[144:145], v[144:145], v[80:81] op_sel_hi:[1,0]
  v_pk_mul_f32 v[148:149], v[148:149], v[82:83] op_sel_hi:[1,0]
  v_pk_mul_f32 v[152:153], v[152:153], v[84:85] op_sel_hi:[1,0]
  v_pk_mul_f32 v[156:157], v[156:157], v[86:87] op_sel_hi:[1,0]
  v_cvt_pk_bf16_f32 v104, v144, v145
  v_cvt_pk_bf16_f32 v105, v148, v149
  v_cvt_pk_bf16_f32 v106, v152, v153
  v_cvt_pk_bf16_f32 v107, v156, v157
  v_and_b32 v11, 1, v8
  v_mul_u32_u24 v11, 18432, v11
  v_permlane16_swap_b32 v104, v105
  v_permlane16_swap_b32 v106, v107
  v_lshl_add_u32 v11, v7, 4, v11
  v_lshrrev_b32 v12, 1, v8
  v_permlane32_swap_b32 v104, v106
  buffer_store_dword v104, v13, s[12:15], s27 offen sc1
  v_lshl_add_u32 v12, v12, 8, v11
  s_lshl_b32 s25, s16, 9
  s_add_u32 s25, s25, s24
  v_pk_mul_f32 v[128:129], v[128:129], v[80:81] op_sel_hi:[1,0]
  v_pk_mul_f32 v[130:131], v[130:131], v[80:81] op_sel_hi:[1,0]
  v_pk_mul_f32 v[132:133], v[132:133], v[82:83] op_sel_hi:[1,0]
  v_pk_mul_f32 v[134:135], v[134:135], v[82:83] op_sel_hi:[1,0]
  v_cvt_pk_bf16_f32 v88, v128, v129
  v_cvt_pk_bf16_f32 v89, v130, v131
  v_cvt_pk_bf16_f32 v90, v132, v133
  v_cvt_pk_bf16_f32 v91, v134, v135
  s_nop 0
  v_permlane16_swap_b32 v88, v90
  v_permlane16_swap_b32 v89, v91
  buffer_store_dwordx4 v[88:91], v12, s[12:15], s25 offen sc1
  s_add_u32 s25, s25, 36864
  v_pk_mul_f32 v[136:137], v[136:137], v[84:85] op_sel_hi:[1,0]
  v_pk_mul_f32 v[138:139], v[138:139], v[84:85] op_sel_hi:[1,0]
  v_pk_mul_f32 v[140:141], v[140:141], v[86:87] op_sel_hi:[1,0]
  v_pk_mul_f32 v[142:143], v[142:143], v[86:87] op_sel_hi:[1,0]
  v_cvt_pk_bf16_f32 v96, v136, v137
  v_cvt_pk_bf16_f32 v97, v138, v139
  v_cvt_pk_bf16_f32 v98, v140, v141
  v_cvt_pk_bf16_f32 v99, v142, v143
  s_nop 0
  v_permlane16_swap_b32 v96, v98
  v_permlane16_swap_b32 v97, v99
  buffer_store_dwordx4 v[96:99], v12, s[12:15], s25 offen sc1
gk_main:
  s_and_b32 s20, s2, 7
  s_lshr_b32 s21, s2, 3
  s_lshr_b32 s16, s20, 1
  s_lshl_b32 s16, s16, 3
  s_lshr_b32 s22, s21, 2
  s_add_u32 s16, s16, s22
  s_and_b32 s17, s20, 1
  s_lshl_b32 s17, s17, 2
  s_and_b32 s22, s21, 3
  s_add_u32 s17, s17, s22
  s_mul_i32 s22, s17, 82944
  s_add_u32 s22, s22, 49491968
  s_add_u32 s12, s4, s22
  s_addc_u32 s13, s5, 0
  s_and_b32 s13, s13, 0xffff
  s_mov_b32 s14, 160768
  s_mov_b32 s15, 0x20000
  s_lshl_b32 s23, s18, 10
  s_add_u32 m0, s23, 122880
  s_nop 0
  buffer_load_dwordx4 v1, s[12:15], m0 offen sc1 lds
  s_add_u32 m0, s23, 126976
  s_nop 0
  buffer_load_dwordx4 v1, s[12:15], m0 offen sc1 lds
  s_add_u32 m0, s23, 131072
  s_nop 0
  buffer_load_dwordx4 v1, s[12:15], m0 offen sc1 lds
  s_add_u32 m0, s23, 135168
  s_nop 0
  buffer_load_dwordx4 v1, s[12:15], m0 offen sc1 lds
  s_add_u32 m0, s23, 139264
  s_nop 0
  buffer_load_dwordx4 v1, s[12:15], m0 offen sc1 lds
  s_add_u32 m0, s23, 143360
  s_nop 0
  buffer_load_dwordx4 v1, s[12:15], m0 offen sc1 lds
  s_add_u32 m0, s23, 147456
  s_nop 0
  buffer_load_dwordx4 v1, s[12:15], m0 offen sc1 lds
  s_add_u32 m0, s23, 151552
  s_nop 0
  buffer_load_dwordx4 v1, s[12:15], m0 offen sc1 lds
  s_add_u32 m0, s23, 155648
  s_nop 0
  buffer_load_dwordx4 v1, s[12:15], m0 offen sc1 lds
  s_waitcnt vmcnt(9)
  s_barrier
  s_cmp_lg_u32 s18, 0
  s_cbranch_scc1 gk_sg
  s_mov_b64 exec, 1
  buffer_store_dword v253, v252, s[96:99], s58 offen sc1
  s_mov_b64 exec, -1
gk_sg:
  s_lshr_b32 s45, s16, 2
  s_lshl_b32 s45, s45, 12
  s_add_u32 s45, s45, s59
  s_add_u32 s45, s45, 32768
  s_add_u32 m0, s23, 77824
  s_nop 0
  buffer_load_dwordx4 v1, s[12:15], m0 offen sc1 lds
  s_add_u32 m0, s23, 81920
  s_nop 0
  buffer_load_dwordx4 v1, s[12:15], m0 offen sc1 lds
  s_add_u32 m0, s23, 86016
  s_nop 0
  buffer_load_dwordx4 v1, s[12:15], m0 offen sc1 lds
  s_add_u32 m0, s23, 90112
  s_nop 0
  buffer_load_dwordx4 v1, s[12:15], m0 offen sc1 lds
  s_add_u32 m0, s23, 94208
  s_nop 0
  buffer_load_dwordx4 v1, s[12:15], m0 offen sc1 lds
  s_add_u32 m0, s23, 98304
  s_nop 0
  buffer_load_dwordx4 v1, s[12:15], m0 offen sc1 lds
  s_add_u32 m0, s23, 102400
  s_nop 0
  buffer_load_dwordx4 v1, s[12:15], m0 offen sc1 lds
  s_add_u32 m0, s23, 106496
  s_nop 0
  buffer_load_dwordx4 v1, s[12:15], m0 offen sc1 lds
  s_add_u32 m0, s23, 110592
  s_nop 0
  buffer_load_dwordx4 v1, s[12:15], m0 offen sc1 lds
  s_add_u32 m0, s23, 114688
  s_nop 0
  buffer_load_dwordx4 v1, s[12:15], m0 offen sc1 lds
  s_add_u32 m0, s23, 118784
  s_nop 0
  buffer_load_dwordx4 v1, s[12:15], m0 offen sc1 lds
  s_cmp_lg_u32 s18, 0
  s_cbranch_scc1 gk_w20
  s_add_u32 m0, s23, 159744
  s_nop 0
  buffer_load_dwordx4 v1, s[12:15], m0 offen sc1 lds
gk_w20:
  s_cmp_eq_u32 s54, 0
  s_cselect_b32 s24, s94, s100
  s_cselect_b32 s25, s95, s101
  s_cselect_b32 s46, 16, 256
  s_cselect_b32 s47, 1152, 16
  s_and_b32 s25, s25, 0xffff
  s_mov_b32 s26, 2359296
  s_mov_b32 s27, 0x20000
  v_and_b32 v10, 15, v254
  v_bfe_u32 v12, v254, 4, 1
  v_lshrrev_b32 v13, 5, v254
  v_lshl_add_u32 v12, v12, 1, v13
  v_mul_lo_u32 v17, v10, s47
  v_mul_lo_u32 v16, v12, s46
  v_add_u32 v16, v16, v17
  s_lshl_b32 s30, s16, 2
  s_add_u32 s30, s30, s18
  s_mul_i32 s31, s30, 18432
  s_mul_i32 s32, s17, 9
  s_mul_i32 s33, s32, s46
  s_add_u32 s33, s33, s31
  s_lshl_b32 s3, s46, 2
  s_add_u32 s48, s33, s3
  s_add_u32 s49, s48, s3
  s_cmp_lg_u32 s54, 0
  s_cbranch_scc1 gk_r0
  buffer_load_dwordx4 v[128:131], v16, s[24:27], s33 offen sc1
  buffer_load_dwordx4 v[132:135], v16, s[24:27], s48 offen sc1
  buffer_load_dwordx4 v[136:139], v17, s[24:27], s49 offen sc1
gk_r0:
  s_add_u32 s8, s100, 11796480
  s_addc_u32 s9, s101, 0
  s_and_b32 s9, s9, 0xffff
  s_mov_b32 s10, 2359296
  s_mov_b32 s11, 0x20000
  s_add_u32 s36, s100, 2359296
  s_addc_u32 s37, s101, 0
  s_and_b32 s37, s37, 0xffff
  s_mov_b32 s38, 2359296
  s_mov_b32 s39, 0x20000
  s_add_u32 s40, s100, 14417920
  s_addc_u32 s41, s101, 0
  s_and_b32 s41, s41, 0xffff
  s_mov_b32 s42, 131072
  s_mov_b32 s43, 0x20000
  v_add_u32 v2, s31, v1
  v_add_u32 v3, 77824, v1
  v_add_u32 v4, 143360, v1
  s_mov_b32 s60, 4096
  s_mov_b32 s61, 8192
  s_mov_b32 s62, 12288
  s_mov_b32 s63, 16384
  v_lshlrev_b32 v18, 4, v10
  v_lshl_add_u32 v9, v12, 8, v18
  s_lshl_b32 s44, s32, 8
  s_add_u32 s44, s44, s31
  s_lshl_b32 s51, s30, 10
  s_lshr_b32 s20, s17, 1
  s_lshl_b32 s20, s20, 8
  s_add_u32 s51, s51, s20
  s_and_b32 s20, s17, 1
  s_lshl_b32 s20, s20, 3
  s_add_u32 s51, s51, s20
  v_mov_b32 v20, 0
  v_mov_b32 v21, 0
  v_mov_b32 v22, 0xffff0000
  v_mov_b32 v23, 0x3f803f80
  s_lshl_b32 s58, s16, 3
  s_add_u32 s58, s58, s17
  s_lshl_b32 s58, s58, 7
  s_add_u32 s58, s58, s59
  s_add_u32 s58, s58, 65536
  s_lshr_b32 s20, s2, 3
  s_lshl_b32 s20, s20, 2
  s_add_u32 s20, s20, s18
  s_mov_b64 exec, 7
  s_getpc_b64 s[28:29]
cpf2:
  s_add_u32 s28, s28, f1_main-cpf2
  s_addc_u32 s29, s29, 0
  v_mul_u32_u24 v248, 128, v254
  v_add_u32 v248, s20, v248
  v_lshlrev_b32 v248, 7, v248
  v_min_u32 v248, code_end-f1_main-4, v248
  global_load_dword v248, v248, s[28:29]
  s_mov_b64 exec, -1
  s_and_b32 s6, s2, 7
  s_lshr_b32 s6, s6, 1
  s_lshl_b32 s6, s6, 3
  s_lshr_b32 s7, s2, 3
  s_and_b32 s7, s7, 7
  s_add_u32 s6, s6, s7
  s_mul_i32 s6, s6, 331776
  s_add_u32 s6, s6, 50233344
  s_add_u32 s84, s4, s6
  s_addc_u32 s85, s5, 0
  s_and_b32 s85, s85, 0xffff
  s_mov_b32 s86, 331776
  s_mov_b32 s87, 0x20000
  s_mul_i32 s88, s18, 9216
  s_mov_b32 s89, 557056
  v_min_u32 v246, 7, v254
  v_lshlrev_b32 v246, 7, v246
  s_cmp_lg_u32 s18, 0
  s_cbranch_scc1 gk_wn
  v_min_u32 v255, 31, v254
  v_lshlrev_b32 v255, 7, v255
  s_mov_b32 s3, 150000
gk_wl:
  buffer_load_dword v249, v255, s[96:99], s45 offen sc1
  s_waitcnt vmcnt(0)
  v_cmp_ne_u32 vcc, v253, v249
  s_nop 1
  s_cmp_eq_u64 vcc, 0
  s_cbranch_scc1 gk_wd
  s_sub_u32 s3, s3, 1
  s_cmp_lg_u32 s3, 0
  s_cbranch_scc1 gk_wl
gk_wn:
  s_waitcnt vmcnt(0)
gk_wd:
  s_barrier
  s_and_b32 s3, s16, 3
  s_or_b32 s3, s3, s17
  s_or_b32 s3, s3, s18
  s_or_b32 s3, s3, s54
  s_cmp_lg_u32 s3, 0
  s_cbranch_scc1 gk_nopk2
  s_lshr_b32 s3, s16, 2
  s_lshl_b32 s3, s3, 7
  s_add_u32 s3, s3, 557056
  s_mov_b64 exec, 1
  buffer_store_dword v253, v252, s[96:99], s3 offen sc1
  s_mov_b64 exec, -1
gk_nopk2:
  s_cmp_eq_u32 s54, 0
  s_cbranch_scc1 gk_r1
  buffer_load_dwordx4 v[128:131], v16, s[24:27], s33 offen sc1
  buffer_load_dwordx4 v[132:135], v16, s[24:27], s48 offen sc1
  buffer_load_dwordx4 v[136:139], v17, s[24:27], s49 offen sc1
gk_r1:
  buffer_load_dwordx4 a[0:3], v2, s[8:11], 0 offen offset:0 sc1
  buffer_load_dwordx4 a[4:7], v2, s[8:11], 0 offen offset:1024 sc1
  buffer_load_dwordx4 a[8:11], v2, s[8:11], 0 offen offset:2048 sc1
  buffer_load_dwordx4 a[12:15], v2, s[8:11], 0 offen offset:3072 sc1
  buffer_load_dwordx4 a[16:19], v2, s[8:11], s60 offen offset:0 sc1
  buffer_load_dwordx4 a[20:23], v2, s[8:11], s60 offen offset:1024 sc1
  buffer_load_dwordx4 a[24:27], v2, s[8:11], s60 offen offset:2048 sc1
  buffer_load_dwordx4 a[28:31], v2, s[8:11], s60 offen offset:3072 sc1
  buffer_load_dwordx4 a[32:35], v2, s[8:11], s61 offen offset:0 sc1
  buffer_load_dwordx4 a[36:39], v2, s[8:11], s61 offen offset:1024 sc1
  buffer_load_dwordx4 a[40:43], v2, s[8:11], s61 offen offset:2048 sc1
  ds_read_b128 v[32:35], v3 offset:0
  ds_read_b128 v[36:39], v3 offset:1024
  ds_read_b128 v[40:43], v3 offset:2048
  ds_read_b128 v[44:47], v3 offset:3072
  ds_read_b128 v[64:67], v3 offset:8192
  ds_read_b128 v[48:51], v3 offset:4096
  ds_read_b128 v[52:55], v3 offset:5120
  ds_read_b128 v[56:59], v3 offset:6144
  ds_read_b128 v[60:63], v3 offset:7168
  s_waitcnt lgkmcnt(4)
  s_waitcnt vmcnt(10)
  v_mfma_f32_16x16x32_bf16 v[104:107], v[32:35], a[0:3], 0
  ds_read_b128 v[68:71], v3 offset:9216
  v_mfma_f32_16x16x32_bf16 v[108:111], v[36:39], a[0:3], 0
  ds_read_b128 v[72:75], v3 offset:10240
  v_mfma_f32_16x16x32_bf16 v[112:115], v[40:43], a[0:3], 0
  ds_read_b128 v[76:79], v3 offset:11264
  v_mfma_f32_16x16x32_bf16 v[116:119], v[44:47], a[0:3], 0
  ds_read_b128 v[80:83], v3 offset:12288
  v_mfma_f32_16x16x32_bf16 v[120:123], v[64:67], a[0:3], 0
  s_waitcnt vmcnt(9)
  s_waitcnt lgkmcnt(4)
  buffer_load_dwordx4 a[44:47], v2, s[8:11], s61 offen offset:3072 sc1
  v_mfma_f32_16x16x32_bf16 v[104:107], v[48:51], a[4:7], v[104:107]
  ds_read_b128 v[100:103], v3 offset:17408
  v_mfma_f32_16x16x32_bf16 v[108:111], v[52:55], a[4:7], v[108:111]
  ds_read_b128 v[84:87], v3 offset:13312
  v_mfma_f32_16x16x32_bf16 v[112:115], v[56:59], a[4:7], v[112:115]
  ds_read_b128 v[88:91], v3 offset:14336
  v_mfma_f32_16x16x32_bf16 v[116:119], v[60:63], a[4:7], v[116:119]
  ds_read_b128 v[92:95], v3 offset:15360
  v_mfma_f32_16x16x32_bf16 v[124:127], v[64:67], a[4:7], 0
  s_waitcnt vmcnt(9)
  s_waitcnt lgkmcnt(3)
  ds_read_b128 v[96:99], v3 offset:16384
  buffer_load_dwordx4 a[48:51], v2, s[8:11], s62 offen offset:0 sc1
  v_mfma_f32_16x16x32_bf16 v[104:107], v[68:71], a[8:11], v[104:107]
  ds_read_b128 v[32:35], v3 offset:18432
  v_mfma_f32_16x16x32_bf16 v[108:111], v[72:75], a[8:11], v[108:111]
  ds_read_b128 v[36:39], v3 offset:19456
  v_mfma_f32_16x16x32_bf16 v[112:115], v[76:79], a[8:11], v[112:115]
  ds_read_b128 v[40:43], v3 offset:20480
  buffer_load_dword v247, v246, s[96:99], s89 offen sc1
  v_mfma_f32_16x16x32_bf16 v[116:119], v[80:83], a[8:11], v[116:119]
  ds_read_b128 v[44:47], v3 offset:21504
  v_mfma_f32_16x16x32_bf16 v[120:123], v[100:103], a[8:11], v[120:123]
  s_waitcnt vmcnt(10)
  s_waitcnt lgkmcnt(4)
  buffer_load_dwordx4 a[52:55], v2, s[8:11], s62 offen offset:1024 sc1
  v_mfma_f32_16x16x32_bf16 v[104:107], v[84:87], a[12:15], v[104:107]
  ds_read_b128 v[64:67], v3 offset:26624
  v_mfma_f32_16x16x32_bf16 v[108:111], v[88:91], a[12:15], v[108:111]
  ds_read_b128 v[48:51], v3 offset:22528
  v_mfma_f32_16x16x32_bf16 v[112:115], v[92:95], a[12:15], v[112:115]
  ds_read_b128 v[52:55], v3 offset:23552
  v_mfma_f32_16x16x32_bf16 v[116:119], v[96:99], a[12:15], v[116:119]
  ds_read_b128 v[56:59], v3 offset:24576
  v_mfma_f32_16x16x32_bf16 v[124:127], v[100:103], a[12:15], v[124:127]
  s_waitcnt vmcnt(10)
  s_waitcnt lgkmcnt(3)
  ds_read_b128 v[60:63], v3 offset:25600
  buffer_load_dwordx4 a[56:59], v2, s[8:11], s62 offen offset:2048 sc1
  v_mfma_f32_16x16x32_bf16 v[104:107], v[32:35], a[16:19], v[104:107]
  ds_read_b128 v[68:71], v3 offset:27648
  v_mfma_f32_16x16x32_bf16 v[108:111], v[36:39], a[16:19], v[108:111]
  ds_read_b128 v[72:75], v3 offset:28672
  v_mfma_f32_16x16x32_bf16 v[112:115], v[40:43], a[16:19], v[112:115]
  ds_read_b128 v[76:79], v3 offset:29696
  v_mfma_f32_16x16x32_bf16 v[116:119], v[44:47], a[16:19], v[116:119]
  ds_read_b128 v[80:83], v3 offset:30720
  v_mfma_f32_16x16x32_bf16 v[120:123], v[64:67], a[16:19], v[120:123]
  s_waitcnt vmcnt(10)
  s_waitcnt lgkmcnt(4)
  buffer_load_dwordx4 a[60:63], v2, s[8:11], s62 offen offset:3072 sc1
  v_mfma_f32_16x16x32_bf16 v[104:107], v[48:51], a[20:23], v[104:107]
  ds_read_b128 v[100:103], v3 offset:35840
  v_mfma_f32_16x16x32_bf16 v[108:111], v[52:55], a[20:23], v[108:111]
  ds_read_b128 v[84:87], v3 offset:31744
  v_mfma_f32_16x16x32_bf16 v[112:115], v[56:59], a[20:23], v[112:115]
  ds_read_b128 v[88:91], v3 offset:32768
  v_mfma_f32_16x16x32_bf16 v[116:119], v[60:63], a[20:23], v[116:119]
  ds_read_b128 v[92:95], v3 offset:33792
  v_mfma_f32_16x16x32_bf16 v[124:127], v[64:67], a[20:23], v[124:127]
  s_waitcnt vmcnt(10)
  s_waitcnt lgkmcnt(3)
  ds_read_b128 v[96:99], v3 offset:34816
  buffer_load_dwordx4 a[64:67], v2, s[8:11], s63 offen offset:0 sc1
  v_mfma_f32_16x16x32_bf16 v[104:107], v[68:71], a[24:27], v[104:107]
  ds_read_b128 v[32:35], v3 offset:36864
  v_mfma_f32_16x16x32_bf16 v[108:111], v[72:75], a[24:27], v[108:111]
  ds_read_b128 v[36:39], v3 offset:37888
  v_mfma_f32_16x16x32_bf16 v[112:115], v[76:79], a[24:27], v[112:115]
  ds_read_b128 v[40:43], v3 offset:38912
  s_waitcnt vmcnt(4)
  v_cmp_ne_u32 vcc, v253, v247
  s_nop 1
  s_cmp_lg_u64 vcc, 0
  s_cbranch_scc1 pkf_slow
pkf_ok:
  v_mfma_f32_16x16x32_bf16 v[116:119], v[80:83], a[24:27], v[116:119]
  ds_read_b128 v[44:47], v3 offset:39936
  v_mfma_f32_16x16x32_bf16 v[120:123], v[100:103], a[24:27], v[120:123]
  s_waitcnt vmcnt(10)
  s_waitcnt lgkmcnt(4)
  buffer_load_dwordx4 a[68:71], v2, s[8:11], s63 offen offset:1024 sc1
  s_add_u32 m0, s88, 0
  s_nop 0
  buffer_load_dwordx4 v1, s[84:87], m0 offen offset:0 sc1 lds
  v_mfma_f32_16x16x32_bf16 v[104:107], v[84:87], a[28:31], v[104:107]
  ds_read_b128 v[64:67], v3 offset:45056
  v_mfma_f32_16x16x32_bf16 v[108:111], v[88:91], a[28:31], v[108:111]
  ds_read_b128 v[48:51], v3 offset:40960
  v_mfma_f32_16x16x32_bf16 v[112:115], v[92:95], a[28:31], v[112:115]
  ds_read_b128 v[52:55], v3 offset:41984
  buffer_load_dwordx4 v1, s[84:87], m0 offen offset:1024 sc1 lds
  v_mfma_f32_16x16x32_bf16 v[116:119], v[96:99], a[28:31], v[116:119]
  ds_read_b128 v[56:59], v3 offset:43008
  v_mfma_f32_16x16x32_bf16 v[124:127], v[100:103], a[28:31], v[124:127]
  s_waitcnt vmcnt(12)
  s_waitcnt lgkmcnt(3)
  ds_read_b128 v[60:63], v3 offset:44032
  v_mfma_f32_16x16x32_bf16 v[104:107], v[32:35], a[32:35], v[104:107]
  ds_read_b128 v[68:71], v3 offset:46080
  buffer_load_dwordx4 v1, s[84:87], m0 offen offset:2048 sc1 lds
  v_mfma_f32_16x16x32_bf16 v[108:111], v[36:39], a[32:35], v[108:111]
  ds_read_b128 v[72:75], v3 offset:47104
  v_mfma_f32_16x16x32_bf16 v[112:115], v[40:43], a[32:35], v[112:115]
  ds_read_b128 v[76:79], v3 offset:48128
  v_mfma_f32_16x16x32_bf16 v[116:119], v[44:47], a[32:35], v[116:119]
  ds_read_b128 v[80:83], v3 offset:49152
  buffer_load_dwordx4 v1, s[84:87], m0 offen offset:3072 sc1 lds
  v_mfma_f32_16x16x32_bf16 v[120:123], v[64:67], a[32:35], v[120:123]
  s_waitcnt vmcnt(13)
  s_waitcnt lgkmcnt(4)
  v_mfma_f32_16x16x32_bf16 v[104:107], v[48:51], a[36:39], v[104:107]
  ds_read_b128 v[100:103], v3 offset:54272
  v_mfma_f32_16x16x32_bf16 v[108:111], v[52:55], a[36:39], v[108:111]
  ds_read_b128 v[84:87], v3 offset:50176
  s_add_u32 m0, s88, 4096
  s_nop 0
  buffer_load_dwordx4 v1, s[84:87], m0 offen offset:0 sc1 lds
  v_mfma_f32_16x16x32_bf16 v[112:115], v[56:59], a[36:39], v[112:115]
  ds_read_b128 v[88:91], v3 offset:51200
  v_mfma_f32_16x16x32_bf16 v[116:119], v[60:63], a[36:39], v[116:119]
  ds_read_b128 v[92:95], v3 offset:52224
  v_mfma_f32_16x16x32_bf16 v[124:127], v[64:67], a[36:39], v[124:127]
  s_waitcnt vmcnt(13)
  s_waitcnt lgkmcnt(3)
  ds_read_b128 v[96:99], v3 offset:53248
  v_mfma_f32_16x16x32_bf16 v[104:107], v[68:71], a[40:43], v[104:107]
  ds_read_b128 v[32:35], v3 offset:55296
  buffer_load_dwordx4 v1, s[84:87], m0 offen offset:1024 sc1 lds
  v_mfma_f32_16x16x32_bf16 v[108:111], v[72:75], a[40:43], v[108:111]
  ds_read_b128 v[36:39], v3 offset:56320
  v_mfma_f32_16x16x32_bf16 v[112:115], v[76:79], a[40:43], v[112:115]
  ds_read_b128 v[40:43], v3 offset:57344
  v_mfma_f32_16x16x32_bf16 v[116:119], v[80:83], a[40:43], v[116:119]
  ds_read_b128 v[44:47], v3 offset:58368
  buffer_load_dwordx4 v1, s[84:87], m0 offen offset:2048 sc1 lds
  v_mfma_f32_16x16x32_bf16 v[120:123], v[100:103], a[40:43], v[120:123]
  s_waitcnt vmcnt(14)
  s_waitcnt lgkmcnt(4)
  v_mfma_f32_16x16x32_bf16 v[104:107], v[84:87], a[44:47], v[104:107]
  ds_read_b128 v[64:67], v3 offset:63488
  v_mfma_f32_16x16x32_bf16 v[108:111], v[88:91], a[44:47], v[108:111]
  ds_read_b128 v[48:51], v3 offset:59392
  buffer_load_dwordx4 v1, s[84:87], m0 offen offset:3072 sc1 lds
  v_mfma_f32_16x16x32_bf16 v[112:115], v[92:95], a[44:47], v[112:115]
  ds_read_b128 v[52:55], v3 offset:60416
  v_mfma_f32_16x16x32_bf16 v[116:119], v[96:99], a[44:47], v[116:119]
  ds_read_b128 v[56:59], v3 offset:61440
  v_mfma_f32_16x16x32_bf16 v[124:127], v[100:103], a[44:47], v[124:127]
  s_waitcnt vmcnt(14)
  s_waitcnt lgkmcnt(3)
  ds_read_b128 v[60:63], v3 offset:62464
  s_add_u32 m0, s88, 8192
  s_nop 0
  buffer_load_dwordx4 v1, s[84:87], m0 offen offset:0 sc1 lds
  v_mfma_f32_16x16x32_bf16 v[104:107], v[32:35], a[48:51], v[104:107]
  ds_read_b128 v[68:71], v3 offset:64512
  v_mfma_f32_16x16x32_bf16 v[108:111], v[36:39], a[48:51], v[108:111]
  ds_read_b128 v[72:75], v4 offset:0
  v_mfma_f32_16x16x32_bf16 v[112:115], v[40:43], a[48:51], v[112:115]
  ds_read_b128 v[76:79], v4 offset:1024
  v_mfma_f32_16x16x32_bf16 v[116:119], v[44:47], a[48:51], v[116:119]
  ds_read_b128 v[80:83], v4 offset:2048
  s_add_u32 m0, s88, 36864
  s_nop 0
  buffer_load_dwordx4 v1, s[84:87], m0 offen offset:0 sc1 lds
  v_mfma_f32_16x16x32_bf16 v[120:123], v[64:67], a[48:51], v[120:123]
  s_waitcnt vmcnt(14)
  s_waitcnt lgkmcnt(4)
  v_mfma_f32_16x16x32_bf16 v[104:107], v[48:51], a[52:55], v[104:107]
  ds_read_b128 v[100:103], v4 offset:7168
  v_mfma_f32_16x16x32_bf16 v[108:111], v[52:55], a[52:55], v[108:111]
  ds_read_b128 v[84:87], v4 offset:3072
  buffer_load_dwordx4 v1, s[84:87], m0 offen offset:1024 sc1 lds
  v_mfma_f32_16x16x32_bf16 v[112:115], v[56:59], a[52:55], v[112:115]
  ds_read_b128 v[88:91], v4 offset:4096
  v_mfma_f32_16x16x32_bf16 v[116:119], v[60:63], a[52:55], v[116:119]
  ds_read_b128 v[92:95], v4 offset:5120
  v_mfma_f32_16x16x32_bf16 v[124:127], v[64:67], a[52:55], v[124:127]
  s_waitcnt vmcnt(14)
  s_waitcnt lgkmcnt(3)
  ds_read_b128 v[96:99], v4 offset:6144
  buffer_load_dwordx4 v1, s[84:87], m0 offen offset:2048 sc1 lds
  v_mfma_f32_16x16x32_bf16 v[104:107], v[68:71], a[56:59], v[104:107]
  ds_read_b128 v[32:35], v4 offset:8192
  v_mfma_f32_16x16x32_bf16 v[108:111], v[72:75], a[56:59], v[108:111]
  ds_read_b128 v[36:39], v4 offset:9216
  v_mfma_f32_16x16x32_bf16 v[112:115], v[76:79], a[56:59], v[112:115]
  ds_read_b128 v[40:43], v4 offset:10240
  buffer_load_dwordx4 v1, s[84:87], m0 offen offset:3072 sc1 lds
  v_mfma_f32_16x16x32_bf16 v[116:119], v[80:83], a[56:59], v[116:119]
  ds_read_b128 v[44:47], v4 offset:11264
  v_mfma_f32_16x16x32_bf16 v[120:123], v[100:103], a[56:59], v[120:123]
  s_waitcnt vmcnt(15)
  s_waitcnt lgkmcnt(4)
  v_mfma_f32_16x16x32_bf16 v[104:107], v[84:87], a[60:63], v[104:107]
  ds_read_b128 v[64:67], v4 offset:16384
  v_mfma_f32_16x16x32_bf16 v[108:111], v[88:91], a[60:63], v[108:111]
  ds_read_b128 v[48:51], v4 offset:12288
  s_add_u32 m0, s88, 40960
  s_nop 0
  buffer_load_dwordx4 v1, s[84:87], m0 offen offset:0 sc1 lds
  v_mfma_f32_16x16x32_bf16 v[112:115], v[92:95], a[60:63], v[112:115]
  ds_read_b128 v[52:55], v4 offset:13312
  v_mfma_f32_16x16x32_bf16 v[116:119], v[96:99], a[60:63], v[116:119]
  ds_read_b128 v[56:59], v4 offset:14336
  v_mfma_f32_16x16x32_bf16 v[124:127], v[100:103], a[60:63], v[124:127]
  s_waitcnt vmcnt(15)
  s_waitcnt lgkmcnt(3)
  ds_read_b128 v[60:63], v4 offset:15360
  buffer_load_dwordx4 v1, s[84:87], m0 offen offset:1024 sc1 lds
  v_mfma_f32_16x16x32_bf16 v[104:107], v[32:35], a[64:67], v[104:107]
  v_mfma_f32_16x16x32_bf16 v[108:111], v[36:39], a[64:67], v[108:111]
  v_mfma_f32_16x16x32_bf16 v[112:115], v[40:43], a[64:67], v[112:115]
  buffer_load_dwordx4 v1, s[84:87], m0 offen offset:2048 sc1 lds
  v_mfma_f32_16x16x32_bf16 v[116:119], v[44:47], a[64:67], v[116:119]
  v_mfma_f32_16x16x32_bf16 v[120:123], v[64:67], a[64:67], v[120:123]
  s_waitcnt vmcnt(16)
  s_waitcnt lgkmcnt(0)
  v_mfma_f32_16x16x32_bf16 v[104:107], v[48:51], a[68:71], v[104:107]
  buffer_load_dwordx4 v1, s[84:87], m0 offen offset:3072 sc1 lds
  v_mfma_f32_16x16x32_bf16 v[108:111], v[52:55], a[68:71], v[108:111]
  v_mfma_f32_16x16x32_bf16 v[112:115], v[56:59], a[68:71], v[112:115]
  v_mfma_f32_16x16x32_bf16 v[116:119], v[60:63], a[68:71], v[116:119]
  v_mfma_f32_16x16x32_bf16 v[124:127], v[64:67], a[68:71], v[124:127]
  s_add_u32 m0, s88, 45056
  s_nop 0
  buffer_load_dwordx4 v1, s[84:87], m0 offen offset:0 sc1 lds
  v_lshlrev_b32 v140, 16, v128
  v_and_b32 v141, v22, v128
  v_lshlrev_b32 v142, 16, v129
  v_and_b32 v143, v22, v129
  v_lshlrev_b32 v144, 16, v130
  v_and_b32 v145, v22, v130
  v_lshlrev_b32 v146, 16, v131
  v_and_b32 v147, v22, v131
  v_lshlrev_b32 v148, 16, v132
  v_and_b32 v149, v22, v132
  v_lshlrev_b32 v150, 16, v133
  v_and_b32 v151, v22, v133
  v_lshlrev_b32 v152, 16, v134
  v_and_b32 v153, v22, v134
  v_lshlrev_b32 v154, 16, v135
  v_and_b32 v155, v22, v135
  v_lshlrev_b32 v156, 16, v136
  v_and_b32 v157, v22, v136
  v_lshlrev_b32 v158, 16, v137
  v_and_b32 v159, v22, v137
  v_lshlrev_b32 v160, 16, v138
  v_and_b32 v161, v22, v138
  v_lshlrev_b32 v162, 16, v139
  v_and_b32 v163, v22, v139
  v_permlane16_swap_b32 v104, v108
  v_permlane16_swap_b32 v105, v109
  v_permlane16_swap_b32 v106, v110
  v_permlane16_swap_b32 v107, v111
  v_pk_add_f32 v[104:105], v[104:105], v[140:141]
  v_pk_add_f32 v[106:107], v[106:107], v[142:143]
  v_pk_add_f32 v[108:109], v[108:109], v[144:145]
  v_pk_add_f32 v[110:111], v[110:111], v[146:147]
  v_cvt_pk_bf16_f32 v164, v104, v105
  v_cvt_pk_bf16_f32 v165, v106, v107
  v_cvt_pk_bf16_f32 v166, v108, v109
  v_cvt_pk_bf16_f32 v167, v110, v111
  buffer_store_dwordx4 v[164:167], v9, s[36:39], s44 offen offset:0 sc1
  v_permlane16_swap_b32 v112, v116
  v_permlane16_swap_b32 v113, v117
  v_permlane16_swap_b32 v114, v118
  v_permlane16_swap_b32 v115, v119
  v_pk_add_f32 v[112:113], v[112:113], v[148:149]
  v_pk_add_f32 v[114:115], v[114:115], v[150:151]
  v_pk_add_f32 v[116:117], v[116:117], v[152:153]
  v_pk_add_f32 v[118:119], v[118:119], v[154:155]
  v_cvt_pk_bf16_f32 v168, v112, v113
  v_cvt_pk_bf16_f32 v169, v114, v115
  v_cvt_pk_bf16_f32 v170, v116, v117
  v_cvt_pk_bf16_f32 v171, v118, v119
  buffer_store_dwordx4 v[168:171], v9, s[36:39], s44 offen offset:1024 sc1
  v_mov_b32 v32, v120
  v_mov_b32 v33, v121
  v_mov_b32 v34, v122
  v_mov_b32 v35, v123
  v_permlane32_swap_b32 v124, v32
  v_permlane32_swap_b32 v125, v33
  v_permlane32_swap_b32 v126, v34
  v_permlane32_swap_b32 v127, v35
  v_pk_add_f32 v[120:121], v[120:121], v[32:33]
  v_pk_add_f32 v[122:123], v[122:123], v[34:35]
  v_mov_b32 v124, v120
  v_mov_b32 v125, v121
  v_mov_b32 v126, v122
  v_mov_b32 v127, v123
  v_permlane16_swap_b32 v120, v124
  v_permlane16_swap_b32 v121, v125
  v_permlane16_swap_b32 v122, v126
  v_permlane16_swap_b32 v123, v127
  s_mov_b64 exec, 0xffff
  v_pk_add_f32 v[120:121], v[120:121], v[156:157]
  v_pk_add_f32 v[122:123], v[122:123], v[158:159]
  v_pk_add_f32 v[124:125], v[124:125], v[160:161]
  v_pk_add_f32 v[126:127], v[126:127], v[162:163]
  v_cvt_pk_bf16_f32 v172, v120, v121
  v_cvt_pk_bf16_f32 v173, v122, v123
  v_cvt_pk_bf16_f32 v174, v124, v125
  v_cvt_pk_bf16_f32 v175, v126, v127
  buffer_store_dwordx4 v[172:175], v18, s[36:39], s44 offen offset:2048 sc1
  v_dot2c_f32_bf16 v20, v172, v23
  v_dot2c_f32_bf16 v21, v172, v172
  v_dot2c_f32_bf16 v20, v173, v23
  v_dot2c_f32_bf16 v21, v173, v173
  v_dot2c_f32_bf16 v20, v174, v23
  v_dot2c_f32_bf16 v21, v174, v174
  v_dot2c_f32_bf16 v20, v175, v23
  v_dot2c_f32_bf16 v21, v175, v175
  s_mov_b64 exec, -1
  v_dot2c_f32_bf16 v20, v164, v23
  v_dot2c_f32_bf16 v21, v164, v164
  v_dot2c_f32_bf16 v20, v165, v23
  v_dot2c_f32_bf16 v21, v165, v165
  v_dot2c_f32_bf16 v20, v166, v23
  v_dot2c_f32_bf16 v21, v166, v166
  v_dot2c_f32_bf16 v20, v167, v23
  v_dot2c_f32_bf16 v21, v167, v167
  v_dot2c_f32_bf16 v20, v168, v23
  v_dot2c_f32_bf16 v21, v168, v168
  v_dot2c_f32_bf16 v20, v169, v23
  v_dot2c_f32_bf16 v21, v169, v169
  v_dot2c_f32_bf16 v20, v170, v23
  v_dot2c_f32_bf16 v21, v170, v170
  v_dot2c_f32_bf16 v20, v171, v23
  v_dot2c_f32_bf16 v21, v171, v171
  s_nop 1
  v_mov_b32 v24, v20
  v_mov_b32 v25, v21
  s_nop 0
  v_permlane16_swap_b32 v20, v24
  v_permlane16_swap_b32 v21, v25
  v_add_f32 v20, v20, v24
  v_add_f32 v21, v21, v25
  v_mov_b32 v24, v20
  v_mov_b32 v25, v21
  s_nop 0
  v_permlane32_swap_b32 v20, v24
  v_permlane32_swap_b32 v21, v25
  v_add_f32 v20, v20, v24
  v_add_f32 v21, v21, v25
  s_mov_b64 exec, 0xffff
  buffer_store_dwordx2 v[20:21], v18, s[40:43], s51 offen sc1
  s_mov_b64 exec, -1
f1_main:
  s_and_b32 s6, s2, 7
  s_lshr_b32 s7, s2, 3
  s_and_b32 s16, s6, 1
  s_lshl_b32 s16, s16, 2
  s_lshr_b32 s17, s7, 3
  s_add_u32 s16, s16, s17
  s_lshr_b32 s17, s6, 1
  s_lshl_b32 s17, s17, 3
  s_and_b32 s7, s7, 7
  s_add_u32 s17, s17, s7
  s_mul_i32 s39, s18, 9216
  s_mul_i32 s6, s17, 331776
  s_add_u32 s6, s6, 50233344
  s_add_u32 s12, s4, s6
  s_addc_u32 s13, s5, 0
  s_and_b32 s13, s13, 0xffff
  s_mov_b32 s14, 331776
  s_waitcnt vmcnt(0)
  s_barrier
  s_cmp_lg_u32 s18, 0
  s_cbranch_scc1 wo_sg
  s_mov_b64 exec, 1
  buffer_store_dword v253, v252, s[96:99], s58 offen sc1
  s_mov_b64 exec, -1
wo_sg:
  s_lshl_b32 s46, s16, 12
  s_add_u32 s46, s46, s59
  s_add_u32 s46, s46, 65536
  s_lshl_b32 s38, s18, 10
  s_add_u32 m0, s39, 73728
  s_nop 0
  buffer_load_dwordx4 v1, s[12:15], m0 offen offset:0 sc1 lds
  buffer_load_dwordx4 v1, s[12:15], m0 offen offset:1024 sc1 lds
  buffer_load_dwordx4 v1, s[12:15], m0 offen offset:2048 sc1 lds
  buffer_load_dwordx4 v1, s[12:15], m0 offen offset:3072 sc1 lds
  s_add_u32 m0, s39, 77824
  s_nop 0
  buffer_load_dwordx4 v1, s[12:15], m0 offen offset:0 sc1 lds
  buffer_load_dwordx4 v1, s[12:15], m0 offen offset:1024 sc1 lds
  buffer_load_dwordx4 v1, s[12:15], m0 offen offset:2048 sc1 lds
  buffer_load_dwordx4 v1, s[12:15], m0 offen offset:3072 sc1 lds
  s_add_u32 m0, s39, 81920
  s_nop 0
  buffer_load_dwordx4 v1, s[12:15], m0 offen offset:0 sc1 lds
  s_lshl_b32 s19, s16, 4
  s_lshl_b32 s6, s18, 2
  s_add_u32 s19, s19, s6
  s_mov_b32 s33, 4096
  s_mov_b32 s34, 8192
  s_mov_b32 s35, 12288
  s_mov_b32 s36, 16384
  s_mul_i32 s6, s19, 18432
  v_add_u32 v2, s6, v1
  v_add_u32 v3, 18432, v2
  v_add_u32 v4, 18432, v3
  v_add_u32 v5, 18432, v4
  v_and_b32 v13, 15, v254
  v_lshrrev_b32 v15, 4, v254
  s_lshl_b32 s6, s19, 10
  v_add_u32 v9, s6, v1
  v_min_u32 v10, 35, v254
  v_lshlrev_b32 v10, 3, v10
  s_mul_i32 s6, s18, 288
  v_add_u32 v10, s6, v10
  s_mul_i32 s42, s17, 1152
  s_add_u32 s43, s42, 36864
  s_add_u32 s44, s42, 73728
  s_add_u32 s8, s100, 2359296
  s_addc_u32 s9, s101, 0
  s_and_b32 s9, s9, 0xffff
  s_mov_b32 s10, 2359296
  s_mov_b32 s11, 0x20000
  s_add_u32 s20, s100, 14417920
  s_addc_u32 s21, s101, 0
  s_and_b32 s21, s21, 0xffff
  s_mov_b32 s22, 131072
  s_mov_b32 s23, 0x20000
  s_add_u32 s28, s4, 66183168
  s_addc_u32 s29, s5, 0
  s_and_b32 s29, s29, 0xffff
  s_mov_b32 s30, 110592
  s_mov_b32 s31, 0x20000
  s_add_u32 s24, s100, 14548992
  s_addc_u32 s25, s101, 0
  s_and_b32 s25, s25, 0xffff
  s_mov_b32 s26, 18874368
  s_mov_b32 s27, 0x20000
  v_add_u32 v6, 65536, v1
  v_add_u32 v7, 131072, v1
  v_add_u32 v8, 147456, v1
  v_and_b32 v11, 1, v15
  v_mul_u32_u24 v11, 147456, v11
  v_lshrrev_b32 v12, 1, v15
  v_lshl_add_u32 v11, v12, 8, v11
  v_lshl_add_u32 v11, v13, 4, v11
  s_mul_i32 s6, s19, 147456
  v_add_u32 v11, s6, v11
  v_add_u32 v12, 294912, v11
  s_lshr_b32 s47, s17, 3
  s_mul_i32 s45, s47, 36864
  s_and_b32 s6, s17, 7
  s_lshl_b32 s6, s6, 9
  s_add_u32 s45, s45, s6
  s_lshl_b32 s46, s16, 12
  s_add_u32 s46, s46, s59
  s_lshl_b32 s58, s17, 7
  s_add_u32 s58, s58, s46
  s_add_u32 s55, s58, 196608
  s_add_u32 s40, s58, 229376
  s_add_u32 s58, s58, 98304
  s_add_u32 s46, s46, 65536
  s_lshr_b32 s7, s2, 3
  s_and_b32 s48, s2, 1
  s_lshl_b32 s48, s48, 3
  s_lshr_b32 s6, s7, 2
  s_add_u32 s48, s48, s6
  s_and_b32 s49, s7, 3
  s_lshl_b32 s6, s49, 2
  s_add_u32 s6, s6, s47
  s_mul_i32 s6, s6, 331776
  s_add_u32 s6, s6, 60850176
  s_add_u32 s60, s4, s6
  s_addc_u32 s61, s5, 0
  s_and_b32 s61, s61, 0xffff
  s_mov_b32 s62, 331776
  s_mov_b32 s63, 0x20000
  s_lshl_b32 s6, s48, 3
  s_lshl_b32 s7, s18, 1
  s_add_u32 s6, s6, s7
  s_mul_i32 s6, s6, 147456
  s_mul_i32 s7, s47, 36864
  s_add_u32 s6, s6, s7
  v_add_u32 v244, s6, v1
  v_add_u32 v245, 147456, v244
  s_lshr_b32 s50, s48, 1
  s_lshl_b32 s50, s50, 5
  s_lshl_b32 s6, s47, 3
  s_add_u32 s50, s50, s6
  s_lshl_b32 s50, s50, 7
  s_add_u32 s50, s50, s59
  s_add_u32 s51, s50, 98304
  s_add_u32 s41, s50, 229376
  s_add_u32 s50, s50, 196608
  v_min_u32 v246, 7, v254
  v_lshlrev_b32 v246, 7, v246
  s_mov_b32 s52, s39
  s_mov_b32 s53, 0
  s_cmp_lg_u32 s18, 0
  s_cbranch_scc1 f1_wn
  v_min_u32 v255, 31, v254
  v_lshlrev_b32 v255, 7, v255
  s_mov_b32 s3, 150000
f1_wl:
  buffer_load_dword v249, v255, s[96:99], s46 offen sc1
  s_waitcnt vmcnt(0)
  v_cmp_ne_u32 vcc, v253, v249
  s_nop 1
  s_cmp_eq_u64 vcc, 0
  s_cbranch_scc1 f1_wd
  s_sub_u32 s3, s3, 1
  s_cmp_lg_u32 s3, 0
  s_cbranch_scc1 f1_wl
f1_wn:
  s_waitcnt vmcnt(0)
f1_wd:
  s_barrier
  buffer_load_dwordx4 a[0:3], v2, s[8:11], 0 offen offset:0 sc1
  buffer_load_dwordx4 a[4:7], v3, s[8:11], 0 offen offset:0 sc1
  buffer_load_dwordx4 a[8:11], v4, s[8:11], 0 offen offset:0 sc1
  buffer_load_dwordx4 a[12:15], v5, s[8:11], 0 offen offset:0 sc1
  buffer_load_dwordx4 a[16:19], v2, s[8:11], 0 offen offset:1024 sc1
  buffer_load_dwordx4 a[20:23], v3, s[8:11], 0 offen offset:1024 sc1
  buffer_load_dwordx4 a[24:27], v4, s[8:11], 0 offen offset:1024 sc1
  buffer_load_dwordx4 a[28:31], v5, s[8:11], 0 offen offset:1024 sc1
  buffer_load_dwordx4 a[32:35], v2, s[8:11], 0 offen offset:2048 sc1
  buffer_load_dwordx4 a[36:39], v3, s[8:11], 0 offen offset:2048 sc1
  buffer_load_dwordx4 a[40:43], v4, s[8:11], 0 offen offset:2048 sc1
  buffer_load_dwordx4 a[44:47], v5, s[8:11], 0 offen offset:2048 sc1
  ds_read_b128 v[168:171], v1 offset:0
  ds_read_b128 v[172:175], v1 offset:1024
  ds_read_b128 v[176:179], v1 offset:36864
  ds_read_b128 v[180:183], v1 offset:37888
  ds_read_b128 v[184:187], v6 offset:8192
  ds_read_b128 v[188:191], v6 offset:9216
  s_waitcnt lgkmcnt(4)
  s_waitcnt vmcnt(8)
  v_mfma_f32_16x16x32_bf16 v[72:75], v[168:171], a[0:3], 0
  ds_read_b128 v[48:51], v1 offset:2048
  v_mfma_f32_16x16x32_bf16 v[88:91], v[172:175], a[0:3], 0
  s_waitcnt lgkmcnt(1)
  ds_read_b128 v[52:55], v1 offset:3072
  v_mfma_f32_16x16x32_bf16 v[104:107], v[176:179], a[0:3], 0
  buffer_load_dwordx4 a[48:51], v2, s[8:11], 0 offen offset:3072 sc1
  v_mfma_f32_16x16x32_bf16 v[120:123], v[180:183], a[0:3], 0
  v_mfma_f32_16x16x32_bf16 v[136:139], v[184:187], a[0:3], 0
  ds_read_b128 v[56:59], v1 offset:38912
  v_mfma_f32_16x16x32_bf16 v[152:155], v[188:191], a[0:3], 0
  ds_read_b128 v[60:63], v1 offset:39936
  v_mfma_f32_16x16x32_bf16 v[156:159], v[188:191], a[4:7], 0
  v_mfma_f32_16x16x32_bf16 v[140:143], v[184:187], a[4:7], 0
  buffer_load_dwordx4 a[52:55], v3, s[8:11], 0 offen offset:3072 sc1
  v_mfma_f32_16x16x32_bf16 v[124:127], v[180:183], a[4:7], 0
  ds_read_b128 v[64:67], v6 offset:10240
  v_mfma_f32_16x16x32_bf16 v[108:111], v[176:179], a[4:7], 0
  ds_read_b128 v[68:71], v6 offset:11264
  v_mfma_f32_16x16x32_bf16 v[92:95], v[172:175], a[4:7], 0
  v_mfma_f32_16x16x32_bf16 v[76:79], v[168:171], a[4:7], 0
  v_mfma_f32_16x16x32_bf16 v[80:83], v[168:171], a[8:11], 0
  v_mfma_f32_16x16x32_bf16 v[96:99], v[172:175], a[8:11], 0
  v_mfma_f32_16x16x32_bf16 v[112:115], v[176:179], a[8:11], 0
  buffer_load_dwordx4 a[56:59], v4, s[8:11], 0 offen offset:3072 sc1
  v_mfma_f32_16x16x32_bf16 v[128:131], v[180:183], a[8:11], 0
  v_mfma_f32_16x16x32_bf16 v[144:147], v[184:187], a[8:11], 0
  v_mfma_f32_16x16x32_bf16 v[160:163], v[188:191], a[8:11], 0
  v_mfma_f32_16x16x32_bf16 v[164:167], v[188:191], a[12:15], 0
  buffer_load_dwordx4 a[60:63], v5, s[8:11], 0 offen offset:3072 sc1
  v_mfma_f32_16x16x32_bf16 v[148:151], v[184:187], a[12:15], 0
  v_mfma_f32_16x16x32_bf16 v[132:135], v[180:183], a[12:15], 0
  v_mfma_f32_16x16x32_bf16 v[116:119], v[176:179], a[12:15], 0
  v_mfma_f32_16x16x32_bf16 v[100:103], v[172:175], a[12:15], 0
  s_waitcnt vmcnt(8)
  v_mfma_f32_16x16x32_bf16 v[84:87], v[168:171], a[12:15], 0
  s_waitcnt lgkmcnt(0)
  v_mfma_f32_16x16x32_bf16 v[72:75], v[48:51], a[16:19], v[72:75]
  ds_read_b128 v[168:171], v1 offset:4096
  v_mfma_f32_16x16x32_bf16 v[88:91], v[52:55], a[16:19], v[88:91]
  ds_read_b128 v[172:175], v1 offset:5120
  v_mfma_f32_16x16x32_bf16 v[104:107], v[56:59], a[16:19], v[104:107]
  buffer_load_dwordx4 a[64:67], v2, s[8:11], s33 offen offset:0 sc1
  v_mfma_f32_16x16x32_bf16 v[120:123], v[60:63], a[16:19], v[120:123]
  v_mfma_f32_16x16x32_bf16 v[136:139], v[64:67], a[16:19], v[136:139]
  ds_read_b128 v[176:179], v1 offset:40960
  v_mfma_f32_16x16x32_bf16 v[152:155], v[68:71], a[16:19], v[152:155]
  ds_read_b128 v[180:183], v1 offset:41984
  v_mfma_f32_16x16x32_bf16 v[156:159], v[68:71], a[20:23], v[156:159]
  v_mfma_f32_16x16x32_bf16 v[140:143], v[64:67], a[20:23], v[140:143]
  buffer_load_dwordx4 a[68:71], v3, s[8:11], s33 offen offset:0 sc1
  v_mfma_f32_16x16x32_bf16 v[124:127], v[60:63], a[20:23], v[124:127]
  ds_read_b128 v[184:187], v6 offset:12288
  v_mfma_f32_16x16x32_bf16 v[108:111], v[56:59], a[20:23], v[108:111]
  ds_read_b128 v[188:191], v6 offset:13312
  v_mfma_f32_16x16x32_bf16 v[92:95], v[52:55], a[20:23], v[92:95]
  v_mfma_f32_16x16x32_bf16 v[76:79], v[48:51], a[20:23], v[76:79]
  v_mfma_f32_16x16x32_bf16 v[80:83], v[48:51], a[24:27], v[80:83]
  v_mfma_f32_16x16x32_bf16 v[96:99], v[52:55], a[24:27], v[96:99]
  v_mfma_f32_16x16x32_bf16 v[112:115], v[56:59], a[24:27], v[112:115]
  buffer_load_dwordx4 a[72:75], v4, s[8:11], s33 offen offset:0 sc1
  v_mfma_f32_16x16x32_bf16 v[128:131], v[60:63], a[24:27], v[128:131]
  v_mfma_f32_16x16x32_bf16 v[144:147], v[64:67], a[24:27], v[144:147]
  v_mfma_f32_16x16x32_bf16 v[160:163], v[68:71], a[24:27], v[160:163]
  v_mfma_f32_16x16x32_bf16 v[164:167], v[68:71], a[28:31], v[164:167]
  buffer_load_dwordx4 a[76:79], v5, s[8:11], s33 offen offset:0 sc1
  v_mfma_f32_16x16x32_bf16 v[148:151], v[64:67], a[28:31], v[148:151]
  v_mfma_f32_16x16x32_bf16 v[132:135], v[60:63], a[28:31], v[132:135]
  v_mfma_f32_16x16x32_bf16 v[116:119], v[56:59], a[28:31], v[116:119]
  v_mfma_f32_16x16x32_bf16 v[100:103], v[52:55], a[28:31], v[100:103]
  s_waitcnt vmcnt(8)
  v_mfma_f32_16x16x32_bf16 v[84:87], v[48:51], a[28:31], v[84:87]
  s_waitcnt lgkmcnt(0)
  v_mfma_f32_16x16x32_bf16 v[72:75], v[168:171], a[32:35], v[72:75]
  ds_read_b128 v[48:51], v1 offset:6144
  v_mfma_f32_16x16x32_bf16 v[88:91], v[172:175], a[32:35], v[88:91]
  ds_read_b128 v[52:55], v1 offset:7168
  v_mfma_f32_16x16x32_bf16 v[104:107], v[176:179], a[32:35], v[104:107]
  buffer_load_dwordx4 a[80:83], v2, s[8:11], s33 offen offset:1024 sc1
  v_mfma_f32_16x16x32_bf16 v[120:123], v[180:183], a[32:35], v[120:123]
  v_mfma_f32_16x16x32_bf16 v[136:139], v[184:187], a[32:35], v[136:139]
  ds_read_b128 v[56:59], v1 offset:43008
  v_mfma_f32_16x16x32_bf16 v[152:155], v[188:191], a[32:35], v[152:155]
  ds_read_b128 v[60:63], v1 offset:44032
  v_mfma_f32_16x16x32_bf16 v[156:159], v[188:191], a[36:39], v[156:159]
  v_mfma_f32_16x16x32_bf16 v[140:143], v[184:187], a[36:39], v[140:143]
  buffer_load_dwordx4 a[84:87], v3, s[8:11], s33 offen offset:1024 sc1
  v_mfma_f32_16x16x32_bf16 v[124:127], v[180:183], a[36:39], v[124:127]
  ds_read_b128 v[64:67], v6 offset:14336
  v_mfma_f32_16x16x32_bf16 v[108:111], v[176:179], a[36:39], v[108:111]
  ds_read_b128 v[68:71], v6 offset:15360
  v_mfma_f32_16x16x32_bf16 v[92:95], v[172:175], a[36:39], v[92:95]
  v_mfma_f32_16x16x32_bf16 v[76:79], v[168:171], a[36:39], v[76:79]
  v_mfma_f32_16x16x32_bf16 v[80:83], v[168:171], a[40:43], v[80:83]
  v_mfma_f32_16x16x32_bf16 v[96:99], v[172:175], a[40:43], v[96:99]
  v_mfma_f32_16x16x32_bf16 v[112:115], v[176:179], a[40:43], v[112:115]
  buffer_load_dwordx4 a[88:91], v4, s[8:11], s33 offen offset:1024 sc1
  v_mfma_f32_16x16x32_bf16 v[128:131], v[180:183], a[40:43], v[128:131]
  v_mfma_f32_16x16x32_bf16 v[144:147], v[184:187], a[40:43], v[144:147]
  v_mfma_f32_16x16x32_bf16 v[160:163], v[188:191], a[40:43], v[160:163]
  v_mfma_f32_16x16x32_bf16 v[164:167], v[188:191], a[44:47], v[164:167]
  buffer_load_dwordx4 a[92:95], v5, s[8:11], s33 offen offset:1024 sc1
  v_mfma_f32_16x16x32_bf16 v[148:151], v[184:187], a[44:47], v[148:151]
  v_mfma_f32_16x16x32_bf16 v[132:135], v[180:183], a[44:47], v[132:135]
  v_mfma_f32_16x16x32_bf16 v[116:119], v[176:179], a[44:47], v[116:119]
  v_mfma_f32_16x16x32_bf16 v[100:103], v[172:175], a[44:47], v[100:103]
  s_waitcnt vmcnt(8)
  v_mfma_f32_16x16x32_bf16 v[84:87], v[168:171], a[44:47], v[84:87]
  s_waitcnt lgkmcnt(0)
  v_mfma_f32_16x16x32_bf16 v[72:75], v[48:51], a[48:51], v[72:75]
  ds_read_b128 v[168:171], v1 offset:8192
  v_mfma_f32_16x16x32_bf16 v[88:91], v[52:55], a[48:51], v[88:91]
  ds_read_b128 v[172:175], v1 offset:9216
  v_mfma_f32_16x16x32_bf16 v[104:107], v[56:59], a[48:51], v[104:107]
  buffer_load_dwordx4 a[96:99], v2, s[8:11], s33 offen offset:2048 sc1
  v_mfma_f32_16x16x32_bf16 v[120:123], v[60:63], a[48:51], v[120:123]
  v_mfma_f32_16x16x32_bf16 v[136:139], v[64:67], a[48:51], v[136:139]
  ds_read_b128 v[176:179], v1 offset:45056
  v_mfma_f32_16x16x32_bf16 v[152:155], v[68:71], a[48:51], v[152:155]
  ds_read_b128 v[180:183], v1 offset:46080
  v_mfma_f32_16x16x32_bf16 v[156:159], v[68:71], a[52:55], v[156:159]
  v_mfma_f32_16x16x32_bf16 v[140:143], v[64:67], a[52:55], v[140:143]
  buffer_load_dwordx4 a[100:103], v3, s[8:11], s33 offen offset:2048 sc1
  v_mfma_f32_16x16x32_bf16 v[124:127], v[60:63], a[52:55], v[124:127]
  ds_read_b128 v[184:187], v6 offset:16384
  v_mfma_f32_16x16x32_bf16 v[108:111], v[56:59], a[52:55], v[108:111]
  ds_read_b128 v[188:191], v6 offset:17408
  v_mfma_f32_16x16x32_bf16 v[92:95], v[52:55], a[52:55], v[92:95]
  v_mfma_f32_16x16x32_bf16 v[76:79], v[48:51], a[52:55], v[76:79]
  v_mfma_f32_16x16x32_bf16 v[80:83], v[48:51], a[56:59], v[80:83]
  v_mfma_f32_16x16x32_bf16 v[96:99], v[52:55], a[56:59], v[96:99]
  v_mfma_f32_16x16x32_bf16 v[112:115], v[56:59], a[56:59], v[112:115]
  buffer_load_dwordx4 a[104:107], v4, s[8:11], s33 offen offset:2048 sc1
  v_mfma_f32_16x16x32_bf16 v[128:131], v[60:63], a[56:59], v[128:131]
  v_mfma_f32_16x16x32_bf16 v[144:147], v[64:67], a[56:59], v[144:147]
  v_mfma_f32_16x16x32_bf16 v[160:163], v[68:71], a[56:59], v[160:163]
  v_mfma_f32_16x16x32_bf16 v[164:167], v[68:71], a[60:63], v[164:167]
  buffer_load_dwordx4 a[108:111], v5, s[8:11], s33 offen offset:2048 sc1
  v_mfma_f32_16x16x32_bf16 v[148:151], v[64:67], a[60:63], v[148:151]
  v_mfma_f32_16x16x32_bf16 v[132:135], v[60:63], a[60:63], v[132:135]
  v_mfma_f32_16x16x32_bf16 v[116:119], v[56:59], a[60:63], v[116:119]
  v_mfma_f32_16x16x32_bf16 v[100:103], v[52:55], a[60:63], v[100:103]
  s_waitcnt vmcnt(8)
  v_mfma_f32_16x16x32_bf16 v[84:87], v[48:51], a[60:63], v[84:87]
  s_waitcnt lgkmcnt(0)
  v_mfma_f32_16x16x32_bf16 v[72:75], v[168:171], a[64:67], v[72:75]
  ds_read_b128 v[48:51], v1 offset:10240
  v_mfma_f32_16x16x32_bf16 v[88:91], v[172:175], a[64:67], v[88:91]
  ds_read_b128 v[52:55], v1 offset:11264
  v_mfma_f32_16x16x32_bf16 v[104:107], v[176:179], a[64:67], v[104:107]
  buffer_load_dwordx4 a[112:115], v2, s[8:11], s33 offen offset:3072 sc1
  v_mfma_f32_16x16x32_bf16 v[120:123], v[180:183], a[64:67], v[120:123]
  v_mfma_f32_16x16x32_bf16 v[136:139], v[184:187], a[64:67], v[136:139]
  ds_read_b128 v[56:59], v1 offset:47104
  v_mfma_f32_16x16x32_bf16 v[152:155], v[188:191], a[64:67], v[152:155]
  ds_read_b128 v[60:63], v1 offset:48128
  v_mfma_f32_16x16x32_bf16 v[156:159], v[188:191], a[68:71], v[156:159]
  v_mfma_f32_16x16x32_bf16 v[140:143], v[184:187], a[68:71], v[140:143]
  buffer_load_dwordx4 a[116:119], v3, s[8:11], s33 offen offset:3072 sc1
  v_mfma_f32_16x16x32_bf16 v[124:127], v[180:183], a[68:71], v[124:127]
  ds_read_b128 v[64:67], v6 offset:18432
  v_mfma_f32_16x16x32_bf16 v[108:111], v[176:179], a[68:71], v[108:111]
  ds_read_b128 v[68:71], v6 offset:19456
  v_mfma_f32_16x16x32_bf16 v[92:95], v[172:175], a[68:71], v[92:95]
  v_mfma_f32_16x16x32_bf16 v[76:79], v[168:171], a[68:71], v[76:79]
  v_mfma_f32_16x16x32_bf16 v[80:83], v[168:171], a[72:75], v[80:83]
  v_mfma_f32_16x16x32_bf16 v[96:99], v[172:175], a[72:75], v[96:99]
  v_mfma_f32_16x16x32_bf16 v[112:115], v[176:179], a[72:75], v[112:115]
  buffer_load_dwordx4 a[120:123], v4, s[8:11], s33 offen offset:3072 sc1
  v_mfma_f32_16x16x32_bf16 v[128:131], v[180:183], a[72:75], v[128:131]
  v_mfma_f32_16x16x32_bf16 v[144:147], v[184:187], a[72:75], v[144:147]
  v_mfma_f32_16x16x32_bf16 v[160:163], v[188:191], a[72:75], v[160:163]
  v_mfma_f32_16x16x32_bf16 v[164:167], v[188:191], a[76:79], v[164:167]
  buffer_load_dwordx4 a[124:127], v5, s[8:11], s33 offen offset:3072 sc1
  v_mfma_f32_16x16x32_bf16 v[148:151], v[184:187], a[76:79], v[148:151]
  v_mfma_f32_16x16x32_bf16 v[132:135], v[180:183], a[76:79], v[132:135]
  v_mfma_f32_16x16x32_bf16 v[116:119], v[176:179], a[76:79], v[116:119]
  v_mfma_f32_16x16x32_bf16 v[100:103], v[172:175], a[76:79], v[100:103]
  s_waitcnt vmcnt(8)
  v_mfma_f32_16x16x32_bf16 v[84:87], v[168:171], a[76:79], v[84:87]
  s_waitcnt lgkmcnt(0)
  v_mfma_f32_16x16x32_bf16 v[72:75], v[48:51], a[80:83], v[72:75]
  ds_read_b128 v[168:171], v1 offset:12288
  v_mfma_f32_16x16x32_bf16 v[88:91], v[52:55], a[80:83], v[88:91]
  ds_read_b128 v[172:175], v1 offset:13312
  v_mfma_f32_16x16x32_bf16 v[104:107], v[56:59], a[80:83], v[104:107]
  buffer_load_dwordx4 a[128:131], v2, s[8:11], s34 offen offset:0 sc1
  v_mfma_f32_16x16x32_bf16 v[120:123], v[60:63], a[80:83], v[120:123]
  v_mfma_f32_16x16x32_bf16 v[136:139], v[64:67], a[80:83], v[136:139]
  ds_read_b128 v[176:179], v1 offset:49152
  v_mfma_f32_16x16x32_bf16 v[152:155], v[68:71], a[80:83], v[152:155]
  ds_read_b128 v[180:183], v1 offset:50176
  v_mfma_f32_16x16x32_bf16 v[156:159], v[68:71], a[84:87], v[156:159]
  buffer_load_dwordx4 a[132:135], v3, s[8:11], s34 offen offset:0 sc1
  v_mfma_f32_16x16x32_bf16 v[140:143], v[64:67], a[84:87], v[140:143]
  v_mfma_f32_16x16x32_bf16 v[124:127], v[60:63], a[84:87], v[124:127]
  ds_read_b128 v[184:187], v6 offset:20480
  v_mfma_f32_16x16x32_bf16 v[108:111], v[56:59], a[84:87], v[108:111]
  ds_read_b128 v[188:191], v6 offset:21504
  v_mfma_f32_16x16x32_bf16 v[92:95], v[52:55], a[84:87], v[92:95]
  buffer_load_dwordx4 a[136:139], v4, s[8:11], s34 offen offset:0 sc1
  v_mfma_f32_16x16x32_bf16 v[76:79], v[48:51], a[84:87], v[76:79]
  buffer_load_dwordx4 a[140:143], v5, s[8:11], s34 offen offset:0 sc1
  v_mfma_f32_16x16x32_bf16 v[80:83], v[48:51], a[88:91], v[80:83]
  v_mfma_f32_16x16x32_bf16 v[96:99], v[52:55], a[88:91], v[96:99]
  v_mfma_f32_16x16x32_bf16 v[112:115], v[56:59], a[88:91], v[112:115]
  v_mfma_f32_16x16x32_bf16 v[128:131], v[60:63], a[88:91], v[128:131]
  buffer_load_dwordx4 v[228:231], v9, s[20:23], 0 offen offset:0 sc1
  v_mfma_f32_16x16x32_bf16 v[144:147], v[64:67], a[88:91], v[144:147]
  v_mfma_f32_16x16x32_bf16 v[160:163], v[68:71], a[88:91], v[160:163]
  v_mfma_f32_16x16x32_bf16 v[164:167], v[68:71], a[92:95], v[164:167]
  buffer_load_dwordx4 v[232:235], v9, s[20:23], 0 offen offset:1024 sc1
  v_mfma_f32_16x16x32_bf16 v[148:151], v[64:67], a[92:95], v[148:151]
  v_mfma_f32_16x16x32_bf16 v[132:135], v[60:63], a[92:95], v[132:135]
  v_mfma_f32_16x16x32_bf16 v[116:119], v[56:59], a[92:95], v[116:119]
  v_mfma_f32_16x16x32_bf16 v[100:103], v[52:55], a[92:95], v[100:103]
  s_waitcnt vmcnt(10)
  v_mfma_f32_16x16x32_bf16 v[84:87], v[48:51], a[92:95], v[84:87]
  s_waitcnt lgkmcnt(0)
  v_mfma_f32_16x16x32_bf16 v[72:75], v[168:171], a[96:99], v[72:75]
  ds_read_b128 v[48:51], v1 offset:14336
  v_mfma_f32_16x16x32_bf16 v[88:91], v[172:175], a[96:99], v[88:91]
  ds_read_b128 v[52:55], v1 offset:15360
  v_mfma_f32_16x16x32_bf16 v[104:107], v[176:179], a[96:99], v[104:107]
  buffer_load_dwordx4 a[144:147], v2, s[8:11], s34 offen offset:1024 sc1
  v_mfma_f32_16x16x32_bf16 v[120:123], v[180:183], a[96:99], v[120:123]
  v_mfma_f32_16x16x32_bf16 v[136:139], v[184:187], a[96:99], v[136:139]
  ds_read_b128 v[56:59], v1 offset:51200
  v_mfma_f32_16x16x32_bf16 v[152:155], v[188:191], a[96:99], v[152:155]
  ds_read_b128 v[60:63], v1 offset:52224
  v_mfma_f32_16x16x32_bf16 v[156:159], v[188:191], a[100:103], v[156:159]
  buffer_load_dwordx4 a[148:151], v3, s[8:11], s34 offen offset:1024 sc1
  v_mfma_f32_16x16x32_bf16 v[140:143], v[184:187], a[100:103], v[140:143]
  v_mfma_f32_16x16x32_bf16 v[124:127], v[180:183], a[100:103], v[124:127]
  ds_read_b128 v[64:67], v6 offset:22528
  v_mfma_f32_16x16x32_bf16 v[108:111], v[176:179], a[100:103], v[108:111]
  ds_read_b128 v[68:71], v6 offset:23552
  v_mfma_f32_16x16x32_bf16 v[92:95], v[172:175], a[100:103], v[92:95]
  buffer_load_dwordx4 a[152:155], v4, s[8:11], s34 offen offset:1024 sc1
  v_mfma_f32_16x16x32_bf16 v[76:79], v[168:171], a[100:103], v[76:79]
  buffer_load_dwordx4 a[156:159], v5, s[8:11], s34 offen offset:1024 sc1
  v_mfma_f32_16x16x32_bf16 v[80:83], v[168:171], a[104:107], v[80:83]
  v_mfma_f32_16x16x32_bf16 v[96:99], v[172:175], a[104:107], v[96:99]
  v_mfma_f32_16x16x32_bf16 v[112:115], v[176:179], a[104:107], v[112:115]
  v_mfma_f32_16x16x32_bf16 v[128:131], v[180:183], a[104:107], v[128:131]
  buffer_load_dwordx4 v[236:239], v9, s[20:23], 0 offen offset:2048 sc1
  v_mfma_f32_16x16x32_bf16 v[144:147], v[184:187], a[104:107], v[144:147]
  v_mfma_f32_16x16x32_bf16 v[160:163], v[188:191], a[104:107], v[160:163]
  v_mfma_f32_16x16x32_bf16 v[164:167], v[188:191], a[108:111], v[164:167]
  buffer_load_dwordx4 v[240:243], v9, s[20:23], 0 offen offset:3072 sc1
  v_mfma_f32_16x16x32_bf16 v[148:151], v[184:187], a[108:111], v[148:151]
  v_mfma_f32_16x16x32_bf16 v[132:135], v[180:183], a[108:111], v[132:135]
  v_mfma_f32_16x16x32_bf16 v[116:119], v[176:179], a[108:111], v[116:119]
  v_mfma_f32_16x16x32_bf16 v[100:103], v[172:175], a[108:111], v[100:103]
  s_waitcnt vmcnt(12)
  v_mfma_f32_16x16x32_bf16 v[84:87], v[168:171], a[108:111], v[84:87]
  s_waitcnt lgkmcnt(0)
  v_mfma_f32_16x16x32_bf16 v[72:75], v[48:51], a[112:115], v[72:75]
  ds_read_b128 v[168:171], v1 offset:16384
  v_mfma_f32_16x16x32_bf16 v[88:91], v[52:55], a[112:115], v[88:91]
  ds_read_b128 v[172:175], v1 offset:17408
  v_mfma_f32_16x16x32_bf16 v[104:107], v[56:59], a[112:115], v[104:107]
  buffer_load_dwordx4 a[160:163], v2, s[8:11], s34 offen offset:2048 sc1
  v_mfma_f32_16x16x32_bf16 v[120:123], v[60:63], a[112:115], v[120:123]
  v_mfma_f32_16x16x32_bf16 v[136:139], v[64:67], a[112:115], v[136:139]
  ds_read_b128 v[176:179], v1 offset:53248
  v_mfma_f32_16x16x32_bf16 v[152:155], v[68:71], a[112:115], v[152:155]
  ds_read_b128 v[180:183], v1 offset:54272
  v_mfma_f32_16x16x32_bf16 v[156:159], v[68:71], a[116:119], v[156:159]
  buffer_load_dwordx4 a[164:167], v3, s[8:11], s34 offen offset:2048 sc1
  v_mfma_f32_16x16x32_bf16 v[140:143], v[64:67], a[116:119], v[140:143]
  v_mfma_f32_16x16x32_bf16 v[124:127], v[60:63], a[116:119], v[124:127]
  ds_read_b128 v[184:187], v6 offset:24576
  v_mfma_f32_16x16x32_bf16 v[108:111], v[56:59], a[116:119], v[108:111]
  ds_read_b128 v[188:191], v6 offset:25600
  v_mfma_f32_16x16x32_bf16 v[92:95], v[52:55], a[116:119], v[92:95]
  buffer_load_dwordx4 a[168:171], v4, s[8:11], s34 offen offset:2048 sc1
  v_mfma_f32_16x16x32_bf16 v[76:79], v[48:51], a[116:119], v[76:79]
  buffer_load_dwordx4 a[172:175], v5, s[8:11], s34 offen offset:2048 sc1
  v_mfma_f32_16x16x32_bf16 v[80:83], v[48:51], a[120:123], v[80:83]
  v_mfma_f32_16x16x32_bf16 v[96:99], v[52:55], a[120:123], v[96:99]
  v_mfma_f32_16x16x32_bf16 v[112:115], v[56:59], a[120:123], v[112:115]
  v_mfma_f32_16x16x32_bf16 v[128:131], v[60:63], a[120:123], v[128:131]
  buffer_load_dwordx2 v[192:193], v10, s[28:31], s42 offen sc1
  v_mfma_f32_16x16x32_bf16 v[144:147], v[64:67], a[120:123], v[144:147]
  v_mfma_f32_16x16x32_bf16 v[160:163], v[68:71], a[120:123], v[160:163]
  v_mfma_f32_16x16x32_bf16 v[164:167], v[68:71], a[124:127], v[164:167]
  buffer_load_dwordx2 v[194:195], v10, s[28:31], s43 offen sc1
  v_mfma_f32_16x16x32_bf16 v[148:151], v[64:67], a[124:127], v[148:151]
  v_mfma_f32_16x16x32_bf16 v[132:135], v[60:63], a[124:127], v[132:135]
  v_mfma_f32_16x16x32_bf16 v[116:119], v[56:59], a[124:127], v[116:119]
  v_mfma_f32_16x16x32_bf16 v[100:103], v[52:55], a[124:127], v[100:103]
  s_waitcnt vmcnt(14)
  v_mfma_f32_16x16x32_bf16 v[84:87], v[48:51], a[124:127], v[84:87]
  s_waitcnt lgkmcnt(0)
  v_mfma_f32_16x16x32_bf16 v[72:75], v[168:171], a[128:131], v[72:75]
  ds_read_b128 v[48:51], v1 offset:18432
  v_mfma_f32_16x16x32_bf16 v[88:91], v[172:175], a[128:131], v[88:91]
  ds_read_b128 v[52:55], v1 offset:19456
  v_mfma_f32_16x16x32_bf16 v[104:107], v[176:179], a[128:131], v[104:107]
  buffer_load_dwordx4 a[176:179], v2, s[8:11], s34 offen offset:3072 sc1
  v_mfma_f32_16x16x32_bf16 v[120:123], v[180:183], a[128:131], v[120:123]
  v_mfma_f32_16x16x32_bf16 v[136:139], v[184:187], a[128:131], v[136:139]
  ds_read_b128 v[56:59], v1 offset:55296
  v_mfma_f32_16x16x32_bf16 v[152:155], v[188:191], a[128:131], v[152:155]
  ds_read_b128 v[60:63], v1 offset:56320
  v_mfma_f32_16x16x32_bf16 v[156:159], v[188:191], a[132:135], v[156:159]
  buffer_load_dwordx4 a[180:183], v3, s[8:11], s34 offen offset:3072 sc1
  v_mfma_f32_16x16x32_bf16 v[140:143], v[184:187], a[132:135], v[140:143]
  v_mfma_f32_16x16x32_bf16 v[124:127], v[180:183], a[132:135], v[124:127]
  ds_read_b128 v[64:67], v6 offset:26624
  v_mfma_f32_16x16x32_bf16 v[108:111], v[176:179], a[132:135], v[108:111]
  ds_read_b128 v[68:71], v6 offset:27648
  v_mfma_f32_16x16x32_bf16 v[92:95], v[172:175], a[132:135], v[92:95]
  buffer_load_dwordx4 a[184:187], v4, s[8:11], s34 offen offset:3072 sc1
  v_mfma_f32_16x16x32_bf16 v[76:79], v[168:171], a[132:135], v[76:79]
  v_mfma_f32_16x16x32_bf16 v[80:83], v[168:171], a[136:139], v[80:83]
  v_mfma_f32_16x16x32_bf16 v[96:99], v[172:175], a[136:139], v[96:99]
  v_mfma_f32_16x16x32_bf16 v[112:115], v[176:179], a[136:139], v[112:115]
  buffer_load_dwordx4 a[188:191], v5, s[8:11], s34 offen offset:3072 sc1
  v_mfma_f32_16x16x32_bf16 v[128:131], v[180:183], a[136:139], v[128:131]
  v_mfma_f32_16x16x32_bf16 v[144:147], v[184:187], a[136:139], v[144:147]
  v_mfma_f32_16x16x32_bf16 v[160:163], v[188:191], a[136:139], v[160:163]
  v_mfma_f32_16x16x32_bf16 v[164:167], v[188:191], a[140:143], v[164:167]
  buffer_load_dwordx2 v[196:197], v10, s[28:31], s44 offen sc1
  v_mfma_f32_16x16x32_bf16 v[148:151], v[184:187], a[140:143], v[148:151]
  v_mfma_f32_16x16x32_bf16 v[132:135], v[180:183], a[140:143], v[132:135]
  v_mfma_f32_16x16x32_bf16 v[116:119], v[176:179], a[140:143], v[116:119]
  v_mfma_f32_16x16x32_bf16 v[100:103], v[172:175], a[140:143], v[100:103]
  s_waitcnt vmcnt(13)
  v_mfma_f32_16x16x32_bf16 v[84:87], v[168:171], a[140:143], v[84:87]
  s_waitcnt lgkmcnt(0)
  v_mfma_f32_16x16x32_bf16 v[72:75], v[48:51], a[144:147], v[72:75]
  ds_read_b128 v[168:171], v1 offset:20480
  v_mfma_f32_16x16x32_bf16 v[88:91], v[52:55], a[144:147], v[88:91]
  ds_read_b128 v[172:175], v1 offset:21504
  v_mfma_f32_16x16x32_bf16 v[104:107], v[56:59], a[144:147], v[104:107]
  buffer_load_dwordx4 a[192:195], v2, s[8:11], s35 offen offset:0 sc1
  v_mfma_f32_16x16x32_bf16 v[120:123], v[60:63], a[144:147], v[120:123]
  v_mfma_f32_16x16x32_bf16 v[136:139], v[64:67], a[144:147], v[136:139]
  ds_read_b128 v[176:179], v1 offset:57344
  v_mfma_f32_16x16x32_bf16 v[152:155], v[68:71], a[144:147], v[152:155]
  ds_read_b128 v[180:183], v1 offset:58368
  v_mfma_f32_16x16x32_bf16 v[156:159], v[68:71], a[148:151], v[156:159]
  v_mfma_f32_16x16x32_bf16 v[140:143], v[64:67], a[148:151], v[140:143]
  buffer_load_dwordx4 a[196:199], v3, s[8:11], s35 offen offset:0 sc1
  v_mfma_f32_16x16x32_bf16 v[124:127], v[60:63], a[148:151], v[124:127]
  ds_read_b128 v[184:187], v6 offset:28672
  v_mfma_f32_16x16x32_bf16 v[108:111], v[56:59], a[148:151], v[108:111]
  ds_read_b128 v[188:191], v6 offset:29696
  v_mfma_f32_16x16x32_bf16 v[92:95], v[52:55], a[148:151], v[92:95]
  v_mfma_f32_16x16x32_bf16 v[76:79], v[48:51], a[148:151], v[76:79]
  v_mfma_f32_16x16x32_bf16 v[80:83], v[48:51], a[152:155], v[80:83]
  v_mfma_f32_16x16x32_bf16 v[96:99], v[52:55], a[152:155], v[96:99]
  v_mfma_f32_16x16x32_bf16 v[112:115], v[56:59], a[152:155], v[112:115]
  buffer_load_dwordx4 a[200:203], v4, s[8:11], s35 offen offset:0 sc1
  v_mfma_f32_16x16x32_bf16 v[128:131], v[60:63], a[152:155], v[128:131]
  v_mfma_f32_16x16x32_bf16 v[144:147], v[64:67], a[152:155], v[144:147]
  v_mfma_f32_16x16x32_bf16 v[160:163], v[68:71], a[152:155], v[160:163]
  v_mfma_f32_16x16x32_bf16 v[164:167], v[68:71], a[156:159], v[164:167]
  buffer_load_dwordx4 a[204:207], v5, s[8:11], s35 offen offset:0 sc1
  v_mfma_f32_16x16x32_bf16 v[148:151], v[64:67], a[156:159], v[148:151]
  v_mfma_f32_16x16x32_bf16 v[132:135], v[60:63], a[156:159], v[132:135]
  v_mfma_f32_16x16x32_bf16 v[116:119], v[56:59], a[156:159], v[116:119]
  v_mfma_f32_16x16x32_bf16 v[100:103], v[52:55], a[156:159], v[100:103]
  s_waitcnt vmcnt(11)
  v_mfma_f32_16x16x32_bf16 v[84:87], v[48:51], a[156:159], v[84:87]
  s_waitcnt lgkmcnt(0)
  v_mfma_f32_16x16x32_bf16 v[72:75], v[168:171], a[160:163], v[72:75]
  ds_read_b128 v[48:51], v1 offset:22528
  v_mfma_f32_16x16x32_bf16 v[88:91], v[172:175], a[160:163], v[88:91]
  ds_read_b128 v[52:55], v1 offset:23552
  v_mfma_f32_16x16x32_bf16 v[104:107], v[176:179], a[160:163], v[104:107]
  buffer_load_dwordx4 a[208:211], v2, s[8:11], s35 offen offset:1024 sc1
  v_mfma_f32_16x16x32_bf16 v[120:123], v[180:183], a[160:163], v[120:123]
  v_mfma_f32_16x16x32_bf16 v[136:139], v[184:187], a[160:163], v[136:139]
  ds_read_b128 v[56:59], v1 offset:59392
  v_mfma_f32_16x16x32_bf16 v[152:155], v[188:191], a[160:163], v[152:155]
  ds_read_b128 v[60:63], v1 offset:60416
  v_mfma_f32_16x16x32_bf16 v[156:159], v[188:191], a[164:167], v[156:159]
  buffer_load_dwordx4 a[212:215], v3, s[8:11], s35 offen offset:1024 sc1
  v_mfma_f32_16x16x32_bf16 v[140:143], v[184:187], a[164:167], v[140:143]
  buffer_load_dwordx4 a[216:219], v4, s[8:11], s35 offen offset:1024 sc1
  v_mfma_f32_16x16x32_bf16 v[124:127], v[180:183], a[164:167], v[124:127]
  ds_read_b128 v[64:67], v6 offset:30720
  v_mfma_f32_16x16x32_bf16 v[108:111], v[176:179], a[164:167], v[108:111]
  ds_read_b128 v[68:71], v6 offset:31744
  v_mfma_f32_16x16x32_bf16 v[92:95], v[172:175], a[164:167], v[92:95]
  buffer_load_dwordx4 a[220:223], v5, s[8:11], s35 offen offset:1024 sc1
  v_mfma_f32_16x16x32_bf16 v[76:79], v[168:171], a[164:167], v[76:79]
  v_mfma_f32_16x16x32_bf16 v[80:83], v[168:171], a[168:171], v[80:83]
  v_mfma_f32_16x16x32_bf16 v[96:99], v[172:175], a[168:171], v[96:99]
  s_add_u32 m0, s39, 110592
  v_mfma_f32_16x16x32_bf16 v[112:115], v[176:179], a[168:171], v[112:115]
  buffer_load_dwordx4 v1, s[12:15], m0 offen offset:0 sc1 lds
  v_mfma_f32_16x16x32_bf16 v[128:131], v[180:183], a[168:171], v[128:131]
  buffer_load_dwordx4 v1, s[12:15], m0 offen offset:1024 sc1 lds
  v_mfma_f32_16x16x32_bf16 v[144:147], v[184:187], a[168:171], v[144:147]
  v_mfma_f32_16x16x32_bf16 v[160:163], v[188:191], a[168:171], v[160:163]
  v_mfma_f32_16x16x32_bf16 v[164:167], v[188:191], a[172:175], v[164:167]
  buffer_load_dwordx4 v1, s[12:15], m0 offen offset:2048 sc1 lds
  v_mfma_f32_16x16x32_bf16 v[148:151], v[184:187], a[172:175], v[148:151]
  v_mfma_f32_16x16x32_bf16 v[132:135], v[180:183], a[172:175], v[132:135]
  v_mfma_f32_16x16x32_bf16 v[116:119], v[176:179], a[172:175], v[116:119]
  v_mfma_f32_16x16x32_bf16 v[100:103], v[172:175], a[172:175], v[100:103]
  s_waitcnt vmcnt(12)
  v_mfma_f32_16x16x32_bf16 v[84:87], v[168:171], a[172:175], v[84:87]
  s_waitcnt lgkmcnt(0)
  v_mfma_f32_16x16x32_bf16 v[72:75], v[48:51], a[176:179], v[72:75]
  s_waitcnt vmcnt(11)
  ds_read_b128 v[168:171], v1 offset:24576
  v_add_f32 v192, v192, v194
  v_mfma_f32_16x16x32_bf16 v[88:91], v[52:55], a[176:179], v[88:91]
  ds_read_b128 v[172:175], v1 offset:25600
  v_add_f32 v192, v192, v196
  v_mfma_f32_16x16x32_bf16 v[104:107], v[56:59], a[176:179], v[104:107]
  buffer_load_dwordx4 a[224:227], v2, s[8:11], s35 offen offset:2048 sc1
  v_mfma_f32_16x16x32_bf16 v[120:123], v[60:63], a[176:179], v[120:123]
  v_add_f32 v193, v193, v195
  v_add_f32 v193, v193, v197
  v_mfma_f32_16x16x32_bf16 v[136:139], v[64:67], a[176:179], v[136:139]
  ds_read_b128 v[176:179], v1 offset:61440
  v_add_u32 v10, 147456, v10
  v_mfma_f32_16x16x32_bf16 v[152:155], v[68:71], a[176:179], v[152:155]
  ds_read_b128 v[180:183], v1 offset:62464
  ds_write_b64 v10, v[192:193]
  v_mfma_f32_16x16x32_bf16 v[156:159], v[68:71], a[180:183], v[156:159]
  buffer_load_dwordx4 a[228:231], v3, s[8:11], s35 offen offset:2048 sc1
  v_mfma_f32_16x16x32_bf16 v[140:143], v[64:67], a[180:183], v[140:143]
  buffer_load_dwordx4 a[232:235], v4, s[8:11], s35 offen offset:2048 sc1
  v_mfma_f32_16x16x32_bf16 v[124:127], v[60:63], a[180:183], v[124:127]
  ds_read_b128 v[184:187], v6 offset:32768
  v_add_f32 v228, v228, v230
  v_mfma_f32_16x16x32_bf16 v[108:111], v[56:59], a[180:183], v[108:111]
  ds_read_b128 v[188:191], v6 offset:33792
  v_add_f32 v229, v229, v231
  v_mfma_f32_16x16x32_bf16 v[92:95], v[52:55], a[180:183], v[92:95]
  buffer_load_dwordx4 a[236:239], v5, s[8:11], s35 offen offset:2048 sc1
  v_mfma_f32_16x16x32_bf16 v[76:79], v[48:51], a[180:183], v[76:79]
  v_add_f32 v232, v232, v234
  v_add_f32 v233, v233, v235
  v_mfma_f32_16x16x32_bf16 v[80:83], v[48:51], a[184:187], v[80:83]
  v_add_f32 v236, v236, v238
  v_add_f32 v237, v237, v239
  v_mfma_f32_16x16x32_bf16 v[96:99], v[52:55], a[184:187], v[96:99]
  v_add_f32 v240, v240, v242
  v_add_f32 v241, v241, v243
  v_mfma_f32_16x16x32_bf16 v[112:115], v[56:59], a[184:187], v[112:115]
  buffer_load_dwordx4 v1, s[12:15], m0 offen offset:3072 sc1 lds
  v_mfma_f32_16x16x32_bf16 v[128:131], v[60:63], a[184:187], v[128:131]
  v_mov_b32 v230, v228
  v_mov_b32 v231, v229
  v_mfma_f32_16x16x32_bf16 v[144:147], v[64:67], a[184:187], v[144:147]
  v_mov_b32 v234, v232
  v_mov_b32 v235, v233
  v_mfma_f32_16x16x32_bf16 v[160:163], v[68:71], a[184:187], v[160:163]
  s_add_u32 m0, s39, 114688
  v_mov_b32 v238, v236
  v_mov_b32 v239, v237
  v_mfma_f32_16x16x32_bf16 v[164:167], v[68:71], a[188:191], v[164:167]
  buffer_load_dwordx4 v1, s[12:15], m0 offen offset:0 sc1 lds
  v_mfma_f32_16x16x32_bf16 v[148:151], v[64:67], a[188:191], v[148:151]
  buffer_load_dwordx4 v1, s[12:15], m0 offen offset:1024 sc1 lds
  v_mfma_f32_16x16x32_bf16 v[132:135], v[60:63], a[188:191], v[132:135]
  v_mov_b32 v242, v240
  v_mov_b32 v243, v241
  v_mfma_f32_16x16x32_bf16 v[116:119], v[56:59], a[188:191], v[116:119]
  v_permlane16_swap_b32 v228, v230
  v_mfma_f32_16x16x32_bf16 v[100:103], v[52:55], a[188:191], v[100:103]
  s_waitcnt vmcnt(14)
  v_permlane16_swap_b32 v229, v231
  v_mfma_f32_16x16x32_bf16 v[84:87], v[48:51], a[188:191], v[84:87]
  s_waitcnt lgkmcnt(0)
  v_permlane16_swap_b32 v232, v234
  v_mfma_f32_16x16x32_bf16 v[72:75], v[168:171], a[192:195], v[72:75]
  ds_read_b128 v[48:51], v1 offset:26624
  v_add_f32 v228, v228, v230
  v_mfma_f32_16x16x32_bf16 v[88:91], v[172:175], a[192:195], v[88:91]
  ds_read_b128 v[52:55], v1 offset:27648
  v_add_f32 v229, v229, v231
  v_mfma_f32_16x16x32_bf16 v[104:107], v[176:179], a[192:195], v[104:107]
  buffer_load_dwordx4 a[240:243], v2, s[8:11], s35 offen offset:3072 sc1
  v_mfma_f32_16x16x32_bf16 v[120:123], v[180:183], a[192:195], v[120:123]
  v_permlane16_swap_b32 v233, v235
  v_mfma_f32_16x16x32_bf16 v[136:139], v[184:187], a[192:195], v[136:139]
  ds_read_b128 v[56:59], v1 offset:63488
  v_add_f32 v232, v232, v234
  v_mfma_f32_16x16x32_bf16 v[152:155], v[188:191], a[192:195], v[152:155]
  ds_read_b128 v[60:63], v1 offset:64512
  v_add_f32 v233, v233, v235
  v_mfma_f32_16x16x32_bf16 v[156:159], v[188:191], a[196:199], v[156:159]
  buffer_load_dwordx4 a[244:247], v3, s[8:11], s35 offen offset:3072 sc1
  v_mfma_f32_16x16x32_bf16 v[140:143], v[184:187], a[196:199], v[140:143]
  buffer_load_dwordx4 a[248:251], v4, s[8:11], s35 offen offset:3072 sc1
  v_mfma_f32_16x16x32_bf16 v[124:127], v[180:183], a[196:199], v[124:127]
  ds_read_b128 v[64:67], v6 offset:34816
  v_mov_b32 v230, v228
  v_mfma_f32_16x16x32_bf16 v[108:111], v[176:179], a[196:199], v[108:111]
  ds_read_b128 v[68:71], v6 offset:35840
  v_mov_b32 v231, v229
  v_mfma_f32_16x16x32_bf16 v[92:95], v[172:175], a[196:199], v[92:95]
  buffer_load_dwordx4 a[252:255], v5, s[8:11], s35 offen offset:3072 sc1
  v_mfma_f32_16x16x32_bf16 v[76:79], v[168:171], a[196:199], v[76:79]
  v_permlane16_swap_b32 v236, v238
  v_mfma_f32_16x16x32_bf16 v[80:83], v[168:171], a[200:203], v[80:83]
  v_permlane16_swap_b32 v237, v239
  v_mfma_f32_16x16x32_bf16 v[96:99], v[172:175], a[200:203], v[96:99]
  v_permlane16_swap_b32 v240, v242
  v_mfma_f32_16x16x32_bf16 v[112:115], v[176:179], a[200:203], v[112:115]
  buffer_load_dwordx4 v1, s[12:15], m0 offen offset:2048 sc1 lds
  v_mfma_f32_16x16x32_bf16 v[128:131], v[180:183], a[200:203], v[128:131]
  buffer_load_dwordx4 v1, s[12:15], m0 offen offset:3072 sc1 lds
  v_mfma_f32_16x16x32_bf16 v[144:147], v[184:187], a[200:203], v[144:147]
  v_permlane16_swap_b32 v241, v243
  v_mfma_f32_16x16x32_bf16 v[160:163], v[188:191], a[200:203], v[160:163]
  s_add_u32 m0, s39, 118784
  v_add_f32 v236, v236, v238
  v_add_f32 v237, v237, v239
  v_mfma_f32_16x16x32_bf16 v[164:167], v[188:191], a[204:207], v[164:167]
  buffer_load_dwordx4 v1, s[12:15], m0 offen offset:0 sc1 lds
  v_mfma_f32_16x16x32_bf16 v[148:151], v[184:187], a[204:207], v[148:151]
  v_add_f32 v240, v240, v242
  v_add_f32 v241, v241, v243
  v_mfma_f32_16x16x32_bf16 v[132:135], v[180:183], a[204:207], v[132:135]
  v_mov_b32 v234, v232
  v_mov_b32 v235, v233
  v_mfma_f32_16x16x32_bf16 v[116:119], v[176:179], a[204:207], v[116:119]
  v_mov_b32 v238, v236
  v_mov_b32 v239, v237
  v_mfma_f32_16x16x32_bf16 v[100:103], v[172:175], a[204:207], v[100:103]
  s_waitcnt vmcnt(17)
  v_mov_b32 v242, v240
  v_mov_b32 v243, v241
  v_mfma_f32_16x16x32_bf16 v[84:87], v[168:171], a[204:207], v[84:87]
  s_waitcnt lgkmcnt(0)
  v_permlane32_swap_b32 v228, v230
  v_mfma_f32_16x16x32_bf16 v[72:75], v[48:51], a[208:211], v[72:75]
  ds_read_b128 v[168:171], v1 offset:28672
  v_add_f32 v228, v228, v230
  v_mfma_f32_16x16x32_bf16 v[88:91], v[52:55], a[208:211], v[88:91]
  ds_read_b128 v[172:175], v1 offset:29696
  v_mul_f32 v228, 0x3ae38e39, v228
  v_mfma_f32_16x16x32_bf16 v[104:107], v[56:59], a[208:211], v[104:107]
  buffer_load_dwordx4 v[16:19], v2, s[8:11], s36 offen offset:0 sc1
  v_mfma_f32_16x16x32_bf16 v[120:123], v[60:63], a[208:211], v[120:123]
  v_permlane32_swap_b32 v229, v231
  v_mfma_f32_16x16x32_bf16 v[136:139], v[64:67], a[208:211], v[136:139]
  ds_read_b128 v[176:179], v6 offset:0
  v_add_f32 v229, v229, v231
  v_mfma_f32_16x16x32_bf16 v[152:155], v[68:71], a[208:211], v[152:155]
  ds_read_b128 v[180:183], v6 offset:1024
  v_mul_f32 v229, 0x3ae38e39, v229
  v_mfma_f32_16x16x32_bf16 v[156:159], v[68:71], a[212:215], v[156:159]
  v_permlane32_swap_b32 v232, v234
  v_mfma_f32_16x16x32_bf16 v[140:143], v[64:67], a[212:215], v[140:143]
  buffer_load_dwordx4 v[20:23], v3, s[8:11], s36 offen offset:0 sc1
  v_mfma_f32_16x16x32_bf16 v[124:127], v[60:63], a[212:215], v[124:127]
  ds_read_b128 v[184:187], v6 offset:36864
  v_add_f32 v232, v232, v234
  v_mfma_f32_16x16x32_bf16 v[108:111], v[56:59], a[212:215], v[108:111]
  ds_read_b128 v[188:191], v6 offset:37888
  v_fma_f32 v229, -v228, v228, v229
  v_mfma_f32_16x16x32_bf16 v[92:95], v[52:55], a[212:215], v[92:95]
  v_permlane32_swap_b32 v233, v235
  v_mfma_f32_16x16x32_bf16 v[76:79], v[48:51], a[212:215], v[76:79]
  v_permlane32_swap_b32 v236, v238
  v_mfma_f32_16x16x32_bf16 v[80:83], v[48:51], a[216:219], v[80:83]
  v_permlane32_swap_b32 v237, v239
  v_mfma_f32_16x16x32_bf16 v[96:99], v[52:55], a[216:219], v[96:99]
  v_permlane32_swap_b32 v240, v242
  v_mfma_f32_16x16x32_bf16 v[112:115], v[56:59], a[216:219], v[112:115]
  buffer_load_dwordx4 v[24:27], v4, s[8:11], s36 offen offset:0 sc1
  v_mfma_f32_16x16x32_bf16 v[128:131], v[60:63], a[216:219], v[128:131]
  v_permlane32_swap_b32 v241, v243
  v_mfma_f32_16x16x32_bf16 v[144:147], v[64:67], a[216:219], v[144:147]
  v_add_f32 v233, v233, v235
  v_add_f32 v236, v236, v238
  v_mfma_f32_16x16x32_bf16 v[160:163], v[68:71], a[216:219], v[160:163]
  v_add_f32 v237, v237, v239
  v_add_f32 v240, v240, v242
  v_mfma_f32_16x16x32_bf16 v[164:167], v[68:71], a[220:223], v[164:167]
  buffer_load_dwordx4 v[28:31], v5, s[8:11], s36 offen offset:0 sc1
  v_mfma_f32_16x16x32_bf16 v[148:151], v[64:67], a[220:223], v[148:151]
  v_add_f32 v241, v241, v243
  v_max_f32 v229, 0, v229
  v_mfma_f32_16x16x32_bf16 v[132:135], v[60:63], a[220:223], v[132:135]
  v_add_f32 v229, 0x3727c5ac, v229
  v_mul_f32 v232, 0x3ae38e39, v232
  v_mfma_f32_16x16x32_bf16 v[116:119], v[56:59], a[220:223], v[116:119]
  v_mul_f32 v233, 0x3ae38e39, v233
  v_fma_f32 v233, -v232, v232, v233
  v_mfma_f32_16x16x32_bf16 v[100:103], v[52:55], a[220:223], v[100:103]
  s_waitcnt vmcnt(14)
  v_max_f32 v233, 0, v233
  v_add_f32 v233, 0x3727c5ac, v233
  v_mfma_f32_16x16x32_bf16 v[84:87], v[48:51], a[220:223], v[84:87]
  s_waitcnt lgkmcnt(0)
  v_mul_f32 v236, 0x3ae38e39, v236
  v_mul_f32 v237, 0x3ae38e39, v237
  v_mfma_f32_16x16x32_bf16 v[72:75], v[168:171], a[224:227], v[72:75]
  ds_read_b128 v[48:51], v1 offset:30720
  v_fma_f32 v237, -v236, v236, v237
  v_mfma_f32_16x16x32_bf16 v[88:91], v[172:175], a[224:227], v[88:91]
  ds_read_b128 v[52:55], v1 offset:31744
  v_max_f32 v237, 0, v237
  v_mfma_f32_16x16x32_bf16 v[104:107], v[176:179], a[224:227], v[104:107]
  buffer_load_dwordx4 v[32:35], v2, s[8:11], s36 offen offset:1024 sc1
  v_mfma_f32_16x16x32_bf16 v[120:123], v[180:183], a[224:227], v[120:123]
  v_add_f32 v237, 0x3727c5ac, v237
  v_mul_f32 v240, 0x3ae38e39, v240
  v_mfma_f32_16x16x32_bf16 v[136:139], v[184:187], a[224:227], v[136:139]
  ds_read_b128 v[56:59], v6 offset:2048
  v_mul_f32 v241, 0x3ae38e39, v241
  v_mfma_f32_16x16x32_bf16 v[152:155], v[188:191], a[224:227], v[152:155]
  ds_read_b128 v[60:63], v6 offset:3072
  v_fma_f32 v241, -v240, v240, v241
  v_mfma_f32_16x16x32_bf16 v[156:159], v[188:191], a[228:231], v[156:159]
  v_max_f32 v241, 0, v241
  v_add_f32 v241, 0x3727c5ac, v241
  v_mfma_f32_16x16x32_bf16 v[140:143], v[184:187], a[228:231], v[140:143]
  buffer_load_dwordx4 v[36:39], v3, s[8:11], s36 offen offset:1024 sc1
  v_mfma_f32_16x16x32_bf16 v[124:127], v[180:183], a[228:231], v[124:127]
  ds_read_b128 v[64:67], v6 offset:38912
  v_sub_f32 v200, 0, v228
  v_mfma_f32_16x16x32_bf16 v[108:111], v[176:179], a[228:231], v[108:111]
  ds_read_b128 v[68:71], v6 offset:39936
  v_mov_b32 v208, v229
  v_mfma_f32_16x16x32_bf16 v[92:95], v[172:175], a[228:231], v[92:95]
  v_rsq_f32 v204, v229
  v_mfma_f32_16x16x32_bf16 v[76:79], v[168:171], a[228:231], v[76:79]
  v_mul_f32 v204, 0xbfb8aa3b, v204
  v_sub_f32 v201, 0, v232
  v_mfma_f32_16x16x32_bf16 v[80:83], v[168:171], a[232:235], v[80:83]
  v_rsq_f32 v205, v233
  v_mfma_f32_16x16x32_bf16 v[96:99], v[172:175], a[232:235], v[96:99]
  v_mov_b32 v209, v233
  v_mul_f32 v205, 0xbfb8aa3b, v205
  v_mfma_f32_16x16x32_bf16 v[112:115], v[176:179], a[232:235], v[112:115]
  buffer_load_dwordx4 v[40:43], v4, s[8:11], s36 offen offset:1024 sc1
  v_mfma_f32_16x16x32_bf16 v[128:131], v[180:183], a[232:235], v[128:131]
  v_rsq_f32 v206, v237
  v_mfma_f32_16x16x32_bf16 v[144:147], v[184:187], a[232:235], v[144:147]
  v_sub_f32 v202, 0, v236
  v_mov_b32 v210, v237
  v_mfma_f32_16x16x32_bf16 v[160:163], v[188:191], a[232:235], v[160:163]
  v_mul_f32 v206, 0xbfb8aa3b, v206
  v_sub_f32 v203, 0, v240
  v_mfma_f32_16x16x32_bf16 v[164:167], v[188:191], a[236:239], v[164:167]
  buffer_load_dwordx4 v[44:47], v5, s[8:11], s36 offen offset:1024 sc1
  v_mfma_f32_16x16x32_bf16 v[148:151], v[184:187], a[236:239], v[148:151]
  v_rsq_f32 v207, v241
  v_mfma_f32_16x16x32_bf16 v[132:135], v[180:183], a[236:239], v[132:135]
  v_mov_b32 v211, v241
  v_mul_f32 v207, 0xbfb8aa3b, v207
  v_mfma_f32_16x16x32_bf16 v[116:119], v[176:179], a[236:239], v[116:119]
  v_lshlrev_b32 v10, 4, v15
  v_add_u32 v10, 147456, v10
  v_mfma_f32_16x16x32_bf16 v[100:103], v[172:175], a[236:239], v[100:103]
  s_waitcnt vmcnt(11)
  v_add_u32 v9, 294912, v1
  v_mfma_f32_16x16x32_bf16 v[84:87], v[168:171], a[236:239], v[84:87]
  s_waitcnt lgkmcnt(0)
  v_mfma_f32_16x16x32_bf16 v[72:75], v[48:51], a[240:243], v[72:75]
  ds_read_b128 v[168:171], v1 offset:32768
  v_mfma_f32_16x16x32_bf16 v[88:91], v[52:55], a[240:243], v[88:91]
  ds_read_b128 v[172:175], v1 offset:33792
  v_mfma_f32_16x16x32_bf16 v[104:107], v[56:59], a[240:243], v[104:107]
  v_mfma_f32_16x16x32_bf16 v[120:123], v[60:63], a[240:243], v[120:123]
  v_mfma_f32_16x16x32_bf16 v[136:139], v[64:67], a[240:243], v[136:139]
  ds_read_b128 v[176:179], v6 offset:4096
  v_mfma_f32_16x16x32_bf16 v[152:155], v[68:71], a[240:243], v[152:155]
  ds_read_b128 v[180:183], v6 offset:5120
  v_mfma_f32_16x16x32_bf16 v[156:159], v[68:71], a[244:247], v[156:159]
  v_mfma_f32_16x16x32_bf16 v[140:143], v[64:67], a[244:247], v[140:143]
  v_mfma_f32_16x16x32_bf16 v[124:127], v[60:63], a[244:247], v[124:127]
  ds_read_b128 v[184:187], v6 offset:40960
  v_mfma_f32_16x16x32_bf16 v[108:111], v[56:59], a[244:247], v[108:111]
  ds_read_b128 v[188:191], v6 offset:41984
  v_mfma_f32_16x16x32_bf16 v[92:95], v[52:55], a[244:247], v[92:95]
  v_mfma_f32_16x16x32_bf16 v[76:79], v[48:51], a[244:247], v[76:79]
  v_mfma_f32_16x16x32_bf16 v[80:83], v[48:51], a[248:251], v[80:83]
  v_mfma_f32_16x16x32_bf16 v[96:99], v[52:55], a[248:251], v[96:99]
  v_mfma_f32_16x16x32_bf16 v[112:115], v[56:59], a[248:251], v[112:115]
  v_mfma_f32_16x16x32_bf16 v[128:131], v[60:63], a[248:251], v[128:131]
  v_mfma_f32_16x16x32_bf16 v[144:147], v[64:67], a[248:251], v[144:147]
  v_mfma_f32_16x16x32_bf16 v[160:163], v[68:71], a[248:251], v[160:163]
  v_mfma_f32_16x16x32_bf16 v[164:167], v[68:71], a[252:255], v[164:167]
  v_mfma_f32_16x16x32_bf16 v[148:151], v[64:67], a[252:255], v[148:151]
  v_mfma_f32_16x16x32_bf16 v[132:135], v[60:63], a[252:255], v[132:135]
  v_mfma_f32_16x16x32_bf16 v[116:119], v[56:59], a[252:255], v[116:119]
  v_mfma_f32_16x16x32_bf16 v[100:103], v[52:55], a[252:255], v[100:103]
  s_waitcnt vmcnt(4)
  v_mfma_f32_16x16x32_bf16 v[84:87], v[48:51], a[252:255], v[84:87]
  s_waitcnt lgkmcnt(0)
  v_mfma_f32_16x16x32_bf16 v[72:75], v[168:171], v[16:19], v[72:75]
  ds_read_b128 v[48:51], v1 offset:34816
  v_mfma_f32_16x16x32_bf16 v[88:91], v[172:175], v[16:19], v[88:91]
  ds_read_b128 v[52:55], v1 offset:35840
  v_mfma_f32_16x16x32_bf16 v[104:107], v[176:179], v[16:19], v[104:107]
  v_mfma_f32_16x16x32_bf16 v[120:123], v[180:183], v[16:19], v[120:123]
  v_mfma_f32_16x16x32_bf16 v[136:139], v[184:187], v[16:19], v[136:139]
  ds_read_b128 v[56:59], v6 offset:6144
  v_mfma_f32_16x16x32_bf16 v[152:155], v[188:191], v[16:19], v[152:155]
  ds_read_b128 v[60:63], v6 offset:7168
  v_mfma_f32_16x16x32_bf16 v[156:159], v[188:191], v[20:23], v[156:159]
  v_mfma_f32_16x16x32_bf16 v[140:143], v[184:187], v[20:23], v[140:143]
  v_mfma_f32_16x16x32_bf16 v[124:127], v[180:183], v[20:23], v[124:127]
  ds_read_b128 v[64:67], v6 offset:43008
  v_mfma_f32_16x16x32_bf16 v[108:111], v[176:179], v[20:23], v[108:111]
  ds_read_b128 v[68:71], v6 offset:44032
  v_mfma_f32_16x16x32_bf16 v[92:95], v[172:175], v[20:23], v[92:95]
  v_mfma_f32_16x16x32_bf16 v[76:79], v[168:171], v[20:23], v[76:79]
  v_mfma_f32_16x16x32_bf16 v[80:83], v[168:171], v[24:27], v[80:83]
  v_mfma_f32_16x16x32_bf16 v[96:99], v[172:175], v[24:27], v[96:99]
  v_mfma_f32_16x16x32_bf16 v[112:115], v[176:179], v[24:27], v[112:115]
  v_mfma_f32_16x16x32_bf16 v[128:131], v[180:183], v[24:27], v[128:131]
  v_mfma_f32_16x16x32_bf16 v[144:147], v[184:187], v[24:27], v[144:147]
  v_mfma_f32_16x16x32_bf16 v[160:163], v[188:191], v[24:27], v[160:163]
  v_mfma_f32_16x16x32_bf16 v[164:167], v[188:191], v[28:31], v[164:167]
  v_mfma_f32_16x16x32_bf16 v[148:151], v[184:187], v[28:31], v[148:151]
  s_waitcnt vmcnt(8)
  v_mfma_f32_16x16x32_bf16 v[132:135], v[180:183], v[28:31], v[132:135]
  s_waitcnt lgkmcnt(15)
  v_mfma_f32_16x16x32_bf16 v[116:119], v[176:179], v[28:31], v[116:119]
  s_barrier
  v_mfma_f32_16x16x32_bf16 v[100:103], v[172:175], v[28:31], v[100:103]
  s_waitcnt vmcnt(0)
  v_mfma_f32_16x16x32_bf16 v[84:87], v[168:171], v[28:31], v[84:87]
  s_waitcnt lgkmcnt(4)
  v_mfma_f32_16x16x32_bf16 v[72:75], v[48:51], v[32:35], v[72:75]
  v_mfma_f32_16x16x32_bf16 v[76:79], v[48:51], v[36:39], v[76:79]
  ds_read_b128 v[212:215], v10 offset:0
  v_mfma_f32_16x16x32_bf16 v[80:83], v[48:51], v[40:43], v[80:83]
  v_mfma_f32_16x16x32_bf16 v[84:87], v[48:51], v[44:47], v[84:87]
  v_mfma_f32_16x16x32_bf16 v[88:91], v[52:55], v[32:35], v[88:91]
  v_mfma_f32_16x16x32_bf16 v[92:95], v[52:55], v[36:39], v[92:95]
  ds_read_b128 v[216:219], v10 offset:64
  v_mfma_f32_16x16x32_bf16 v[96:99], v[52:55], v[40:43], v[96:99]
  v_mfma_f32_16x16x32_bf16 v[100:103], v[52:55], v[44:47], v[100:103]
  s_waitcnt lgkmcnt(4)
  v_mfma_f32_16x16x32_bf16 v[104:107], v[56:59], v[32:35], v[104:107]
  ds_read_b128 v[48:51], v6 offset:45056
  v_mfma_f32_16x16x32_bf16 v[108:111], v[56:59], v[36:39], v[108:111]
  v_mfma_f32_16x16x32_bf16 v[112:115], v[56:59], v[40:43], v[112:115]
  v_mfma_f32_16x16x32_bf16 v[116:119], v[56:59], v[44:47], v[116:119]
  v_mfma_f32_16x16x32_bf16 v[120:123], v[60:63], v[32:35], v[120:123]
  ds_read_b128 v[52:55], v6 offset:46080
  v_mfma_f32_16x16x32_bf16 v[124:127], v[60:63], v[36:39], v[124:127]
  v_mfma_f32_16x16x32_bf16 v[128:131], v[60:63], v[40:43], v[128:131]
  v_mfma_f32_16x16x32_bf16 v[132:135], v[60:63], v[44:47], v[132:135]
  s_waitcnt lgkmcnt(4)
  v_mfma_f32_16x16x32_bf16 v[136:139], v[64:67], v[32:35], v[136:139]
  ds_read_b128 v[56:59], v6 offset:47104
  v_mfma_f32_16x16x32_bf16 v[140:143], v[64:67], v[36:39], v[140:143]
  v_mfma_f32_16x16x32_bf16 v[144:147], v[64:67], v[40:43], v[144:147]
  v_mfma_f32_16x16x32_bf16 v[148:151], v[64:67], v[44:47], v[148:151]
  v_mfma_f32_16x16x32_bf16 v[152:155], v[68:71], v[32:35], v[152:155]
  ds_read_b128 v[60:63], v6 offset:48128
  v_mfma_f32_16x16x32_bf16 v[156:159], v[68:71], v[36:39], v[156:159]
  v_mfma_f32_16x16x32_bf16 v[160:163], v[68:71], v[40:43], v[160:163]
  s_barrier
  v_mfma_f32_16x16x32_bf16 v[164:167], v[68:71], v[44:47], v[164:167]
  s_waitcnt lgkmcnt(2)
  v_mfma_f32_16x16x32_bf16 v[168:171], v[48:51], a[0:3], 0
  ds_read_b128 v[64:67], v6 offset:49152
  v_mfma_f32_16x16x32_bf16 v[184:187], v[52:55], a[0:3], 0
  s_waitcnt lgkmcnt(5)
  v_fmac_f32 v72, v200, v212
  v_fmac_f32 v73, v200, v213
  v_mfma_f32_16x16x32_bf16 v[188:191], v[52:55], a[4:7], 0
  s_add_u32 m0, s39, 0
  v_fmac_f32 v74, v200, v214
  v_fmac_f32 v75, v200, v215
  v_mfma_f32_16x16x32_bf16 v[172:175], v[48:51], a[4:7], 0
  buffer_load_dwordx4 v8, s[12:15], m0 offen offset:0 sc1 lds
  v_mfma_f32_16x16x32_bf16 v[176:179], v[48:51], a[8:11], 0
  ds_read_b128 v[68:71], v6 offset:50176
  v_mul_f32 v228, v204, v72
  v_mfma_f32_16x16x32_bf16 v[192:195], v[52:55], a[8:11], 0
  v_mul_f32 v229, v204, v73
  v_mul_f32 v230, v204, v74
  v_mfma_f32_16x16x32_bf16 v[196:199], v[52:55], a[12:15], 0
  v_mul_f32 v231, v204, v75
  v_fmac_f32 v88, v200, v216
  v_mfma_f32_16x16x32_bf16 v[180:183], v[48:51], a[12:15], 0
  s_waitcnt lgkmcnt(2)
  v_exp_f32 v228, v228
  v_mfma_f32_16x16x32_bf16 v[168:171], v[56:59], a[16:19], v[168:171]
  ds_read_b128 v[48:51], v6 offset:51200
  v_fmac_f32 v89, v200, v217
  v_mfma_f32_16x16x32_bf16 v[184:187], v[60:63], a[16:19], v[184:187]
  v_exp_f32 v229, v229
  v_mfma_f32_16x16x32_bf16 v[188:191], v[60:63], a[20:23], v[188:191]
  buffer_load_dwordx4 v8, s[12:15], m0 offen offset:1024 sc1 lds
  v_mfma_f32_16x16x32_bf16 v[172:175], v[56:59], a[20:23], v[172:175]
  v_exp_f32 v230, v230
  v_mfma_f32_16x16x32_bf16 v[176:179], v[56:59], a[24:27], v[176:179]
  ds_read_b128 v[52:55], v6 offset:52224
  v_fmac_f32 v90, v200, v218
  v_mfma_f32_16x16x32_bf16 v[192:195], v[60:63], a[24:27], v[192:195]
  v_exp_f32 v231, v231
  v_mfma_f32_16x16x32_bf16 v[196:199], v[60:63], a[28:31], v[196:199]
  v_fmac_f32 v91, v200, v219
  v_fma_f32 v228, v228, v208, v208
  v_mfma_f32_16x16x32_bf16 v[180:183], v[56:59], a[28:31], v[180:183]
  s_waitcnt lgkmcnt(2)
  v_fma_f32 v229, v229, v208, v208
  v_fma_f32 v230, v230, v208, v208
  v_mfma_f32_16x16x32_bf16 v[168:171], v[64:67], a[32:35], v[168:171]
  ds_read_b128 v[56:59], v6 offset:53248
  v_fma_f32 v231, v231, v208, v208
  v_mfma_f32_16x16x32_bf16 v[184:187], v[68:71], a[32:35], v[184:187]
  v_rcp_f32 v228, v228
  v_mfma_f32_16x16x32_bf16 v[188:191], v[68:71], a[36:39], v[188:191]
  buffer_load_dwordx4 v8, s[12:15], m0 offen offset:2048 sc1 lds
  v_mfma_f32_16x16x32_bf16 v[172:175], v[64:67], a[36:39], v[172:175]
  v_rcp_f32 v229, v229
  v_mfma_f32_16x16x32_bf16 v[176:179], v[64:67], a[40:43], v[176:179]
  ds_read_b128 v[60:63], v6 offset:54272
  v_mul_f32 v72, v72, v88
  v_mfma_f32_16x16x32_bf16 v[192:195], v[68:71], a[40:43], v[192:195]
  v_rcp_f32 v230, v230
  v_mfma_f32_16x16x32_bf16 v[196:199], v[68:71], a[44:47], v[196:199]
  v_rcp_f32 v231, v231
  v_mfma_f32_16x16x32_bf16 v[180:183], v[64:67], a[44:47], v[180:183]
  s_waitcnt lgkmcnt(2)
  v_mul_f32 v73, v73, v89
  v_mul_f32 v74, v74, v90
  v_mfma_f32_16x16x32_bf16 v[168:171], v[48:51], a[48:51], v[168:171]
  ds_read_b128 v[64:67], v6 offset:55296
  v_mul_f32 v75, v75, v91
  v_mfma_f32_16x16x32_bf16 v[184:187], v[52:55], a[48:51], v[184:187]
  v_mul_f32 v72, v72, v228
  v_mul_f32 v73, v73, v229
  v_mfma_f32_16x16x32_bf16 v[188:191], v[52:55], a[52:55], v[188:191]
  buffer_load_dwordx4 v8, s[12:15], m0 offen offset:3072 sc1 lds
  v_mfma_f32_16x16x32_bf16 v[172:175], v[48:51], a[52:55], v[172:175]
  v_mul_f32 v74, v74, v230
  v_mul_f32 v75, v75, v231
  v_mfma_f32_16x16x32_bf16 v[176:179], v[48:51], a[56:59], v[176:179]
  ds_read_b128 v[68:71], v6 offset:56320
  v_cvt_pk_bf16_f32 v236, v72, v73
  v_mfma_f32_16x16x32_bf16 v[192:195], v[52:55], a[56:59], v[192:195]
  v_cvt_pk_bf16_f32 v237, v74, v75
  v_fmac_f32 v76, v201, v212
  v_mfma_f32_16x16x32_bf16 v[196:199], v[52:55], a[60:63], v[196:199]
  ds_read_b128 v[220:223], v10 offset:128
  ds_read_b128 v[224:227], v10 offset:192
  v_mfma_f32_16x16x32_bf16 v[180:183], v[48:51], a[60:63], v[180:183]
  s_waitcnt lgkmcnt(4)
  v_fmac_f32 v77, v201, v213
  v_fmac_f32 v78, v201, v214
  v_mfma_f32_16x16x32_bf16 v[168:171], v[56:59], a[64:67], v[168:171]
  ds_read_b128 v[48:51], v6 offset:57344
  v_fmac_f32 v79, v201, v215
  v_mfma_f32_16x16x32_bf16 v[184:187], v[60:63], a[64:67], v[184:187]
  s_add_u32 m0, s39, 4096
  v_mul_f32 v232, v205, v76
  v_mul_f32 v233, v205, v77
  v_mfma_f32_16x16x32_bf16 v[188:191], v[60:63], a[68:71], v[188:191]
  buffer_load_dwordx4 v8, s[12:15], m0 offen offset:0 sc1 lds
  v_mfma_f32_16x16x32_bf16 v[172:175], v[56:59], a[68:71], v[172:175]
  v_mul_f32 v234, v205, v78
  v_mul_f32 v235, v205, v79
  v_mfma_f32_16x16x32_bf16 v[176:179], v[56:59], a[72:75], v[176:179]
  ds_read_b128 v[52:55], v6 offset:58368
  v_fmac_f32 v92, v201, v216
  v_mfma_f32_16x16x32_bf16 v[192:195], v[60:63], a[72:75], v[192:195]
  v_exp_f32 v232, v232
  v_mfma_f32_16x16x32_bf16 v[196:199], v[60:63], a[76:79], v[196:199]
  v_exp_f32 v233, v233
  v_mfma_f32_16x16x32_bf16 v[180:183], v[56:59], a[76:79], v[180:183]
  s_waitcnt lgkmcnt(4)
  buffer_load_dwordx4 v8, s[12:15], m0 offen offset:1024 sc1 lds
  v_mfma_f32_16x16x32_bf16 v[168:171], v[64:67], a[80:83], v[168:171]
  ds_read_b128 v[56:59], v6 offset:59392
  v_fmac_f32 v93, v201, v217
  v_mfma_f32_16x16x32_bf16 v[184:187], v[68:71], a[80:83], v[184:187]
  v_exp_f32 v234, v234
  v_mfma_f32_16x16x32_bf16 v[188:191], v[68:71], a[84:87], v[188:191]
  v_exp_f32 v235, v235
  v_mfma_f32_16x16x32_bf16 v[172:175], v[64:67], a[84:87], v[172:175]
  v_fmac_f32 v94, v201, v218
  v_fmac_f32 v95, v201, v219
  v_mfma_f32_16x16x32_bf16 v[176:179], v[64:67], a[88:91], v[176:179]
  ds_read_b128 v[60:63], v6 offset:60416
  v_fma_f32 v232, v232, v209, v209
  v_mfma_f32_16x16x32_bf16 v[192:195], v[68:71], a[88:91], v[192:195]
  v_fma_f32 v233, v233, v209, v209
  v_fma_f32 v234, v234, v209, v209
  v_mfma_f32_16x16x32_bf16 v[196:199], v[68:71], a[92:95], v[196:199]
  buffer_load_dwordx4 v8, s[12:15], m0 offen offset:2048 sc1 lds
  v_mfma_f32_16x16x32_bf16 v[180:183], v[64:67], a[92:95], v[180:183]
  s_waitcnt lgkmcnt(2)
  v_fma_f32 v235, v235, v209, v209
  v_mul_f32 v76, v76, v92
  v_mfma_f32_16x16x32_bf16 v[168:171], v[48:51], a[96:99], v[168:171]
  ds_read_b128 v[64:67], v6 offset:61440
  v_mul_f32 v77, v77, v93
  v_mfma_f32_16x16x32_bf16 v[184:187], v[52:55], a[96:99], v[184:187]
  v_rcp_f32 v232, v232
  v_mfma_f32_16x16x32_bf16 v[188:191], v[52:55], a[100:103], v[188:191]
  v_rcp_f32 v233, v233
  v_mfma_f32_16x16x32_bf16 v[172:175], v[48:51], a[100:103], v[172:175]
  v_rcp_f32 v234, v234
  v_mfma_f32_16x16x32_bf16 v[176:179], v[48:51], a[104:107], v[176:179]
  ds_read_b128 v[68:71], v6 offset:62464
  v_mul_f32 v78, v78, v94
  v_mfma_f32_16x16x32_bf16 v[192:195], v[52:55], a[104:107], v[192:195]
  v_rcp_f32 v235, v235
  v_mfma_f32_16x16x32_bf16 v[196:199], v[52:55], a[108:111], v[196:199]
  buffer_load_dwordx4 v8, s[12:15], m0 offen offset:3072 sc1 lds
  v_mfma_f32_16x16x32_bf16 v[180:183], v[48:51], a[108:111], v[180:183]
  s_waitcnt lgkmcnt(2)
  v_mul_f32 v79, v79, v95
  v_mul_f32 v76, v76, v232
  v_mfma_f32_16x16x32_bf16 v[168:171], v[56:59], a[112:115], v[168:171]
  ds_read_b128 v[48:51], v6 offset:63488
  v_mul_f32 v77, v77, v233
  v_mfma_f32_16x16x32_bf16 v[184:187], v[60:63], a[112:115], v[184:187]
  v_mul_f32 v78, v78, v234
  v_mul_f32 v79, v79, v235
  v_mfma_f32_16x16x32_bf16 v[188:191], v[60:63], a[116:119], v[188:191]
  v_cvt_pk_bf16_f32 v239, v78, v79
  v_cvt_pk_bf16_f32 v238, v76, v77
  v_mfma_f32_16x16x32_bf16 v[172:175], v[56:59], a[116:119], v[172:175]
  v_permlane16_swap_b32 v237, v239
  v_mfma_f32_16x16x32_bf16 v[176:179], v[56:59], a[120:123], v[176:179]
  ds_read_b128 v[52:55], v6 offset:64512
  v_fmac_f32 v80, v202, v212
  v_mfma_f32_16x16x32_bf16 v[192:195], v[60:63], a[120:123], v[192:195]
  s_add_u32 m0, s39, 8192
  v_permlane16_swap_b32 v236, v238
  buffer_store_dwordx4 v[236:239], v11, s[24:27], s45 offen sc1
  v_mfma_f32_16x16x32_bf16 v[196:199], v[60:63], a[124:127], v[196:199]
  buffer_load_dwordx4 v8, s[12:15], m0 offen offset:0 sc1 lds
  v_mfma_f32_16x16x32_bf16 v[180:183], v[56:59], a[124:127], v[180:183]
  s_waitcnt lgkmcnt(2)
  v_fmac_f32 v81, v202, v213
  v_fmac_f32 v82, v202, v214
  v_mfma_f32_16x16x32_bf16 v[168:171], v[64:67], a[128:131], v[168:171]
  ds_read_b128 v[56:59], v7 offset:0
  v_fmac_f32 v83, v202, v215
  v_mfma_f32_16x16x32_bf16 v[184:187], v[68:71], a[128:131], v[184:187]
  v_mul_f32 v228, v206, v80
  v_mul_f32 v229, v206, v81
  v_mfma_f32_16x16x32_bf16 v[188:191], v[68:71], a[132:135], v[188:191]
  v_mul_f32 v230, v206, v82
  v_mul_f32 v231, v206, v83
  v_mfma_f32_16x16x32_bf16 v[172:175], v[64:67], a[132:135], v[172:175]
  v_exp_f32 v228, v228
  v_mfma_f32_16x16x32_bf16 v[176:179], v[64:67], a[136:139], v[176:179]
  ds_read_b128 v[60:63], v7 offset:1024
  v_fmac_f32 v96, v202, v216
  v_mfma_f32_16x16x32_bf16 v[192:195], v[68:71], a[136:139], v[192:195]
  v_exp_f32 v229, v229
  v_mfma_f32_16x16x32_bf16 v[196:199], v[68:71], a[140:143], v[196:199]
  v_exp_f32 v230, v230
  v_mfma_f32_16x16x32_bf16 v[180:183], v[64:67], a[140:143], v[180:183]
  s_waitcnt lgkmcnt(2)
  v_exp_f32 v231, v231
  v_mfma_f32_16x16x32_bf16 v[168:171], v[48:51], a[144:147], v[168:171]
  ds_read_b128 v[64:67], v7 offset:2048
  v_fmac_f32 v97, v202, v217
  v_mfma_f32_16x16x32_bf16 v[184:187], v[52:55], a[144:147], v[184:187]
  v_fmac_f32 v98, v202, v218
  v_fmac_f32 v99, v202, v219
  v_mfma_f32_16x16x32_bf16 v[188:191], v[52:55], a[148:151], v[188:191]
  s_add_u32 m0, s39, 36864
  v_fma_f32 v228, v228, v210, v210
  v_fma_f32 v229, v229, v210, v210
  v_mfma_f32_16x16x32_bf16 v[172:175], v[48:51], a[148:151], v[172:175]
  buffer_load_dwordx4 v8, s[12:15], m0 offen offset:0 sc1 lds
  v_mfma_f32_16x16x32_bf16 v[176:179], v[48:51], a[152:155], v[176:179]
  ds_read_b128 v[68:71], v7 offset:3072
  v_fma_f32 v230, v230, v210, v210
  v_mfma_f32_16x16x32_bf16 v[192:195], v[52:55], a[152:155], v[192:195]
  v_fma_f32 v231, v231, v210, v210
  v_mul_f32 v80, v80, v96
  v_mfma_f32_16x16x32_bf16 v[196:199], v[52:55], a[156:159], v[196:199]
  v_rcp_f32 v228, v228
  v_mfma_f32_16x16x32_bf16 v[180:183], v[48:51], a[156:159], v[180:183]
  s_waitcnt lgkmcnt(2)
  v_rcp_f32 v229, v229
  v_mfma_f32_16x16x32_bf16 v[168:171], v[56:59], a[160:163], v[168:171]
  ds_read_b128 v[48:51], v7 offset:4096
  v_mul_f32 v81, v81, v97
  v_mfma_f32_16x16x32_bf16 v[184:187], v[60:63], a[160:163], v[184:187]
  v_rcp_f32 v230, v230
  v_mfma_f32_16x16x32_bf16 v[188:191], v[60:63], a[164:167], v[188:191]
  v_rcp_f32 v231, v231
  v_mfma_f32_16x16x32_bf16 v[172:175], v[56:59], a[164:167], v[172:175]
  buffer_load_dwordx4 v8, s[12:15], m0 offen offset:1024 sc1 lds
  v_mfma_f32_16x16x32_bf16 v[176:179], v[56:59], a[168:171], v[176:179]
  ds_read_b128 v[52:55], v7 offset:5120
  v_mul_f32 v82, v82, v98
  v_mfma_f32_16x16x32_bf16 v[192:195], v[60:63], a[168:171], v[192:195]
  v_mul_f32 v83, v83, v99
  v_mul_f32 v80, v80, v228
  v_mfma_f32_16x16x32_bf16 v[196:199], v[60:63], a[172:175], v[196:199]
  v_mul_f32 v81, v81, v229
  v_mul_f32 v82, v82, v230
  v_mfma_f32_16x16x32_bf16 v[180:183], v[56:59], a[172:175], v[180:183]
  s_waitcnt lgkmcnt(2)
  v_cvt_pk_bf16_f32 v240, v80, v81
  v_mul_f32 v83, v83, v231
  v_mfma_f32_16x16x32_bf16 v[168:171], v[64:67], a[176:179], v[168:171]
  ds_read_b128 v[56:59], v7 offset:6144
  v_cvt_pk_bf16_f32 v241, v82, v83
  v_mfma_f32_16x16x32_bf16 v[184:187], v[68:71], a[176:179], v[184:187]
  v_fmac_f32 v84, v203, v212
  v_fmac_f32 v85, v203, v213
  v_mfma_f32_16x16x32_bf16 v[188:191], v[68:71], a[180:183], v[188:191]
  buffer_load_dwordx4 v8, s[12:15], m0 offen offset:2048 sc1 lds
  v_mfma_f32_16x16x32_bf16 v[172:175], v[64:67], a[180:183], v[172:175]
  v_fmac_f32 v86, v203, v214
  v_fmac_f32 v87, v203, v215
  v_mfma_f32_16x16x32_bf16 v[176:179], v[64:67], a[184:187], v[176:179]
  ds_read_b128 v[60:63], v7 offset:7168
  v_mul_f32 v232, v207, v84
  v_mfma_f32_16x16x32_bf16 v[192:195], v[68:71], a[184:187], v[192:195]
  v_mul_f32 v233, v207, v85
  v_mul_f32 v234, v207, v86
  v_mfma_f32_16x16x32_bf16 v[196:199], v[68:71], a[188:191], v[196:199]
  v_mul_f32 v235, v207, v87
  v_fmac_f32 v100, v203, v216
  v_mfma_f32_16x16x32_bf16 v[180:183], v[64:67], a[188:191], v[180:183]
  s_waitcnt lgkmcnt(2)
  v_exp_f32 v232, v232
  v_mfma_f32_16x16x32_bf16 v[168:171], v[48:51], a[192:195], v[168:171]
  ds_read_b128 v[64:67], v7 offset:8192
  v_fmac_f32 v101, v203, v217
  v_mfma_f32_16x16x32_bf16 v[184:187], v[52:55], a[192:195], v[184:187]
  v_exp_f32 v233, v233
  v_mfma_f32_16x16x32_bf16 v[188:191], v[52:55], a[196:199], v[188:191]
  buffer_load_dwordx4 v8, s[12:15], m0 offen offset:3072 sc1 lds
  v_mfma_f32_16x16x32_bf16 v[172:175], v[48:51], a[196:199], v[172:175]
  v_exp_f32 v234, v234
  v_mfma_f32_16x16x32_bf16 v[176:179], v[48:51], a[200:203], v[176:179]
  ds_read_b128 v[68:71], v7 offset:9216
  v_fmac_f32 v102, v203, v218
  v_mfma_f32_16x16x32_bf16 v[192:195], v[52:55], a[200:203], v[192:195]
  v_exp_f32 v235, v235
  v_mfma_f32_16x16x32_bf16 v[196:199], v[52:55], a[204:207], v[196:199]
  v_fmac_f32 v103, v203, v219
  v_fma_f32 v232, v232, v211, v211
  v_mfma_f32_16x16x32_bf16 v[180:183], v[48:51], a[204:207], v[180:183]
  s_waitcnt lgkmcnt(2)
  v_fma_f32 v233, v233, v211, v211
  v_fma_f32 v234, v234, v211, v211
  v_mfma_f32_16x16x32_bf16 v[168:171], v[56:59], a[208:211], v[168:171]
  ds_read_b128 v[48:51], v7 offset:10240
  v_fma_f32 v235, v235, v211, v211
  v_mfma_f32_16x16x32_bf16 v[184:187], v[60:63], a[208:211], v[184:187]
  s_add_u32 m0, s39, 40960
  v_rcp_f32 v232, v232
  v_mfma_f32_16x16x32_bf16 v[188:191], v[60:63], a[212:215], v[188:191]
  buffer_load_dwordx4 v8, s[12:15], m0 offen offset:0 sc1 lds
  v_mfma_f32_16x16x32_bf16 v[172:175], v[56:59], a[212:215], v[172:175]
  v_rcp_f32 v233, v233
  v_mfma_f32_16x16x32_bf16 v[176:179], v[56:59], a[216:219], v[176:179]
  ds_read_b128 v[52:55], v7 offset:11264
  v_mul_f32 v84, v84, v100
  v_mfma_f32_16x16x32_bf16 v[192:195], v[60:63], a[216:219], v[192:195]
  v_rcp_f32 v234, v234
  v_mfma_f32_16x16x32_bf16 v[196:199], v[60:63], a[220:223], v[196:199]
  v_rcp_f32 v235, v235
  v_mfma_f32_16x16x32_bf16 v[180:183], v[56:59], a[220:223], v[180:183]
  s_waitcnt lgkmcnt(2)
  v_mul_f32 v85, v85, v101
  v_mul_f32 v86, v86, v102
  v_mfma_f32_16x16x32_bf16 v[168:171], v[64:67], a[224:227], v[168:171]
  ds_read_b128 v[56:59], v7 offset:12288
  v_mul_f32 v87, v87, v103
  v_mfma_f32_16x16x32_bf16 v[184:187], v[68:71], a[224:227], v[184:187]
  v_mul_f32 v84, v84, v232
  v_mul_f32 v85, v85, v233
  v_mfma_f32_16x16x32_bf16 v[188:191], v[68:71], a[228:231], v[188:191]
  buffer_load_dwordx4 v8, s[12:15], m0 offen offset:1024 sc1 lds
  v_mfma_f32_16x16x32_bf16 v[172:175], v[64:67], a[228:231], v[172:175]
  v_mul_f32 v86, v86, v234
  v_mul_f32 v87, v87, v235
  v_mfma_f32_16x16x32_bf16 v[176:179], v[64:67], a[232:235], v[176:179]
  ds_read_b128 v[60:63], v7 offset:13312
  v_cvt_pk_bf16_f32 v242, v84, v85
  v_mfma_f32_16x16x32_bf16 v[192:195], v[68:71], a[232:235], v[192:195]
  v_cvt_pk_bf16_f32 v243, v86, v87
  v_fmac_f32 v104, v200, v220
  v_mfma_f32_16x16x32_bf16 v[196:199], v[68:71], a[236:239], v[196:199]
  v_permlane16_swap_b32 v240, v242
  v_mfma_f32_16x16x32_bf16 v[180:183], v[64:67], a[236:239], v[180:183]
  s_waitcnt lgkmcnt(2)
  v_permlane16_swap_b32 v241, v243
  buffer_store_dwordx4 v[240:243], v12, s[24:27], s45 offen sc1
  v_mfma_f32_16x16x32_bf16 v[168:171], v[48:51], a[240:243], v[168:171]
  s_add_u32 s45, s45, 4096
  ds_read_b128 v[64:67], v7 offset:14336
  v_fmac_f32 v105, v200, v221
  v_mfma_f32_16x16x32_bf16 v[184:187], v[52:55], a[240:243], v[184:187]
  v_fmac_f32 v106, v200, v222
  v_fmac_f32 v107, v200, v223
  v_mfma_f32_16x16x32_bf16 v[188:191], v[52:55], a[244:247], v[188:191]
  buffer_load_dwordx4 v8, s[12:15], m0 offen offset:2048 sc1 lds
  v_mfma_f32_16x16x32_bf16 v[172:175], v[48:51], a[244:247], v[172:175]
  v_mul_f32 v228, v204, v104
  v_mul_f32 v229, v204, v105
  v_mfma_f32_16x16x32_bf16 v[176:179], v[48:51], a[248:251], v[176:179]
  ds_read_b128 v[68:71], v7 offset:15360
  v_mul_f32 v230, v204, v106
  v_mfma_f32_16x16x32_bf16 v[192:195], v[52:55], a[248:251], v[192:195]
  s_waitcnt vmcnt(8)
  v_mul_f32 v231, v204, v107
  v_fmac_f32 v120, v200, v224
  v_mfma_f32_16x16x32_bf16 v[196:199], v[52:55], a[252:255], v[196:199]
  s_barrier
  v_exp_f32 v228, v228
  v_mfma_f32_16x16x32_bf16 v[180:183], v[48:51], a[252:255], v[180:183]
  s_waitcnt lgkmcnt(2)
  v_exp_f32 v229, v229
  v_mfma_f32_16x16x32_bf16 v[168:171], v[56:59], v[16:19], v[168:171]
  ds_read_b128 v[48:51], v1 offset:0
  v_fmac_f32 v121, v200, v225
  v_mfma_f32_16x16x32_bf16 v[184:187], v[60:63], v[16:19], v[184:187]
  v_exp_f32 v230, v230
  v_mfma_f32_16x16x32_bf16 v[188:191], v[60:63], v[20:23], v[188:191]
  buffer_load_dwordx4 v8, s[12:15], m0 offen offset:3072 sc1 lds
  v_mfma_f32_16x16x32_bf16 v[172:175], v[56:59], v[20:23], v[172:175]
  v_exp_f32 v231, v231
  v_mfma_f32_16x16x32_bf16 v[176:179], v[56:59], v[24:27], v[176:179]
  ds_read_b128 v[52:55], v1 offset:1024
  v_fmac_f32 v122, v200, v226
  v_mfma_f32_16x16x32_bf16 v[192:195], v[60:63], v[24:27], v[192:195]
  v_fmac_f32 v123, v200, v227
  v_fma_f32 v228, v228, v208, v208
  v_mfma_f32_16x16x32_bf16 v[196:199], v[60:63], v[28:31], v[196:199]
  v_fma_f32 v229, v229, v208, v208
  v_fma_f32 v230, v230, v208, v208
  v_mfma_f32_16x16x32_bf16 v[180:183], v[56:59], v[28:31], v[180:183]
  s_waitcnt lgkmcnt(2)
  v_fma_f32 v231, v231, v208, v208
  v_mul_f32 v104, v104, v120
  v_mfma_f32_16x16x32_bf16 v[168:171], v[64:67], v[32:35], v[168:171]
  ds_read_b128 v[56:59], v1 offset:2048
  v_mul_f32 v105, v105, v121
  v_mfma_f32_16x16x32_bf16 v[184:187], v[68:71], v[32:35], v[184:187]
  s_add_u32 m0, s39, 45056
  v_rcp_f32 v228, v228
  v_mfma_f32_16x16x32_bf16 v[188:191], v[68:71], v[36:39], v[188:191]
  buffer_load_dwordx4 v8, s[12:15], m0 offen offset:0 sc1 lds
  v_mfma_f32_16x16x32_bf16 v[172:175], v[64:67], v[36:39], v[172:175]
  v_rcp_f32 v229, v229
  v_mfma_f32_16x16x32_bf16 v[176:179], v[64:67], v[40:43], v[176:179]
  ds_read_b128 v[60:63], v1 offset:3072
  v_mul_f32 v106, v106, v122
  v_mfma_f32_16x16x32_bf16 v[192:195], v[68:71], v[40:43], v[192:195]
  v_rcp_f32 v230, v230
  v_mfma_f32_16x16x32_bf16 v[196:199], v[68:71], v[44:47], v[196:199]
  v_rcp_f32 v231, v231
  v_mfma_f32_16x16x32_bf16 v[180:183], v[64:67], v[44:47], v[180:183]
  s_waitcnt lgkmcnt(2)
  v_mul_f32 v107, v107, v123
  v_mul_f32 v104, v104, v228
  v_mfma_f32_16x16x32_bf16 v[72:75], v[48:51], a[0:3], 0
  ds_read_b128 v[64:67], v1 offset:4096
  v_mul_f32 v105, v105, v229
  v_mfma_f32_16x16x32_bf16 v[88:91], v[52:55], a[0:3], 0
  v_mul_f32 v106, v106, v230
  v_mul_f32 v107, v107, v231
  v_mfma_f32_16x16x32_bf16 v[92:95], v[52:55], a[4:7], 0
  v_cvt_pk_bf16_f32 v237, v106, v107
  v_cvt_pk_bf16_f32 v236, v104, v105
  v_mfma_f32_16x16x32_bf16 v[76:79], v[48:51], a[4:7], 0
  ds_read_b128 v[212:215], v10 offset:256
  ds_read_b128 v[216:219], v10 offset:320
  v_mfma_f32_16x16x32_bf16 v[80:83], v[48:51], a[8:11], 0
  ds_read_b128 v[68:71], v1 offset:5120
  v_fmac_f32 v108, v201, v220
  v_mfma_f32_16x16x32_bf16 v[96:99], v[52:55], a[8:11], 0
  s_add_u32 m0, s39, 73728
  v_fmac_f32 v109, v201, v221
  v_fmac_f32 v110, v201, v222
  v_mfma_f32_16x16x32_bf16 v[100:103], v[52:55], a[12:15], 0
  buffer_load_dwordx4 v8, s[12:15], m0 offen offset:0 sc1 lds
  v_mfma_f32_16x16x32_bf16 v[84:87], v[48:51], a[12:15], 0
  s_waitcnt lgkmcnt(4)
  v_fmac_f32 v111, v201, v223
  v_mul_f32 v232, v205, v108
  v_mfma_f32_16x16x32_bf16 v[72:75], v[56:59], a[16:19], v[72:75]
  ds_read_b128 v[48:51], v1 offset:6144
  v_mul_f32 v233, v205, v109
  v_mfma_f32_16x16x32_bf16 v[88:91], v[60:63], a[16:19], v[88:91]
  v_mul_f32 v234, v205, v110
  v_mul_f32 v235, v205, v111
  v_mfma_f32_16x16x32_bf16 v[92:95], v[60:63], a[20:23], v[92:95]
  v_exp_f32 v232, v232
  v_mfma_f32_16x16x32_bf16 v[76:79], v[56:59], a[20:23], v[76:79]
  v_exp_f32 v233, v233
  v_mfma_f32_16x16x32_bf16 v[80:83], v[56:59], a[24:27], v[80:83]
  ds_read_b128 v[52:55], v1 offset:7168
  v_fmac_f32 v124, v201, v224
  v_mfma_f32_16x16x32_bf16 v[96:99], v[60:63], a[24:27], v[96:99]
  v_exp_f32 v234, v234
  v_mfma_f32_16x16x32_bf16 v[100:103], v[60:63], a[28:31], v[100:103]
  v_exp_f32 v235, v235
  v_mfma_f32_16x16x32_bf16 v[84:87], v[56:59], a[28:31], v[84:87]
  s_waitcnt lgkmcnt(2)
  v_fmac_f32 v125, v201, v225
  v_fmac_f32 v126, v201, v226
  v_mfma_f32_16x16x32_bf16 v[72:75], v[64:67], a[32:35], v[72:75]
  ds_read_b128 v[56:59], v1 offset:8192
  v_fmac_f32 v127, v201, v227
  v_mfma_f32_16x16x32_bf16 v[88:91], v[68:71], a[32:35], v[88:91]
  v_fma_f32 v232, v232, v209, v209
  v_fma_f32 v233, v233, v209, v209
  v_mfma_f32_16x16x32_bf16 v[92:95], v[68:71], a[36:39], v[92:95]
  v_fma_f32 v234, v234, v209, v209
  v_fma_f32 v235, v235, v209, v209
  v_mfma_f32_16x16x32_bf16 v[76:79], v[64:67], a[36:39], v[76:79]
  v_rcp_f32 v232, v232
  v_mfma_f32_16x16x32_bf16 v[80:83], v[64:67], a[40:43], v[80:83]
  ds_read_b128 v[60:63], v1 offset:9216
  v_mul_f32 v108, v108, v124
  v_mfma_f32_16x16x32_bf16 v[96:99], v[68:71], a[40:43], v[96:99]
  v_rcp_f32 v233, v233
  v_mfma_f32_16x16x32_bf16 v[100:103], v[68:71], a[44:47], v[100:103]
  buffer_load_dwordx4 v8, s[12:15], m0 offen offset:1024 sc1 lds
  v_mfma_f32_16x16x32_bf16 v[84:87], v[64:67], a[44:47], v[84:87]
  s_waitcnt lgkmcnt(2)
  v_rcp_f32 v234, v234
  v_mfma_f32_16x16x32_bf16 v[72:75], v[48:51], a[48:51], v[72:75]
  ds_read_b128 v[64:67], v1 offset:10240
  v_mul_f32 v109, v109, v125
  v_mfma_f32_16x16x32_bf16 v[88:91], v[52:55], a[48:51], v[88:91]
  v_rcp_f32 v235, v235
  v_mfma_f32_16x16x32_bf16 v[92:95], v[52:55], a[52:55], v[92:95]
  v_mul_f32 v110, v110, v126
  v_mul_f32 v111, v111, v127
  v_mfma_f32_16x16x32_bf16 v[76:79], v[48:51], a[52:55], v[76:79]
  v_mul_f32 v108, v108, v232
  v_mul_f32 v109, v109, v233
  v_mfma_f32_16x16x32_bf16 v[80:83], v[48:51], a[56:59], v[80:83]
  ds_read_b128 v[68:71], v1 offset:11264
  v_mul_f32 v110, v110, v234
  v_mfma_f32_16x16x32_bf16 v[96:99], v[52:55], a[56:59], v[96:99]
  v_cvt_pk_bf16_f32 v238, v108, v109
  v_mul_f32 v111, v111, v235
  v_mfma_f32_16x16x32_bf16 v[100:103], v[52:55], a[60:63], v[100:103]
  v_cvt_pk_bf16_f32 v239, v110, v111
  v_fmac_f32 v112, v202, v220
  v_mfma_f32_16x16x32_bf16 v[84:87], v[48:51], a[60:63], v[84:87]
  s_waitcnt lgkmcnt(2)
  v_permlane16_swap_b32 v236, v238
  v_mfma_f32_16x16x32_bf16 v[72:75], v[56:59], a[64:67], v[72:75]
  ds_read_b128 v[48:51], v1 offset:12288
  v_fmac_f32 v113, v202, v221
  v_mfma_f32_16x16x32_bf16 v[88:91], v[60:63], a[64:67], v[88:91]
  v_permlane16_swap_b32 v237, v239
  buffer_store_dwordx4 v[236:239], v11, s[24:27], s45 offen sc1
  v_mfma_f32_16x16x32_bf16 v[92:95], v[60:63], a[68:71], v[92:95]
  buffer_load_dwordx4 v8, s[12:15], m0 offen offset:2048 sc1 lds
  v_mfma_f32_16x16x32_bf16 v[76:79], v[56:59], a[68:71], v[76:79]
  v_fmac_f32 v114, v202, v222
  v_fmac_f32 v115, v202, v223
  v_mfma_f32_16x16x32_bf16 v[80:83], v[56:59], a[72:75], v[80:83]
  ds_read_b128 v[52:55], v1 offset:13312
  v_mul_f32 v228, v206, v112
  v_mfma_f32_16x16x32_bf16 v[96:99], v[60:63], a[72:75], v[96:99]
  v_mul_f32 v229, v206, v113
  v_mul_f32 v230, v206, v114
  v_mfma_f32_16x16x32_bf16 v[100:103], v[60:63], a[76:79], v[100:103]
  v_mul_f32 v231, v206, v115
  v_fmac_f32 v128, v202, v224
  v_mfma_f32_16x16x32_bf16 v[84:87], v[56:59], a[76:79], v[84:87]
  s_waitcnt lgkmcnt(2)
  v_exp_f32 v228, v228
  v_mfma_f32_16x16x32_bf16 v[72:75], v[64:67], a[80:83], v[72:75]
  ds_read_b128 v[56:59], v1 offset:14336
  v_fmac_f32 v129, v202, v225
  v_mfma_f32_16x16x32_bf16 v[88:91], v[68:71], a[80:83], v[88:91]
  v_exp_f32 v229, v229
  v_mfma_f32_16x16x32_bf16 v[92:95], v[68:71], a[84:87], v[92:95]
  v_exp_f32 v230, v230
  v_mfma_f32_16x16x32_bf16 v[76:79], v[64:67], a[84:87], v[76:79]
  v_exp_f32 v231, v231
  v_mfma_f32_16x16x32_bf16 v[80:83], v[64:67], a[88:91], v[80:83]
  ds_read_b128 v[60:63], v1 offset:15360
  v_fmac_f32 v130, v202, v226
  v_mfma_f32_16x16x32_bf16 v[96:99], v[68:71], a[88:91], v[96:99]
  v_fmac_f32 v131, v202, v227
  v_fma_f32 v228, v228, v210, v210
  v_mfma_f32_16x16x32_bf16 v[100:103], v[68:71], a[92:95], v[100:103]
  buffer_load_dwordx4 v8, s[12:15], m0 offen offset:3072 sc1 lds
  v_mfma_f32_16x16x32_bf16 v[84:87], v[64:67], a[92:95], v[84:87]
  s_waitcnt lgkmcnt(2)
  v_fma_f32 v229, v229, v210, v210
  v_fma_f32 v230, v230, v210, v210
  v_mfma_f32_16x16x32_bf16 v[72:75], v[48:51], a[96:99], v[72:75]
  ds_read_b128 v[64:67], v1 offset:16384
  v_fma_f32 v231, v231, v210, v210
  v_mfma_f32_16x16x32_bf16 v[88:91], v[52:55], a[96:99], v[88:91]
  v_rcp_f32 v228, v228
  v_mfma_f32_16x16x32_bf16 v[92:95], v[52:55], a[100:103], v[92:95]
  v_rcp_f32 v229, v229
  v_mfma_f32_16x16x32_bf16 v[76:79], v[48:51], a[100:103], v[76:79]
  v_rcp_f32 v230, v230
  v_mfma_f32_16x16x32_bf16 v[80:83], v[48:51], a[104:107], v[80:83]
  ds_read_b128 v[68:71], v1 offset:17408
  v_mul_f32 v112, v112, v128
  v_mfma_f32_16x16x32_bf16 v[96:99], v[52:55], a[104:107], v[96:99]
  v_rcp_f32 v231, v231
  v_mfma_f32_16x16x32_bf16 v[100:103], v[52:55], a[108:111], v[100:103]
  v_mul_f32 v113, v113, v129
  v_mul_f32 v114, v114, v130
  v_mfma_f32_16x16x32_bf16 v[84:87], v[48:51], a[108:111], v[84:87]
  s_waitcnt lgkmcnt(2)
  v_mul_f32 v115, v115, v131
  v_mul_f32 v112, v112, v228
  v_mfma_f32_16x16x32_bf16 v[72:75], v[56:59], a[112:115], v[72:75]
  ds_read_b128 v[48:51], v1 offset:18432
  v_mul_f32 v113, v113, v229
  v_mfma_f32_16x16x32_bf16 v[88:91], v[60:63], a[112:115], v[88:91]
  v_mul_f32 v114, v114, v230
  v_mul_f32 v115, v115, v231
  v_mfma_f32_16x16x32_bf16 v[92:95], v[60:63], a[116:119], v[92:95]
  v_cvt_pk_bf16_f32 v241, v114, v115
  v_cvt_pk_bf16_f32 v240, v112, v113
  v_mfma_f32_16x16x32_bf16 v[76:79], v[56:59], a[116:119], v[76:79]
  v_fmac_f32 v116, v203, v220
  v_fmac_f32 v117, v203, v221
  v_mfma_f32_16x16x32_bf16 v[80:83], v[56:59], a[120:123], v[80:83]
  ds_read_b128 v[52:55], v1 offset:19456
  v_fmac_f32 v118, v203, v222
  v_mfma_f32_16x16x32_bf16 v[96:99], v[60:63], a[120:123], v[96:99]
  s_add_u32 m0, s39, 77824
  v_fmac_f32 v119, v203, v223
  v_mul_f32 v232, v207, v116
  v_mfma_f32_16x16x32_bf16 v[100:103], v[60:63], a[124:127], v[100:103]
  buffer_load_dwordx4 v8, s[12:15], m0 offen offset:0 sc1 lds
  v_mfma_f32_16x16x32_bf16 v[84:87], v[56:59], a[124:127], v[84:87]
  s_waitcnt lgkmcnt(2)
  v_mul_f32 v233, v207, v117
  v_mul_f32 v234, v207, v118
  v_mfma_f32_16x16x32_bf16 v[72:75], v[64:67], a[128:131], v[72:75]
  ds_read_b128 v[56:59], v1 offset:20480
  v_mul_f32 v235, v207, v119
  v_mfma_f32_16x16x32_bf16 v[88:91], v[68:71], a[128:131], v[88:91]
  v_exp_f32 v232, v232
  v_mfma_f32_16x16x32_bf16 v[92:95], v[68:71], a[132:135], v[92:95]
  v_exp_f32 v233, v233
  v_mfma_f32_16x16x32_bf16 v[76:79], v[64:67], a[132:135], v[76:79]
  v_exp_f32 v234, v234
  v_mfma_f32_16x16x32_bf16 v[80:83], v[64:67], a[136:139], v[80:83]
  ds_read_b128 v[60:63], v1 offset:21504
  v_fmac_f32 v132, v203, v224
  v_mfma_f32_16x16x32_bf16 v[96:99], v[68:71], a[136:139], v[96:99]
  v_exp_f32 v235, v235
  v_mfma_f32_16x16x32_bf16 v[100:103], v[68:71], a[140:143], v[100:103]
  v_fmac_f32 v133, v203, v225
  v_fmac_f32 v134, v203, v226
  v_mfma_f32_16x16x32_bf16 v[84:87], v[64:67], a[140:143], v[84:87]
  s_waitcnt lgkmcnt(2)
  v_fmac_f32 v135, v203, v227
  v_fma_f32 v232, v232, v211, v211
  v_mfma_f32_16x16x32_bf16 v[72:75], v[48:51], a[144:147], v[72:75]
  ds_read_b128 v[64:67], v1 offset:22528
  v_fma_f32 v233, v233, v211, v211
  v_mfma_f32_16x16x32_bf16 v[88:91], v[52:55], a[144:147], v[88:91]
  v_fma_f32 v234, v234, v211, v211
  v_fma_f32 v235, v235, v211, v211
  v_mfma_f32_16x16x32_bf16 v[92:95], v[52:55], a[148:151], v[92:95]
  buffer_load_dwordx4 v8, s[12:15], m0 offen offset:1024 sc1 lds
  v_mfma_f32_16x16x32_bf16 v[76:79], v[48:51], a[148:151], v[76:79]
  v_rcp_f32 v232, v232
  v_mfma_f32_16x16x32_bf16 v[80:83], v[48:51], a[152:155], v[80:83]
  ds_read_b128 v[68:71], v1 offset:23552
  v_mul_f32 v116, v116, v132
  v_mfma_f32_16x16x32_bf16 v[96:99], v[52:55], a[152:155], v[96:99]
  v_rcp_f32 v233, v233
  v_mfma_f32_16x16x32_bf16 v[100:103], v[52:55], a[156:159], v[100:103]
  v_rcp_f32 v234, v234
  v_mfma_f32_16x16x32_bf16 v[84:87], v[48:51], a[156:159], v[84:87]
  s_waitcnt lgkmcnt(2)
  v_rcp_f32 v235, v235
  v_mfma_f32_16x16x32_bf16 v[72:75], v[56:59], a[160:163], v[72:75]
  ds_read_b128 v[48:51], v1 offset:24576
  v_mul_f32 v117, v117, v133
  v_mfma_f32_16x16x32_bf16 v[88:91], v[60:63], a[160:163], v[88:91]
  v_mul_f32 v118, v118, v134
  v_mul_f32 v119, v119, v135
  v_mfma_f32_16x16x32_bf16 v[92:95], v[60:63], a[164:167], v[92:95]
  v_mul_f32 v116, v116, v232
  v_mul_f32 v117, v117, v233
  v_mfma_f32_16x16x32_bf16 v[76:79], v[56:59], a[164:167], v[76:79]
  v_mul_f32 v118, v118, v234
  v_mul_f32 v119, v119, v235
  v_mfma_f32_16x16x32_bf16 v[80:83], v[56:59], a[168:171], v[80:83]
  ds_read_b128 v[52:55], v1 offset:25600
  v_cvt_pk_bf16_f32 v242, v116, v117
  v_mfma_f32_16x16x32_bf16 v[96:99], v[60:63], a[168:171], v[96:99]
  v_cvt_pk_bf16_f32 v243, v118, v119
  v_fmac_f32 v136, v200, v212
  v_mfma_f32_16x16x32_bf16 v[100:103], v[60:63], a[172:175], v[100:103]
  buffer_load_dwordx4 v8, s[12:15], m0 offen offset:2048 sc1 lds
  v_mfma_f32_16x16x32_bf16 v[84:87], v[56:59], a[172:175], v[84:87]
  s_waitcnt lgkmcnt(2)
  v_permlane16_swap_b32 v240, v242
  v_mfma_f32_16x16x32_bf16 v[72:75], v[64:67], a[176:179], v[72:75]
  ds_read_b128 v[56:59], v1 offset:26624
  v_fmac_f32 v137, v200, v213
  v_mfma_f32_16x16x32_bf16 v[88:91], v[68:71], a[176:179], v[88:91]
  v_permlane16_swap_b32 v241, v243
  buffer_store_dwordx4 v[240:243], v12, s[24:27], s45 offen sc1
  v_mfma_f32_16x16x32_bf16 v[92:95], v[68:71], a[180:183], v[92:95]
  s_add_u32 s45, s45, 4096
  v_fmac_f32 v138, v200, v214
  v_fmac_f32 v139, v200, v215
  v_mfma_f32_16x16x32_bf16 v[76:79], v[64:67], a[180:183], v[76:79]
  v_mul_f32 v228, v204, v136
  v_mul_f32 v229, v204, v137
  v_mfma_f32_16x16x32_bf16 v[80:83], v[64:67], a[184:187], v[80:83]
  ds_read_b128 v[60:63], v1 offset:27648
  v_mul_f32 v230, v204, v138
  v_mfma_f32_16x16x32_bf16 v[96:99], v[68:71], a[184:187], v[96:99]
  v_mul_f32 v231, v204, v139
  v_fmac_f32 v152, v200, v216
  v_mfma_f32_16x16x32_bf16 v[100:103], v[68:71], a[188:191], v[100:103]
  v_exp_f32 v228, v228
  v_mfma_f32_16x16x32_bf16 v[84:87], v[64:67], a[188:191], v[84:87]
  s_waitcnt lgkmcnt(2)
  v_exp_f32 v229, v229
  v_mfma_f32_16x16x32_bf16 v[72:75], v[48:51], a[192:195], v[72:75]
  ds_read_b128 v[64:67], v1 offset:28672
  v_fmac_f32 v153, v200, v217
  v_mfma_f32_16x16x32_bf16 v[88:91], v[52:55], a[192:195], v[88:91]
  v_exp_f32 v230, v230
  v_mfma_f32_16x16x32_bf16 v[92:95], v[52:55], a[196:199], v[92:95]
  v_exp_f32 v231, v231
  v_mfma_f32_16x16x32_bf16 v[76:79], v[48:51], a[196:199], v[76:79]
  v_fmac_f32 v154, v200, v218
  v_fmac_f32 v155, v200, v219
  v_mfma_f32_16x16x32_bf16 v[80:83], v[48:51], a[200:203], v[80:83]
  ds_read_b128 v[68:71], v1 offset:29696
  v_fma_f32 v228, v228, v208, v208
  v_mfma_f32_16x16x32_bf16 v[96:99], v[52:55], a[200:203], v[96:99]
  v_fma_f32 v229, v229, v208, v208
  v_fma_f32 v230, v230, v208, v208
  v_mfma_f32_16x16x32_bf16 v[100:103], v[52:55], a[204:207], v[100:103]
  buffer_load_dwordx4 v8, s[12:15], m0 offen offset:3072 sc1 lds
  v_mfma_f32_16x16x32_bf16 v[84:87], v[48:51], a[204:207], v[84:87]
  s_waitcnt lgkmcnt(2)
  v_fma_f32 v231, v231, v208, v208
  v_mul_f32 v136, v136, v152
  v_mfma_f32_16x16x32_bf16 v[72:75], v[56:59], a[208:211], v[72:75]
  ds_read_b128 v[48:51], v1 offset:30720
  v_mul_f32 v137, v137, v153
  v_mfma_f32_16x16x32_bf16 v[88:91], v[60:63], a[208:211], v[88:91]
  v_rcp_f32 v228, v228
  v_mfma_f32_16x16x32_bf16 v[92:95], v[60:63], a[212:215], v[92:95]
  v_rcp_f32 v229, v229
  v_mfma_f32_16x16x32_bf16 v[76:79], v[56:59], a[212:215], v[76:79]
  v_rcp_f32 v230, v230
  v_mfma_f32_16x16x32_bf16 v[80:83], v[56:59], a[216:219], v[80:83]
  ds_read_b128 v[52:55], v1 offset:31744
  v_mul_f32 v138, v138, v154
  v_mfma_f32_16x16x32_bf16 v[96:99], v[60:63], a[216:219], v[96:99]
  v_rcp_f32 v231, v231
  v_mfma_f32_16x16x32_bf16 v[100:103], v[60:63], a[220:223], v[100:103]
  v_mul_f32 v139, v139, v155
  v_mul_f32 v136, v136, v228
  v_mfma_f32_16x16x32_bf16 v[84:87], v[56:59], a[220:223], v[84:87]
  s_waitcnt lgkmcnt(2)
  v_mul_f32 v137, v137, v229
  v_mul_f32 v138, v138, v230
  v_mfma_f32_16x16x32_bf16 v[72:75], v[64:67], a[224:227], v[72:75]
  ds_read_b128 v[56:59], v1 offset:32768
  v_mul_f32 v139, v139, v231
  v_mfma_f32_16x16x32_bf16 v[88:91], v[68:71], a[224:227], v[88:91]
  s_add_u32 m0, s39, 81920
  v_cvt_pk_bf16_f32 v237, v138, v139
  v_cvt_pk_bf16_f32 v236, v136, v137
  v_mfma_f32_16x16x32_bf16 v[92:95], v[68:71], a[228:231], v[92:95]
  buffer_load_dwordx4 v8, s[12:15], m0 offen offset:0 sc1 lds
  v_mfma_f32_16x16x32_bf16 v[76:79], v[64:67], a[228:231], v[76:79]
  ds_read_b128 v[220:223], v10 offset:384
  ds_read_b128 v[224:227], v10 offset:448
  v_mfma_f32_16x16x32_bf16 v[80:83], v[64:67], a[232:235], v[80:83]
  ds_read_b128 v[60:63], v1 offset:33792
  v_fmac_f32 v140, v201, v212
  v_mfma_f32_16x16x32_bf16 v[96:99], v[68:71], a[232:235], v[96:99]
  v_fmac_f32 v141, v201, v213
  v_fmac_f32 v142, v201, v214
  v_mfma_f32_16x16x32_bf16 v[100:103], v[68:71], a[236:239], v[100:103]
  v_fmac_f32 v143, v201, v215
  v_mul_f32 v232, v205, v140
  v_mfma_f32_16x16x32_bf16 v[84:87], v[64:67], a[236:239], v[84:87]
  s_waitcnt lgkmcnt(4)
  v_mul_f32 v233, v205, v141
  v_mul_f32 v234, v205, v142
  v_mfma_f32_16x16x32_bf16 v[72:75], v[48:51], a[240:243], v[72:75]
  ds_read_b128 v[64:67], v1 offset:34816
  v_mul_f32 v235, v205, v143
  v_mfma_f32_16x16x32_bf16 v[88:91], v[52:55], a[240:243], v[88:91]
  v_exp_f32 v232, v232
  v_mfma_f32_16x16x32_bf16 v[92:95], v[52:55], a[244:247], v[92:95]
  v_exp_f32 v233, v233
  v_mfma_f32_16x16x32_bf16 v[76:79], v[48:51], a[244:247], v[76:79]
  v_exp_f32 v234, v234
  v_mfma_f32_16x16x32_bf16 v[80:83], v[48:51], a[248:251], v[80:83]
  ds_read_b128 v[68:71], v1 offset:35840
  v_fmac_f32 v156, v201, v216
  v_mfma_f32_16x16x32_bf16 v[96:99], v[52:55], a[248:251], v[96:99]
  s_waitcnt vmcnt(11)
  v_exp_f32 v235, v235
  v_mfma_f32_16x16x32_bf16 v[100:103], v[52:55], a[252:255], v[100:103]
  s_barrier
  v_fmac_f32 v157, v201, v217
  v_fmac_f32 v158, v201, v218
  v_mfma_f32_16x16x32_bf16 v[84:87], v[48:51], a[252:255], v[84:87]
  s_waitcnt lgkmcnt(2)
  v_fmac_f32 v159, v201, v219
  v_fma_f32 v232, v232, v209, v209
  v_mfma_f32_16x16x32_bf16 v[72:75], v[56:59], v[16:19], v[72:75]
  ds_read_b128 v[48:51], v1 offset:36864
  v_fma_f32 v233, v233, v209, v209
  v_mfma_f32_16x16x32_bf16 v[88:91], v[60:63], v[16:19], v[88:91]
  v_fma_f32 v234, v234, v209, v209
  v_fma_f32 v235, v235, v209, v209
  v_mfma_f32_16x16x32_bf16 v[92:95], v[60:63], v[20:23], v[92:95]
  v_rcp_f32 v232, v232
  v_mfma_f32_16x16x32_bf16 v[76:79], v[56:59], v[20:23], v[76:79]
  v_rcp_f32 v233, v233
  v_mfma_f32_16x16x32_bf16 v[80:83], v[56:59], v[24:27], v[80:83]
  ds_read_b128 v[52:55], v1 offset:37888
  v_mul_f32 v140, v140, v156
  v_mfma_f32_16x16x32_bf16 v[96:99], v[60:63], v[24:27], v[96:99]
  v_rcp_f32 v234, v234
  v_mfma_f32_16x16x32_bf16 v[100:103], v[60:63], v[28:31], v[100:103]
  v_rcp_f32 v235, v235
  v_mfma_f32_16x16x32_bf16 v[84:87], v[56:59], v[28:31], v[84:87]
  s_waitcnt lgkmcnt(2)
  v_mul_f32 v141, v141, v157
  v_mul_f32 v142, v142, v158
  v_mfma_f32_16x16x32_bf16 v[72:75], v[64:67], v[32:35], v[72:75]
  ds_read_b128 v[56:59], v1 offset:38912
  v_mul_f32 v143, v143, v159
  v_mfma_f32_16x16x32_bf16 v[88:91], v[68:71], v[32:35], v[88:91]
  v_mul_f32 v140, v140, v232
  v_mul_f32 v141, v141, v233
  v_mfma_f32_16x16x32_bf16 v[92:95], v[68:71], v[36:39], v[92:95]
  v_mul_f32 v142, v142, v234
  v_mul_f32 v143, v143, v235
  v_mfma_f32_16x16x32_bf16 v[76:79], v[64:67], v[36:39], v[76:79]
  v_cvt_pk_bf16_f32 v239, v142, v143
  v_cvt_pk_bf16_f32 v238, v140, v141
  v_mfma_f32_16x16x32_bf16 v[80:83], v[64:67], v[40:43], v[80:83]
  ds_read_b128 v[60:63], v1 offset:39936
  v_fmac_f32 v144, v202, v212
  v_mfma_f32_16x16x32_bf16 v[96:99], v[68:71], v[40:43], v[96:99]
  v_permlane16_swap_b32 v236, v238
  v_mfma_f32_16x16x32_bf16 v[100:103], v[68:71], v[44:47], v[100:103]
  v_permlane16_swap_b32 v237, v239
  buffer_store_dwordx4 v[236:239], v11, s[24:27], s45 offen sc1
  v_mfma_f32_16x16x32_bf16 v[84:87], v[64:67], v[44:47], v[84:87]
  s_waitcnt lgkmcnt(2)
  v_fmac_f32 v145, v202, v213
  v_fmac_f32 v146, v202, v214
  v_mfma_f32_16x16x32_bf16 v[104:107], v[48:51], a[0:3], 0
  ds_read_b128 v[64:67], v1 offset:40960
  v_fmac_f32 v147, v202, v215
  v_mfma_f32_16x16x32_bf16 v[120:123], v[52:55], a[0:3], 0
  v_mul_f32 v228, v206, v144
  v_mul_f32 v229, v206, v145
  v_mfma_f32_16x16x32_bf16 v[124:127], v[52:55], a[4:7], 0
  v_mul_f32 v230, v206, v146
  v_mul_f32 v231, v206, v147
  v_mfma_f32_16x16x32_bf16 v[108:111], v[48:51], a[4:7], 0
  v_exp_f32 v228, v228
  v_mfma_f32_16x16x32_bf16 v[112:115], v[48:51], a[8:11], 0
  ds_read_b128 v[68:71], v1 offset:41984
  v_fmac_f32 v160, v202, v216
  v_mfma_f32_16x16x32_bf16 v[128:131], v[52:55], a[8:11], 0
  s_add_u32 m0, s39, 110592
  v_exp_f32 v229, v229
  v_mfma_f32_16x16x32_bf16 v[132:135], v[52:55], a[12:15], 0
  buffer_load_dwordx4 v8, s[12:15], m0 offen offset:0 sc1 lds
  v_mfma_f32_16x16x32_bf16 v[116:119], v[48:51], a[12:15], 0
  s_waitcnt lgkmcnt(2)
  v_exp_f32 v230, v230
  v_mfma_f32_16x16x32_bf16 v[104:107], v[56:59], a[16:19], v[104:107]
  ds_read_b128 v[48:51], v1 offset:43008
  v_fmac_f32 v161, v202, v217
  v_mfma_f32_16x16x32_bf16 v[120:123], v[60:63], a[16:19], v[120:123]
  v_exp_f32 v231, v231
  v_mfma_f32_16x16x32_bf16 v[124:127], v[60:63], a[20:23], v[124:127]
  v_fmac_f32 v162, v202, v218
  v_fmac_f32 v163, v202, v219
  v_mfma_f32_16x16x32_bf16 v[108:111], v[56:59], a[20:23], v[108:111]
  v_fma_f32 v228, v228, v210, v210
  v_fma_f32 v229, v229, v210, v210
  v_mfma_f32_16x16x32_bf16 v[112:115], v[56:59], a[24:27], v[112:115]
  ds_read_b128 v[52:55], v1 offset:44032
  v_fma_f32 v230, v230, v210, v210
  v_mfma_f32_16x16x32_bf16 v[128:131], v[60:63], a[24:27], v[128:131]
  v_fma_f32 v231, v231, v210, v210
  v_mul_f32 v144, v144, v160
  v_mfma_f32_16x16x32_bf16 v[132:135], v[60:63], a[28:31], v[132:135]
  v_rcp_f32 v228, v228
  v_mfma_f32_16x16x32_bf16 v[116:119], v[56:59], a[28:31], v[116:119]
  s_waitcnt lgkmcnt(2)
  v_rcp_f32 v229, v229
  v_mfma_f32_16x16x32_bf16 v[104:107], v[64:67], a[32:35], v[104:107]
  ds_read_b128 v[56:59], v1 offset:45056
  v_mul_f32 v145, v145, v161
  v_mfma_f32_16x16x32_bf16 v[120:123], v[68:71], a[32:35], v[120:123]
  v_rcp_f32 v230, v230
  v_mfma_f32_16x16x32_bf16 v[124:127], v[68:71], a[36:39], v[124:127]
  v_rcp_f32 v231, v231
  v_mfma_f32_16x16x32_bf16 v[108:111], v[64:67], a[36:39], v[108:111]
  v_mul_f32 v146, v146, v162
  v_mul_f32 v147, v147, v163
  v_mfma_f32_16x16x32_bf16 v[112:115], v[64:67], a[40:43], v[112:115]
  ds_read_b128 v[60:63], v1 offset:46080
  v_mul_f32 v144, v144, v228
  v_mfma_f32_16x16x32_bf16 v[128:131], v[68:71], a[40:43], v[128:131]
  v_mul_f32 v145, v145, v229
  v_mul_f32 v146, v146, v230
  v_mfma_f32_16x16x32_bf16 v[132:135], v[68:71], a[44:47], v[132:135]
  buffer_load_dwordx4 v8, s[12:15], m0 offen offset:1024 sc1 lds
  v_mfma_f32_16x16x32_bf16 v[116:119], v[64:67], a[44:47], v[116:119]
  s_waitcnt lgkmcnt(2)
  v_cvt_pk_bf16_f32 v240, v144, v145
  v_mul_f32 v147, v147, v231
  v_mfma_f32_16x16x32_bf16 v[104:107], v[48:51], a[48:51], v[104:107]
  ds_read_b128 v[64:67], v1 offset:47104
  v_cvt_pk_bf16_f32 v241, v146, v147
  v_mfma_f32_16x16x32_bf16 v[120:123], v[52:55], a[48:51], v[120:123]
  v_fmac_f32 v148, v203, v212
  v_fmac_f32 v149, v203, v213
  v_mfma_f32_16x16x32_bf16 v[124:127], v[52:55], a[52:55], v[124:127]
  v_fmac_f32 v150, v203, v214
  v_fmac_f32 v151, v203, v215
  v_mfma_f32_16x16x32_bf16 v[108:111], v[48:51], a[52:55], v[108:111]
  v_mul_f32 v232, v207, v148
  v_mul_f32 v233, v207, v149
  v_mfma_f32_16x16x32_bf16 v[112:115], v[48:51], a[56:59], v[112:115]
  ds_read_b128 v[68:71], v1 offset:48128
  v_mul_f32 v234, v207, v150
  v_mfma_f32_16x16x32_bf16 v[128:131], v[52:55], a[56:59], v[128:131]
  v_mul_f32 v235, v207, v151
  v_fmac_f32 v164, v203, v216
  v_mfma_f32_16x16x32_bf16 v[132:135], v[52:55], a[60:63], v[132:135]
  v_exp_f32 v232, v232
  v_mfma_f32_16x16x32_bf16 v[116:119], v[48:51], a[60:63], v[116:119]
  s_waitcnt lgkmcnt(2)
  v_exp_f32 v233, v233
  v_mfma_f32_16x16x32_bf16 v[104:107], v[56:59], a[64:67], v[104:107]
  ds_read_b128 v[48:51], v1 offset:49152
  v_fmac_f32 v165, v203, v217
  v_mfma_f32_16x16x32_bf16 v[120:123], v[60:63], a[64:67], v[120:123]
  v_exp_f32 v234, v234
  v_mfma_f32_16x16x32_bf16 v[124:127], v[60:63], a[68:71], v[124:127]
  buffer_load_dwordx4 v8, s[12:15], m0 offen offset:2048 sc1 lds
  v_mfma_f32_16x16x32_bf16 v[108:111], v[56:59], a[68:71], v[108:111]
  v_exp_f32 v235, v235
  v_mfma_f32_16x16x32_bf16 v[112:115], v[56:59], a[72:75], v[112:115]
  ds_read_b128 v[52:55], v1 offset:50176
  v_fmac_f32 v166, v203, v218
  v_mfma_f32_16x16x32_bf16 v[128:131], v[60:63], a[72:75], v[128:131]
  v_fmac_f32 v167, v203, v219
  v_fma_f32 v232, v232, v211, v211
  v_mfma_f32_16x16x32_bf16 v[132:135], v[60:63], a[76:79], v[132:135]
  v_fma_f32 v233, v233, v211, v211
  v_fma_f32 v234, v234, v211, v211
  v_mfma_f32_16x16x32_bf16 v[116:119], v[56:59], a[76:79], v[116:119]
  s_waitcnt lgkmcnt(2)
  v_fma_f32 v235, v235, v211, v211
  v_mul_f32 v148, v148, v164
  v_mfma_f32_16x16x32_bf16 v[104:107], v[64:67], a[80:83], v[104:107]
  ds_read_b128 v[56:59], v1 offset:51200
  v_mul_f32 v149, v149, v165
  v_mfma_f32_16x16x32_bf16 v[120:123], v[68:71], a[80:83], v[120:123]
  v_rcp_f32 v232, v232
  v_mfma_f32_16x16x32_bf16 v[124:127], v[68:71], a[84:87], v[124:127]
  v_rcp_f32 v233, v233
  v_mfma_f32_16x16x32_bf16 v[108:111], v[64:67], a[84:87], v[108:111]
  v_rcp_f32 v234, v234
  v_mfma_f32_16x16x32_bf16 v[112:115], v[64:67], a[88:91], v[112:115]
  ds_read_b128 v[60:63], v1 offset:52224
  v_mul_f32 v150, v150, v166
  v_mfma_f32_16x16x32_bf16 v[128:131], v[68:71], a[88:91], v[128:131]
  v_rcp_f32 v235, v235
  v_mfma_f32_16x16x32_bf16 v[132:135], v[68:71], a[92:95], v[132:135]
  buffer_load_dwordx4 v8, s[12:15], m0 offen offset:3072 sc1 lds
  v_mfma_f32_16x16x32_bf16 v[116:119], v[64:67], a[92:95], v[116:119]
  s_waitcnt lgkmcnt(2)
  v_mul_f32 v151, v151, v167
  v_mul_f32 v148, v148, v232
  v_mfma_f32_16x16x32_bf16 v[104:107], v[48:51], a[96:99], v[104:107]
  ds_read_b128 v[64:67], v1 offset:53248
  v_mul_f32 v149, v149, v233
  v_mfma_f32_16x16x32_bf16 v[120:123], v[52:55], a[96:99], v[120:123]
  v_mul_f32 v150, v150, v234
  v_mul_f32 v151, v151, v235
  v_mfma_f32_16x16x32_bf16 v[124:127], v[52:55], a[100:103], v[124:127]
  v_cvt_pk_bf16_f32 v243, v150, v151
  v_cvt_pk_bf16_f32 v242, v148, v149
  v_mfma_f32_16x16x32_bf16 v[108:111], v[48:51], a[100:103], v[108:111]
  v_permlane16_swap_b32 v241, v243
  v_mfma_f32_16x16x32_bf16 v[112:115], v[48:51], a[104:107], v[112:115]
  ds_read_b128 v[68:71], v1 offset:54272
  v_fmac_f32 v168, v200, v220
  v_mfma_f32_16x16x32_bf16 v[128:131], v[52:55], a[104:107], v[128:131]
  v_permlane16_swap_b32 v240, v242
  buffer_store_dwordx4 v[240:243], v12, s[24:27], s45 offen sc1
  v_mfma_f32_16x16x32_bf16 v[132:135], v[52:55], a[108:111], v[132:135]
  s_add_u32 s45, s45, 4096
  v_fmac_f32 v169, v200, v221
  v_fmac_f32 v170, v200, v222
  v_mfma_f32_16x16x32_bf16 v[116:119], v[48:51], a[108:111], v[116:119]
  s_waitcnt lgkmcnt(2)
  v_fmac_f32 v171, v200, v223
  v_mul_f32 v228, v204, v168
  v_mfma_f32_16x16x32_bf16 v[104:107], v[56:59], a[112:115], v[104:107]
  ds_read_b128 v[48:51], v1 offset:55296
  v_mul_f32 v229, v204, v169
  v_mfma_f32_16x16x32_bf16 v[120:123], v[60:63], a[112:115], v[120:123]
  v_mul_f32 v230, v204, v170
  v_mul_f32 v231, v204, v171
  v_mfma_f32_16x16x32_bf16 v[124:127], v[60:63], a[116:119], v[124:127]
  v_exp_f32 v228, v228
  v_mfma_f32_16x16x32_bf16 v[108:111], v[56:59], a[116:119], v[108:111]
  v_exp_f32 v229, v229
  v_mfma_f32_16x16x32_bf16 v[112:115], v[56:59], a[120:123], v[112:115]
  ds_read_b128 v[52:55], v1 offset:56320
  v_fmac_f32 v184, v200, v224
  v_mfma_f32_16x16x32_bf16 v[128:131], v[60:63], a[120:123], v[128:131]
  s_add_u32 m0, s39, 114688
  v_exp_f32 v230, v230
  v_mfma_f32_16x16x32_bf16 v[132:135], v[60:63], a[124:127], v[132:135]
  buffer_load_dwordx4 v8, s[12:15], m0 offen offset:0 sc1 lds
  v_mfma_f32_16x16x32_bf16 v[116:119], v[56:59], a[124:127], v[116:119]
  s_waitcnt lgkmcnt(2)
  v_exp_f32 v231, v231
  v_mfma_f32_16x16x32_bf16 v[104:107], v[64:67], a[128:131], v[104:107]
  ds_read_b128 v[56:59], v1 offset:57344
  v_fmac_f32 v185, v200, v225
  v_mfma_f32_16x16x32_bf16 v[120:123], v[68:71], a[128:131], v[120:123]
  v_fmac_f32 v186, v200, v226
  v_fmac_f32 v187, v200, v227
  v_mfma_f32_16x16x32_bf16 v[124:127], v[68:71], a[132:135], v[124:127]
  v_fma_f32 v228, v228, v208, v208
  v_fma_f32 v229, v229, v208, v208
  v_mfma_f32_16x16x32_bf16 v[108:111], v[64:67], a[132:135], v[108:111]
  v_fma_f32 v230, v230, v208, v208
  v_fma_f32 v231, v231, v208, v208
  v_mfma_f32_16x16x32_bf16 v[112:115], v[64:67], a[136:139], v[112:115]
  ds_read_b128 v[60:63], v1 offset:58368
  v_mul_f32 v168, v168, v184
  v_mfma_f32_16x16x32_bf16 v[128:131], v[68:71], a[136:139], v[128:131]
  v_rcp_f32 v228, v228
  v_mfma_f32_16x16x32_bf16 v[132:135], v[68:71], a[140:143], v[132:135]
  v_rcp_f32 v229, v229
  v_mfma_f32_16x16x32_bf16 v[116:119], v[64:67], a[140:143], v[116:119]
  s_waitcnt lgkmcnt(2)
  v_rcp_f32 v230, v230
  v_mfma_f32_16x16x32_bf16 v[104:107], v[48:51], a[144:147], v[104:107]
  ds_read_b128 v[64:67], v1 offset:59392
  v_mul_f32 v169, v169, v185
  v_mfma_f32_16x16x32_bf16 v[120:123], v[52:55], a[144:147], v[120:123]
  v_rcp_f32 v231, v231
  v_mfma_f32_16x16x32_bf16 v[124:127], v[52:55], a[148:151], v[124:127]
  buffer_load_dwordx4 v8, s[12:15], m0 offen offset:1024 sc1 lds
  v_mfma_f32_16x16x32_bf16 v[108:111], v[48:51], a[148:151], v[108:111]
  v_mul_f32 v170, v170, v186
  v_mul_f32 v171, v171, v187
  v_mfma_f32_16x16x32_bf16 v[112:115], v[48:51], a[152:155], v[112:115]
  ds_read_b128 v[68:71], v1 offset:60416
  v_mul_f32 v168, v168, v228
  v_mfma_f32_16x16x32_bf16 v[128:131], v[52:55], a[152:155], v[128:131]
  v_mul_f32 v169, v169, v229
  v_mul_f32 v170, v170, v230
  v_mfma_f32_16x16x32_bf16 v[132:135], v[52:55], a[156:159], v[132:135]
  v_cvt_pk_bf16_f32 v236, v168, v169
  v_mul_f32 v171, v171, v231
  v_mfma_f32_16x16x32_bf16 v[116:119], v[48:51], a[156:159], v[116:119]
  s_waitcnt lgkmcnt(2)
  v_cvt_pk_bf16_f32 v237, v170, v171
  v_fmac_f32 v172, v201, v220
  v_mfma_f32_16x16x32_bf16 v[104:107], v[56:59], a[160:163], v[104:107]
  ds_read_b128 v[48:51], v1 offset:61440
  ds_read_b128 v[212:215], v10 offset:512
  v_mfma_f32_16x16x32_bf16 v[120:123], v[60:63], a[160:163], v[120:123]
  ds_read_b128 v[216:219], v10 offset:576
  v_fmac_f32 v173, v201, v221
  v_mfma_f32_16x16x32_bf16 v[124:127], v[60:63], a[164:167], v[124:127]
  v_fmac_f32 v174, v201, v222
  v_fmac_f32 v175, v201, v223
  v_mfma_f32_16x16x32_bf16 v[108:111], v[56:59], a[164:167], v[108:111]
  v_mul_f32 v232, v205, v172
  v_mul_f32 v233, v205, v173
  v_mfma_f32_16x16x32_bf16 v[112:115], v[56:59], a[168:171], v[112:115]
  ds_read_b128 v[52:55], v1 offset:62464
  v_mul_f32 v234, v205, v174
  v_mfma_f32_16x16x32_bf16 v[128:131], v[60:63], a[168:171], v[128:131]
  v_mul_f32 v235, v205, v175
  v_fmac_f32 v188, v201, v224
  v_mfma_f32_16x16x32_bf16 v[132:135], v[60:63], a[172:175], v[132:135]
  buffer_load_dwordx4 v8, s[12:15], m0 offen offset:2048 sc1 lds
  v_mfma_f32_16x16x32_bf16 v[116:119], v[56:59], a[172:175], v[116:119]
  s_waitcnt lgkmcnt(4)
  v_exp_f32 v232, v232
  v_mfma_f32_16x16x32_bf16 v[104:107], v[64:67], a[176:179], v[104:107]
  ds_read_b128 v[56:59], v1 offset:63488
  v_fmac_f32 v189, v201, v225
  v_mfma_f32_16x16x32_bf16 v[120:123], v[68:71], a[176:179], v[120:123]
  v_exp_f32 v233, v233
  v_mfma_f32_16x16x32_bf16 v[124:127], v[68:71], a[180:183], v[124:127]
  v_exp_f32 v234, v234
  v_mfma_f32_16x16x32_bf16 v[108:111], v[64:67], a[180:183], v[108:111]
  v_exp_f32 v235, v235
  v_mfma_f32_16x16x32_bf16 v[112:115], v[64:67], a[184:187], v[112:115]
  ds_read_b128 v[60:63], v1 offset:64512
  v_fmac_f32 v190, v201, v226
  v_mfma_f32_16x16x32_bf16 v[128:131], v[68:71], a[184:187], v[128:131]
  v_fmac_f32 v191, v201, v227
  v_fma_f32 v232, v232, v209, v209
  v_mfma_f32_16x16x32_bf16 v[132:135], v[68:71], a[188:191], v[132:135]
  v_fma_f32 v233, v233, v209, v209
  v_fma_f32 v234, v234, v209, v209
  v_mfma_f32_16x16x32_bf16 v[116:119], v[64:67], a[188:191], v[116:119]
  s_waitcnt lgkmcnt(2)
  v_fma_f32 v235, v235, v209, v209
  v_mul_f32 v172, v172, v188
  v_mfma_f32_16x16x32_bf16 v[104:107], v[48:51], a[192:195], v[104:107]
  ds_read_b128 v[64:67], v6 offset:0
  v_mul_f32 v173, v173, v189
  v_mfma_f32_16x16x32_bf16 v[120:123], v[52:55], a[192:195], v[120:123]
  v_rcp_f32 v232, v232
  v_mfma_f32_16x16x32_bf16 v[124:127], v[52:55], a[196:199], v[124:127]
  v_rcp_f32 v233, v233
  v_mfma_f32_16x16x32_bf16 v[108:111], v[48:51], a[196:199], v[108:111]
  v_rcp_f32 v234, v234
  v_mfma_f32_16x16x32_bf16 v[112:115], v[48:51], a[200:203], v[112:115]
  ds_read_b128 v[68:71], v6 offset:1024
  v_mul_f32 v174, v174, v190
  v_mfma_f32_16x16x32_bf16 v[128:131], v[52:55], a[200:203], v[128:131]
  v_rcp_f32 v235, v235
  v_mfma_f32_16x16x32_bf16 v[132:135], v[52:55], a[204:207], v[132:135]
  buffer_load_dwordx4 v8, s[12:15], m0 offen offset:3072 sc1 lds
  v_mfma_f32_16x16x32_bf16 v[116:119], v[48:51], a[204:207], v[116:119]
  s_waitcnt lgkmcnt(2)
  v_mul_f32 v175, v175, v191
  v_mul_f32 v172, v172, v232
  v_mfma_f32_16x16x32_bf16 v[104:107], v[56:59], a[208:211], v[104:107]
  ds_read_b128 v[48:51], v6 offset:2048
  v_mul_f32 v173, v173, v233
  v_mfma_f32_16x16x32_bf16 v[120:123], v[60:63], a[208:211], v[120:123]
  v_mul_f32 v174, v174, v234
  v_mul_f32 v175, v175, v235
  v_mfma_f32_16x16x32_bf16 v[124:127], v[60:63], a[212:215], v[124:127]
  v_cvt_pk_bf16_f32 v239, v174, v175
  v_cvt_pk_bf16_f32 v238, v172, v173
  v_mfma_f32_16x16x32_bf16 v[108:111], v[56:59], a[212:215], v[108:111]
  v_permlane16_swap_b32 v237, v239
  v_mfma_f32_16x16x32_bf16 v[112:115], v[56:59], a[216:219], v[112:115]
  ds_read_b128 v[52:55], v6 offset:3072
  v_fmac_f32 v176, v202, v220
  v_mfma_f32_16x16x32_bf16 v[128:131], v[60:63], a[216:219], v[128:131]
  v_permlane16_swap_b32 v236, v238
  buffer_store_dwordx4 v[236:239], v11, s[24:27], s45 offen sc1
  v_mfma_f32_16x16x32_bf16 v[132:135], v[60:63], a[220:223], v[132:135]
  v_fmac_f32 v177, v202, v221
  v_fmac_f32 v178, v202, v222
  v_mfma_f32_16x16x32_bf16 v[116:119], v[56:59], a[220:223], v[116:119]
  s_waitcnt lgkmcnt(2)
  v_fmac_f32 v179, v202, v223
  v_mul_f32 v228, v206, v176
  v_mfma_f32_16x16x32_bf16 v[104:107], v[64:67], a[224:227], v[104:107]
  ds_read_b128 v[56:59], v6 offset:4096
  v_mul_f32 v229, v206, v177
  v_mfma_f32_16x16x32_bf16 v[120:123], v[68:71], a[224:227], v[120:123]
  s_add_u32 m0, s39, 118784
  v_mul_f32 v230, v206, v178
  v_mul_f32 v231, v206, v179
  v_mfma_f32_16x16x32_bf16 v[124:127], v[68:71], a[228:231], v[124:127]
  buffer_load_dwordx4 v8, s[12:15], m0 offen offset:0 sc1 lds
  v_mfma_f32_16x16x32_bf16 v[108:111], v[64:67], a[228:231], v[108:111]
  v_exp_f32 v228, v228
  v_mfma_f32_16x16x32_bf16 v[112:115], v[64:67], a[232:235], v[112:115]
  ds_read_b128 v[60:63], v6 offset:5120
  v_fmac_f32 v192, v202, v224
  v_mfma_f32_16x16x32_bf16 v[128:131], v[68:71], a[232:235], v[128:131]
  v_exp_f32 v229, v229
  v_mfma_f32_16x16x32_bf16 v[132:135], v[68:71], a[236:239], v[132:135]
  v_exp_f32 v230, v230
  v_mfma_f32_16x16x32_bf16 v[116:119], v[64:67], a[236:239], v[116:119]
  s_waitcnt lgkmcnt(2)
  v_exp_f32 v231, v231
  v_mfma_f32_16x16x32_bf16 v[104:107], v[48:51], a[240:243], v[104:107]
  ds_read_b128 v[64:67], v6 offset:6144
  v_fmac_f32 v193, v202, v225
  v_mfma_f32_16x16x32_bf16 v[120:123], v[52:55], a[240:243], v[120:123]
  v_fmac_f32 v194, v202, v226
  v_fmac_f32 v195, v202, v227
  v_mfma_f32_16x16x32_bf16 v[124:127], v[52:55], a[244:247], v[124:127]
  v_fma_f32 v228, v228, v210, v210
  v_fma_f32 v229, v229, v210, v210
  v_mfma_f32_16x16x32_bf16 v[108:111], v[48:51], a[244:247], v[108:111]
  v_fma_f32 v230, v230, v210, v210
  v_fma_f32 v231, v231, v210, v210
  v_mfma_f32_16x16x32_bf16 v[112:115], v[48:51], a[248:251], v[112:115]
  ds_read_b128 v[68:71], v6 offset:7168
  v_mul_f32 v176, v176, v192
  v_mfma_f32_16x16x32_bf16 v[128:131], v[52:55], a[248:251], v[128:131]
  s_waitcnt vmcnt(12)
  v_rcp_f32 v228, v228
  v_mfma_f32_16x16x32_bf16 v[132:135], v[52:55], a[252:255], v[132:135]
  s_barrier
  v_rcp_f32 v229, v229
  v_mfma_f32_16x16x32_bf16 v[116:119], v[48:51], a[252:255], v[116:119]
  s_waitcnt lgkmcnt(2)
  v_rcp_f32 v230, v230
  v_mfma_f32_16x16x32_bf16 v[104:107], v[56:59], v[16:19], v[104:107]
  ds_read_b128 v[48:51], v6 offset:8192
  v_mul_f32 v177, v177, v193
  v_mfma_f32_16x16x32_bf16 v[120:123], v[60:63], v[16:19], v[120:123]
  v_rcp_f32 v231, v231
  v_mfma_f32_16x16x32_bf16 v[124:127], v[60:63], v[20:23], v[124:127]
  v_mul_f32 v178, v178, v194
  v_mul_f32 v179, v179, v195
  v_mfma_f32_16x16x32_bf16 v[108:111], v[56:59], v[20:23], v[108:111]
  v_mul_f32 v176, v176, v228
  v_mul_f32 v177, v177, v229
  v_mfma_f32_16x16x32_bf16 v[112:115], v[56:59], v[24:27], v[112:115]
  ds_read_b128 v[52:55], v6 offset:9216
  v_mul_f32 v178, v178, v230
  v_mfma_f32_16x16x32_bf16 v[128:131], v[60:63], v[24:27], v[128:131]
  v_cvt_pk_bf16_f32 v240, v176, v177
  v_mul_f32 v179, v179, v231
  v_mfma_f32_16x16x32_bf16 v[132:135], v[60:63], v[28:31], v[132:135]
  v_cvt_pk_bf16_f32 v241, v178, v179
  v_fmac_f32 v180, v203, v220
  v_mfma_f32_16x16x32_bf16 v[116:119], v[56:59], v[28:31], v[116:119]
  s_waitcnt lgkmcnt(2)
  v_fmac_f32 v181, v203, v221
  v_fmac_f32 v182, v203, v222
  v_mfma_f32_16x16x32_bf16 v[104:107], v[64:67], v[32:35], v[104:107]
  ds_read_b128 v[56:59], v6 offset:10240
  v_fmac_f32 v183, v203, v223
  v_mfma_f32_16x16x32_bf16 v[120:123], v[68:71], v[32:35], v[120:123]
  v_mul_f32 v232, v207, v180
  v_mul_f32 v233, v207, v181
  v_mfma_f32_16x16x32_bf16 v[124:127], v[68:71], v[36:39], v[124:127]
  v_mul_f32 v234, v207, v182
  v_mul_f32 v235, v207, v183
  v_mfma_f32_16x16x32_bf16 v[108:111], v[64:67], v[36:39], v[108:111]
  v_exp_f32 v232, v232
  v_mfma_f32_16x16x32_bf16 v[112:115], v[64:67], v[40:43], v[112:115]
  ds_read_b128 v[60:63], v6 offset:11264
  v_fmac_f32 v196, v203, v224
  v_mfma_f32_16x16x32_bf16 v[128:131], v[68:71], v[40:43], v[128:131]
  v_exp_f32 v233, v233
  v_mfma_f32_16x16x32_bf16 v[132:135], v[68:71], v[44:47], v[132:135]
  v_exp_f32 v234, v234
  v_mfma_f32_16x16x32_bf16 v[116:119], v[64:67], v[44:47], v[116:119]
  s_waitcnt lgkmcnt(2)
  v_exp_f32 v235, v235
  v_mfma_f32_16x16x32_bf16 v[136:139], v[48:51], a[0:3], 0
  ds_read_b128 v[64:67], v6 offset:12288
  v_fmac_f32 v197, v203, v225
  v_mfma_f32_16x16x32_bf16 v[152:155], v[52:55], a[0:3], 0
  v_fmac_f32 v198, v203, v226
  v_fmac_f32 v199, v203, v227
  v_mfma_f32_16x16x32_bf16 v[156:159], v[52:55], a[4:7], 0
  v_fma_f32 v232, v232, v211, v211
  v_fma_f32 v233, v233, v211, v211
  v_mfma_f32_16x16x32_bf16 v[140:143], v[48:51], a[4:7], 0
  v_fma_f32 v234, v234, v211, v211
  v_fma_f32 v235, v235, v211, v211
  v_mfma_f32_16x16x32_bf16 v[144:147], v[48:51], a[8:11], 0
  ds_read_b128 v[68:71], v6 offset:13312
  v_mul_f32 v180, v180, v196
  v_mfma_f32_16x16x32_bf16 v[160:163], v[52:55], a[8:11], 0
  s_add_u32 m0, s39, 0
  v_rcp_f32 v232, v232
  v_mfma_f32_16x16x32_bf16 v[164:167], v[52:55], a[12:15], 0
  buffer_load_dwordx4 v9, s[12:15], m0 offen offset:0 sc1 lds
  v_mfma_f32_16x16x32_bf16 v[148:151], v[48:51], a[12:15], 0
  s_waitcnt lgkmcnt(2)
  v_rcp_f32 v233, v233
  v_mfma_f32_16x16x32_bf16 v[136:139], v[56:59], a[16:19], v[136:139]
  ds_read_b128 v[48:51], v6 offset:14336
  v_mul_f32 v181, v181, v197
  v_mfma_f32_16x16x32_bf16 v[152:155], v[60:63], a[16:19], v[152:155]
  v_rcp_f32 v234, v234
  v_mfma_f32_16x16x32_bf16 v[156:159], v[60:63], a[20:23], v[156:159]
  v_rcp_f32 v235, v235
  v_mfma_f32_16x16x32_bf16 v[140:143], v[56:59], a[20:23], v[140:143]
  v_mul_f32 v182, v182, v198
  v_mul_f32 v183, v183, v199
  v_mfma_f32_16x16x32_bf16 v[144:147], v[56:59], a[24:27], v[144:147]
  ds_read_b128 v[52:55], v6 offset:15360
  v_mul_f32 v180, v180, v232
  v_mfma_f32_16x16x32_bf16 v[160:163], v[60:63], a[24:27], v[160:163]
  v_mul_f32 v181, v181, v233
  v_mul_f32 v182, v182, v234
  v_mfma_f32_16x16x32_bf16 v[164:167], v[60:63], a[28:31], v[164:167]
  v_cvt_pk_bf16_f32 v242, v180, v181
  v_mul_f32 v183, v183, v235
  v_mfma_f32_16x16x32_bf16 v[148:151], v[56:59], a[28:31], v[148:151]
  s_waitcnt lgkmcnt(2)
  v_cvt_pk_bf16_f32 v243, v182, v183
  v_fmac_f32 v72, v200, v212
  v_mfma_f32_16x16x32_bf16 v[136:139], v[64:67], a[32:35], v[136:139]
  ds_read_b128 v[56:59], v6 offset:16384
  v_fmac_f32 v73, v200, v213
  v_mfma_f32_16x16x32_bf16 v[152:155], v[68:71], a[32:35], v[152:155]
  v_permlane16_swap_b32 v240, v242
  v_mfma_f32_16x16x32_bf16 v[156:159], v[68:71], a[36:39], v[156:159]
  v_permlane16_swap_b32 v241, v243
  buffer_store_dwordx4 v[240:243], v12, s[24:27], s45 offen sc1
  v_mfma_f32_16x16x32_bf16 v[140:143], v[64:67], a[36:39], v[140:143]
  s_add_u32 s45, s45, 4096
  v_fmac_f32 v74, v200, v214
  v_fmac_f32 v75, v200, v215
  v_mfma_f32_16x16x32_bf16 v[144:147], v[64:67], a[40:43], v[144:147]
  ds_read_b128 v[60:63], v6 offset:17408
  v_mul_f32 v228, v204, v72
  v_mfma_f32_16x16x32_bf16 v[160:163], v[68:71], a[40:43], v[160:163]
  v_mul_f32 v229, v204, v73
  v_mul_f32 v230, v204, v74
  v_mfma_f32_16x16x32_bf16 v[164:167], v[68:71], a[44:47], v[164:167]
  buffer_load_dwordx4 v9, s[12:15], m0 offen offset:1024 sc1 lds
  v_mfma_f32_16x16x32_bf16 v[148:151], v[64:67], a[44:47], v[148:151]
  s_waitcnt lgkmcnt(2)
  v_mul_f32 v231, v204, v75
  v_fmac_f32 v88, v200, v216
  v_mfma_f32_16x16x32_bf16 v[136:139], v[48:51], a[48:51], v[136:139]
  ds_read_b128 v[64:67], v6 offset:18432
  v_fmac_f32 v89, v200, v217
  v_mfma_f32_16x16x32_bf16 v[152:155], v[52:55], a[48:51], v[152:155]
  v_exp_f32 v228, v228
  v_mfma_f32_16x16x32_bf16 v[156:159], v[52:55], a[52:55], v[156:159]
  v_exp_f32 v229, v229
  v_mfma_f32_16x16x32_bf16 v[140:143], v[48:51], a[52:55], v[140:143]
  v_exp_f32 v230, v230
  v_mfma_f32_16x16x32_bf16 v[144:147], v[48:51], a[56:59], v[144:147]
  ds_read_b128 v[68:71], v6 offset:19456
  v_fmac_f32 v90, v200, v218
  v_mfma_f32_16x16x32_bf16 v[160:163], v[52:55], a[56:59], v[160:163]
  v_exp_f32 v231, v231
  v_mfma_f32_16x16x32_bf16 v[164:167], v[52:55], a[60:63], v[164:167]
  v_fmac_f32 v91, v200, v219
  v_fma_f32 v228, v228, v208, v208
  v_mfma_f32_16x16x32_bf16 v[148:151], v[48:51], a[60:63], v[148:151]
  s_waitcnt lgkmcnt(2)
  v_fma_f32 v229, v229, v208, v208
  v_fma_f32 v230, v230, v208, v208
  v_mfma_f32_16x16x32_bf16 v[136:139], v[56:59], a[64:67], v[136:139]
  ds_read_b128 v[48:51], v6 offset:20480
  v_fma_f32 v231, v231, v208, v208
  v_mfma_f32_16x16x32_bf16 v[152:155], v[60:63], a[64:67], v[152:155]
  v_rcp_f32 v228, v228
  v_mfma_f32_16x16x32_bf16 v[156:159], v[60:63], a[68:71], v[156:159]
  buffer_load_dwordx4 v9, s[12:15], m0 offen offset:2048 sc1 lds
  v_mfma_f32_16x16x32_bf16 v[140:143], v[56:59], a[68:71], v[140:143]
  v_rcp_f32 v229, v229
  v_mfma_f32_16x16x32_bf16 v[144:147], v[56:59], a[72:75], v[144:147]
  ds_read_b128 v[52:55], v6 offset:21504
  v_mul_f32 v72, v72, v88
  v_mfma_f32_16x16x32_bf16 v[160:163], v[60:63], a[72:75], v[160:163]
  v_rcp_f32 v230, v230
  v_mfma_f32_16x16x32_bf16 v[164:167], v[60:63], a[76:79], v[164:167]
  v_rcp_f32 v231, v231
  v_mfma_f32_16x16x32_bf16 v[148:151], v[56:59], a[76:79], v[148:151]
  s_waitcnt lgkmcnt(2)
  v_mul_f32 v73, v73, v89
  v_mul_f32 v74, v74, v90
  v_mfma_f32_16x16x32_bf16 v[136:139], v[64:67], a[80:83], v[136:139]
  ds_read_b128 v[56:59], v6 offset:22528
  v_mul_f32 v75, v75, v91
  v_mfma_f32_16x16x32_bf16 v[152:155], v[68:71], a[80:83], v[152:155]
  v_mul_f32 v72, v72, v228
  v_mul_f32 v73, v73, v229
  v_mfma_f32_16x16x32_bf16 v[156:159], v[68:71], a[84:87], v[156:159]
  v_mul_f32 v74, v74, v230
  v_mul_f32 v75, v75, v231
  v_mfma_f32_16x16x32_bf16 v[140:143], v[64:67], a[84:87], v[140:143]
  v_cvt_pk_bf16_f32 v237, v74, v75
  v_cvt_pk_bf16_f32 v236, v72, v73
  v_mfma_f32_16x16x32_bf16 v[144:147], v[64:67], a[88:91], v[144:147]
  ds_read_b128 v[60:63], v6 offset:23552
  ds_read_b128 v[220:223], v10 offset:640
  v_mfma_f32_16x16x32_bf16 v[160:163], v[68:71], a[88:91], v[160:163]
  ds_read_b128 v[224:227], v10 offset:704
  v_fmac_f32 v76, v201, v212
  v_mfma_f32_16x16x32_bf16 v[164:167], v[68:71], a[92:95], v[164:167]
  buffer_load_dwordx4 v9, s[12:15], m0 offen offset:3072 sc1 lds
  v_mfma_f32_16x16x32_bf16 v[148:151], v[64:67], a[92:95], v[148:151]
  s_waitcnt lgkmcnt(4)
  v_fmac_f32 v77, v201, v213
  v_fmac_f32 v78, v201, v214
  v_mfma_f32_16x16x32_bf16 v[136:139], v[48:51], a[96:99], v[136:139]
  ds_read_b128 v[64:67], v6 offset:24576
  v_fmac_f32 v79, v201, v215
  v_mfma_f32_16x16x32_bf16 v[152:155], v[52:55], a[96:99], v[152:155]
  v_mul_f32 v232, v205, v76
  v_mul_f32 v233, v205, v77
  v_mfma_f32_16x16x32_bf16 v[156:159], v[52:55], a[100:103], v[156:159]
  v_mul_f32 v234, v205, v78
  v_mul_f32 v235, v205, v79
  v_mfma_f32_16x16x32_bf16 v[140:143], v[48:51], a[100:103], v[140:143]
  v_exp_f32 v232, v232
  v_mfma_f32_16x16x32_bf16 v[144:147], v[48:51], a[104:107], v[144:147]
  ds_read_b128 v[68:71], v6 offset:25600
  v_fmac_f32 v92, v201, v216
  v_mfma_f32_16x16x32_bf16 v[160:163], v[52:55], a[104:107], v[160:163]
  v_exp_f32 v233, v233
  v_mfma_f32_16x16x32_bf16 v[164:167], v[52:55], a[108:111], v[164:167]
  v_exp_f32 v234, v234
  v_mfma_f32_16x16x32_bf16 v[148:151], v[48:51], a[108:111], v[148:151]
  s_waitcnt lgkmcnt(4)
  v_exp_f32 v235, v235
  v_mfma_f32_16x16x32_bf16 v[136:139], v[56:59], a[112:115], v[136:139]
  ds_read_b128 v[48:51], v6 offset:26624
  v_fmac_f32 v93, v201, v217
  v_mfma_f32_16x16x32_bf16 v[152:155], v[60:63], a[112:115], v[152:155]
  v_fmac_f32 v94, v201, v218
  v_fmac_f32 v95, v201, v219
  v_mfma_f32_16x16x32_bf16 v[156:159], v[60:63], a[116:119], v[156:159]
  v_fma_f32 v232, v232, v209, v209
  v_fma_f32 v233, v233, v209, v209
  v_mfma_f32_16x16x32_bf16 v[140:143], v[56:59], a[116:119], v[140:143]
  v_fma_f32 v234, v234, v209, v209
  v_fma_f32 v235, v235, v209, v209
  v_mfma_f32_16x16x32_bf16 v[144:147], v[56:59], a[120:123], v[144:147]
  ds_read_b128 v[52:55], v6 offset:27648
  v_mul_f32 v76, v76, v92
  v_mfma_f32_16x16x32_bf16 v[160:163], v[60:63], a[120:123], v[160:163]
  s_add_u32 m0, s39, 4096
  v_rcp_f32 v232, v232
  v_mfma_f32_16x16x32_bf16 v[164:167], v[60:63], a[124:127], v[164:167]
  buffer_load_dwordx4 v9, s[12:15], m0 offen offset:0 sc1 lds
  v_mfma_f32_16x16x32_bf16 v[148:151], v[56:59], a[124:127], v[148:151]
  s_waitcnt lgkmcnt(2)
  v_rcp_f32 v233, v233
  v_mfma_f32_16x16x32_bf16 v[136:139], v[64:67], a[128:131], v[136:139]
  ds_read_b128 v[56:59], v6 offset:28672
  v_mul_f32 v77, v77, v93
  v_mfma_f32_16x16x32_bf16 v[152:155], v[68:71], a[128:131], v[152:155]
  v_rcp_f32 v234, v234
  v_mfma_f32_16x16x32_bf16 v[156:159], v[68:71], a[132:135], v[156:159]
  v_rcp_f32 v235, v235
  v_mfma_f32_16x16x32_bf16 v[140:143], v[64:67], a[132:135], v[140:143]
  v_mul_f32 v78, v78, v94
  v_mul_f32 v79, v79, v95
  v_mfma_f32_16x16x32_bf16 v[144:147], v[64:67], a[136:139], v[144:147]
  ds_read_b128 v[60:63], v6 offset:29696
  v_mul_f32 v76, v76, v232
  v_mfma_f32_16x16x32_bf16 v[160:163], v[68:71], a[136:139], v[160:163]
  v_mul_f32 v77, v77, v233
  v_mul_f32 v78, v78, v234
  v_mfma_f32_16x16x32_bf16 v[164:167], v[68:71], a[140:143], v[164:167]
  v_cvt_pk_bf16_f32 v238, v76, v77
  v_mul_f32 v79, v79, v235
  v_mfma_f32_16x16x32_bf16 v[148:151], v[64:67], a[140:143], v[148:151]
  s_waitcnt lgkmcnt(2)
  v_cvt_pk_bf16_f32 v239, v78, v79
  v_fmac_f32 v80, v202, v212
  v_mfma_f32_16x16x32_bf16 v[136:139], v[48:51], a[144:147], v[136:139]
  ds_read_b128 v[64:67], v6 offset:30720
  v_fmac_f32 v81, v202, v213
  v_mfma_f32_16x16x32_bf16 v[152:155], v[52:55], a[144:147], v[152:155]
  v_permlane16_swap_b32 v236, v238
  v_mfma_f32_16x16x32_bf16 v[156:159], v[52:55], a[148:151], v[156:159]
  buffer_load_dwordx4 v9, s[12:15], m0 offen offset:1024 sc1 lds
  v_mfma_f32_16x16x32_bf16 v[140:143], v[48:51], a[148:151], v[140:143]
  v_permlane16_swap_b32 v237, v239
  buffer_store_dwordx4 v[236:239], v11, s[24:27], s45 offen sc1
  v_mfma_f32_16x16x32_bf16 v[144:147], v[48:51], a[152:155], v[144:147]
  ds_read_b128 v[68:71], v6 offset:31744
  v_fmac_f32 v82, v202, v214
  v_mfma_f32_16x16x32_bf16 v[160:163], v[52:55], a[152:155], v[160:163]
  v_fmac_f32 v83, v202, v215
  v_mul_f32 v228, v206, v80
  v_mfma_f32_16x16x32_bf16 v[164:167], v[52:55], a[156:159], v[164:167]
  v_mul_f32 v229, v206, v81
  v_mul_f32 v230, v206, v82
  v_mfma_f32_16x16x32_bf16 v[148:151], v[48:51], a[156:159], v[148:151]
  s_waitcnt lgkmcnt(2)
  v_mul_f32 v231, v206, v83
  v_fmac_f32 v96, v202, v216
  v_mfma_f32_16x16x32_bf16 v[136:139], v[56:59], a[160:163], v[136:139]
  ds_read_b128 v[48:51], v6 offset:32768
  v_fmac_f32 v97, v202, v217
  v_mfma_f32_16x16x32_bf16 v[152:155], v[60:63], a[160:163], v[152:155]
  v_exp_f32 v228, v228
  v_mfma_f32_16x16x32_bf16 v[156:159], v[60:63], a[164:167], v[156:159]
  v_exp_f32 v229, v229
  v_mfma_f32_16x16x32_bf16 v[140:143], v[56:59], a[164:167], v[140:143]
  v_exp_f32 v230, v230
  v_mfma_f32_16x16x32_bf16 v[144:147], v[56:59], a[168:171], v[144:147]
  ds_read_b128 v[52:55], v6 offset:33792
  v_fmac_f32 v98, v202, v218
  v_mfma_f32_16x16x32_bf16 v[160:163], v[60:63], a[168:171], v[160:163]
  v_exp_f32 v231, v231
  v_mfma_f32_16x16x32_bf16 v[164:167], v[60:63], a[172:175], v[164:167]
  buffer_load_dwordx4 v9, s[12:15], m0 offen offset:2048 sc1 lds
  v_mfma_f32_16x16x32_bf16 v[148:151], v[56:59], a[172:175], v[148:151]
  s_waitcnt lgkmcnt(2)
  v_fmac_f32 v99, v202, v219
  v_fma_f32 v228, v228, v210, v210
  v_mfma_f32_16x16x32_bf16 v[136:139], v[64:67], a[176:179], v[136:139]
  ds_read_b128 v[56:59], v6 offset:34816
  v_fma_f32 v229, v229, v210, v210
  v_mfma_f32_16x16x32_bf16 v[152:155], v[68:71], a[176:179], v[152:155]
  v_fma_f32 v230, v230, v210, v210
  v_fma_f32 v231, v231, v210, v210
  v_mfma_f32_16x16x32_bf16 v[156:159], v[68:71], a[180:183], v[156:159]
  v_rcp_f32 v228, v228
  v_mfma_f32_16x16x32_bf16 v[140:143], v[64:67], a[180:183], v[140:143]
  v_rcp_f32 v229, v229
  v_mfma_f32_16x16x32_bf16 v[144:147], v[64:67], a[184:187], v[144:147]
  ds_read_b128 v[60:63], v6 offset:35840
  v_mul_f32 v80, v80, v96
  v_mfma_f32_16x16x32_bf16 v[160:163], v[68:71], a[184:187], v[160:163]
  v_rcp_f32 v230, v230
  v_mfma_f32_16x16x32_bf16 v[164:167], v[68:71], a[188:191], v[164:167]
  v_rcp_f32 v231, v231
  v_mfma_f32_16x16x32_bf16 v[148:151], v[64:67], a[188:191], v[148:151]
  s_waitcnt lgkmcnt(2)
  v_mul_f32 v81, v81, v97
  v_mul_f32 v82, v82, v98
  v_mfma_f32_16x16x32_bf16 v[136:139], v[48:51], a[192:195], v[136:139]
  ds_read_b128 v[64:67], v6 offset:36864
  v_mul_f32 v83, v83, v99
  v_mfma_f32_16x16x32_bf16 v[152:155], v[52:55], a[192:195], v[152:155]
  v_mul_f32 v80, v80, v228
  v_mul_f32 v81, v81, v229
  v_mfma_f32_16x16x32_bf16 v[156:159], v[52:55], a[196:199], v[156:159]
  v_mul_f32 v82, v82, v230
  v_mul_f32 v83, v83, v231
  v_mfma_f32_16x16x32_bf16 v[140:143], v[48:51], a[196:199], v[140:143]
  v_cvt_pk_bf16_f32 v241, v82, v83
  v_cvt_pk_bf16_f32 v240, v80, v81
  v_mfma_f32_16x16x32_bf16 v[144:147], v[48:51], a[200:203], v[144:147]
  ds_read_b128 v[68:71], v6 offset:37888
  v_fmac_f32 v84, v203, v212
  v_mfma_f32_16x16x32_bf16 v[160:163], v[52:55], a[200:203], v[160:163]
  v_fmac_f32 v85, v203, v213
  v_fmac_f32 v86, v203, v214
  v_mfma_f32_16x16x32_bf16 v[164:167], v[52:55], a[204:207], v[164:167]
  buffer_load_dwordx4 v9, s[12:15], m0 offen offset:3072 sc1 lds
  v_mfma_f32_16x16x32_bf16 v[148:151], v[48:51], a[204:207], v[148:151]
  s_waitcnt lgkmcnt(2)
  v_fmac_f32 v87, v203, v215
  v_mul_f32 v232, v207, v84
  v_mfma_f32_16x16x32_bf16 v[136:139], v[56:59], a[208:211], v[136:139]
  ds_read_b128 v[48:51], v6 offset:38912
  v_mul_f32 v233, v207, v85
  v_mfma_f32_16x16x32_bf16 v[152:155], v[60:63], a[208:211], v[152:155]
  v_mul_f32 v234, v207, v86
  v_mul_f32 v235, v207, v87
  v_mfma_f32_16x16x32_bf16 v[156:159], v[60:63], a[212:215], v[156:159]
  v_exp_f32 v232, v232
  v_mfma_f32_16x16x32_bf16 v[140:143], v[56:59], a[212:215], v[140:143]
  v_exp_f32 v233, v233
  v_mfma_f32_16x16x32_bf16 v[144:147], v[56:59], a[216:219], v[144:147]
  ds_read_b128 v[52:55], v6 offset:39936
  v_fmac_f32 v100, v203, v216
  v_mfma_f32_16x16x32_bf16 v[160:163], v[60:63], a[216:219], v[160:163]
  v_exp_f32 v234, v234
  v_mfma_f32_16x16x32_bf16 v[164:167], v[60:63], a[220:223], v[164:167]
  v_exp_f32 v235, v235
  v_mfma_f32_16x16x32_bf16 v[148:151], v[56:59], a[220:223], v[148:151]
  s_waitcnt lgkmcnt(2)
  v_fmac_f32 v101, v203, v217
  v_fmac_f32 v102, v203, v218
  v_mfma_f32_16x16x32_bf16 v[136:139], v[64:67], a[224:227], v[136:139]
  ds_read_b128 v[56:59], v6 offset:40960
  v_fmac_f32 v103, v203, v219
  v_mfma_f32_16x16x32_bf16 v[152:155], v[68:71], a[224:227], v[152:155]
  s_add_u32 m0, s39, 8192
  v_fma_f32 v232, v232, v211, v211
  v_fma_f32 v233, v233, v211, v211
  v_mfma_f32_16x16x32_bf16 v[156:159], v[68:71], a[228:231], v[156:159]
  buffer_load_dwordx4 v9, s[12:15], m0 offen offset:0 sc1 lds
  v_mfma_f32_16x16x32_bf16 v[140:143], v[64:67], a[228:231], v[140:143]
  v_fma_f32 v234, v234, v211, v211
  v_fma_f32 v235, v235, v211, v211
  v_mfma_f32_16x16x32_bf16 v[144:147], v[64:67], a[232:235], v[144:147]
  ds_read_b128 v[60:63], v6 offset:41984
  v_mul_f32 v84, v84, v100
  v_mfma_f32_16x16x32_bf16 v[160:163], v[68:71], a[232:235], v[160:163]
  v_rcp_f32 v232, v232
  v_mfma_f32_16x16x32_bf16 v[164:167], v[68:71], a[236:239], v[164:167]
  v_rcp_f32 v233, v233
  v_mfma_f32_16x16x32_bf16 v[148:151], v[64:67], a[236:239], v[148:151]
  s_waitcnt lgkmcnt(2)
  v_rcp_f32 v234, v234
  v_mfma_f32_16x16x32_bf16 v[136:139], v[48:51], a[240:243], v[136:139]
  ds_read_b128 v[64:67], v6 offset:43008
  v_mul_f32 v85, v85, v101
  v_mfma_f32_16x16x32_bf16 v[152:155], v[52:55], a[240:243], v[152:155]
  v_rcp_f32 v235, v235
  v_mfma_f32_16x16x32_bf16 v[156:159], v[52:55], a[244:247], v[156:159]
  v_mul_f32 v86, v86, v102
  v_mul_f32 v87, v87, v103
  v_mfma_f32_16x16x32_bf16 v[140:143], v[48:51], a[244:247], v[140:143]
  v_mul_f32 v84, v84, v232
  v_mul_f32 v85, v85, v233
  v_mfma_f32_16x16x32_bf16 v[144:147], v[48:51], a[248:251], v[144:147]
  ds_read_b128 v[68:71], v6 offset:44032
  v_mul_f32 v86, v86, v234
  v_mfma_f32_16x16x32_bf16 v[160:163], v[52:55], a[248:251], v[160:163]
  s_waitcnt vmcnt(11)
  v_cvt_pk_bf16_f32 v242, v84, v85
  v_mul_f32 v87, v87, v235
  v_mfma_f32_16x16x32_bf16 v[164:167], v[52:55], a[252:255], v[164:167]
  s_barrier
  v_cvt_pk_bf16_f32 v243, v86, v87
  v_fmac_f32 v104, v200, v220
  v_mfma_f32_16x16x32_bf16 v[148:151], v[48:51], a[252:255], v[148:151]
  s_waitcnt lgkmcnt(2)
  v_permlane16_swap_b32 v240, v242
  v_mfma_f32_16x16x32_bf16 v[136:139], v[56:59], v[16:19], v[136:139]
  ds_read_b128 v[48:51], v6 offset:45056
  v_fmac_f32 v105, v200, v221
  v_mfma_f32_16x16x32_bf16 v[152:155], v[60:63], v[16:19], v[152:155]
  v_permlane16_swap_b32 v241, v243
  buffer_store_dwordx4 v[240:243], v12, s[24:27], s45 offen sc1
  v_mfma_f32_16x16x32_bf16 v[156:159], v[60:63], v[20:23], v[156:159]
  s_add_u32 s45, s45, 4096
  s_lshr_b32 s6, s2, 3
  s_lshl_b32 s6, s6, 2
  s_add_u32 s6, s6, s18
  s_mov_b64 exec, 7
  s_getpc_b64 s[20:21]
cpf3:
  s_sub_u32 s20, s20, cpf3-q2_l1
  s_subb_u32 s21, s21, 0
  v_mul_u32_u24 v248, 128, v254
  v_add_u32 v248, s6, v248
  v_lshlrev_b32 v248, 7, v248
  v_min_u32 v248, at_main-q2_l1-4, v248
  global_load_dword v248, v248, s[20:21]
  s_getpc_b64 s[20:21]
cpf4:
  s_add_u32 s20, s20, fa_ok-cpf4
  s_addc_u32 s21, s21, 0
  v_mul_u32_u24 v249, 128, v254
  v_add_u32 v249, s6, v249
  v_lshlrev_b32 v249, 7, v249
  v_min_u32 v249, code_end-fa_ok-4, v249
  global_load_dword v249, v249, s[20:21]
  s_mov_b64 exec, -1
  v_mfma_f32_16x16x32_bf16 v[140:143], v[56:59], v[20:23], v[140:143]
  v_fmac_f32 v106, v200, v222
  v_fmac_f32 v107, v200, v223
  v_mfma_f32_16x16x32_bf16 v[144:147], v[56:59], v[24:27], v[144:147]
  ds_read_b128 v[52:55], v6 offset:46080
  v_mul_f32 v228, v204, v104
  v_mfma_f32_16x16x32_bf16 v[160:163], v[60:63], v[24:27], v[160:163]
  v_mul_f32 v229, v204, v105
  v_mul_f32 v230, v204, v106
  v_mfma_f32_16x16x32_bf16 v[164:167], v[60:63], v[28:31], v[164:167]
  v_mul_f32 v231, v204, v107
  v_fmac_f32 v120, v200, v224
  v_mfma_f32_16x16x32_bf16 v[148:151], v[56:59], v[28:31], v[148:151]
  s_waitcnt lgkmcnt(2)
  v_exp_f32 v228, v228
  v_mfma_f32_16x16x32_bf16 v[136:139], v[64:67], v[32:35], v[136:139]
  ds_read_b128 v[56:59], v6 offset:47104
  v_fmac_f32 v121, v200, v225
  v_mfma_f32_16x16x32_bf16 v[152:155], v[68:71], v[32:35], v[152:155]
  v_exp_f32 v229, v229
  v_mfma_f32_16x16x32_bf16 v[156:159], v[68:71], v[36:39], v[156:159]
  v_exp_f32 v230, v230
  v_mfma_f32_16x16x32_bf16 v[140:143], v[64:67], v[36:39], v[140:143]
  v_exp_f32 v231, v231
  v_mfma_f32_16x16x32_bf16 v[144:147], v[64:67], v[40:43], v[144:147]
  ds_read_b128 v[60:63], v6 offset:48128
  v_fmac_f32 v122, v200, v226
  v_mfma_f32_16x16x32_bf16 v[160:163], v[68:71], v[40:43], v[160:163]
  v_fmac_f32 v123, v200, v227
  v_fma_f32 v228, v228, v208, v208
  v_mfma_f32_16x16x32_bf16 v[164:167], v[68:71], v[44:47], v[164:167]
  v_fma_f32 v229, v229, v208, v208
  v_fma_f32 v230, v230, v208, v208
  v_mfma_f32_16x16x32_bf16 v[148:151], v[64:67], v[44:47], v[148:151]
  s_waitcnt lgkmcnt(2)
  v_fma_f32 v231, v231, v208, v208
  v_mul_f32 v104, v104, v120
  v_mfma_f32_16x16x32_bf16 v[168:171], v[48:51], a[0:3], 0
  ds_read_b128 v[64:67], v6 offset:49152
  v_mul_f32 v105, v105, v121
  v_mfma_f32_16x16x32_bf16 v[184:187], v[52:55], a[0:3], 0
  v_rcp_f32 v228, v228
  v_mfma_f32_16x16x32_bf16 v[188:191], v[52:55], a[4:7], 0
  s_add_u32 m0, s39, 36864
  s_nop 0
  buffer_load_dwordx4 v1, s[60:63], s52 offen offset:0 sc1 lds
  v_mfma_f32_16x16x32_bf16 v[172:175], v[48:51], a[4:7], 0
  v_rcp_f32 v229, v229
  v_mfma_f32_16x16x32_bf16 v[176:179], v[48:51], a[8:11], 0
  ds_read_b128 v[68:71], v6 offset:50176
  v_mul_f32 v106, v106, v122
  v_mfma_f32_16x16x32_bf16 v[192:195], v[52:55], a[8:11], 0
  v_rcp_f32 v230, v230
  v_mfma_f32_16x16x32_bf16 v[196:199], v[52:55], a[12:15], 0
  v_rcp_f32 v231, v231
  v_mfma_f32_16x16x32_bf16 v[180:183], v[48:51], a[12:15], 0
  s_waitcnt lgkmcnt(2)
  v_mul_f32 v107, v107, v123
  v_mul_f32 v104, v104, v228
  v_mfma_f32_16x16x32_bf16 v[168:171], v[56:59], a[16:19], v[168:171]
  ds_read_b128 v[48:51], v6 offset:51200
  v_mul_f32 v105, v105, v229
  v_mfma_f32_16x16x32_bf16 v[184:187], v[60:63], a[16:19], v[184:187]
  v_mul_f32 v106, v106, v230
  v_mul_f32 v107, v107, v231
  v_mfma_f32_16x16x32_bf16 v[188:191], v[60:63], a[20:23], v[188:191]
  v_cvt_pk_bf16_f32 v237, v106, v107
  v_cvt_pk_bf16_f32 v236, v104, v105
  v_mfma_f32_16x16x32_bf16 v[172:175], v[56:59], a[20:23], v[172:175]
  buffer_load_dwordx4 v1, s[60:63], s52 offen offset:1024 sc1 lds
  v_mfma_f32_16x16x32_bf16 v[176:179], v[56:59], a[24:27], v[176:179]
  ds_read_b128 v[52:55], v6 offset:52224
  ds_read_b128 v[212:215], v10 offset:768
  v_mfma_f32_16x16x32_bf16 v[192:195], v[60:63], a[24:27], v[192:195]
  ds_read_b128 v[216:219], v10 offset:832
  v_fmac_f32 v108, v201, v220
  v_mfma_f32_16x16x32_bf16 v[196:199], v[60:63], a[28:31], v[196:199]
  v_fmac_f32 v109, v201, v221
  v_fmac_f32 v110, v201, v222
  v_mfma_f32_16x16x32_bf16 v[180:183], v[56:59], a[28:31], v[180:183]
  s_waitcnt lgkmcnt(4)
  v_fmac_f32 v111, v201, v223
  v_mul_f32 v232, v205, v108
  v_mfma_f32_16x16x32_bf16 v[168:171], v[64:67], a[32:35], v[168:171]
  ds_read_b128 v[56:59], v6 offset:53248
  v_mul_f32 v233, v205, v109
  v_mfma_f32_16x16x32_bf16 v[184:187], v[68:71], a[32:35], v[184:187]
  v_mul_f32 v234, v205, v110
  v_mul_f32 v235, v205, v111
  v_mfma_f32_16x16x32_bf16 v[188:191], v[68:71], a[36:39], v[188:191]
  v_exp_f32 v232, v232
  v_mfma_f32_16x16x32_bf16 v[172:175], v[64:67], a[36:39], v[172:175]
  v_exp_f32 v233, v233
  v_mfma_f32_16x16x32_bf16 v[176:179], v[64:67], a[40:43], v[176:179]
  ds_read_b128 v[60:63], v6 offset:54272
  v_fmac_f32 v124, v201, v224
  v_mfma_f32_16x16x32_bf16 v[192:195], v[68:71], a[40:43], v[192:195]
  buffer_load_dwordx4 v1, s[60:63], s52 offen offset:2048 sc1 lds
  v_mfma_f32_16x16x32_bf16 v[196:199], v[68:71], a[44:47], v[196:199]
  v_exp_f32 v234, v234
  v_mfma_f32_16x16x32_bf16 v[180:183], v[64:67], a[44:47], v[180:183]
  s_waitcnt lgkmcnt(4)
  v_exp_f32 v235, v235
  v_mfma_f32_16x16x32_bf16 v[168:171], v[48:51], a[48:51], v[168:171]
  ds_read_b128 v[64:67], v6 offset:55296
  v_fmac_f32 v125, v201, v225
  v_mfma_f32_16x16x32_bf16 v[184:187], v[52:55], a[48:51], v[184:187]
  v_fmac_f32 v126, v201, v226
  v_fmac_f32 v127, v201, v227
  v_mfma_f32_16x16x32_bf16 v[188:191], v[52:55], a[52:55], v[188:191]
  v_fma_f32 v232, v232, v209, v209
  v_fma_f32 v233, v233, v209, v209
  v_mfma_f32_16x16x32_bf16 v[172:175], v[48:51], a[52:55], v[172:175]
  v_fma_f32 v234, v234, v209, v209
  v_fma_f32 v235, v235, v209, v209
  v_mfma_f32_16x16x32_bf16 v[176:179], v[48:51], a[56:59], v[176:179]
  ds_read_b128 v[68:71], v6 offset:56320
  v_mul_f32 v108, v108, v124
  v_mfma_f32_16x16x32_bf16 v[192:195], v[52:55], a[56:59], v[192:195]
  v_rcp_f32 v232, v232
  v_mfma_f32_16x16x32_bf16 v[196:199], v[52:55], a[60:63], v[196:199]
  buffer_load_dwordx4 v1, s[60:63], s52 offen offset:3072 sc1 lds
  v_mfma_f32_16x16x32_bf16 v[180:183], v[48:51], a[60:63], v[180:183]
  s_waitcnt lgkmcnt(2)
  v_rcp_f32 v233, v233
  v_mfma_f32_16x16x32_bf16 v[168:171], v[56:59], a[64:67], v[168:171]
  ds_read_b128 v[48:51], v6 offset:57344
  v_mul_f32 v109, v109, v125
  v_mfma_f32_16x16x32_bf16 v[184:187], v[60:63], a[64:67], v[184:187]
  v_rcp_f32 v234, v234
  v_mfma_f32_16x16x32_bf16 v[188:191], v[60:63], a[68:71], v[188:191]
  v_rcp_f32 v235, v235
  v_mfma_f32_16x16x32_bf16 v[172:175], v[56:59], a[68:71], v[172:175]
  v_mul_f32 v110, v110, v126
  v_mul_f32 v111, v111, v127
  v_mfma_f32_16x16x32_bf16 v[176:179], v[56:59], a[72:75], v[176:179]
  ds_read_b128 v[52:55], v6 offset:58368
  v_mul_f32 v108, v108, v232
  v_mfma_f32_16x16x32_bf16 v[192:195], v[60:63], a[72:75], v[192:195]
  v_mul_f32 v109, v109, v233
  v_mul_f32 v110, v110, v234
  v_mfma_f32_16x16x32_bf16 v[196:199], v[60:63], a[76:79], v[196:199]
  v_cvt_pk_bf16_f32 v238, v108, v109
  v_mul_f32 v111, v111, v235
  v_mfma_f32_16x16x32_bf16 v[180:183], v[56:59], a[76:79], v[180:183]
  s_waitcnt lgkmcnt(2)
  s_add_u32 m0, s39, 40960
  s_add_u32 s52, s52, 4096
  buffer_load_dwordx4 v1, s[60:63], s52 offen offset:0 sc1 lds
  v_mfma_f32_16x16x32_bf16 v[168:171], v[64:67], a[80:83], v[168:171]
  ds_read_b128 v[56:59], v6 offset:59392
  v_cvt_pk_bf16_f32 v239, v110, v111
  v_mfma_f32_16x16x32_bf16 v[184:187], v[68:71], a[80:83], v[184:187]
  v_permlane16_swap_b32 v236, v238
  v_mfma_f32_16x16x32_bf16 v[188:191], v[68:71], a[84:87], v[188:191]
  v_permlane16_swap_b32 v237, v239
  buffer_store_dwordx4 v[236:239], v11, s[24:27], s45 offen sc1
  v_mfma_f32_16x16x32_bf16 v[172:175], v[64:67], a[84:87], v[172:175]
  v_fmac_f32 v112, v202, v220
  v_fmac_f32 v113, v202, v221
  v_mfma_f32_16x16x32_bf16 v[176:179], v[64:67], a[88:91], v[176:179]
  ds_read_b128 v[60:63], v6 offset:60416
  v_fmac_f32 v114, v202, v222
  v_mfma_f32_16x16x32_bf16 v[192:195], v[68:71], a[88:91], v[192:195]
  v_fmac_f32 v115, v202, v223
  v_mul_f32 v228, v206, v112
  v_mfma_f32_16x16x32_bf16 v[196:199], v[68:71], a[92:95], v[196:199]
  v_mul_f32 v229, v206, v113
  v_mul_f32 v230, v206, v114
  v_mfma_f32_16x16x32_bf16 v[180:183], v[64:67], a[92:95], v[180:183]
  s_waitcnt lgkmcnt(2)
  v_mul_f32 v231, v206, v115
  v_fmac_f32 v128, v202, v224
  v_mfma_f32_16x16x32_bf16 v[168:171], v[48:51], a[96:99], v[168:171]
  ds_read_b128 v[64:67], v6 offset:61440
  v_fmac_f32 v129, v202, v225
  v_mfma_f32_16x16x32_bf16 v[184:187], v[52:55], a[96:99], v[184:187]
  buffer_load_dwordx4 v1, s[60:63], s52 offen offset:1024 sc1 lds
  v_mfma_f32_16x16x32_bf16 v[188:191], v[52:55], a[100:103], v[188:191]
  v_exp_f32 v228, v228
  v_mfma_f32_16x16x32_bf16 v[172:175], v[48:51], a[100:103], v[172:175]
  v_exp_f32 v229, v229
  v_mfma_f32_16x16x32_bf16 v[176:179], v[48:51], a[104:107], v[176:179]
  ds_read_b128 v[68:71], v6 offset:62464
  v_fmac_f32 v130, v202, v226
  v_mfma_f32_16x16x32_bf16 v[192:195], v[52:55], a[104:107], v[192:195]
  v_exp_f32 v230, v230
  v_mfma_f32_16x16x32_bf16 v[196:199], v[52:55], a[108:111], v[196:199]
  v_exp_f32 v231, v231
  v_mfma_f32_16x16x32_bf16 v[180:183], v[48:51], a[108:111], v[180:183]
  s_waitcnt lgkmcnt(2)
  v_fmac_f32 v131, v202, v227
  v_fma_f32 v228, v228, v210, v210
  v_mfma_f32_16x16x32_bf16 v[168:171], v[56:59], a[112:115], v[168:171]
  ds_read_b128 v[48:51], v6 offset:63488
  v_fma_f32 v229, v229, v210, v210
  v_mfma_f32_16x16x32_bf16 v[184:187], v[60:63], a[112:115], v[184:187]
  v_fma_f32 v230, v230, v210, v210
  v_fma_f32 v231, v231, v210, v210
  v_mfma_f32_16x16x32_bf16 v[188:191], v[60:63], a[116:119], v[188:191]
  buffer_load_dwordx4 v1, s[60:63], s52 offen offset:2048 sc1 lds
  v_mfma_f32_16x16x32_bf16 v[172:175], v[56:59], a[116:119], v[172:175]
  v_rcp_f32 v228, v228
  v_mfma_f32_16x16x32_bf16 v[176:179], v[56:59], a[120:123], v[176:179]
  ds_read_b128 v[52:55], v6 offset:64512
  v_mul_f32 v112, v112, v128
  v_mfma_f32_16x16x32_bf16 v[192:195], v[60:63], a[120:123], v[192:195]
  v_rcp_f32 v229, v229
  v_mfma_f32_16x16x32_bf16 v[196:199], v[60:63], a[124:127], v[196:199]
  v_rcp_f32 v230, v230
  v_mfma_f32_16x16x32_bf16 v[180:183], v[56:59], a[124:127], v[180:183]
  s_waitcnt lgkmcnt(2)
  v_rcp_f32 v231, v231
  v_mfma_f32_16x16x32_bf16 v[168:171], v[64:67], a[128:131], v[168:171]
  ds_read_b128 v[56:59], v7 offset:0
  v_mul_f32 v113, v113, v129
  v_mfma_f32_16x16x32_bf16 v[184:187], v[68:71], a[128:131], v[184:187]
  v_mul_f32 v114, v114, v130
  v_mul_f32 v115, v115, v131
  v_mfma_f32_16x16x32_bf16 v[188:191], v[68:71], a[132:135], v[188:191]
  v_mul_f32 v112, v112, v228
  v_mul_f32 v113, v113, v229
  v_mfma_f32_16x16x32_bf16 v[172:175], v[64:67], a[132:135], v[172:175]
  buffer_load_dwordx4 v1, s[60:63], s52 offen offset:3072 sc1 lds
  v_mfma_f32_16x16x32_bf16 v[176:179], v[64:67], a[136:139], v[176:179]
  ds_read_b128 v[60:63], v7 offset:1024
  v_mul_f32 v114, v114, v230
  v_mfma_f32_16x16x32_bf16 v[192:195], v[68:71], a[136:139], v[192:195]
  v_cvt_pk_bf16_f32 v240, v112, v113
  v_mul_f32 v115, v115, v231
  v_mfma_f32_16x16x32_bf16 v[196:199], v[68:71], a[140:143], v[196:199]
  v_cvt_pk_bf16_f32 v241, v114, v115
  v_fmac_f32 v116, v203, v220
  v_mfma_f32_16x16x32_bf16 v[180:183], v[64:67], a[140:143], v[180:183]
  s_waitcnt lgkmcnt(2)
  v_fmac_f32 v117, v203, v221
  v_fmac_f32 v118, v203, v222
  v_mfma_f32_16x16x32_bf16 v[168:171], v[48:51], a[144:147], v[168:171]
  ds_read_b128 v[64:67], v7 offset:2048
  v_fmac_f32 v119, v203, v223
  v_mfma_f32_16x16x32_bf16 v[184:187], v[52:55], a[144:147], v[184:187]
  v_mul_f32 v232, v207, v116
  v_mul_f32 v233, v207, v117
  v_mfma_f32_16x16x32_bf16 v[188:191], v[52:55], a[148:151], v[188:191]
  v_mul_f32 v234, v207, v118
  v_mul_f32 v235, v207, v119
  v_mfma_f32_16x16x32_bf16 v[172:175], v[48:51], a[148:151], v[172:175]
  v_exp_f32 v232, v232
  v_mfma_f32_16x16x32_bf16 v[176:179], v[48:51], a[152:155], v[176:179]
  ds_read_b128 v[68:71], v7 offset:3072
  v_fmac_f32 v132, v203, v224
  v_mfma_f32_16x16x32_bf16 v[192:195], v[52:55], a[152:155], v[192:195]
  s_add_u32 m0, s39, 45056
  s_add_u32 s52, s52, 4096
  buffer_load_dwordx4 v1, s[60:63], s52 offen offset:0 sc1 lds
  v_mfma_f32_16x16x32_bf16 v[196:199], v[52:55], a[156:159], v[196:199]
  v_exp_f32 v233, v233
  v_mfma_f32_16x16x32_bf16 v[180:183], v[48:51], a[156:159], v[180:183]
  s_waitcnt lgkmcnt(2)
  v_exp_f32 v234, v234
  v_mfma_f32_16x16x32_bf16 v[168:171], v[56:59], a[160:163], v[168:171]
  ds_read_b128 v[48:51], v7 offset:4096
  v_fmac_f32 v133, v203, v225
  v_mfma_f32_16x16x32_bf16 v[184:187], v[60:63], a[160:163], v[184:187]
  v_exp_f32 v235, v235
  v_mfma_f32_16x16x32_bf16 v[188:191], v[60:63], a[164:167], v[188:191]
  v_fmac_f32 v134, v203, v226
  v_fmac_f32 v135, v203, v227
  v_mfma_f32_16x16x32_bf16 v[172:175], v[56:59], a[164:167], v[172:175]
  v_fma_f32 v232, v232, v211, v211
  v_fma_f32 v233, v233, v211, v211
  v_mfma_f32_16x16x32_bf16 v[176:179], v[56:59], a[168:171], v[176:179]
  ds_read_b128 v[52:55], v7 offset:5120
  v_fma_f32 v234, v234, v211, v211
  v_mfma_f32_16x16x32_bf16 v[192:195], v[60:63], a[168:171], v[192:195]
  v_fma_f32 v235, v235, v211, v211
  v_mul_f32 v116, v116, v132
  v_mfma_f32_16x16x32_bf16 v[196:199], v[60:63], a[172:175], v[196:199]
  v_rcp_f32 v232, v232
  v_mfma_f32_16x16x32_bf16 v[180:183], v[56:59], a[172:175], v[180:183]
  s_waitcnt lgkmcnt(2)
  v_rcp_f32 v233, v233
  v_mfma_f32_16x16x32_bf16 v[168:171], v[64:67], a[176:179], v[168:171]
  ds_read_b128 v[56:59], v7 offset:6144
  v_mul_f32 v117, v117, v133
  v_mfma_f32_16x16x32_bf16 v[184:187], v[68:71], a[176:179], v[184:187]
  v_rcp_f32 v234, v234
  v_mfma_f32_16x16x32_bf16 v[188:191], v[68:71], a[180:183], v[188:191]
  v_rcp_f32 v235, v235
  v_mfma_f32_16x16x32_bf16 v[172:175], v[64:67], a[180:183], v[172:175]
  v_mul_f32 v118, v118, v134
  v_mul_f32 v119, v119, v135
  v_mfma_f32_16x16x32_bf16 v[176:179], v[64:67], a[184:187], v[176:179]
  ds_read_b128 v[60:63], v7 offset:7168
  v_mul_f32 v116, v116, v232
  v_mfma_f32_16x16x32_bf16 v[192:195], v[68:71], a[184:187], v[192:195]
  v_mul_f32 v117, v117, v233
  v_mul_f32 v118, v118, v234
  v_mfma_f32_16x16x32_bf16 v[196:199], v[68:71], a[188:191], v[196:199]
  v_cvt_pk_bf16_f32 v242, v116, v117
  v_mul_f32 v119, v119, v235
  v_mfma_f32_16x16x32_bf16 v[180:183], v[64:67], a[188:191], v[180:183]
  s_waitcnt lgkmcnt(2)
  v_cvt_pk_bf16_f32 v243, v118, v119
  v_fmac_f32 v136, v200, v212
  v_mfma_f32_16x16x32_bf16 v[168:171], v[48:51], a[192:195], v[168:171]
  ds_read_b128 v[64:67], v7 offset:8192
  v_fmac_f32 v137, v200, v213
  v_mfma_f32_16x16x32_bf16 v[184:187], v[52:55], a[192:195], v[184:187]
  v_permlane16_swap_b32 v240, v242
  v_mfma_f32_16x16x32_bf16 v[188:191], v[52:55], a[196:199], v[188:191]
  v_permlane16_swap_b32 v241, v243
  buffer_store_dwordx4 v[240:243], v12, s[24:27], s45 offen sc1
  v_mfma_f32_16x16x32_bf16 v[172:175], v[48:51], a[196:199], v[172:175]
  s_add_u32 s45, s45, 4096
  v_fmac_f32 v138, v200, v214
  v_fmac_f32 v139, v200, v215
  v_mfma_f32_16x16x32_bf16 v[176:179], v[48:51], a[200:203], v[176:179]
  ds_read_b128 v[68:71], v7 offset:9216
  v_mul_f32 v228, v204, v136
  v_mfma_f32_16x16x32_bf16 v[192:195], v[52:55], a[200:203], v[192:195]
  v_mul_f32 v229, v204, v137
  v_mul_f32 v230, v204, v138
  v_mfma_f32_16x16x32_bf16 v[196:199], v[52:55], a[204:207], v[196:199]
  v_mul_f32 v231, v204, v139
  v_fmac_f32 v152, v200, v216
  v_mfma_f32_16x16x32_bf16 v[180:183], v[48:51], a[204:207], v[180:183]
  s_waitcnt lgkmcnt(2)
  v_exp_f32 v228, v228
  v_mfma_f32_16x16x32_bf16 v[168:171], v[56:59], a[208:211], v[168:171]
  ds_read_b128 v[48:51], v7 offset:10240
  v_fmac_f32 v153, v200, v217
  v_mfma_f32_16x16x32_bf16 v[184:187], v[60:63], a[208:211], v[184:187]
  v_exp_f32 v229, v229
  v_mfma_f32_16x16x32_bf16 v[188:191], v[60:63], a[212:215], v[188:191]
  v_exp_f32 v230, v230
  v_mfma_f32_16x16x32_bf16 v[172:175], v[56:59], a[212:215], v[172:175]
  v_exp_f32 v231, v231
  v_mfma_f32_16x16x32_bf16 v[176:179], v[56:59], a[216:219], v[176:179]
  ds_read_b128 v[52:55], v7 offset:11264
  v_fmac_f32 v154, v200, v218
  v_mfma_f32_16x16x32_bf16 v[192:195], v[60:63], a[216:219], v[192:195]
  v_fmac_f32 v155, v200, v219
  v_fma_f32 v228, v228, v208, v208
  v_mfma_f32_16x16x32_bf16 v[196:199], v[60:63], a[220:223], v[196:199]
  v_fma_f32 v229, v229, v208, v208
  v_fma_f32 v230, v230, v208, v208
  v_mfma_f32_16x16x32_bf16 v[180:183], v[56:59], a[220:223], v[180:183]
  s_waitcnt lgkmcnt(2)
  v_fma_f32 v231, v231, v208, v208
  v_mul_f32 v136, v136, v152
  v_mfma_f32_16x16x32_bf16 v[168:171], v[64:67], a[224:227], v[168:171]
  ds_read_b128 v[56:59], v7 offset:12288
  v_mul_f32 v137, v137, v153
  v_mfma_f32_16x16x32_bf16 v[184:187], v[68:71], a[224:227], v[184:187]
  v_rcp_f32 v228, v228
  v_mfma_f32_16x16x32_bf16 v[188:191], v[68:71], a[228:231], v[188:191]
  v_rcp_f32 v229, v229
  v_mfma_f32_16x16x32_bf16 v[172:175], v[64:67], a[228:231], v[172:175]
  v_rcp_f32 v230, v230
  v_mfma_f32_16x16x32_bf16 v[176:179], v[64:67], a[232:235], v[176:179]
  ds_read_b128 v[60:63], v7 offset:13312
  v_mul_f32 v138, v138, v154
  v_mfma_f32_16x16x32_bf16 v[192:195], v[68:71], a[232:235], v[192:195]
  v_rcp_f32 v231, v231
  v_mfma_f32_16x16x32_bf16 v[196:199], v[68:71], a[236:239], v[196:199]
  v_mul_f32 v139, v139, v155
  v_mul_f32 v136, v136, v228
  v_mfma_f32_16x16x32_bf16 v[180:183], v[64:67], a[236:239], v[180:183]
  s_waitcnt lgkmcnt(2)
  v_mul_f32 v137, v137, v229
  v_mul_f32 v138, v138, v230
  v_mfma_f32_16x16x32_bf16 v[168:171], v[48:51], a[240:243], v[168:171]
  ds_read_b128 v[64:67], v7 offset:14336
  v_mul_f32 v139, v139, v231
  v_mfma_f32_16x16x32_bf16 v[184:187], v[52:55], a[240:243], v[184:187]
  v_cvt_pk_bf16_f32 v237, v138, v139
  v_cvt_pk_bf16_f32 v236, v136, v137
  v_mfma_f32_16x16x32_bf16 v[188:191], v[52:55], a[244:247], v[188:191]
  ds_read_b128 v[220:223], v10 offset:896
  ds_read_b128 v[224:227], v10 offset:960
  v_mfma_f32_16x16x32_bf16 v[172:175], v[48:51], a[244:247], v[172:175]
  v_fmac_f32 v140, v201, v212
  v_fmac_f32 v141, v201, v213
  v_mfma_f32_16x16x32_bf16 v[176:179], v[48:51], a[248:251], v[176:179]
  s_waitcnt vmcnt(13)
  ds_read_b128 v[68:71], v7 offset:15360
  v_fmac_f32 v142, v201, v214
  v_mfma_f32_16x16x32_bf16 v[192:195], v[52:55], a[248:251], v[192:195]
  s_waitcnt vmcnt(14)
  v_fmac_f32 v143, v201, v215
  v_mul_f32 v232, v205, v140
  v_mfma_f32_16x16x32_bf16 v[196:199], v[52:55], a[252:255], v[196:199]
  s_barrier
  v_mul_f32 v233, v205, v141
  v_mul_f32 v234, v205, v142
  v_mfma_f32_16x16x32_bf16 v[180:183], v[48:51], a[252:255], v[180:183]
  s_waitcnt lgkmcnt(4)
  v_mul_f32 v235, v205, v143
  v_fmac_f32 v156, v201, v216
  v_mfma_f32_16x16x32_bf16 v[168:171], v[56:59], v[16:19], v[168:171]
  ds_read_b128 v[48:51], v1 offset:0
  v_fmac_f32 v157, v201, v217
  v_mfma_f32_16x16x32_bf16 v[184:187], v[60:63], v[16:19], v[184:187]
  v_exp_f32 v232, v232
  v_mfma_f32_16x16x32_bf16 v[188:191], v[60:63], v[20:23], v[188:191]
  s_mov_b64 exec, 1
  buffer_store_dword v253, v252, s[96:99], s55 offen sc1
  s_mov_b64 exec, -1
  v_mfma_f32_16x16x32_bf16 v[172:175], v[56:59], v[20:23], v[172:175]
  v_exp_f32 v233, v233
  v_mfma_f32_16x16x32_bf16 v[176:179], v[56:59], v[24:27], v[176:179]
  ds_read_b128 v[52:55], v1 offset:1024
  v_fmac_f32 v158, v201, v218
  v_mfma_f32_16x16x32_bf16 v[192:195], v[60:63], v[24:27], v[192:195]
  v_exp_f32 v234, v234
  v_mfma_f32_16x16x32_bf16 v[196:199], v[60:63], v[28:31], v[196:199]
  v_exp_f32 v235, v235
  v_mfma_f32_16x16x32_bf16 v[180:183], v[56:59], v[28:31], v[180:183]
  s_waitcnt lgkmcnt(2)
  v_fmac_f32 v159, v201, v219
  v_fma_f32 v232, v232, v209, v209
  v_mfma_f32_16x16x32_bf16 v[168:171], v[64:67], v[32:35], v[168:171]
  ds_read_b128 v[56:59], v1 offset:2048
  v_fma_f32 v233, v233, v209, v209
  v_mfma_f32_16x16x32_bf16 v[184:187], v[68:71], v[32:35], v[184:187]
  v_fma_f32 v234, v234, v209, v209
  v_fma_f32 v235, v235, v209, v209
  v_mfma_f32_16x16x32_bf16 v[188:191], v[68:71], v[36:39], v[188:191]
  v_rcp_f32 v232, v232
  v_mfma_f32_16x16x32_bf16 v[172:175], v[64:67], v[36:39], v[172:175]
  v_rcp_f32 v233, v233
  v_mfma_f32_16x16x32_bf16 v[176:179], v[64:67], v[40:43], v[176:179]
  ds_read_b128 v[60:63], v1 offset:3072
  v_mul_f32 v140, v140, v156
  v_mfma_f32_16x16x32_bf16 v[192:195], v[68:71], v[40:43], v[192:195]
  v_rcp_f32 v234, v234
  v_mfma_f32_16x16x32_bf16 v[196:199], v[68:71], v[44:47], v[196:199]
  v_rcp_f32 v235, v235
  v_mfma_f32_16x16x32_bf16 v[180:183], v[64:67], v[44:47], v[180:183]
  s_waitcnt lgkmcnt(2)
  v_mul_f32 v141, v141, v157
  v_mul_f32 v142, v142, v158
  v_mfma_f32_16x16x32_bf16 v[72:75], v[48:51], a[0:3], 0
  ds_read_b128 v[64:67], v1 offset:4096
  v_mul_f32 v143, v143, v159
  v_mfma_f32_16x16x32_bf16 v[88:91], v[52:55], a[0:3], 0
  v_mul_f32 v140, v140, v232
  v_mul_f32 v141, v141, v233
  v_mfma_f32_16x16x32_bf16 v[92:95], v[52:55], a[4:7], 0
  s_add_u32 m0, s39, 73728
  s_add_u32 s52, s52, 28672
  buffer_load_dwordx4 v1, s[60:63], s52 offen offset:0 sc1 lds
  v_mfma_f32_16x16x32_bf16 v[76:79], v[48:51], a[4:7], 0
  v_mul_f32 v142, v142, v234
  v_mul_f32 v143, v143, v235
  v_mfma_f32_16x16x32_bf16 v[80:83], v[48:51], a[8:11], 0
  ds_read_b128 v[68:71], v1 offset:5120
  v_cvt_pk_bf16_f32 v238, v140, v141
  v_mfma_f32_16x16x32_bf16 v[96:99], v[52:55], a[8:11], 0
  v_cvt_pk_bf16_f32 v239, v142, v143
  v_fmac_f32 v144, v202, v212
  v_mfma_f32_16x16x32_bf16 v[100:103], v[52:55], a[12:15], 0
  v_permlane16_swap_b32 v236, v238
  v_mfma_f32_16x16x32_bf16 v[84:87], v[48:51], a[12:15], 0
  s_waitcnt lgkmcnt(2)
  v_permlane16_swap_b32 v237, v239
  buffer_store_dwordx4 v[236:239], v11, s[24:27], s45 offen sc1
  v_mfma_f32_16x16x32_bf16 v[72:75], v[56:59], a[16:19], v[72:75]
  ds_read_b128 v[48:51], v1 offset:6144
  v_fmac_f32 v145, v202, v213
  v_mfma_f32_16x16x32_bf16 v[88:91], v[60:63], a[16:19], v[88:91]
  v_fmac_f32 v146, v202, v214
  v_fmac_f32 v147, v202, v215
  v_mfma_f32_16x16x32_bf16 v[92:95], v[60:63], a[20:23], v[92:95]
  v_mul_f32 v228, v206, v144
  v_mul_f32 v229, v206, v145
  v_mfma_f32_16x16x32_bf16 v[76:79], v[56:59], a[20:23], v[76:79]
  buffer_load_dwordx4 v1, s[60:63], s52 offen offset:1024 sc1 lds
  v_mfma_f32_16x16x32_bf16 v[80:83], v[56:59], a[24:27], v[80:83]
  ds_read_b128 v[52:55], v1 offset:7168
  v_mul_f32 v230, v206, v146
  v_mfma_f32_16x16x32_bf16 v[96:99], v[60:63], a[24:27], v[96:99]
  v_mul_f32 v231, v206, v147
  v_fmac_f32 v160, v202, v216
  v_mfma_f32_16x16x32_bf16 v[100:103], v[60:63], a[28:31], v[100:103]
  v_exp_f32 v228, v228
  v_mfma_f32_16x16x32_bf16 v[84:87], v[56:59], a[28:31], v[84:87]
  s_waitcnt lgkmcnt(2)
  v_exp_f32 v229, v229
  v_mfma_f32_16x16x32_bf16 v[72:75], v[64:67], a[32:35], v[72:75]
  ds_read_b128 v[56:59], v1 offset:8192
  v_fmac_f32 v161, v202, v217
  v_mfma_f32_16x16x32_bf16 v[88:91], v[68:71], a[32:35], v[88:91]
  v_exp_f32 v230, v230
  v_mfma_f32_16x16x32_bf16 v[92:95], v[68:71], a[36:39], v[92:95]
  v_exp_f32 v231, v231
  v_mfma_f32_16x16x32_bf16 v[76:79], v[64:67], a[36:39], v[76:79]
  v_fmac_f32 v162, v202, v218
  v_fmac_f32 v163, v202, v219
  v_mfma_f32_16x16x32_bf16 v[80:83], v[64:67], a[40:43], v[80:83]
  ds_read_b128 v[60:63], v1 offset:9216
  v_fma_f32 v228, v228, v210, v210
  v_mfma_f32_16x16x32_bf16 v[96:99], v[68:71], a[40:43], v[96:99]
  buffer_load_dwordx4 v1, s[60:63], s52 offen offset:2048 sc1 lds
  v_mfma_f32_16x16x32_bf16 v[100:103], v[68:71], a[44:47], v[100:103]
  v_fma_f32 v229, v229, v210, v210
  v_fma_f32 v230, v230, v210, v210
  v_mfma_f32_16x16x32_bf16 v[84:87], v[64:67], a[44:47], v[84:87]
  s_waitcnt lgkmcnt(2)
  v_fma_f32 v231, v231, v210, v210
  v_mul_f32 v144, v144, v160
  v_mfma_f32_16x16x32_bf16 v[72:75], v[48:51], a[48:51], v[72:75]
  ds_read_b128 v[64:67], v1 offset:10240
  v_mul_f32 v145, v145, v161
  v_mfma_f32_16x16x32_bf16 v[88:91], v[52:55], a[48:51], v[88:91]
  v_rcp_f32 v228, v228
  v_mfma_f32_16x16x32_bf16 v[92:95], v[52:55], a[52:55], v[92:95]
  v_rcp_f32 v229, v229
  v_mfma_f32_16x16x32_bf16 v[76:79], v[48:51], a[52:55], v[76:79]
  v_rcp_f32 v230, v230
  v_mfma_f32_16x16x32_bf16 v[80:83], v[48:51], a[56:59], v[80:83]
  ds_read_b128 v[68:71], v1 offset:11264
  v_mul_f32 v146, v146, v162
  v_mfma_f32_16x16x32_bf16 v[96:99], v[52:55], a[56:59], v[96:99]
  v_rcp_f32 v231, v231
  v_mfma_f32_16x16x32_bf16 v[100:103], v[52:55], a[60:63], v[100:103]
  buffer_load_dwordx4 v1, s[60:63], s52 offen offset:3072 sc1 lds
  v_mfma_f32_16x16x32_bf16 v[84:87], v[48:51], a[60:63], v[84:87]
  s_waitcnt lgkmcnt(2)
  v_mul_f32 v147, v147, v163
  v_mul_f32 v144, v144, v228
  v_mfma_f32_16x16x32_bf16 v[72:75], v[56:59], a[64:67], v[72:75]
  ds_read_b128 v[48:51], v1 offset:12288
  v_mul_f32 v145, v145, v229
  v_mfma_f32_16x16x32_bf16 v[88:91], v[60:63], a[64:67], v[88:91]
  v_mul_f32 v146, v146, v230
  v_mul_f32 v147, v147, v231
  v_mfma_f32_16x16x32_bf16 v[92:95], v[60:63], a[68:71], v[92:95]
  v_cvt_pk_bf16_f32 v241, v146, v147
  v_cvt_pk_bf16_f32 v240, v144, v145
  v_mfma_f32_16x16x32_bf16 v[76:79], v[56:59], a[68:71], v[76:79]
  v_fmac_f32 v148, v203, v212
  v_fmac_f32 v149, v203, v213
  v_mfma_f32_16x16x32_bf16 v[80:83], v[56:59], a[72:75], v[80:83]
  ds_read_b128 v[52:55], v1 offset:13312
  v_fmac_f32 v150, v203, v214
  v_mfma_f32_16x16x32_bf16 v[96:99], v[60:63], a[72:75], v[96:99]
  v_fmac_f32 v151, v203, v215
  v_mul_f32 v232, v207, v148
  v_mfma_f32_16x16x32_bf16 v[100:103], v[60:63], a[76:79], v[100:103]
  v_mul_f32 v233, v207, v149
  v_mul_f32 v234, v207, v150
  v_mfma_f32_16x16x32_bf16 v[84:87], v[56:59], a[76:79], v[84:87]
  s_waitcnt lgkmcnt(2)
  s_add_u32 m0, s39, 77824
  s_add_u32 s52, s52, 4096
  buffer_load_dwordx4 v1, s[60:63], s52 offen offset:0 sc1 lds
  v_mfma_f32_16x16x32_bf16 v[72:75], v[64:67], a[80:83], v[72:75]
  ds_read_b128 v[56:59], v1 offset:14336
  v_mul_f32 v235, v207, v151
  v_mfma_f32_16x16x32_bf16 v[88:91], v[68:71], a[80:83], v[88:91]
  buffer_load_dword v247, v246, s[96:99], s50 offen sc1
  v_mfma_f32_16x16x32_bf16 v[92:95], v[68:71], a[84:87], v[92:95]
  v_exp_f32 v232, v232
  v_mfma_f32_16x16x32_bf16 v[76:79], v[64:67], a[84:87], v[76:79]
  v_exp_f32 v233, v233
  v_mfma_f32_16x16x32_bf16 v[80:83], v[64:67], a[88:91], v[80:83]
  ds_read_b128 v[60:63], v1 offset:15360
  v_fmac_f32 v164, v203, v216
  v_mfma_f32_16x16x32_bf16 v[96:99], v[68:71], a[88:91], v[96:99]
  v_exp_f32 v234, v234
  v_mfma_f32_16x16x32_bf16 v[100:103], v[68:71], a[92:95], v[100:103]
  v_exp_f32 v235, v235
  v_mfma_f32_16x16x32_bf16 v[84:87], v[64:67], a[92:95], v[84:87]
  s_waitcnt lgkmcnt(2)
  v_fmac_f32 v165, v203, v217
  v_fmac_f32 v166, v203, v218
  v_mfma_f32_16x16x32_bf16 v[72:75], v[48:51], a[96:99], v[72:75]
  ds_read_b128 v[64:67], v1 offset:16384
  v_fmac_f32 v167, v203, v219
  v_mfma_f32_16x16x32_bf16 v[88:91], v[52:55], a[96:99], v[88:91]
  buffer_load_dwordx4 v1, s[60:63], s52 offen offset:1024 sc1 lds
  v_mfma_f32_16x16x32_bf16 v[92:95], v[52:55], a[100:103], v[92:95]
  v_fma_f32 v232, v232, v211, v211
  v_fma_f32 v233, v233, v211, v211
  v_mfma_f32_16x16x32_bf16 v[76:79], v[48:51], a[100:103], v[76:79]
  v_fma_f32 v234, v234, v211, v211
  v_fma_f32 v235, v235, v211, v211
  v_mfma_f32_16x16x32_bf16 v[80:83], v[48:51], a[104:107], v[80:83]
  ds_read_b128 v[68:71], v1 offset:17408
  v_mul_f32 v148, v148, v164
  v_mfma_f32_16x16x32_bf16 v[96:99], v[52:55], a[104:107], v[96:99]
  v_rcp_f32 v232, v232
  v_mfma_f32_16x16x32_bf16 v[100:103], v[52:55], a[108:111], v[100:103]
  v_rcp_f32 v233, v233
  v_mfma_f32_16x16x32_bf16 v[84:87], v[48:51], a[108:111], v[84:87]
  s_waitcnt lgkmcnt(2)
  v_rcp_f32 v234, v234
  v_mfma_f32_16x16x32_bf16 v[72:75], v[56:59], a[112:115], v[72:75]
  ds_read_b128 v[48:51], v1 offset:18432
  v_mul_f32 v149, v149, v165
  v_mfma_f32_16x16x32_bf16 v[88:91], v[60:63], a[112:115], v[88:91]
  v_rcp_f32 v235, v235
  v_mfma_f32_16x16x32_bf16 v[92:95], v[60:63], a[116:119], v[92:95]
  buffer_load_dwordx4 v1, s[60:63], s52 offen offset:2048 sc1 lds
  v_mfma_f32_16x16x32_bf16 v[76:79], v[56:59], a[116:119], v[76:79]
  v_mul_f32 v150, v150, v166
  v_mul_f32 v151, v151, v167
  v_mfma_f32_16x16x32_bf16 v[80:83], v[56:59], a[120:123], v[80:83]
  ds_read_b128 v[52:55], v1 offset:19456
  v_mul_f32 v148, v148, v232
  v_mfma_f32_16x16x32_bf16 v[96:99], v[60:63], a[120:123], v[96:99]
  v_mul_f32 v149, v149, v233
  v_mul_f32 v150, v150, v234
  v_mfma_f32_16x16x32_bf16 v[100:103], v[60:63], a[124:127], v[100:103]
  v_cvt_pk_bf16_f32 v242, v148, v149
  v_mul_f32 v151, v151, v235
  v_mfma_f32_16x16x32_bf16 v[84:87], v[56:59], a[124:127], v[84:87]
  s_waitcnt lgkmcnt(2)
  v_cvt_pk_bf16_f32 v243, v150, v151
  v_fmac_f32 v168, v200, v220
  v_mfma_f32_16x16x32_bf16 v[72:75], v[64:67], a[128:131], v[72:75]
  ds_read_b128 v[56:59], v1 offset:20480
  v_fmac_f32 v169, v200, v221
  v_mfma_f32_16x16x32_bf16 v[88:91], v[68:71], a[128:131], v[88:91]
  v_permlane16_swap_b32 v240, v242
  v_mfma_f32_16x16x32_bf16 v[92:95], v[68:71], a[132:135], v[92:95]
  v_permlane16_swap_b32 v241, v243
  buffer_store_dwordx4 v[240:243], v12, s[24:27], s45 offen sc1
  v_mfma_f32_16x16x32_bf16 v[76:79], v[64:67], a[132:135], v[76:79]
  s_add_u32 s45, s45, 4096
  buffer_load_dwordx4 v1, s[60:63], s52 offen offset:3072 sc1 lds
  v_mfma_f32_16x16x32_bf16 v[80:83], v[64:67], a[136:139], v[80:83]
  ds_read_b128 v[60:63], v1 offset:21504
  v_fmac_f32 v170, v200, v222
  v_mfma_f32_16x16x32_bf16 v[96:99], v[68:71], a[136:139], v[96:99]
  v_fmac_f32 v171, v200, v223
  v_mul_f32 v228, v204, v168
  v_mfma_f32_16x16x32_bf16 v[100:103], v[68:71], a[140:143], v[100:103]
  v_mul_f32 v229, v204, v169
  v_mul_f32 v230, v204, v170
  v_mfma_f32_16x16x32_bf16 v[84:87], v[64:67], a[140:143], v[84:87]
  s_waitcnt lgkmcnt(2)
  v_mul_f32 v231, v204, v171
  v_fmac_f32 v184, v200, v224
  v_mfma_f32_16x16x32_bf16 v[72:75], v[48:51], a[144:147], v[72:75]
  ds_read_b128 v[64:67], v1 offset:22528
  v_fmac_f32 v185, v200, v225
  v_mfma_f32_16x16x32_bf16 v[88:91], v[52:55], a[144:147], v[88:91]
  v_exp_f32 v228, v228
  v_mfma_f32_16x16x32_bf16 v[92:95], v[52:55], a[148:151], v[92:95]
  v_exp_f32 v229, v229
  v_mfma_f32_16x16x32_bf16 v[76:79], v[48:51], a[148:151], v[76:79]
  v_exp_f32 v230, v230
  v_mfma_f32_16x16x32_bf16 v[80:83], v[48:51], a[152:155], v[80:83]
  ds_read_b128 v[68:71], v1 offset:23552
  v_fmac_f32 v186, v200, v226
  v_mfma_f32_16x16x32_bf16 v[96:99], v[52:55], a[152:155], v[96:99]
  s_add_u32 m0, s39, 81920
  s_add_u32 s52, s52, 4096
  buffer_load_dwordx4 v1, s[60:63], s52 offen offset:0 sc1 lds
  v_mfma_f32_16x16x32_bf16 v[100:103], v[52:55], a[156:159], v[100:103]
  v_exp_f32 v231, v231
  v_mfma_f32_16x16x32_bf16 v[84:87], v[48:51], a[156:159], v[84:87]
  s_waitcnt lgkmcnt(2)
  v_fmac_f32 v187, v200, v227
  v_fma_f32 v228, v228, v208, v208
  v_mfma_f32_16x16x32_bf16 v[72:75], v[56:59], a[160:163], v[72:75]
  ds_read_b128 v[48:51], v1 offset:24576
  v_fma_f32 v229, v229, v208, v208
  v_mfma_f32_16x16x32_bf16 v[88:91], v[60:63], a[160:163], v[88:91]
  v_fma_f32 v230, v230, v208, v208
  v_fma_f32 v231, v231, v208, v208
  v_mfma_f32_16x16x32_bf16 v[92:95], v[60:63], a[164:167], v[92:95]
  v_rcp_f32 v228, v228
  v_mfma_f32_16x16x32_bf16 v[76:79], v[56:59], a[164:167], v[76:79]
  v_rcp_f32 v229, v229
  v_mfma_f32_16x16x32_bf16 v[80:83], v[56:59], a[168:171], v[80:83]
  ds_read_b128 v[52:55], v1 offset:25600
  v_mul_f32 v168, v168, v184
  v_mfma_f32_16x16x32_bf16 v[96:99], v[60:63], a[168:171], v[96:99]
  v_rcp_f32 v230, v230
  v_mfma_f32_16x16x32_bf16 v[100:103], v[60:63], a[172:175], v[100:103]
  s_waitcnt vmcnt(5)
  v_cmp_ne_u32 vcc, v253, v247
  s_nop 1
  s_cmp_lg_u64 vcc, 0
  s_cbranch_scc1 fa_slow
fa_ok:
  v_mfma_f32_16x16x32_bf16 v[84:87], v[56:59], a[172:175], v[84:87]
  s_waitcnt lgkmcnt(2)
  v_rcp_f32 v231, v231
  v_mfma_f32_16x16x32_bf16 v[72:75], v[64:67], a[176:179], v[72:75]
  ds_read_b128 v[56:59], v1 offset:26624
  v_mul_f32 v169, v169, v185
  v_mfma_f32_16x16x32_bf16 v[88:91], v[68:71], a[176:179], v[88:91]
  v_mul_f32 v170, v170, v186
  v_mul_f32 v171, v171, v187
  v_mfma_f32_16x16x32_bf16 v[92:95], v[68:71], a[180:183], v[92:95]
  buffer_load_dwordx4 a[0:3], v244, s[24:27], s53 offen offset:0 sc1
  v_mfma_f32_16x16x32_bf16 v[76:79], v[64:67], a[180:183], v[76:79]
  v_mul_f32 v168, v168, v228
  v_mul_f32 v169, v169, v229
  v_mfma_f32_16x16x32_bf16 v[80:83], v[64:67], a[184:187], v[80:83]
  ds_read_b128 v[60:63], v1 offset:27648
  v_mul_f32 v170, v170, v230
  v_mfma_f32_16x16x32_bf16 v[96:99], v[68:71], a[184:187], v[96:99]
  buffer_load_dwordx4 a[4:7], v245, s[24:27], s53 offen offset:0 sc1
  v_mfma_f32_16x16x32_bf16 v[100:103], v[68:71], a[188:191], v[100:103]
  v_cvt_pk_bf16_f32 v236, v168, v169
  v_mul_f32 v171, v171, v231
  v_mfma_f32_16x16x32_bf16 v[84:87], v[64:67], a[188:191], v[84:87]
  s_waitcnt lgkmcnt(2)
  buffer_load_dwordx4 a[8:11], v244, s[24:27], s53 offen offset:1024 sc1
  v_mfma_f32_16x16x32_bf16 v[72:75], v[48:51], a[192:195], v[72:75]
  ds_read_b128 v[64:67], v1 offset:28672
  v_cvt_pk_bf16_f32 v237, v170, v171
  v_mfma_f32_16x16x32_bf16 v[88:91], v[52:55], a[192:195], v[88:91]
  buffer_load_dwordx4 a[12:15], v245, s[24:27], s53 offen offset:1024 sc1
  v_mfma_f32_16x16x32_bf16 v[92:95], v[52:55], a[196:199], v[92:95]
  ds_read_b128 v[212:215], v10 offset:1024
  ds_read_b128 v[216:219], v10 offset:1088
  v_mfma_f32_16x16x32_bf16 v[76:79], v[48:51], a[196:199], v[76:79]
  buffer_load_dwordx4 a[16:19], v244, s[24:27], s53 offen offset:2048 sc1
  v_mfma_f32_16x16x32_bf16 v[80:83], v[48:51], a[200:203], v[80:83]
  ds_read_b128 v[68:71], v1 offset:29696
  v_fmac_f32 v172, v201, v220
  v_mfma_f32_16x16x32_bf16 v[96:99], v[52:55], a[200:203], v[96:99]
  buffer_load_dwordx4 a[20:23], v245, s[24:27], s53 offen offset:2048 sc1
  v_mfma_f32_16x16x32_bf16 v[100:103], v[52:55], a[204:207], v[100:103]
  v_fmac_f32 v173, v201, v221
  v_fmac_f32 v174, v201, v222
  v_mfma_f32_16x16x32_bf16 v[84:87], v[48:51], a[204:207], v[84:87]
  s_waitcnt lgkmcnt(4)
  buffer_load_dwordx4 a[24:27], v244, s[24:27], s53 offen offset:3072 sc1
  v_mfma_f32_16x16x32_bf16 v[72:75], v[56:59], a[208:211], v[72:75]
  ds_read_b128 v[48:51], v1 offset:30720
  v_fmac_f32 v175, v201, v223
  v_mfma_f32_16x16x32_bf16 v[88:91], v[60:63], a[208:211], v[88:91]
  buffer_load_dwordx4 a[28:31], v245, s[24:27], s53 offen offset:3072 sc1
  s_add_u32 s53, s53, 4096
  v_mfma_f32_16x16x32_bf16 v[92:95], v[60:63], a[212:215], v[92:95]
  v_mul_f32 v232, v205, v172
  v_mul_f32 v233, v205, v173
  v_mfma_f32_16x16x32_bf16 v[76:79], v[56:59], a[212:215], v[76:79]
  buffer_load_dwordx4 a[32:35], v244, s[24:27], s53 offen offset:0 sc1
  v_mfma_f32_16x16x32_bf16 v[80:83], v[56:59], a[216:219], v[80:83]
  ds_read_b128 v[52:55], v1 offset:31744
  v_mul_f32 v234, v205, v174
  v_mfma_f32_16x16x32_bf16 v[96:99], v[60:63], a[216:219], v[96:99]
  buffer_load_dwordx4 a[36:39], v245, s[24:27], s53 offen offset:0 sc1
  v_mfma_f32_16x16x32_bf16 v[100:103], v[60:63], a[220:223], v[100:103]
  v_mul_f32 v235, v205, v175
  v_fmac_f32 v188, v201, v224
  v_mfma_f32_16x16x32_bf16 v[84:87], v[56:59], a[220:223], v[84:87]
  s_waitcnt lgkmcnt(2)
  buffer_load_dwordx4 a[112:115], v244, s[24:27], s53 offen offset:1024 sc1
  v_mfma_f32_16x16x32_bf16 v[72:75], v[64:67], a[224:227], v[72:75]
  ds_read_b128 v[56:59], v1 offset:32768
  v_fmac_f32 v189, v201, v225
  v_mfma_f32_16x16x32_bf16 v[88:91], v[68:71], a[224:227], v[88:91]
  buffer_load_dwordx4 a[116:119], v245, s[24:27], s53 offen offset:1024 sc1
  v_mfma_f32_16x16x32_bf16 v[92:95], v[68:71], a[228:231], v[92:95]
  v_exp_f32 v232, v232
  v_mfma_f32_16x16x32_bf16 v[76:79], v[64:67], a[228:231], v[76:79]
  buffer_load_dwordx4 a[120:123], v244, s[24:27], s53 offen offset:2048 sc1
  v_mfma_f32_16x16x32_bf16 v[80:83], v[64:67], a[232:235], v[80:83]
  ds_read_b128 v[60:63], v1 offset:33792
  v_fmac_f32 v190, v201, v226
  v_mfma_f32_16x16x32_bf16 v[96:99], v[68:71], a[232:235], v[96:99]
  buffer_load_dwordx4 a[124:127], v245, s[24:27], s53 offen offset:2048 sc1
  v_mfma_f32_16x16x32_bf16 v[100:103], v[68:71], a[236:239], v[100:103]
  v_exp_f32 v233, v233
  v_mfma_f32_16x16x32_bf16 v[84:87], v[64:67], a[236:239], v[84:87]
  s_waitcnt lgkmcnt(2)
  buffer_load_dwordx4 a[128:131], v244, s[24:27], s53 offen offset:3072 sc1
  v_mfma_f32_16x16x32_bf16 v[72:75], v[48:51], a[240:243], v[72:75]
  ds_read_b128 v[64:67], v1 offset:34816
  v_fmac_f32 v191, v201, v227
  v_mfma_f32_16x16x32_bf16 v[88:91], v[52:55], a[240:243], v[88:91]
  buffer_load_dwordx4 a[132:135], v245, s[24:27], s53 offen offset:3072 sc1
  s_add_u32 s53, s53, 4096
  v_mfma_f32_16x16x32_bf16 v[92:95], v[52:55], a[244:247], v[92:95]
  v_exp_f32 v234, v234
  v_mfma_f32_16x16x32_bf16 v[76:79], v[48:51], a[244:247], v[76:79]
  v_exp_f32 v235, v235
  v_mfma_f32_16x16x32_bf16 v[80:83], v[48:51], a[248:251], v[80:83]
  ds_read_b128 v[68:71], v1 offset:35840
  v_fma_f32 v232, v232, v209, v209
  v_mfma_f32_16x16x32_bf16 v[96:99], v[52:55], a[248:251], v[96:99]
  s_waitcnt vmcnt(30)
  v_fma_f32 v233, v233, v209, v209
  v_fma_f32 v234, v234, v209, v209
  v_mfma_f32_16x16x32_bf16 v[100:103], v[52:55], a[252:255], v[100:103]
  s_barrier
  v_fma_f32 v235, v235, v209, v209
  v_mul_f32 v172, v172, v188
  v_mfma_f32_16x16x32_bf16 v[84:87], v[48:51], a[252:255], v[84:87]
  s_waitcnt lgkmcnt(2)
  v_rcp_f32 v232, v232
  v_mfma_f32_16x16x32_bf16 v[72:75], v[56:59], v[16:19], v[72:75]
  v_rcp_f32 v233, v233
  v_mfma_f32_16x16x32_bf16 v[88:91], v[60:63], v[16:19], v[88:91]
  ds_read_b128 a[40:43], v1 offset:36864
  v_mul_f32 v173, v173, v189
  v_mfma_f32_16x16x32_bf16 v[92:95], v[60:63], v[20:23], v[92:95]
  ds_read_b128 a[44:47], v1 offset:37888
  v_mul_f32 v174, v174, v190
  v_mfma_f32_16x16x32_bf16 v[76:79], v[56:59], v[20:23], v[76:79]
  ds_read_b128 a[48:51], v1 offset:38912
  v_mul_f32 v175, v175, v191
  v_mfma_f32_16x16x32_bf16 v[80:83], v[56:59], v[24:27], v[80:83]
  ds_read_b128 a[52:55], v1 offset:39936
  v_mul_f32 v172, v172, v232
  v_mfma_f32_16x16x32_bf16 v[96:99], v[60:63], v[24:27], v[96:99]
  ds_read_b128 a[56:59], v1 offset:40960
  v_mul_f32 v173, v173, v233
  v_mfma_f32_16x16x32_bf16 v[100:103], v[60:63], v[28:31], v[100:103]
  ds_read_b128 a[60:63], v1 offset:41984
  v_cvt_pk_bf16_f32 v238, v172, v173
  v_mfma_f32_16x16x32_bf16 v[84:87], v[56:59], v[28:31], v[84:87]
  s_waitcnt lgkmcnt(6)
  ds_read_b128 a[64:67], v1 offset:43008
  v_fmac_f32 v176, v202, v220
  v_mfma_f32_16x16x32_bf16 v[72:75], v[64:67], v[32:35], v[72:75]
  ds_read_b128 a[68:71], v1 offset:44032
  v_fmac_f32 v177, v202, v221
  v_mfma_f32_16x16x32_bf16 v[88:91], v[68:71], v[32:35], v[88:91]
  ds_read_b128 a[72:75], v1 offset:45056
  v_fmac_f32 v178, v202, v222
  v_mfma_f32_16x16x32_bf16 v[92:95], v[68:71], v[36:39], v[92:95]
  v_rcp_f32 v234, v234
  v_mfma_f32_16x16x32_bf16 v[76:79], v[64:67], v[36:39], v[76:79]
  v_rcp_f32 v235, v235
  v_mfma_f32_16x16x32_bf16 v[80:83], v[64:67], v[40:43], v[80:83]
  v_mul_f32 v174, v174, v234
  v_mul_f32 v175, v175, v235
  v_mfma_f32_16x16x32_bf16 v[96:99], v[68:71], v[40:43], v[96:99]
  v_cvt_pk_bf16_f32 v239, v174, v175
  v_fmac_f32 v179, v202, v223
  v_mfma_f32_16x16x32_bf16 v[100:103], v[68:71], v[44:47], v[100:103]
  s_waitcnt vmcnt(14)
  v_permlane16_swap_b32 v236, v238
  v_mfma_f32_16x16x32_bf16 v[84:87], v[64:67], v[44:47], v[84:87]
  s_waitcnt lgkmcnt(6)
  v_permlane16_swap_b32 v237, v239
  buffer_store_dwordx4 v[236:239], v11, s[24:27], s45 offen sc1
  v_mfma_f32_16x16x32_bf16 v[16:19], a[40:43], a[0:3], 0
  ds_read_b128 a[76:79], v1 offset:46080
  v_mul_f32 v228, v206, v176
  v_mul_f32 v229, v206, v177
  v_mfma_f32_16x16x32_bf16 v[20:23], a[44:47], a[0:3], 0
  buffer_load_dwordx4 a[136:139], v244, s[24:27], s53 offen offset:0 sc1
  v_mfma_f32_16x16x32_bf16 v[24:27], a[48:51], a[0:3], 0
  s_waitcnt lgkmcnt(4)
  ds_read_b128 a[80:83], v1 offset:47104
  v_mul_f32 v230, v206, v178
  v_mul_f32 v231, v206, v179
  v_mfma_f32_16x16x32_bf16 v[28:31], a[52:55], a[0:3], 0
  buffer_load_dwordx4 a[140:143], v245, s[24:27], s53 offen offset:0 sc1
  v_mfma_f32_16x16x32_bf16 v[32:35], a[56:59], a[0:3], 0
  ds_read_b128 a[84:87], v1 offset:48128
  v_exp_f32 v228, v228
  v_mfma_f32_16x16x32_bf16 v[36:39], a[60:63], a[0:3], 0
  s_waitcnt lgkmcnt(3)
  v_exp_f32 v229, v229
  v_fmac_f32 v192, v202, v224
  v_mfma_f32_16x16x32_bf16 v[40:43], a[64:67], a[0:3], 0
  ds_read_b128 a[88:91], v1 offset:49152
  v_exp_f32 v230, v230
  v_mfma_f32_16x16x32_bf16 v[44:47], a[68:71], a[0:3], 0
  s_add_u32 m0, s39, 110592
  s_add_u32 s52, s52, 28672
  buffer_load_dwordx4 v1, s[60:63], s52 offen offset:0 sc1 lds
  v_mfma_f32_16x16x32_bf16 v[48:51], a[72:75], a[0:3], 0
  ds_read_b128 a[92:95], v1 offset:50176
  v_exp_f32 v231, v231
  v_mfma_f32_16x16x32_bf16 v[116:119], a[72:75], a[4:7], 0
  buffer_load_dwordx4 v1, s[60:63], s52 offen offset:1024 sc1 lds
  v_mfma_f32_16x16x32_bf16 v[112:115], a[68:71], a[4:7], 0
  ds_read_b128 a[96:99], v1 offset:51200
  v_fmac_f32 v193, v202, v225
  v_fmac_f32 v194, v202, v226
  v_mfma_f32_16x16x32_bf16 v[108:111], a[64:67], a[4:7], 0
  v_fmac_f32 v195, v202, v227
  v_fma_f32 v228, v228, v210, v210
  v_fma_f32 v229, v229, v210, v210
  v_mfma_f32_16x16x32_bf16 v[104:107], a[60:63], a[4:7], 0
  ds_read_b128 a[100:103], v1 offset:52224
  v_fma_f32 v230, v230, v210, v210
  v_fma_f32 v231, v231, v210, v210
  v_mfma_f32_16x16x32_bf16 v[68:71], a[56:59], a[4:7], 0
  buffer_load_dwordx4 v1, s[60:63], s52 offen offset:2048 sc1 lds
  v_mfma_f32_16x16x32_bf16 v[64:67], a[52:55], a[4:7], 0
  ds_read_b128 a[104:107], v1 offset:53248
  v_rcp_f32 v228, v228
  v_mfma_f32_16x16x32_bf16 v[60:63], a[48:51], a[4:7], 0
  v_rcp_f32 v229, v229
  v_mul_f32 v176, v176, v192
  v_mfma_f32_16x16x32_bf16 v[56:59], a[44:47], a[4:7], 0
  s_waitcnt vmcnt(18)
  ds_read_b128 a[108:111], v1 offset:54272
  v_rcp_f32 v230, v230
  v_mfma_f32_16x16x32_bf16 v[52:55], a[40:43], a[4:7], 0
  s_waitcnt lgkmcnt(6)
  v_rcp_f32 v231, v231
  v_mul_f32 v177, v177, v193
  v_mfma_f32_16x16x32_bf16 v[16:19], a[76:79], a[8:11], v[16:19]
  ds_read_b128 a[40:43], v1 offset:55296
  v_mul_f32 v178, v178, v194
  v_mul_f32 v179, v179, v195
  v_mfma_f32_16x16x32_bf16 v[20:23], a[80:83], a[8:11], v[20:23]
  buffer_load_dwordx4 a[144:147], v244, s[24:27], s53 offen offset:1024 sc1
  v_mfma_f32_16x16x32_bf16 v[24:27], a[84:87], a[8:11], v[24:27]
  s_waitcnt lgkmcnt(4)
  ds_read_b128 a[44:47], v1 offset:56320
  v_mul_f32 v176, v176, v228
  v_mul_f32 v177, v177, v229
  v_mfma_f32_16x16x32_bf16 v[28:31], a[88:91], a[8:11], v[28:31]
  buffer_load_dwordx4 a[148:151], v245, s[24:27], s53 offen offset:1024 sc1
  v_mfma_f32_16x16x32_bf16 v[32:35], a[92:95], a[8:11], v[32:35]
  ds_read_b128 a[48:51], v1 offset:57344
  v_mul_f32 v178, v178, v230
  v_mul_f32 v179, v179, v231
  v_mfma_f32_16x16x32_bf16 v[36:39], a[96:99], a[8:11], v[36:39]
  s_waitcnt lgkmcnt(3)
  v_cvt_pk_bf16_f32 v240, v176, v177
  v_cvt_pk_bf16_f32 v241, v178, v179
  v_fmac_f32 v180, v203, v220
  v_mfma_f32_16x16x32_bf16 v[40:43], a[100:103], a[8:11], v[40:43]
  ds_read_b128 a[52:55], v1 offset:58368
  v_fmac_f32 v181, v203, v221
  v_fmac_f32 v182, v203, v222
  v_mfma_f32_16x16x32_bf16 v[44:47], a[104:107], a[8:11], v[44:47]
  buffer_load_dwordx4 v1, s[60:63], s52 offen offset:3072 sc1 lds
  v_mfma_f32_16x16x32_bf16 v[48:51], a[108:111], a[8:11], v[48:51]
  ds_read_b128 a[56:59], v1 offset:59392
  v_fmac_f32 v183, v203, v223
  v_mul_f32 v232, v207, v180
  v_mfma_f32_16x16x32_bf16 v[116:119], a[108:111], a[12:15], v[116:119]
  s_add_u32 m0, s39, 114688
  s_add_u32 s52, s52, 4096
  buffer_load_dwordx4 v1, s[60:63], s52 offen offset:0 sc1 lds
  v_mfma_f32_16x16x32_bf16 v[112:115], a[104:107], a[12:15], v[112:115]
  ds_read_b128 a[60:63], v1 offset:60416
  v_mul_f32 v233, v207, v181
  v_mul_f32 v234, v207, v182
  v_mfma_f32_16x16x32_bf16 v[108:111], a[100:103], a[12:15], v[108:111]
  v_mul_f32 v235, v207, v183
  v_exp_f32 v232, v232
  v_mfma_f32_16x16x32_bf16 v[104:107], a[96:99], a[12:15], v[104:107]
  ds_read_b128 a[64:67], v1 offset:61440
  v_exp_f32 v233, v233
  v_mfma_f32_16x16x32_bf16 v[68:71], a[92:95], a[12:15], v[68:71]
  buffer_load_dwordx4 v1, s[60:63], s52 offen offset:1024 sc1 lds
  v_mfma_f32_16x16x32_bf16 v[64:67], a[88:91], a[12:15], v[64:67]
  ds_read_b128 a[68:71], v1 offset:62464
  v_exp_f32 v234, v234
  v_mfma_f32_16x16x32_bf16 v[60:63], a[84:87], a[12:15], v[60:63]
  v_exp_f32 v235, v235
  v_fmac_f32 v196, v203, v224
  v_mfma_f32_16x16x32_bf16 v[56:59], a[80:83], a[12:15], v[56:59]
  s_waitcnt vmcnt(21)
  ds_read_b128 a[72:75], v1 offset:63488
  v_fmac_f32 v197, v203, v225
  v_fmac_f32 v198, v203, v226
  v_mfma_f32_16x16x32_bf16 v[52:55], a[76:79], a[12:15], v[52:55]
  s_waitcnt lgkmcnt(6)
  v_fmac_f32 v199, v203, v227
  v_fma_f32 v232, v232, v211, v211
  v_fma_f32 v233, v233, v211, v211
  v_mfma_f32_16x16x32_bf16 v[16:19], a[40:43], a[16:19], v[16:19]
  ds_read_b128 a[76:79], v1 offset:64512
  v_fma_f32 v234, v234, v211, v211
  v_fma_f32 v235, v235, v211, v211
  v_mfma_f32_16x16x32_bf16 v[20:23], a[44:47], a[16:19], v[20:23]
  buffer_load_dwordx4 a[152:155], v244, s[24:27], s53 offen offset:2048 sc1
  v_mfma_f32_16x16x32_bf16 v[24:27], a[48:51], a[16:19], v[24:27]
  s_waitcnt lgkmcnt(4)
  ds_read_b128 a[80:83], v6 offset:0
  v_rcp_f32 v232, v232
  v_mfma_f32_16x16x32_bf16 v[28:31], a[52:55], a[16:19], v[28:31]
  buffer_load_dwordx4 a[156:159], v245, s[24:27], s53 offen offset:2048 sc1
  v_mfma_f32_16x16x32_bf16 v[32:35], a[56:59], a[16:19], v[32:35]
  ds_read_b128 a[84:87], v6 offset:1024
  v_rcp_f32 v233, v233
  v_mfma_f32_16x16x32_bf16 v[36:39], a[60:63], a[16:19], v[36:39]
  s_waitcnt lgkmcnt(3)
  v_rcp_f32 v234, v234
  v_mul_f32 v180, v180, v196
  v_mfma_f32_16x16x32_bf16 v[40:43], a[64:67], a[16:19], v[40:43]
  ds_read_b128 a[88:91], v6 offset:2048
  v_rcp_f32 v235, v235
  v_mfma_f32_16x16x32_bf16 v[44:47], a[68:71], a[16:19], v[44:47]
  buffer_load_dwordx4 v1, s[60:63], s52 offen offset:2048 sc1 lds
  v_mfma_f32_16x16x32_bf16 v[48:51], a[72:75], a[16:19], v[48:51]
  ds_read_b128 a[92:95], v6 offset:3072
  v_mul_f32 v181, v181, v197
  v_mul_f32 v182, v182, v198
  v_mfma_f32_16x16x32_bf16 v[116:119], a[72:75], a[20:23], v[116:119]
  buffer_load_dwordx4 v1, s[60:63], s52 offen offset:3072 sc1 lds
  v_mfma_f32_16x16x32_bf16 v[112:115], a[68:71], a[20:23], v[112:115]
  ds_read_b128 a[96:99], v6 offset:4096
  v_mul_f32 v183, v183, v199
  v_mul_f32 v180, v180, v232
  v_mfma_f32_16x16x32_bf16 v[108:111], a[64:67], a[20:23], v[108:111]
  v_mul_f32 v181, v181, v233
  v_mul_f32 v182, v182, v234
  v_mul_f32 v183, v183, v235
  v_mfma_f32_16x16x32_bf16 v[104:107], a[60:63], a[20:23], v[104:107]
  s_waitcnt vmcnt(31)
  ds_read_b128 a[100:103], v6 offset:5120
  v_cvt_pk_bf16_f32 v243, v182, v183
  v_cvt_pk_bf16_f32 v242, v180, v181
  v_mfma_f32_16x16x32_bf16 v[68:71], a[56:59], a[20:23], v[68:71]
  s_add_u32 m0, s39, 118784
  s_add_u32 s52, s52, 4096
  buffer_load_dwordx4 v1, s[60:63], s52 offen offset:0 sc1 lds
  v_mfma_f32_16x16x32_bf16 v[64:67], a[52:55], a[20:23], v[64:67]
  s_barrier
  ds_read_b128 a[104:107], v6 offset:6144
  v_permlane16_swap_b32 v240, v242
  v_mfma_f32_16x16x32_bf16 v[60:63], a[48:51], a[20:23], v[60:63]
  v_permlane16_swap_b32 v241, v243
  buffer_store_dwordx4 v[240:243], v12, s[24:27], s45 offen sc1
  v_fmac_f32 v72, v200, v212
  v_mfma_f32_16x16x32_bf16 v[56:59], a[44:47], a[20:23], v[56:59]
  s_waitcnt vmcnt(25)
  ds_read_b128 a[108:111], v6 offset:7168
  v_fmac_f32 v73, v200, v213
  v_fmac_f32 v74, v200, v214
  v_mfma_f32_16x16x32_bf16 v[52:55], a[40:43], a[20:23], v[52:55]
  s_waitcnt lgkmcnt(6)
  v_fmac_f32 v75, v200, v215
  v_mul_f32 v228, v204, v72
  v_mul_f32 v229, v204, v73
  v_mfma_f32_16x16x32_bf16 v[16:19], a[76:79], a[24:27], v[16:19]
  s_add_u32 s45, s45, 4096
  ds_read_b128 a[40:43], v6 offset:8192
  v_mul_f32 v230, v204, v74
  v_mul_f32 v231, v204, v75
  v_mfma_f32_16x16x32_bf16 v[20:23], a[80:83], a[24:27], v[20:23]
  buffer_load_dwordx4 a[160:163], v244, s[24:27], s53 offen offset:3072 sc1
  v_mfma_f32_16x16x32_bf16 v[24:27], a[84:87], a[24:27], v[24:27]
  s_waitcnt lgkmcnt(4)
  ds_read_b128 a[44:47], v6 offset:9216
  v_exp_f32 v228, v228
  v_mfma_f32_16x16x32_bf16 v[28:31], a[88:91], a[24:27], v[28:31]
  v_exp_f32 v229, v229
  v_fmac_f32 v88, v200, v216
  v_mfma_f32_16x16x32_bf16 v[32:35], a[92:95], a[24:27], v[32:35]
  ds_read_b128 a[48:51], v6 offset:10240
  v_exp_f32 v230, v230
  v_mfma_f32_16x16x32_bf16 v[36:39], a[96:99], a[24:27], v[36:39]
  s_waitcnt lgkmcnt(3)
  v_exp_f32 v231, v231
  v_fmac_f32 v89, v200, v217
  v_mfma_f32_16x16x32_bf16 v[40:43], a[100:103], a[24:27], v[40:43]
  ds_read_b128 a[52:55], v6 offset:11264
  v_fmac_f32 v90, v200, v218
  v_fmac_f32 v91, v200, v219
  v_mfma_f32_16x16x32_bf16 v[44:47], a[104:107], a[24:27], v[44:47]
  v_fma_f32 v228, v228, v208, v208
  v_fma_f32 v229, v229, v208, v208
  v_fma_f32 v230, v230, v208, v208
  v_mfma_f32_16x16x32_bf16 v[48:51], a[108:111], a[24:27], v[48:51]
  ds_read_b128 a[56:59], v6 offset:12288
  v_fma_f32 v231, v231, v208, v208
  v_mul_f32 v72, v72, v88
  v_mfma_f32_16x16x32_bf16 v[116:119], a[108:111], a[28:31], v[116:119]
  buffer_load_dwordx4 a[164:167], v245, s[24:27], s53 offen offset:3072 sc1
  s_add_u32 s53, s53, 4096
  v_mfma_f32_16x16x32_bf16 v[112:115], a[104:107], a[28:31], v[112:115]
  ds_read_b128 a[60:63], v6 offset:13312
  v_rcp_f32 v228, v228
  v_mfma_f32_16x16x32_bf16 v[108:111], a[100:103], a[28:31], v[108:111]
  v_rcp_f32 v229, v229
  v_mul_f32 v73, v73, v89
  v_mfma_f32_16x16x32_bf16 v[104:107], a[96:99], a[28:31], v[104:107]
  ds_read_b128 a[64:67], v6 offset:14336
  v_rcp_f32 v230, v230
  v_mfma_f32_16x16x32_bf16 v[68:71], a[92:95], a[28:31], v[68:71]
  v_rcp_f32 v231, v231
  v_mul_f32 v74, v74, v90
  v_mfma_f32_16x16x32_bf16 v[64:67], a[88:91], a[28:31], v[64:67]
  ds_read_b128 a[68:71], v6 offset:15360
  v_mul_f32 v75, v75, v91
  v_mul_f32 v72, v72, v228
  v_mfma_f32_16x16x32_bf16 v[60:63], a[84:87], a[28:31], v[60:63]
  v_mul_f32 v73, v73, v229
  v_mul_f32 v74, v74, v230
  v_mul_f32 v75, v75, v231
  v_mfma_f32_16x16x32_bf16 v[56:59], a[80:83], a[28:31], v[56:59]
  s_waitcnt vmcnt(25)
  ds_read_b128 a[72:75], v6 offset:16384
  v_cvt_pk_bf16_f32 v237, v74, v75
  v_cvt_pk_bf16_f32 v236, v72, v73
  v_mfma_f32_16x16x32_bf16 v[52:55], a[76:79], a[28:31], v[52:55]
  s_waitcnt lgkmcnt(6)
  v_fmac_f32 v76, v201, v212
  v_fmac_f32 v77, v201, v213
  v_fmac_f32 v78, v201, v214
  v_mfma_f32_16x16x32_bf16 v[16:19], a[40:43], a[32:35], v[16:19]
  ds_read_b128 a[76:79], v6 offset:17408
  v_fmac_f32 v79, v201, v215
  v_mul_f32 v232, v205, v76
  v_mfma_f32_16x16x32_bf16 v[20:23], a[44:47], a[32:35], v[20:23]
  buffer_load_dwordx4 a[168:171], v244, s[24:27], s53 offen offset:0 sc1
  v_mfma_f32_16x16x32_bf16 v[24:27], a[48:51], a[32:35], v[24:27]
  s_waitcnt lgkmcnt(4)
  ds_read_b128 a[80:83], v6 offset:18432
  v_mul_f32 v233, v205, v77
  v_mul_f32 v234, v205, v78
  v_mfma_f32_16x16x32_bf16 v[28:31], a[52:55], a[32:35], v[28:31]
  buffer_load_dwordx4 a[172:175], v245, s[24:27], s53 offen offset:0 sc1
  v_mfma_f32_16x16x32_bf16 v[32:35], a[56:59], a[32:35], v[32:35]
  ds_read_b128 a[84:87], v6 offset:19456
  v_mul_f32 v235, v205, v79
  v_fmac_f32 v92, v201, v216
  v_mfma_f32_16x16x32_bf16 v[36:39], a[60:63], a[32:35], v[36:39]
  s_waitcnt lgkmcnt(3)
  v_exp_f32 v232, v232
  v_fmac_f32 v93, v201, v217
  v_mfma_f32_16x16x32_bf16 v[40:43], a[64:67], a[32:35], v[40:43]
  ds_read_b128 a[88:91], v6 offset:20480
  v_exp_f32 v233, v233
  v_mfma_f32_16x16x32_bf16 v[44:47], a[68:71], a[32:35], v[44:47]
  s_add_u32 m0, s39, 0
  s_add_u32 s52, s52, 28672
  buffer_load_dwordx4 v1, s[60:63], s52 offen offset:0 sc1 lds
  v_mfma_f32_16x16x32_bf16 v[48:51], a[72:75], a[32:35], v[48:51]
  ds_read_b128 a[92:95], v6 offset:21504
  v_exp_f32 v234, v234
  v_mfma_f32_16x16x32_bf16 v[116:119], a[72:75], a[36:39], v[116:119]
  buffer_load_dwordx4 v1, s[60:63], s52 offen offset:1024 sc1 lds
  v_mfma_f32_16x16x32_bf16 v[112:115], a[68:71], a[36:39], v[112:115]
  ds_read_b128 a[96:99], v6 offset:22528
  v_exp_f32 v235, v235
  v_mfma_f32_16x16x32_bf16 v[108:111], a[64:67], a[36:39], v[108:111]
  v_fmac_f32 v94, v201, v218
  v_fmac_f32 v95, v201, v219
  v_fma_f32 v232, v232, v209, v209
  v_mfma_f32_16x16x32_bf16 v[104:107], a[60:63], a[36:39], v[104:107]
  ds_read_b128 a[100:103], v6 offset:23552
  v_fma_f32 v233, v233, v209, v209
  v_fma_f32 v234, v234, v209, v209
  v_mfma_f32_16x16x32_bf16 v[68:71], a[56:59], a[36:39], v[68:71]
  buffer_load_dwordx4 v1, s[60:63], s52 offen offset:2048 sc1 lds
  v_mfma_f32_16x16x32_bf16 v[64:67], a[52:55], a[36:39], v[64:67]
  ds_read_b128 a[104:107], v6 offset:24576
  v_fma_f32 v235, v235, v209, v209
  v_mul_f32 v76, v76, v92
  v_mfma_f32_16x16x32_bf16 v[60:63], a[48:51], a[36:39], v[60:63]
  v_rcp_f32 v232, v232
  v_mul_f32 v77, v77, v93
  v_mfma_f32_16x16x32_bf16 v[56:59], a[44:47], a[36:39], v[56:59]
  s_waitcnt vmcnt(28)
  ds_read_b128 a[108:111], v6 offset:25600
  v_rcp_f32 v233, v233
  v_mfma_f32_16x16x32_bf16 v[52:55], a[40:43], a[36:39], v[52:55]
  s_waitcnt lgkmcnt(6)
  v_rcp_f32 v234, v234
  v_mul_f32 v78, v78, v94
  v_mfma_f32_16x16x32_bf16 v[16:19], a[76:79], a[112:115], v[16:19]
  ds_read_b128 a[40:43], v6 offset:26624
  v_rcp_f32 v235, v235
  v_mfma_f32_16x16x32_bf16 v[20:23], a[80:83], a[112:115], v[20:23]
  buffer_load_dwordx4 a[176:179], v244, s[24:27], s53 offen offset:1024 sc1
  v_mfma_f32_16x16x32_bf16 v[24:27], a[84:87], a[112:115], v[24:27]
  s_waitcnt lgkmcnt(4)
  ds_read_b128 a[44:47], v6 offset:27648
  v_mul_f32 v79, v79, v95
  v_mul_f32 v76, v76, v232
  v_mfma_f32_16x16x32_bf16 v[28:31], a[88:91], a[112:115], v[28:31]
  buffer_load_dwordx4 a[180:183], v245, s[24:27], s53 offen offset:1024 sc1
  v_mfma_f32_16x16x32_bf16 v[32:35], a[92:95], a[112:115], v[32:35]
  ds_read_b128 a[48:51], v6 offset:28672
  v_mul_f32 v77, v77, v233
  v_mul_f32 v78, v78, v234
  v_mfma_f32_16x16x32_bf16 v[36:39], a[96:99], a[112:115], v[36:39]
  s_waitcnt lgkmcnt(3)
  v_mul_f32 v79, v79, v235
  v_cvt_pk_bf16_f32 v238, v76, v77
  v_cvt_pk_bf16_f32 v239, v78, v79
  v_mfma_f32_16x16x32_bf16 v[40:43], a[100:103], a[112:115], v[40:43]
  ds_read_b128 a[52:55], v6 offset:29696
  v_permlane16_swap_b32 v236, v238
  v_mfma_f32_16x16x32_bf16 v[44:47], a[104:107], a[112:115], v[44:47]
  buffer_load_dwordx4 v1, s[60:63], s52 offen offset:3072 sc1 lds
  v_mfma_f32_16x16x32_bf16 v[48:51], a[108:111], a[112:115], v[48:51]
  ds_read_b128 a[56:59], v6 offset:30720
  v_permlane16_swap_b32 v237, v239
  buffer_store_dwordx4 v[236:239], v11, s[24:27], s45 offen sc1
  v_mfma_f32_16x16x32_bf16 v[116:119], a[108:111], a[116:119], v[116:119]
  s_add_u32 m0, s39, 4096
  s_add_u32 s52, s52, 4096
  buffer_load_dwordx4 v1, s[60:63], s52 offen offset:0 sc1 lds
  v_mfma_f32_16x16x32_bf16 v[112:115], a[104:107], a[116:119], v[112:115]
  ds_read_b128 a[60:63], v6 offset:31744
  v_fmac_f32 v80, v202, v212
  v_fmac_f32 v81, v202, v213
  v_mfma_f32_16x16x32_bf16 v[108:111], a[100:103], a[116:119], v[108:111]
  v_fmac_f32 v82, v202, v214
  v_fmac_f32 v83, v202, v215
  v_mul_f32 v228, v206, v80
  v_mfma_f32_16x16x32_bf16 v[104:107], a[96:99], a[116:119], v[104:107]
  ds_read_b128 a[64:67], v6 offset:32768
  v_mul_f32 v229, v206, v81
  v_mul_f32 v230, v206, v82
  v_mfma_f32_16x16x32_bf16 v[68:71], a[92:95], a[116:119], v[68:71]
  buffer_load_dwordx4 v1, s[60:63], s52 offen offset:1024 sc1 lds
  v_mfma_f32_16x16x32_bf16 v[64:67], a[88:91], a[116:119], v[64:67]
  ds_read_b128 a[68:71], v6 offset:33792
  v_mul_f32 v231, v206, v83
  v_fmac_f32 v96, v202, v216
  v_mfma_f32_16x16x32_bf16 v[60:63], a[84:87], a[116:119], v[60:63]
  v_exp_f32 v228, v228
  v_fmac_f32 v97, v202, v217
  v_mfma_f32_16x16x32_bf16 v[56:59], a[80:83], a[116:119], v[56:59]
  s_waitcnt vmcnt(32)
  ds_read_b128 a[72:75], v6 offset:34816
  v_exp_f32 v229, v229
  v_mfma_f32_16x16x32_bf16 v[52:55], a[76:79], a[116:119], v[52:55]
  s_waitcnt lgkmcnt(6)
  v_exp_f32 v230, v230
  v_fmac_f32 v98, v202, v218
  v_mfma_f32_16x16x32_bf16 v[16:19], a[40:43], a[120:123], v[16:19]
  ds_read_b128 a[76:79], v6 offset:35840
  v_exp_f32 v231, v231
  v_mfma_f32_16x16x32_bf16 v[20:23], a[44:47], a[120:123], v[20:23]
  buffer_load_dwordx4 a[184:187], v244, s[24:27], s53 offen offset:2048 sc1
  v_mfma_f32_16x16x32_bf16 v[24:27], a[48:51], a[120:123], v[24:27]
  s_waitcnt lgkmcnt(4)
  ds_read_b128 a[80:83], v6 offset:36864
  v_fmac_f32 v99, v202, v219
  v_fma_f32 v228, v228, v210, v210
  v_mfma_f32_16x16x32_bf16 v[28:31], a[52:55], a[120:123], v[28:31]
  buffer_load_dwordx4 a[188:191], v245, s[24:27], s53 offen offset:2048 sc1
  v_mfma_f32_16x16x32_bf16 v[32:35], a[56:59], a[120:123], v[32:35]
  ds_read_b128 a[84:87], v6 offset:37888
  v_fma_f32 v229, v229, v210, v210
  v_fma_f32 v230, v230, v210, v210
  v_mfma_f32_16x16x32_bf16 v[36:39], a[60:63], a[120:123], v[36:39]
  s_waitcnt lgkmcnt(3)
  v_fma_f32 v231, v231, v210, v210
  v_rcp_f32 v228, v228
  v_mfma_f32_16x16x32_bf16 v[40:43], a[64:67], a[120:123], v[40:43]
  ds_read_b128 a[88:91], v6 offset:38912
  v_rcp_f32 v229, v229
  v_mfma_f32_16x16x32_bf16 v[44:47], a[68:71], a[120:123], v[44:47]
  buffer_load_dwordx4 v1, s[60:63], s52 offen offset:2048 sc1 lds
  v_mfma_f32_16x16x32_bf16 v[48:51], a[72:75], a[120:123], v[48:51]
  ds_read_b128 a[92:95], v6 offset:39936
  v_rcp_f32 v230, v230
  v_mfma_f32_16x16x32_bf16 v[116:119], a[72:75], a[124:127], v[116:119]
  buffer_load_dwordx4 v1, s[60:63], s52 offen offset:3072 sc1 lds
  v_mfma_f32_16x16x32_bf16 v[112:115], a[68:71], a[124:127], v[112:115]
  ds_read_b128 a[96:99], v6 offset:40960
  v_rcp_f32 v231, v231
  v_mfma_f32_16x16x32_bf16 v[108:111], a[64:67], a[124:127], v[108:111]
  v_mul_f32 v80, v80, v96
  v_mul_f32 v81, v81, v97
  v_mul_f32 v82, v82, v98
  v_mfma_f32_16x16x32_bf16 v[104:107], a[60:63], a[124:127], v[104:107]
  s_waitcnt vmcnt(18)
  ds_read_b128 a[100:103], v6 offset:41984
  v_mul_f32 v83, v83, v99
  v_mul_f32 v80, v80, v228
  v_mfma_f32_16x16x32_bf16 v[68:71], a[56:59], a[124:127], v[68:71]
  s_add_u32 m0, s39, 8192
  s_add_u32 s52, s52, 4096
  buffer_load_dwordx4 v1, s[60:63], s52 offen offset:0 sc1 lds
  v_mfma_f32_16x16x32_bf16 v[64:67], a[52:55], a[124:127], v[64:67]
  s_barrier
  ds_read_b128 a[104:107], v6 offset:43008
  v_mul_f32 v81, v81, v229
  v_mul_f32 v82, v82, v230
  v_mfma_f32_16x16x32_bf16 v[60:63], a[48:51], a[124:127], v[60:63]
  v_mul_f32 v83, v83, v231
  v_cvt_pk_bf16_f32 v240, v80, v81
  v_cvt_pk_bf16_f32 v241, v82, v83
  v_mfma_f32_16x16x32_bf16 v[56:59], a[44:47], a[124:127], v[56:59]
  s_waitcnt vmcnt(35)
  ds_read_b128 a[108:111], v6 offset:44032
  v_fmac_f32 v84, v203, v212
  v_fmac_f32 v85, v203, v213
  v_mfma_f32_16x16x32_bf16 v[52:55], a[40:43], a[124:127], v[52:55]
  s_waitcnt lgkmcnt(6)
  v_fmac_f32 v86, v203, v214
  v_fmac_f32 v87, v203, v215
  v_mul_f32 v232, v207, v84
  v_mfma_f32_16x16x32_bf16 v[16:19], a[76:79], a[128:131], v[16:19]
  ds_read_b128 a[40:43], v6 offset:45056
  v_mul_f32 v233, v207, v85
  v_mul_f32 v234, v207, v86
  v_mfma_f32_16x16x32_bf16 v[20:23], a[80:83], a[128:131], v[20:23]
  buffer_load_dwordx4 a[192:195], v244, s[24:27], s53 offen offset:3072 sc1
  v_mfma_f32_16x16x32_bf16 v[24:27], a[84:87], a[128:131], v[24:27]
  s_waitcnt lgkmcnt(4)
  ds_read_b128 a[44:47], v6 offset:46080
  v_mul_f32 v235, v207, v87
  v_fmac_f32 v100, v203, v216
  v_mfma_f32_16x16x32_bf16 v[28:31], a[88:91], a[128:131], v[28:31]
  v_exp_f32 v232, v232
  v_fmac_f32 v101, v203, v217
  v_mfma_f32_16x16x32_bf16 v[32:35], a[92:95], a[128:131], v[32:35]
  ds_read_b128 a[48:51], v6 offset:47104
  v_exp_f32 v233, v233
  v_mfma_f32_16x16x32_bf16 v[36:39], a[96:99], a[128:131], v[36:39]
  s_waitcnt lgkmcnt(3)
  v_exp_f32 v234, v234
  v_fmac_f32 v102, v203, v218
  v_mfma_f32_16x16x32_bf16 v[40:43], a[100:103], a[128:131], v[40:43]
  ds_read_b128 a[52:55], v6 offset:48128
  v_exp_f32 v235, v235
  v_mfma_f32_16x16x32_bf16 v[44:47], a[104:107], a[128:131], v[44:47]
  v_fmac_f32 v103, v203, v219
  v_fma_f32 v232, v232, v211, v211
  v_fma_f32 v233, v233, v211, v211
  v_mfma_f32_16x16x32_bf16 v[48:51], a[108:111], a[128:131], v[48:51]
  ds_read_b128 a[56:59], v6 offset:49152
  v_fma_f32 v234, v234, v211, v211
  v_fma_f32 v235, v235, v211, v211
  v_mfma_f32_16x16x32_bf16 v[116:119], a[108:111], a[132:135], v[116:119]
  buffer_load_dwordx4 a[196:199], v245, s[24:27], s53 offen offset:3072 sc1
  s_add_u32 s53, s53, 4096
  v_mfma_f32_16x16x32_bf16 v[112:115], a[104:107], a[132:135], v[112:115]
  ds_read_b128 a[60:63], v6 offset:50176
  v_rcp_f32 v232, v232
  v_mfma_f32_16x16x32_bf16 v[108:111], a[100:103], a[132:135], v[108:111]
  v_rcp_f32 v233, v233
  v_mul_f32 v84, v84, v100
  v_mfma_f32_16x16x32_bf16 v[104:107], a[96:99], a[132:135], v[104:107]
  ds_read_b128 a[64:67], v6 offset:51200
  v_rcp_f32 v234, v234
  v_mfma_f32_16x16x32_bf16 v[68:71], a[92:95], a[132:135], v[68:71]
  v_rcp_f32 v235, v235
  v_mul_f32 v85, v85, v101
  v_mfma_f32_16x16x32_bf16 v[64:67], a[88:91], a[132:135], v[64:67]
  ds_read_b128 a[68:71], v6 offset:52224
  v_mul_f32 v86, v86, v102
  v_mul_f32 v87, v87, v103
  v_mfma_f32_16x16x32_bf16 v[60:63], a[84:87], a[132:135], v[60:63]
  v_mul_f32 v84, v84, v232
  v_mul_f32 v85, v85, v233
  v_mul_f32 v86, v86, v234
  v_mfma_f32_16x16x32_bf16 v[56:59], a[80:83], a[132:135], v[56:59]
  s_waitcnt vmcnt(34)
  ds_read_b128 a[72:75], v6 offset:53248
  v_cvt_pk_bf16_f32 v242, v84, v85
  v_mul_f32 v87, v87, v235
  v_mfma_f32_16x16x32_bf16 v[52:55], a[76:79], a[132:135], v[52:55]
  s_waitcnt lgkmcnt(6)
  v_cvt_pk_bf16_f32 v243, v86, v87
  v_permlane16_swap_b32 v240, v242
  v_mfma_f32_16x16x32_bf16 v[16:19], a[40:43], a[136:139], v[16:19]
  ds_read_b128 a[76:79], v6 offset:54272
  v_permlane16_swap_b32 v241, v243
  buffer_store_dwordx4 v[240:243], v12, s[24:27], s45 offen sc1
  v_mfma_f32_16x16x32_bf16 v[20:23], a[44:47], a[136:139], v[20:23]
  buffer_load_dwordx4 a[200:203], v244, s[24:27], s53 offen offset:0 sc1
  v_mfma_f32_16x16x32_bf16 v[24:27], a[48:51], a[136:139], v[24:27]
  s_waitcnt lgkmcnt(4)
  ds_read_b128 a[80:83], v6 offset:55296
  v_mfma_f32_16x16x32_bf16 v[28:31], a[52:55], a[136:139], v[28:31]
  buffer_load_dwordx4 a[204:207], v245, s[24:27], s53 offen offset:0 sc1
  v_mfma_f32_16x16x32_bf16 v[32:35], a[56:59], a[136:139], v[32:35]
  ds_read_b128 a[84:87], v6 offset:56320
  v_mfma_f32_16x16x32_bf16 v[36:39], a[60:63], a[136:139], v[36:39]
  s_waitcnt lgkmcnt(3)
  v_mfma_f32_16x16x32_bf16 v[40:43], a[64:67], a[136:139], v[40:43]
  ds_read_b128 a[88:91], v6 offset:57344
  v_mfma_f32_16x16x32_bf16 v[44:47], a[68:71], a[136:139], v[44:47]
  s_add_u32 m0, s39, 36864
  s_add_u32 s52, s52, 28672
  buffer_load_dwordx4 v1, s[60:63], s52 offen offset:0 sc1 lds
  v_mfma_f32_16x16x32_bf16 v[48:51], a[72:75], a[136:139], v[48:51]
  ds_read_b128 a[92:95], v6 offset:58368
  v_mfma_f32_16x16x32_bf16 v[116:119], a[72:75], a[140:143], v[116:119]
  buffer_load_dwordx4 v1, s[60:63], s52 offen offset:1024 sc1 lds
  v_mfma_f32_16x16x32_bf16 v[112:115], a[68:71], a[140:143], v[112:115]
  ds_read_b128 a[96:99], v6 offset:59392
  v_mfma_f32_16x16x32_bf16 v[108:111], a[64:67], a[140:143], v[108:111]
  v_mfma_f32_16x16x32_bf16 v[104:107], a[60:63], a[140:143], v[104:107]
  ds_read_b128 a[100:103], v6 offset:60416
  v_mfma_f32_16x16x32_bf16 v[68:71], a[56:59], a[140:143], v[68:71]
  buffer_load_dwordx4 v1, s[60:63], s52 offen offset:2048 sc1 lds
  v_mfma_f32_16x16x32_bf16 v[64:67], a[52:55], a[140:143], v[64:67]
  ds_read_b128 a[104:107], v6 offset:61440
  v_mfma_f32_16x16x32_bf16 v[60:63], a[48:51], a[140:143], v[60:63]
  v_mfma_f32_16x16x32_bf16 v[56:59], a[44:47], a[140:143], v[56:59]
  s_waitcnt vmcnt(35)
  ds_read_b128 a[108:111], v6 offset:62464
  v_mfma_f32_16x16x32_bf16 v[52:55], a[40:43], a[140:143], v[52:55]
  s_waitcnt lgkmcnt(6)
  v_mfma_f32_16x16x32_bf16 v[16:19], a[76:79], a[144:147], v[16:19]
  ds_read_b128 a[40:43], v6 offset:63488
  v_mfma_f32_16x16x32_bf16 v[20:23], a[80:83], a[144:147], v[20:23]
  buffer_load_dwordx4 a[208:211], v244, s[24:27], s53 offen offset:1024 sc1
  v_mfma_f32_16x16x32_bf16 v[24:27], a[84:87], a[144:147], v[24:27]
  s_waitcnt lgkmcnt(4)
  ds_read_b128 a[44:47], v6 offset:64512
  v_mfma_f32_16x16x32_bf16 v[28:31], a[88:91], a[144:147], v[28:31]
  buffer_load_dwordx4 a[212:215], v245, s[24:27], s53 offen offset:1024 sc1
  v_mfma_f32_16x16x32_bf16 v[32:35], a[92:95], a[144:147], v[32:35]
  ds_read_b128 a[48:51], v7 offset:0
  v_mfma_f32_16x16x32_bf16 v[36:39], a[96:99], a[144:147], v[36:39]
  s_waitcnt lgkmcnt(3)
  v_mfma_f32_16x16x32_bf16 v[40:43], a[100:103], a[144:147], v[40:43]
  ds_read_b128 a[52:55], v7 offset:1024
  v_mfma_f32_16x16x32_bf16 v[44:47], a[104:107], a[144:147], v[44:47]
  buffer_load_dwordx4 v1, s[60:63], s52 offen offset:3072 sc1 lds
  v_mfma_f32_16x16x32_bf16 v[48:51], a[108:111], a[144:147], v[48:51]
  ds_read_b128 a[56:59], v7 offset:2048
  v_mfma_f32_16x16x32_bf16 v[116:119], a[108:111], a[148:151], v[116:119]
  s_add_u32 m0, s39, 40960
  s_add_u32 s52, s52, 4096
  buffer_load_dwordx4 v1, s[60:63], s52 offen offset:0 sc1 lds
  v_mfma_f32_16x16x32_bf16 v[112:115], a[104:107], a[148:151], v[112:115]
  ds_read_b128 a[60:63], v7 offset:3072
  v_mfma_f32_16x16x32_bf16 v[108:111], a[100:103], a[148:151], v[108:111]
  v_mfma_f32_16x16x32_bf16 v[104:107], a[96:99], a[148:151], v[104:107]
  ds_read_b128 a[64:67], v7 offset:4096
  v_mfma_f32_16x16x32_bf16 v[68:71], a[92:95], a[148:151], v[68:71]
  buffer_load_dwordx4 v1, s[60:63], s52 offen offset:1024 sc1 lds
  v_mfma_f32_16x16x32_bf16 v[64:67], a[88:91], a[148:151], v[64:67]
  ds_read_b128 a[68:71], v7 offset:5120
  v_mfma_f32_16x16x32_bf16 v[60:63], a[84:87], a[148:151], v[60:63]
  v_mfma_f32_16x16x32_bf16 v[56:59], a[80:83], a[148:151], v[56:59]
  s_waitcnt vmcnt(35)
  ds_read_b128 a[72:75], v7 offset:6144
  v_mfma_f32_16x16x32_bf16 v[52:55], a[76:79], a[148:151], v[52:55]
  s_waitcnt lgkmcnt(6)
  v_mfma_f32_16x16x32_bf16 v[16:19], a[40:43], a[152:155], v[16:19]
  ds_read_b128 a[76:79], v7 offset:7168
  v_mfma_f32_16x16x32_bf16 v[20:23], a[44:47], a[152:155], v[20:23]
  buffer_load_dwordx4 a[216:219], v244, s[24:27], s53 offen offset:2048 sc1
  v_mfma_f32_16x16x32_bf16 v[24:27], a[48:51], a[152:155], v[24:27]
  s_waitcnt lgkmcnt(4)
  ds_read_b128 a[80:83], v7 offset:8192
  v_mfma_f32_16x16x32_bf16 v[28:31], a[52:55], a[152:155], v[28:31]
  buffer_load_dwordx4 a[220:223], v245, s[24:27], s53 offen offset:2048 sc1
  v_mfma_f32_16x16x32_bf16 v[32:35], a[56:59], a[152:155], v[32:35]
  ds_read_b128 a[84:87], v7 offset:9216
  v_mfma_f32_16x16x32_bf16 v[36:39], a[60:63], a[152:155], v[36:39]
  s_waitcnt lgkmcnt(3)
  v_mfma_f32_16x16x32_bf16 v[40:43], a[64:67], a[152:155], v[40:43]
  ds_read_b128 a[88:91], v7 offset:10240
  v_mfma_f32_16x16x32_bf16 v[44:47], a[68:71], a[152:155], v[44:47]
  buffer_load_dwordx4 v1, s[60:63], s52 offen offset:2048 sc1 lds
  v_mfma_f32_16x16x32_bf16 v[48:51], a[72:75], a[152:155], v[48:51]
  ds_read_b128 a[92:95], v7 offset:11264
  v_mfma_f32_16x16x32_bf16 v[116:119], a[72:75], a[156:159], v[116:119]
  buffer_load_dwordx4 v1, s[60:63], s52 offen offset:3072 sc1 lds
  v_mfma_f32_16x16x32_bf16 v[112:115], a[68:71], a[156:159], v[112:115]
  s_waitcnt vmcnt(14)
  ds_read_b128 a[96:99], v7 offset:12288
  v_mfma_f32_16x16x32_bf16 v[108:111], a[64:67], a[156:159], v[108:111]
  v_mfma_f32_16x16x32_bf16 v[104:107], a[60:63], a[156:159], v[104:107]
  s_waitcnt vmcnt(17)
  ds_read_b128 a[100:103], v7 offset:13312
  v_mfma_f32_16x16x32_bf16 v[68:71], a[56:59], a[156:159], v[68:71]
  s_add_u32 m0, s39, 45056
  s_add_u32 s52, s52, 4096
  buffer_load_dwordx4 v1, s[60:63], s52 offen offset:0 sc1 lds
  v_mfma_f32_16x16x32_bf16 v[64:67], a[52:55], a[156:159], v[64:67]
  s_barrier
  ds_read_b128 a[104:107], v7 offset:14336
  v_mfma_f32_16x16x32_bf16 v[60:63], a[48:51], a[156:159], v[60:63]
  v_mfma_f32_16x16x32_bf16 v[56:59], a[44:47], a[156:159], v[56:59]
  s_waitcnt vmcnt(34)
  ds_read_b128 a[108:111], v7 offset:15360
  v_mfma_f32_16x16x32_bf16 v[52:55], a[40:43], a[156:159], v[52:55]
  s_waitcnt lgkmcnt(6)
  v_mfma_f32_16x16x32_bf16 v[16:19], a[76:79], a[160:163], v[16:19]
  ds_read_b128 a[40:43], v1 offset:0
  v_mfma_f32_16x16x32_bf16 v[20:23], a[80:83], a[160:163], v[20:23]
  buffer_load_dwordx4 a[224:227], v244, s[24:27], s53 offen offset:3072 sc1
  v_mfma_f32_16x16x32_bf16 v[24:27], a[84:87], a[160:163], v[24:27]
  s_waitcnt lgkmcnt(4)
  ds_read_b128 a[44:47], v1 offset:1024
  v_mfma_f32_16x16x32_bf16 v[28:31], a[88:91], a[160:163], v[28:31]
  v_mfma_f32_16x16x32_bf16 v[32:35], a[92:95], a[160:163], v[32:35]
  ds_read_b128 a[48:51], v1 offset:2048
  v_mfma_f32_16x16x32_bf16 v[36:39], a[96:99], a[160:163], v[36:39]
  s_waitcnt lgkmcnt(3)
  v_mfma_f32_16x16x32_bf16 v[40:43], a[100:103], a[160:163], v[40:43]
  ds_read_b128 a[52:55], v1 offset:3072
  v_mfma_f32_16x16x32_bf16 v[44:47], a[104:107], a[160:163], v[44:47]
  v_mfma_f32_16x16x32_bf16 v[48:51], a[108:111], a[160:163], v[48:51]
  ds_read_b128 a[56:59], v1 offset:4096
  v_mfma_f32_16x16x32_bf16 v[116:119], a[108:111], a[164:167], v[116:119]
  buffer_load_dwordx4 a[228:231], v245, s[24:27], s53 offen offset:3072 sc1
  s_add_u32 s53, s53, 4096
  v_mfma_f32_16x16x32_bf16 v[112:115], a[104:107], a[164:167], v[112:115]
  ds_read_b128 a[60:63], v1 offset:5120
  v_mfma_f32_16x16x32_bf16 v[108:111], a[100:103], a[164:167], v[108:111]
  v_mfma_f32_16x16x32_bf16 v[104:107], a[96:99], a[164:167], v[104:107]
  ds_read_b128 a[64:67], v1 offset:6144
  v_mfma_f32_16x16x32_bf16 v[68:71], a[92:95], a[164:167], v[68:71]
  s_mov_b64 exec, 1
  buffer_store_dword v253, v252, s[96:99], s58 offen sc1
  s_mov_b64 exec, -1
  v_mfma_f32_16x16x32_bf16 v[64:67], a[88:91], a[164:167], v[64:67]
  ds_read_b128 a[68:71], v1 offset:7168
  v_mfma_f32_16x16x32_bf16 v[60:63], a[84:87], a[164:167], v[60:63]
  v_mfma_f32_16x16x32_bf16 v[56:59], a[80:83], a[164:167], v[56:59]
  s_waitcnt vmcnt(35)
  ds_read_b128 a[72:75], v1 offset:8192
  v_mfma_f32_16x16x32_bf16 v[52:55], a[76:79], a[164:167], v[52:55]
  s_waitcnt lgkmcnt(6)
  v_mfma_f32_16x16x32_bf16 v[16:19], a[40:43], a[168:171], v[16:19]
  ds_read_b128 a[76:79], v1 offset:9216
  v_mfma_f32_16x16x32_bf16 v[20:23], a[44:47], a[168:171], v[20:23]
  s_add_u32 m0, s39, 73728
  s_add_u32 s52, s52, 28672
  buffer_load_dwordx4 v1, s[60:63], s52 offen offset:0 sc1 lds
  v_mfma_f32_16x16x32_bf16 v[24:27], a[48:51], a[168:171], v[24:27]
  s_waitcnt lgkmcnt(4)
  ds_read_b128 a[80:83], v1 offset:10240
  v_mfma_f32_16x16x32_bf16 v[28:31], a[52:55], a[168:171], v[28:31]
  v_mfma_f32_16x16x32_bf16 v[32:35], a[56:59], a[168:171], v[32:35]
  ds_read_b128 a[84:87], v1 offset:11264
  v_mfma_f32_16x16x32_bf16 v[36:39], a[60:63], a[168:171], v[36:39]
  s_waitcnt lgkmcnt(3)
  buffer_load_dwordx4 v1, s[60:63], s52 offen offset:1024 sc1 lds
  v_mfma_f32_16x16x32_bf16 v[40:43], a[64:67], a[168:171], v[40:43]
  ds_read_b128 a[88:91], v1 offset:12288
  v_mfma_f32_16x16x32_bf16 v[44:47], a[68:71], a[168:171], v[44:47]
  v_mfma_f32_16x16x32_bf16 v[48:51], a[72:75], a[168:171], v[48:51]
  ds_read_b128 a[92:95], v1 offset:13312
  v_mfma_f32_16x16x32_bf16 v[116:119], a[72:75], a[172:175], v[116:119]
  v_mfma_f32_16x16x32_bf16 v[112:115], a[68:71], a[172:175], v[112:115]
  ds_read_b128 a[96:99], v1 offset:14336
  v_mfma_f32_16x16x32_bf16 v[108:111], a[64:67], a[172:175], v[108:111]
  buffer_load_dwordx4 v1, s[60:63], s52 offen offset:2048 sc1 lds
  v_mfma_f32_16x16x32_bf16 v[104:107], a[60:63], a[172:175], v[104:107]
  ds_read_b128 a[100:103], v1 offset:15360
  v_mfma_f32_16x16x32_bf16 v[68:71], a[56:59], a[172:175], v[68:71]
  v_mfma_f32_16x16x32_bf16 v[64:67], a[52:55], a[172:175], v[64:67]
  ds_read_b128 a[104:107], v1 offset:16384
  v_mfma_f32_16x16x32_bf16 v[60:63], a[48:51], a[172:175], v[60:63]
  v_mfma_f32_16x16x32_bf16 v[56:59], a[44:47], a[172:175], v[56:59]
  s_waitcnt vmcnt(33)
  ds_read_b128 a[108:111], v1 offset:17408
  v_mfma_f32_16x16x32_bf16 v[52:55], a[40:43], a[172:175], v[52:55]
  s_waitcnt lgkmcnt(6)
  v_mfma_f32_16x16x32_bf16 v[16:19], a[76:79], a[176:179], v[16:19]
  ds_read_b128 a[40:43], v1 offset:18432
  v_mfma_f32_16x16x32_bf16 v[20:23], a[80:83], a[176:179], v[20:23]
  buffer_load_dwordx4 v1, s[60:63], s52 offen offset:3072 sc1 lds
  v_mfma_f32_16x16x32_bf16 v[24:27], a[84:87], a[176:179], v[24:27]
  s_waitcnt lgkmcnt(4)
  ds_read_b128 a[44:47], v1 offset:19456
  v_mfma_f32_16x16x32_bf16 v[28:31], a[88:91], a[176:179], v[28:31]
  v_mfma_f32_16x16x32_bf16 v[32:35], a[92:95], a[176:179], v[32:35]
  ds_read_b128 a[48:51], v1 offset:20480
  v_mfma_f32_16x16x32_bf16 v[36:39], a[96:99], a[176:179], v[36:39]
  s_waitcnt lgkmcnt(3)
  s_add_u32 m0, s39, 77824
  s_add_u32 s52, s52, 4096
  buffer_load_dwordx4 v1, s[60:63], s52 offen offset:0 sc1 lds
  v_mfma_f32_16x16x32_bf16 v[40:43], a[100:103], a[176:179], v[40:43]
  ds_read_b128 a[52:55], v1 offset:21504
  v_mfma_f32_16x16x32_bf16 v[44:47], a[104:107], a[176:179], v[44:47]
  v_mfma_f32_16x16x32_bf16 v[48:51], a[108:111], a[176:179], v[48:51]
  ds_read_b128 a[56:59], v1 offset:22528
  v_mfma_f32_16x16x32_bf16 v[116:119], a[108:111], a[180:183], v[116:119]
  v_mfma_f32_16x16x32_bf16 v[112:115], a[104:107], a[180:183], v[112:115]
  ds_read_b128 a[60:63], v1 offset:23552
  v_mfma_f32_16x16x32_bf16 v[108:111], a[100:103], a[180:183], v[108:111]
  buffer_load_dwordx4 v1, s[60:63], s52 offen offset:1024 sc1 lds
  v_mfma_f32_16x16x32_bf16 v[104:107], a[96:99], a[180:183], v[104:107]
  ds_read_b128 a[64:67], v1 offset:24576
  v_mfma_f32_16x16x32_bf16 v[68:71], a[92:95], a[180:183], v[68:71]
  v_mfma_f32_16x16x32_bf16 v[64:67], a[88:91], a[180:183], v[64:67]
  ds_read_b128 a[68:71], v1 offset:25600
  v_mfma_f32_16x16x32_bf16 v[60:63], a[84:87], a[180:183], v[60:63]
  v_mfma_f32_16x16x32_bf16 v[56:59], a[80:83], a[180:183], v[56:59]
  s_waitcnt vmcnt(30)
  ds_read_b128 a[72:75], v1 offset:26624
  v_mfma_f32_16x16x32_bf16 v[52:55], a[76:79], a[180:183], v[52:55]
  s_waitcnt lgkmcnt(6)
  v_mfma_f32_16x16x32_bf16 v[16:19], a[40:43], a[184:187], v[16:19]
  ds_read_b128 a[76:79], v1 offset:27648
  v_mfma_f32_16x16x32_bf16 v[20:23], a[44:47], a[184:187], v[20:23]
  buffer_load_dwordx4 v1, s[60:63], s52 offen offset:2048 sc1 lds
  v_mfma_f32_16x16x32_bf16 v[24:27], a[48:51], a[184:187], v[24:27]
  s_waitcnt lgkmcnt(4)
  ds_read_b128 a[80:83], v1 offset:28672
  v_mfma_f32_16x16x32_bf16 v[28:31], a[52:55], a[184:187], v[28:31]
  v_mfma_f32_16x16x32_bf16 v[32:35], a[56:59], a[184:187], v[32:35]
  ds_read_b128 a[84:87], v1 offset:29696
  v_mfma_f32_16x16x32_bf16 v[36:39], a[60:63], a[184:187], v[36:39]
  s_waitcnt lgkmcnt(3)
  buffer_load_dwordx4 v1, s[60:63], s52 offen offset:3072 sc1 lds
  v_mfma_f32_16x16x32_bf16 v[40:43], a[64:67], a[184:187], v[40:43]
  ds_read_b128 a[88:91], v1 offset:30720
  v_mfma_f32_16x16x32_bf16 v[44:47], a[68:71], a[184:187], v[44:47]
  v_mfma_f32_16x16x32_bf16 v[48:51], a[72:75], a[184:187], v[48:51]
  ds_read_b128 a[92:95], v1 offset:31744
  v_mfma_f32_16x16x32_bf16 v[116:119], a[72:75], a[188:191], v[116:119]
  v_mfma_f32_16x16x32_bf16 v[112:115], a[68:71], a[188:191], v[112:115]
  ds_read_b128 a[96:99], v1 offset:32768
  v_mfma_f32_16x16x32_bf16 v[108:111], a[64:67], a[188:191], v[108:111]
  s_add_u32 m0, s39, 81920
  s_add_u32 s52, s52, 4096
  buffer_load_dwordx4 v1, s[60:63], s52 offen offset:0 sc1 lds
  v_mfma_f32_16x16x32_bf16 v[104:107], a[60:63], a[188:191], v[104:107]
  s_waitcnt vmcnt(12)
  ds_read_b128 a[100:103], v1 offset:33792
  v_mfma_f32_16x16x32_bf16 v[68:71], a[56:59], a[188:191], v[68:71]
  v_mfma_f32_16x16x32_bf16 v[64:67], a[52:55], a[188:191], v[64:67]
  s_barrier
  ds_read_b128 a[104:107], v1 offset:34816
  v_mfma_f32_16x16x32_bf16 v[60:63], a[48:51], a[188:191], v[60:63]
  buffer_load_dword v247, v246, s[96:99], s51 offen sc1
  v_mfma_f32_16x16x32_bf16 v[56:59], a[44:47], a[188:191], v[56:59]
  s_waitcnt vmcnt(29)
  ds_read_b128 a[108:111], v1 offset:35840
  v_mfma_f32_16x16x32_bf16 v[52:55], a[40:43], a[188:191], v[52:55]
  s_waitcnt lgkmcnt(6)
  v_mfma_f32_16x16x32_bf16 v[16:19], a[76:79], a[192:195], v[16:19]
  ds_read_b128 a[40:43], v1 offset:36864
  v_mfma_f32_16x16x32_bf16 v[20:23], a[80:83], a[192:195], v[20:23]
  v_mfma_f32_16x16x32_bf16 v[24:27], a[84:87], a[192:195], v[24:27]
  s_waitcnt lgkmcnt(4)
  ds_read_b128 a[44:47], v1 offset:37888
  v_mfma_f32_16x16x32_bf16 v[28:31], a[88:91], a[192:195], v[28:31]
  v_mfma_f32_16x16x32_bf16 v[32:35], a[92:95], a[192:195], v[32:35]
  ds_read_b128 a[48:51], v1 offset:38912
  v_mfma_f32_16x16x32_bf16 v[36:39], a[96:99], a[192:195], v[36:39]
  s_waitcnt lgkmcnt(3)
  v_mfma_f32_16x16x32_bf16 v[40:43], a[100:103], a[192:195], v[40:43]
  ds_read_b128 a[52:55], v1 offset:39936
  v_mfma_f32_16x16x32_bf16 v[44:47], a[104:107], a[192:195], v[44:47]
  v_mfma_f32_16x16x32_bf16 v[48:51], a[108:111], a[192:195], v[48:51]
  ds_read_b128 a[56:59], v1 offset:40960
  v_mfma_f32_16x16x32_bf16 v[116:119], a[108:111], a[196:199], v[116:119]
  v_mfma_f32_16x16x32_bf16 v[112:115], a[104:107], a[196:199], v[112:115]
  ds_read_b128 a[60:63], v1 offset:41984
  v_mfma_f32_16x16x32_bf16 v[108:111], a[100:103], a[196:199], v[108:111]
  v_mfma_f32_16x16x32_bf16 v[104:107], a[96:99], a[196:199], v[104:107]
  ds_read_b128 a[64:67], v1 offset:43008
  v_mfma_f32_16x16x32_bf16 v[68:71], a[92:95], a[196:199], v[68:71]
  v_mfma_f32_16x16x32_bf16 v[64:67], a[88:91], a[196:199], v[64:67]
  ds_read_b128 a[68:71], v1 offset:44032
  v_mfma_f32_16x16x32_bf16 v[60:63], a[84:87], a[196:199], v[60:63]
  v_mfma_f32_16x16x32_bf16 v[56:59], a[80:83], a[196:199], v[56:59]
  s_waitcnt vmcnt(26)
  ds_read_b128 a[72:75], v1 offset:45056
  v_mfma_f32_16x16x32_bf16 v[52:55], a[76:79], a[196:199], v[52:55]
  s_waitcnt lgkmcnt(6)
  v_mfma_f32_16x16x32_bf16 v[16:19], a[40:43], a[200:203], v[16:19]
  ds_read_b128 a[76:79], v1 offset:46080
  v_mfma_f32_16x16x32_bf16 v[20:23], a[44:47], a[200:203], v[20:23]
  s_add_u32 m0, s39, 110592
  s_add_u32 s52, s52, 28672
  buffer_load_dwordx4 v1, s[60:63], s52 offen offset:0 sc1 lds
  v_mfma_f32_16x16x32_bf16 v[24:27], a[48:51], a[200:203], v[24:27]
  s_waitcnt lgkmcnt(4)
  ds_read_b128 a[80:83], v1 offset:47104
  v_mfma_f32_16x16x32_bf16 v[28:31], a[52:55], a[200:203], v[28:31]
  v_mfma_f32_16x16x32_bf16 v[32:35], a[56:59], a[200:203], v[32:35]
  ds_read_b128 a[84:87], v1 offset:48128
  v_mfma_f32_16x16x32_bf16 v[36:39], a[60:63], a[200:203], v[36:39]
  s_waitcnt lgkmcnt(3)
  buffer_load_dwordx4 v1, s[60:63], s52 offen offset:1024 sc1 lds
  v_mfma_f32_16x16x32_bf16 v[40:43], a[64:67], a[200:203], v[40:43]
  ds_read_b128 a[88:91], v1 offset:49152
  v_mfma_f32_16x16x32_bf16 v[44:47], a[68:71], a[200:203], v[44:47]
  v_mfma_f32_16x16x32_bf16 v[48:51], a[72:75], a[200:203], v[48:51]
  ds_read_b128 a[92:95], v1 offset:50176
  v_mfma_f32_16x16x32_bf16 v[116:119], a[72:75], a[204:207], v[116:119]
  v_mfma_f32_16x16x32_bf16 v[112:115], a[68:71], a[204:207], v[112:115]
  ds_read_b128 a[96:99], v1 offset:51200
  v_mfma_f32_16x16x32_bf16 v[108:111], a[64:67], a[204:207], v[108:111]
  buffer_load_dwordx4 v1, s[60:63], s52 offen offset:2048 sc1 lds
  v_mfma_f32_16x16x32_bf16 v[104:107], a[60:63], a[204:207], v[104:107]
  ds_read_b128 a[100:103], v1 offset:52224
  v_mfma_f32_16x16x32_bf16 v[68:71], a[56:59], a[204:207], v[68:71]
  v_mfma_f32_16x16x32_bf16 v[64:67], a[52:55], a[204:207], v[64:67]
  ds_read_b128 a[104:107], v1 offset:53248
  v_mfma_f32_16x16x32_bf16 v[60:63], a[48:51], a[204:207], v[60:63]
  s_waitcnt vmcnt(3)
  v_cmp_ne_u32 vcc, v253, v247
  s_nop 1
  s_cmp_lg_u64 vcc, 0
  s_cbranch_scc1 fb_slow
fb_ok:
  v_mfma_f32_16x16x32_bf16 v[56:59], a[44:47], a[204:207], v[56:59]
  s_waitcnt vmcnt(24)
  ds_read_b128 a[108:111], v1 offset:54272
  v_mfma_f32_16x16x32_bf16 v[52:55], a[40:43], a[204:207], v[52:55]
  s_waitcnt lgkmcnt(6)
  v_mfma_f32_16x16x32_bf16 v[16:19], a[76:79], a[208:211], v[16:19]
  ds_read_b128 a[40:43], v1 offset:55296
  v_mfma_f32_16x16x32_bf16 v[20:23], a[80:83], a[208:211], v[20:23]
  buffer_load_dwordx4 a[232:235], v244, s[24:27], s53 offen offset:0 sc1
  v_mfma_f32_16x16x32_bf16 v[24:27], a[84:87], a[208:211], v[24:27]
  s_waitcnt lgkmcnt(4)
  ds_read_b128 a[44:47], v1 offset:56320
  v_mfma_f32_16x16x32_bf16 v[28:31], a[88:91], a[208:211], v[28:31]
  buffer_load_dwordx4 a[236:239], v245, s[24:27], s53 offen offset:0 sc1
  v_mfma_f32_16x16x32_bf16 v[32:35], a[92:95], a[208:211], v[32:35]
  ds_read_b128 a[48:51], v1 offset:57344
  v_mfma_f32_16x16x32_bf16 v[36:39], a[96:99], a[208:211], v[36:39]
  s_waitcnt lgkmcnt(3)
  v_mfma_f32_16x16x32_bf16 v[40:43], a[100:103], a[208:211], v[40:43]
  ds_read_b128 a[52:55], v1 offset:58368
  v_mfma_f32_16x16x32_bf16 v[44:47], a[104:107], a[208:211], v[44:47]
  buffer_load_dwordx4 v1, s[60:63], s52 offen offset:3072 sc1 lds
  v_mfma_f32_16x16x32_bf16 v[48:51], a[108:111], a[208:211], v[48:51]
  ds_read_b128 a[56:59], v1 offset:59392
  v_mfma_f32_16x16x32_bf16 v[116:119], a[108:111], a[212:215], v[116:119]
  s_add_u32 m0, s39, 114688
  s_add_u32 s52, s52, 4096
  buffer_load_dwordx4 v1, s[60:63], s52 offen offset:0 sc1 lds
  v_mfma_f32_16x16x32_bf16 v[112:115], a[104:107], a[212:215], v[112:115]
  ds_read_b128 a[60:63], v1 offset:60416
  v_mfma_f32_16x16x32_bf16 v[108:111], a[100:103], a[212:215], v[108:111]
  v_mfma_f32_16x16x32_bf16 v[104:107], a[96:99], a[212:215], v[104:107]
  ds_read_b128 a[64:67], v1 offset:61440
  v_mfma_f32_16x16x32_bf16 v[68:71], a[92:95], a[212:215], v[68:71]
  buffer_load_dwordx4 v1, s[60:63], s52 offen offset:1024 sc1 lds
  v_mfma_f32_16x16x32_bf16 v[64:67], a[88:91], a[212:215], v[64:67]
  ds_read_b128 a[68:71], v1 offset:62464
  v_mfma_f32_16x16x32_bf16 v[60:63], a[84:87], a[212:215], v[60:63]
  v_mfma_f32_16x16x32_bf16 v[56:59], a[80:83], a[212:215], v[56:59]
  s_waitcnt vmcnt(24)
  ds_read_b128 a[72:75], v1 offset:63488
  v_mfma_f32_16x16x32_bf16 v[52:55], a[76:79], a[212:215], v[52:55]
  s_waitcnt lgkmcnt(6)
  v_mfma_f32_16x16x32_bf16 v[16:19], a[40:43], a[216:219], v[16:19]
  ds_read_b128 a[76:79], v1 offset:64512
  v_mfma_f32_16x16x32_bf16 v[20:23], a[44:47], a[216:219], v[20:23]
  buffer_load_dwordx4 a[240:243], v244, s[24:27], s53 offen offset:1024 sc1
  v_mfma_f32_16x16x32_bf16 v[24:27], a[48:51], a[216:219], v[24:27]
  s_waitcnt lgkmcnt(4)
  ds_read_b128 a[80:83], v6 offset:0
  v_mfma_f32_16x16x32_bf16 v[28:31], a[52:55], a[216:219], v[28:31]
  buffer_load_dwordx4 a[244:247], v245, s[24:27], s53 offen offset:1024 sc1
  v_mfma_f32_16x16x32_bf16 v[32:35], a[56:59], a[216:219], v[32:35]
  ds_read_b128 a[84:87], v6 offset:1024
  v_mfma_f32_16x16x32_bf16 v[36:39], a[60:63], a[216:219], v[36:39]
  s_waitcnt lgkmcnt(3)
  v_mfma_f32_16x16x32_bf16 v[40:43], a[64:67], a[216:219], v[40:43]
  ds_read_b128 a[88:91], v6 offset:2048
  v_mfma_f32_16x16x32_bf16 v[44:47], a[68:71], a[216:219], v[44:47]
  buffer_load_dwordx4 v1, s[60:63], s52 offen offset:2048 sc1 lds
  v_mfma_f32_16x16x32_bf16 v[48:51], a[72:75], a[216:219], v[48:51]
  ds_read_b128 a[92:95], v6 offset:3072
  v_mfma_f32_16x16x32_bf16 v[116:119], a[72:75], a[220:223], v[116:119]
  buffer_load_dwordx4 v1, s[60:63], s52 offen offset:3072 sc1 lds
  v_mfma_f32_16x16x32_bf16 v[112:115], a[68:71], a[220:223], v[112:115]
  ds_read_b128 a[96:99], v6 offset:4096
  v_mfma_f32_16x16x32_bf16 v[108:111], a[64:67], a[220:223], v[108:111]
  v_mfma_f32_16x16x32_bf16 v[104:107], a[60:63], a[220:223], v[104:107]
  s_waitcnt vmcnt(13)
  ds_read_b128 a[100:103], v6 offset:5120
  v_mfma_f32_16x16x32_bf16 v[68:71], a[56:59], a[220:223], v[68:71]
  s_add_u32 m0, s39, 118784
  s_add_u32 s52, s52, 4096
  buffer_load_dwordx4 v1, s[60:63], s52 offen offset:0 sc1 lds
  v_mfma_f32_16x16x32_bf16 v[64:67], a[52:55], a[220:223], v[64:67]
  s_barrier
  ds_read_b128 a[104:107], v6 offset:6144
  v_mfma_f32_16x16x32_bf16 v[60:63], a[48:51], a[220:223], v[60:63]
  v_mfma_f32_16x16x32_bf16 v[56:59], a[44:47], a[220:223], v[56:59]
  s_waitcnt vmcnt(24)
  ds_read_b128 a[108:111], v6 offset:7168
  v_mfma_f32_16x16x32_bf16 v[52:55], a[40:43], a[220:223], v[52:55]
  s_waitcnt lgkmcnt(6)
  v_mfma_f32_16x16x32_bf16 v[16:19], a[76:79], a[224:227], v[16:19]
  ds_read_b128 a[40:43], v6 offset:8192
  v_mfma_f32_16x16x32_bf16 v[20:23], a[80:83], a[224:227], v[20:23]
  buffer_load_dwordx4 a[248:251], v244, s[24:27], s53 offen offset:2048 sc1
  v_mfma_f32_16x16x32_bf16 v[24:27], a[84:87], a[224:227], v[24:27]
  s_waitcnt lgkmcnt(4)
  ds_read_b128 a[44:47], v6 offset:9216
  v_mfma_f32_16x16x32_bf16 v[28:31], a[88:91], a[224:227], v[28:31]
  v_mfma_f32_16x16x32_bf16 v[32:35], a[92:95], a[224:227], v[32:35]
  ds_read_b128 a[48:51], v6 offset:10240
  v_mfma_f32_16x16x32_bf16 v[36:39], a[96:99], a[224:227], v[36:39]
  s_waitcnt lgkmcnt(3)
  v_mfma_f32_16x16x32_bf16 v[40:43], a[100:103], a[224:227], v[40:43]
  ds_read_b128 a[52:55], v6 offset:11264
  v_mfma_f32_16x16x32_bf16 v[44:47], a[104:107], a[224:227], v[44:47]
  v_mfma_f32_16x16x32_bf16 v[48:51], a[108:111], a[224:227], v[48:51]
  ds_read_b128 a[56:59], v6 offset:12288
  v_mfma_f32_16x16x32_bf16 v[116:119], a[108:111], a[228:231], v[116:119]
  buffer_load_dwordx4 a[252:255], v245, s[24:27], s53 offen offset:2048 sc1
  v_mfma_f32_16x16x32_bf16 v[112:115], a[104:107], a[228:231], v[112:115]
  ds_read_b128 a[60:63], v6 offset:13312
  v_mfma_f32_16x16x32_bf16 v[108:111], a[100:103], a[228:231], v[108:111]
  v_mfma_f32_16x16x32_bf16 v[104:107], a[96:99], a[228:231], v[104:107]
  ds_read_b128 a[64:67], v6 offset:14336
  v_mfma_f32_16x16x32_bf16 v[68:71], a[92:95], a[228:231], v[68:71]
  v_mfma_f32_16x16x32_bf16 v[64:67], a[88:91], a[228:231], v[64:67]
  ds_read_b128 a[68:71], v6 offset:15360
  v_mfma_f32_16x16x32_bf16 v[60:63], a[84:87], a[228:231], v[60:63]
  v_mfma_f32_16x16x32_bf16 v[56:59], a[80:83], a[228:231], v[56:59]
  s_waitcnt vmcnt(10)
  ds_read_b128 a[72:75], v6 offset:16384
  v_mfma_f32_16x16x32_bf16 v[52:55], a[76:79], a[228:231], v[52:55]
  s_waitcnt lgkmcnt(6)
  v_mfma_f32_16x16x32_bf16 v[16:19], a[40:43], a[232:235], v[16:19]
  ds_read_b128 a[76:79], v6 offset:17408
  v_mfma_f32_16x16x32_bf16 v[20:23], a[44:47], a[232:235], v[20:23]
  buffer_load_dwordx4 a[0:3], v244, s[24:27], s53 offen offset:3072 sc1
  v_mfma_f32_16x16x32_bf16 v[24:27], a[48:51], a[232:235], v[24:27]
  s_waitcnt lgkmcnt(4)
  ds_read_b128 a[80:83], v6 offset:18432
  v_mfma_f32_16x16x32_bf16 v[28:31], a[52:55], a[232:235], v[28:31]
  buffer_load_dwordx4 a[4:7], v245, s[24:27], s53 offen offset:3072 sc1
  s_add_u32 s53, s53, 4096
  v_mfma_f32_16x16x32_bf16 v[32:35], a[56:59], a[232:235], v[32:35]
  ds_read_b128 a[84:87], v6 offset:19456
  v_mfma_f32_16x16x32_bf16 v[36:39], a[60:63], a[232:235], v[36:39]
  s_waitcnt lgkmcnt(3)
  v_mfma_f32_16x16x32_bf16 v[40:43], a[64:67], a[232:235], v[40:43]
  ds_read_b128 a[88:91], v6 offset:20480
  v_mfma_f32_16x16x32_bf16 v[44:47], a[68:71], a[232:235], v[44:47]
  s_add_u32 m0, s39, 0
  s_add_u32 s52, s52, 28672
  buffer_load_dwordx4 v1, s[60:63], s52 offen offset:0 sc1 lds
  v_mfma_f32_16x16x32_bf16 v[48:51], a[72:75], a[232:235], v[48:51]
  ds_read_b128 a[92:95], v6 offset:21504
  v_mfma_f32_16x16x32_bf16 v[116:119], a[72:75], a[236:239], v[116:119]
  buffer_load_dwordx4 v1, s[60:63], s52 offen offset:1024 sc1 lds
  v_mfma_f32_16x16x32_bf16 v[112:115], a[68:71], a[236:239], v[112:115]
  ds_read_b128 a[96:99], v6 offset:22528
  v_mfma_f32_16x16x32_bf16 v[108:111], a[64:67], a[236:239], v[108:111]
  v_mfma_f32_16x16x32_bf16 v[104:107], a[60:63], a[236:239], v[104:107]
  ds_read_b128 a[100:103], v6 offset:23552
  v_mfma_f32_16x16x32_bf16 v[68:71], a[56:59], a[236:239], v[68:71]
  buffer_load_dwordx4 v1, s[60:63], s52 offen offset:2048 sc1 lds
  v_mfma_f32_16x16x32_bf16 v[64:67], a[52:55], a[236:239], v[64:67]
  ds_read_b128 a[104:107], v6 offset:24576
  v_mfma_f32_16x16x32_bf16 v[60:63], a[48:51], a[236:239], v[60:63]
  v_mfma_f32_16x16x32_bf16 v[56:59], a[44:47], a[236:239], v[56:59]
  s_waitcnt vmcnt(10)
  ds_read_b128 a[108:111], v6 offset:25600
  v_mfma_f32_16x16x32_bf16 v[52:55], a[40:43], a[236:239], v[52:55]
  s_waitcnt lgkmcnt(6)
  v_mfma_f32_16x16x32_bf16 v[16:19], a[76:79], a[240:243], v[16:19]
  ds_read_b128 a[40:43], v6 offset:26624
  v_mfma_f32_16x16x32_bf16 v[20:23], a[80:83], a[240:243], v[20:23]
  buffer_load_dwordx4 a[8:11], v244, s[24:27], s53 offen offset:0 sc1
  v_mfma_f32_16x16x32_bf16 v[24:27], a[84:87], a[240:243], v[24:27]
  s_waitcnt lgkmcnt(4)
  ds_read_b128 a[44:47], v6 offset:27648
  v_mfma_f32_16x16x32_bf16 v[28:31], a[88:91], a[240:243], v[28:31]
  buffer_load_dwordx4 a[12:15], v245, s[24:27], s53 offen offset:0 sc1
  v_mfma_f32_16x16x32_bf16 v[32:35], a[92:95], a[240:243], v[32:35]
  ds_read_b128 a[48:51], v6 offset:28672
  v_mfma_f32_16x16x32_bf16 v[36:39], a[96:99], a[240:243], v[36:39]
  s_waitcnt lgkmcnt(3)
  buffer_load_dwordx4 a[16:19], v244, s[24:27], s53 offen offset:1024 sc1
  v_mfma_f32_16x16x32_bf16 v[40:43], a[100:103], a[240:243], v[40:43]
  ds_read_b128 a[52:55], v6 offset:29696
  v_mfma_f32_16x16x32_bf16 v[44:47], a[104:107], a[240:243], v[44:47]
  buffer_load_dwordx4 a[20:23], v245, s[24:27], s53 offen offset:1024 sc1
  v_mfma_f32_16x16x32_bf16 v[48:51], a[108:111], a[240:243], v[48:51]
  ds_read_b128 a[56:59], v6 offset:30720
  v_mfma_f32_16x16x32_bf16 v[116:119], a[108:111], a[244:247], v[116:119]
  buffer_load_dwordx4 v1, s[60:63], s52 offen offset:3072 sc1 lds
  v_mfma_f32_16x16x32_bf16 v[112:115], a[104:107], a[244:247], v[112:115]
  ds_read_b128 a[60:63], v6 offset:31744
  v_mfma_f32_16x16x32_bf16 v[108:111], a[100:103], a[244:247], v[108:111]
  s_add_u32 m0, s39, 4096
  s_add_u32 s52, s52, 4096
  buffer_load_dwordx4 v1, s[60:63], s52 offen offset:0 sc1 lds
  v_mfma_f32_16x16x32_bf16 v[104:107], a[96:99], a[244:247], v[104:107]
  ds_read_b128 a[64:67], v6 offset:32768
  v_mfma_f32_16x16x32_bf16 v[68:71], a[92:95], a[244:247], v[68:71]
  buffer_load_dwordx4 v1, s[60:63], s52 offen offset:1024 sc1 lds
  v_mfma_f32_16x16x32_bf16 v[64:67], a[88:91], a[244:247], v[64:67]
  ds_read_b128 a[68:71], v6 offset:33792
  v_mfma_f32_16x16x32_bf16 v[60:63], a[84:87], a[244:247], v[60:63]
  v_mfma_f32_16x16x32_bf16 v[56:59], a[80:83], a[244:247], v[56:59]
  s_waitcnt vmcnt(12)
  ds_read_b128 a[72:75], v6 offset:34816
  v_mfma_f32_16x16x32_bf16 v[52:55], a[76:79], a[244:247], v[52:55]
  s_waitcnt lgkmcnt(6)
  v_mfma_f32_16x16x32_bf16 v[16:19], a[40:43], a[248:251], v[16:19]
  ds_read_b128 a[76:79], v6 offset:35840
  v_mfma_f32_16x16x32_bf16 v[20:23], a[44:47], a[248:251], v[20:23]
  buffer_load_dwordx4 a[24:27], v244, s[24:27], s53 offen offset:2048 sc1
  v_mfma_f32_16x16x32_bf16 v[24:27], a[48:51], a[248:251], v[24:27]
  s_waitcnt lgkmcnt(4)
  ds_read_b128 a[80:83], v6 offset:36864
  v_mfma_f32_16x16x32_bf16 v[28:31], a[52:55], a[248:251], v[28:31]
  buffer_load_dwordx4 a[28:31], v245, s[24:27], s53 offen offset:2048 sc1
  v_mfma_f32_16x16x32_bf16 v[32:35], a[56:59], a[248:251], v[32:35]
  ds_read_b128 a[84:87], v6 offset:37888
  v_mfma_f32_16x16x32_bf16 v[36:39], a[60:63], a[248:251], v[36:39]
  s_waitcnt lgkmcnt(3)
  v_mfma_f32_16x16x32_bf16 v[40:43], a[64:67], a[248:251], v[40:43]
  ds_read_b128 a[88:91], v6 offset:38912
  v_mfma_f32_16x16x32_bf16 v[44:47], a[68:71], a[248:251], v[44:47]
  buffer_load_dwordx4 v1, s[60:63], s52 offen offset:2048 sc1 lds
  v_mfma_f32_16x16x32_bf16 v[48:51], a[72:75], a[248:251], v[48:51]
  ds_read_b128 a[92:95], v6 offset:39936
  v_mfma_f32_16x16x32_bf16 v[116:119], a[72:75], a[252:255], v[116:119]
  buffer_load_dwordx4 v1, s[60:63], s52 offen offset:3072 sc1 lds
  v_mfma_f32_16x16x32_bf16 v[112:115], a[68:71], a[252:255], v[112:115]
  ds_read_b128 a[96:99], v6 offset:40960
  v_mfma_f32_16x16x32_bf16 v[108:111], a[64:67], a[252:255], v[108:111]
  v_mfma_f32_16x16x32_bf16 v[104:107], a[60:63], a[252:255], v[104:107]
  s_waitcnt vmcnt(18)
  ds_read_b128 a[100:103], v6 offset:41984
  v_mfma_f32_16x16x32_bf16 v[68:71], a[56:59], a[252:255], v[68:71]
  s_add_u32 m0, s39, 8192
  s_add_u32 s52, s52, 4096
  buffer_load_dwordx4 v1, s[60:63], s52 offen offset:0 sc1 lds
  v_mfma_f32_16x16x32_bf16 v[64:67], a[52:55], a[252:255], v[64:67]
  s_barrier
  ds_read_b128 a[104:107], v6 offset:43008
  v_mfma_f32_16x16x32_bf16 v[60:63], a[48:51], a[252:255], v[60:63]
  v_mfma_f32_16x16x32_bf16 v[56:59], a[44:47], a[252:255], v[56:59]
  s_waitcnt vmcnt(15)
  ds_read_b128 a[108:111], v6 offset:44032
  v_mfma_f32_16x16x32_bf16 v[52:55], a[40:43], a[252:255], v[52:55]
  s_waitcnt lgkmcnt(6)
  v_mfma_f32_16x16x32_bf16 v[16:19], a[76:79], a[0:3], v[16:19]
  ds_read_b128 a[40:43], v6 offset:45056
  v_mfma_f32_16x16x32_bf16 v[20:23], a[80:83], a[0:3], v[20:23]
  buffer_load_dwordx4 a[32:35], v244, s[24:27], s53 offen offset:3072 sc1
  v_mfma_f32_16x16x32_bf16 v[24:27], a[84:87], a[0:3], v[24:27]
  s_waitcnt lgkmcnt(4)
  ds_read_b128 a[44:47], v6 offset:46080
  v_mfma_f32_16x16x32_bf16 v[28:31], a[88:91], a[0:3], v[28:31]
  v_mfma_f32_16x16x32_bf16 v[32:35], a[92:95], a[0:3], v[32:35]
  ds_read_b128 a[48:51], v6 offset:47104
  v_mfma_f32_16x16x32_bf16 v[36:39], a[96:99], a[0:3], v[36:39]
  s_waitcnt lgkmcnt(3)
  v_mfma_f32_16x16x32_bf16 v[40:43], a[100:103], a[0:3], v[40:43]
  ds_read_b128 a[52:55], v6 offset:48128
  v_mfma_f32_16x16x32_bf16 v[44:47], a[104:107], a[0:3], v[44:47]
  v_mfma_f32_16x16x32_bf16 v[48:51], a[108:111], a[0:3], v[48:51]
  ds_read_b128 a[56:59], v6 offset:49152
  v_mfma_f32_16x16x32_bf16 v[116:119], a[108:111], a[4:7], v[116:119]
  buffer_load_dwordx4 a[36:39], v245, s[24:27], s53 offen offset:3072 sc1
  s_add_u32 s53, s53, 4096
  v_mfma_f32_16x16x32_bf16 v[112:115], a[104:107], a[4:7], v[112:115]
  ds_read_b128 a[60:63], v6 offset:50176
  v_mfma_f32_16x16x32_bf16 v[108:111], a[100:103], a[4:7], v[108:111]
  v_mfma_f32_16x16x32_bf16 v[104:107], a[96:99], a[4:7], v[104:107]
  ds_read_b128 a[64:67], v6 offset:51200
  v_mfma_f32_16x16x32_bf16 v[68:71], a[92:95], a[4:7], v[68:71]
  v_mfma_f32_16x16x32_bf16 v[64:67], a[88:91], a[4:7], v[64:67]
  ds_read_b128 a[68:71], v6 offset:52224
  v_mfma_f32_16x16x32_bf16 v[60:63], a[84:87], a[4:7], v[60:63]
  v_mfma_f32_16x16x32_bf16 v[56:59], a[80:83], a[4:7], v[56:59]
  s_waitcnt vmcnt(12)
  ds_read_b128 a[72:75], v6 offset:53248
  v_mfma_f32_16x16x32_bf16 v[52:55], a[76:79], a[4:7], v[52:55]
  s_waitcnt lgkmcnt(6)
  v_mfma_f32_16x16x32_bf16 v[16:19], a[40:43], a[8:11], v[16:19]
  ds_read_b128 a[76:79], v6 offset:54272
  v_mfma_f32_16x16x32_bf16 v[20:23], a[44:47], a[8:11], v[20:23]
  buffer_load_dwordx4 a[112:115], v244, s[24:27], s53 offen offset:0 sc1
  v_mfma_f32_16x16x32_bf16 v[24:27], a[48:51], a[8:11], v[24:27]
  s_waitcnt lgkmcnt(4)
  ds_read_b128 a[80:83], v6 offset:55296
  v_mfma_f32_16x16x32_bf16 v[28:31], a[52:55], a[8:11], v[28:31]
  buffer_load_dwordx4 a[116:119], v245, s[24:27], s53 offen offset:0 sc1
  v_mfma_f32_16x16x32_bf16 v[32:35], a[56:59], a[8:11], v[32:35]
  ds_read_b128 a[84:87], v6 offset:56320
  v_mfma_f32_16x16x32_bf16 v[36:39], a[60:63], a[8:11], v[36:39]
  s_waitcnt lgkmcnt(3)
  v_mfma_f32_16x16x32_bf16 v[40:43], a[64:67], a[8:11], v[40:43]
  ds_read_b128 a[88:91], v6 offset:57344
  v_mfma_f32_16x16x32_bf16 v[44:47], a[68:71], a[8:11], v[44:47]
  s_add_u32 m0, s39, 36864
  s_add_u32 s52, s52, 28672
  buffer_load_dwordx4 v1, s[60:63], s52 offen offset:0 sc1 lds
  v_mfma_f32_16x16x32_bf16 v[48:51], a[72:75], a[8:11], v[48:51]
  ds_read_b128 a[92:95], v6 offset:58368
  v_mfma_f32_16x16x32_bf16 v[116:119], a[72:75], a[12:15], v[116:119]
  buffer_load_dwordx4 v1, s[60:63], s52 offen offset:1024 sc1 lds
  v_mfma_f32_16x16x32_bf16 v[112:115], a[68:71], a[12:15], v[112:115]
  ds_read_b128 a[96:99], v6 offset:59392
  v_mfma_f32_16x16x32_bf16 v[108:111], a[64:67], a[12:15], v[108:111]
  v_mfma_f32_16x16x32_bf16 v[104:107], a[60:63], a[12:15], v[104:107]
  ds_read_b128 a[100:103], v6 offset:60416
  v_mfma_f32_16x16x32_bf16 v[68:71], a[56:59], a[12:15], v[68:71]
  buffer_load_dwordx4 v1, s[60:63], s52 offen offset:2048 sc1 lds
  v_mfma_f32_16x16x32_bf16 v[64:67], a[52:55], a[12:15], v[64:67]
  ds_read_b128 a[104:107], v6 offset:61440
  v_mfma_f32_16x16x32_bf16 v[60:63], a[48:51], a[12:15], v[60:63]
  v_mfma_f32_16x16x32_bf16 v[56:59], a[44:47], a[12:15], v[56:59]
  s_waitcnt vmcnt(15)
  ds_read_b128 a[108:111], v6 offset:62464
  v_mfma_f32_16x16x32_bf16 v[52:55], a[40:43], a[12:15], v[52:55]
  s_waitcnt lgkmcnt(6)
  v_mfma_f32_16x16x32_bf16 v[16:19], a[76:79], a[16:19], v[16:19]
  ds_read_b128 a[40:43], v6 offset:63488
  v_mfma_f32_16x16x32_bf16 v[20:23], a[80:83], a[16:19], v[20:23]
  buffer_load_dwordx4 a[120:123], v244, s[24:27], s53 offen offset:1024 sc1
  v_mfma_f32_16x16x32_bf16 v[24:27], a[84:87], a[16:19], v[24:27]
  s_waitcnt lgkmcnt(4)
  ds_read_b128 a[44:47], v6 offset:64512
  v_mfma_f32_16x16x32_bf16 v[28:31], a[88:91], a[16:19], v[28:31]
  buffer_load_dwordx4 a[124:127], v245, s[24:27], s53 offen offset:1024 sc1
  v_mfma_f32_16x16x32_bf16 v[32:35], a[92:95], a[16:19], v[32:35]
  ds_read_b128 a[48:51], v7 offset:0
  v_mfma_f32_16x16x32_bf16 v[36:39], a[96:99], a[16:19], v[36:39]
  s_waitcnt lgkmcnt(3)
  v_mfma_f32_16x16x32_bf16 v[40:43], a[100:103], a[16:19], v[40:43]
  ds_read_b128 a[52:55], v7 offset:1024
  v_mfma_f32_16x16x32_bf16 v[44:47], a[104:107], a[16:19], v[44:47]
  buffer_load_dwordx4 v1, s[60:63], s52 offen offset:3072 sc1 lds
  v_mfma_f32_16x16x32_bf16 v[48:51], a[108:111], a[16:19], v[48:51]
  ds_read_b128 a[56:59], v7 offset:2048
  v_mfma_f32_16x16x32_bf16 v[116:119], a[108:111], a[20:23], v[116:119]
  s_add_u32 m0, s39, 40960
  s_add_u32 s52, s52, 4096
  buffer_load_dwordx4 v1, s[60:63], s52 offen offset:0 sc1 lds
  v_mfma_f32_16x16x32_bf16 v[112:115], a[104:107], a[20:23], v[112:115]
  ds_read_b128 a[60:63], v7 offset:3072
  v_mfma_f32_16x16x32_bf16 v[108:111], a[100:103], a[20:23], v[108:111]
  v_mfma_f32_16x16x32_bf16 v[104:107], a[96:99], a[20:23], v[104:107]
  ds_read_b128 a[64:67], v7 offset:4096
  v_mfma_f32_16x16x32_bf16 v[68:71], a[92:95], a[20:23], v[68:71]
  buffer_load_dwordx4 v1, s[60:63], s52 offen offset:1024 sc1 lds
  v_mfma_f32_16x16x32_bf16 v[64:67], a[88:91], a[20:23], v[64:67]
  ds_read_b128 a[68:71], v7 offset:5120
  v_mfma_f32_16x16x32_bf16 v[60:63], a[84:87], a[20:23], v[60:63]
  v_mfma_f32_16x16x32_bf16 v[56:59], a[80:83], a[20:23], v[56:59]
  s_waitcnt vmcnt(15)
  ds_read_b128 a[72:75], v7 offset:6144
  v_mfma_f32_16x16x32_bf16 v[52:55], a[76:79], a[20:23], v[52:55]
  s_waitcnt lgkmcnt(6)
  v_mfma_f32_16x16x32_bf16 v[16:19], a[40:43], a[24:27], v[16:19]
  ds_read_b128 a[76:79], v7 offset:7168
  v_mfma_f32_16x16x32_bf16 v[20:23], a[44:47], a[24:27], v[20:23]
  buffer_load_dwordx4 a[128:131], v244, s[24:27], s53 offen offset:2048 sc1
  v_mfma_f32_16x16x32_bf16 v[24:27], a[48:51], a[24:27], v[24:27]
  s_waitcnt lgkmcnt(4)
  ds_read_b128 a[80:83], v7 offset:8192
  v_mfma_f32_16x16x32_bf16 v[28:31], a[52:55], a[24:27], v[28:31]
  buffer_load_dwordx4 a[132:135], v245, s[24:27], s53 offen offset:2048 sc1
  v_mfma_f32_16x16x32_bf16 v[32:35], a[56:59], a[24:27], v[32:35]
  ds_read_b128 a[84:87], v7 offset:9216
  v_mfma_f32_16x16x32_bf16 v[36:39], a[60:63], a[24:27], v[36:39]
  s_waitcnt lgkmcnt(3)
  buffer_load_dwordx4 a[136:139], v244, s[24:27], s53 offen offset:3072 sc1
  v_mfma_f32_16x16x32_bf16 v[40:43], a[64:67], a[24:27], v[40:43]
  ds_read_b128 a[88:91], v7 offset:10240
  v_mfma_f32_16x16x32_bf16 v[44:47], a[68:71], a[24:27], v[44:47]
  buffer_load_dwordx4 a[140:143], v245, s[24:27], s53 offen offset:3072 sc1
  s_add_u32 s53, s53, 4096
  v_mfma_f32_16x16x32_bf16 v[48:51], a[72:75], a[24:27], v[48:51]
  ds_read_b128 a[92:95], v7 offset:11264
  v_mfma_f32_16x16x32_bf16 v[116:119], a[72:75], a[28:31], v[116:119]
  buffer_load_dwordx4 v1, s[60:63], s52 offen offset:2048 sc1 lds
  v_mfma_f32_16x16x32_bf16 v[112:115], a[68:71], a[28:31], v[112:115]
  ds_read_b128 a[96:99], v7 offset:12288
  v_mfma_f32_16x16x32_bf16 v[108:111], a[64:67], a[28:31], v[108:111]
  buffer_load_dwordx4 v1, s[60:63], s52 offen offset:3072 sc1 lds
  v_mfma_f32_16x16x32_bf16 v[104:107], a[60:63], a[28:31], v[104:107]
  s_waitcnt vmcnt(18)
  ds_read_b128 a[100:103], v7 offset:13312
  v_mfma_f32_16x16x32_bf16 v[68:71], a[56:59], a[28:31], v[68:71]
  s_add_u32 m0, s39, 45056
  s_add_u32 s52, s52, 4096
  buffer_load_dwordx4 v1, s[60:63], s52 offen offset:0 sc1 lds
  v_mfma_f32_16x16x32_bf16 v[64:67], a[52:55], a[28:31], v[64:67]
  s_barrier
  ds_read_b128 a[104:107], v7 offset:14336
  v_mfma_f32_16x16x32_bf16 v[60:63], a[48:51], a[28:31], v[60:63]
  v_mfma_f32_16x16x32_bf16 v[56:59], a[44:47], a[28:31], v[56:59]
  s_waitcnt vmcnt(17)
  ds_read_b128 a[108:111], v7 offset:15360
  v_mfma_f32_16x16x32_bf16 v[52:55], a[40:43], a[28:31], v[52:55]
  s_waitcnt lgkmcnt(6)
  v_mfma_f32_16x16x32_bf16 v[16:19], a[76:79], a[32:35], v[16:19]
  ds_read_b128 a[40:43], v1 offset:0
  v_mfma_f32_16x16x32_bf16 v[20:23], a[80:83], a[32:35], v[20:23]
  buffer_load_dwordx4 a[144:147], v244, s[24:27], s53 offen offset:0 sc1
  v_mfma_f32_16x16x32_bf16 v[24:27], a[84:87], a[32:35], v[24:27]
  s_waitcnt lgkmcnt(4)
  ds_read_b128 a[44:47], v1 offset:1024
  v_mfma_f32_16x16x32_bf16 v[28:31], a[88:91], a[32:35], v[28:31]
  v_mfma_f32_16x16x32_bf16 v[32:35], a[92:95], a[32:35], v[32:35]
  ds_read_b128 a[48:51], v1 offset:2048
  v_mfma_f32_16x16x32_bf16 v[36:39], a[96:99], a[32:35], v[36:39]
  s_waitcnt lgkmcnt(3)
  v_mfma_f32_16x16x32_bf16 v[40:43], a[100:103], a[32:35], v[40:43]
  ds_read_b128 a[52:55], v1 offset:3072
  v_mfma_f32_16x16x32_bf16 v[44:47], a[104:107], a[32:35], v[44:47]
  v_mfma_f32_16x16x32_bf16 v[48:51], a[108:111], a[32:35], v[48:51]
  ds_read_b128 a[56:59], v1 offset:4096
  v_mfma_f32_16x16x32_bf16 v[116:119], a[108:111], a[36:39], v[116:119]
  buffer_load_dwordx4 a[148:151], v245, s[24:27], s53 offen offset:0 sc1
  v_mfma_f32_16x16x32_bf16 v[112:115], a[104:107], a[36:39], v[112:115]
  ds_read_b128 a[60:63], v1 offset:5120
  v_mfma_f32_16x16x32_bf16 v[108:111], a[100:103], a[36:39], v[108:111]
  v_mfma_f32_16x16x32_bf16 v[104:107], a[96:99], a[36:39], v[104:107]
  ds_read_b128 a[64:67], v1 offset:6144
  v_mfma_f32_16x16x32_bf16 v[68:71], a[92:95], a[36:39], v[68:71]
  v_mfma_f32_16x16x32_bf16 v[64:67], a[88:91], a[36:39], v[64:67]
  ds_read_b128 a[68:71], v1 offset:7168
  v_mfma_f32_16x16x32_bf16 v[60:63], a[84:87], a[36:39], v[60:63]
  v_mfma_f32_16x16x32_bf16 v[56:59], a[80:83], a[36:39], v[56:59]
  s_waitcnt vmcnt(17)
  ds_read_b128 a[72:75], v1 offset:8192
  v_mfma_f32_16x16x32_bf16 v[52:55], a[76:79], a[36:39], v[52:55]
  s_waitcnt lgkmcnt(6)
  v_mfma_f32_16x16x32_bf16 v[16:19], a[40:43], a[112:115], v[16:19]
  ds_read_b128 a[76:79], v1 offset:9216
  v_mfma_f32_16x16x32_bf16 v[20:23], a[44:47], a[112:115], v[20:23]
  buffer_load_dwordx4 a[152:155], v244, s[24:27], s53 offen offset:1024 sc1
  v_mfma_f32_16x16x32_bf16 v[24:27], a[48:51], a[112:115], v[24:27]
  s_waitcnt lgkmcnt(4)
  ds_read_b128 a[80:83], v1 offset:10240
  v_mfma_f32_16x16x32_bf16 v[28:31], a[52:55], a[112:115], v[28:31]
  v_mfma_f32_16x16x32_bf16 v[32:35], a[56:59], a[112:115], v[32:35]
  ds_read_b128 a[84:87], v1 offset:11264
  v_mfma_f32_16x16x32_bf16 v[36:39], a[60:63], a[112:115], v[36:39]
  s_waitcnt lgkmcnt(3)
  v_mfma_f32_16x16x32_bf16 v[40:43], a[64:67], a[112:115], v[40:43]
  ds_read_b128 a[88:91], v1 offset:12288
  v_mfma_f32_16x16x32_bf16 v[44:47], a[68:71], a[112:115], v[44:47]
  v_mfma_f32_16x16x32_bf16 v[48:51], a[72:75], a[112:115], v[48:51]
  ds_read_b128 a[92:95], v1 offset:13312
  v_mfma_f32_16x16x32_bf16 v[116:119], a[72:75], a[116:119], v[116:119]
  buffer_load_dwordx4 a[156:159], v245, s[24:27], s53 offen offset:1024 sc1
  v_mfma_f32_16x16x32_bf16 v[112:115], a[68:71], a[116:119], v[112:115]
  ds_read_b128 a[96:99], v1 offset:14336
  v_mfma_f32_16x16x32_bf16 v[108:111], a[64:67], a[116:119], v[108:111]
  v_mfma_f32_16x16x32_bf16 v[104:107], a[60:63], a[116:119], v[104:107]
  ds_read_b128 a[100:103], v1 offset:15360
  v_mfma_f32_16x16x32_bf16 v[68:71], a[56:59], a[116:119], v[68:71]
  v_mfma_f32_16x16x32_bf16 v[64:67], a[52:55], a[116:119], v[64:67]
  ds_read_b128 a[104:107], v1 offset:16384
  v_mfma_f32_16x16x32_bf16 v[60:63], a[48:51], a[116:119], v[60:63]
  v_mfma_f32_16x16x32_bf16 v[56:59], a[44:47], a[116:119], v[56:59]
  s_waitcnt vmcnt(14)
  ds_read_b128 a[108:111], v1 offset:17408
  v_mfma_f32_16x16x32_bf16 v[52:55], a[40:43], a[116:119], v[52:55]
  s_waitcnt lgkmcnt(6)
  v_mfma_f32_16x16x32_bf16 v[16:19], a[76:79], a[120:123], v[16:19]
  ds_read_b128 a[40:43], v1 offset:18432
  v_mfma_f32_16x16x32_bf16 v[20:23], a[80:83], a[120:123], v[20:23]
  buffer_load_dwordx4 a[160:163], v244, s[24:27], s53 offen offset:2048 sc1
  v_mfma_f32_16x16x32_bf16 v[24:27], a[84:87], a[120:123], v[24:27]
  s_waitcnt lgkmcnt(4)
  ds_read_b128 a[44:47], v1 offset:19456
  v_mfma_f32_16x16x32_bf16 v[28:31], a[88:91], a[120:123], v[28:31]
  v_mfma_f32_16x16x32_bf16 v[32:35], a[92:95], a[120:123], v[32:35]
  ds_read_b128 a[48:51], v1 offset:20480
  v_mfma_f32_16x16x32_bf16 v[36:39], a[96:99], a[120:123], v[36:39]
  s_waitcnt lgkmcnt(3)
  v_mfma_f32_16x16x32_bf16 v[40:43], a[100:103], a[120:123], v[40:43]
  ds_read_b128 a[52:55], v1 offset:21504
  v_mfma_f32_16x16x32_bf16 v[44:47], a[104:107], a[120:123], v[44:47]
  v_mfma_f32_16x16x32_bf16 v[48:51], a[108:111], a[120:123], v[48:51]
  ds_read_b128 a[56:59], v1 offset:22528
  v_mfma_f32_16x16x32_bf16 v[116:119], a[108:111], a[124:127], v[116:119]
  buffer_load_dwordx4 a[164:167], v245, s[24:27], s53 offen offset:2048 sc1
  v_mfma_f32_16x16x32_bf16 v[112:115], a[104:107], a[124:127], v[112:115]
  ds_read_b128 a[60:63], v1 offset:23552
  v_mfma_f32_16x16x32_bf16 v[108:111], a[100:103], a[124:127], v[108:111]
  v_mfma_f32_16x16x32_bf16 v[104:107], a[96:99], a[124:127], v[104:107]
  ds_read_b128 a[64:67], v1 offset:24576
  v_mfma_f32_16x16x32_bf16 v[68:71], a[92:95], a[124:127], v[68:71]
  v_mfma_f32_16x16x32_bf16 v[64:67], a[88:91], a[124:127], v[64:67]
  ds_read_b128 a[68:71], v1 offset:25600
  v_mfma_f32_16x16x32_bf16 v[60:63], a[84:87], a[124:127], v[60:63]
  v_mfma_f32_16x16x32_bf16 v[56:59], a[80:83], a[124:127], v[56:59]
  s_waitcnt vmcnt(11)
  ds_read_b128 a[72:75], v1 offset:26624
  v_mfma_f32_16x16x32_bf16 v[52:55], a[76:79], a[124:127], v[52:55]
  s_waitcnt lgkmcnt(6)
  v_mfma_f32_16x16x32_bf16 v[16:19], a[40:43], a[128:131], v[16:19]
  ds_read_b128 a[76:79], v1 offset:27648
  v_mfma_f32_16x16x32_bf16 v[20:23], a[44:47], a[128:131], v[20:23]
  buffer_load_dwordx4 a[168:171], v244, s[24:27], s53 offen offset:3072 sc1
  v_mfma_f32_16x16x32_bf16 v[24:27], a[48:51], a[128:131], v[24:27]
  s_waitcnt lgkmcnt(4)
  ds_read_b128 a[80:83], v1 offset:28672
  v_mfma_f32_16x16x32_bf16 v[28:31], a[52:55], a[128:131], v[28:31]
  v_mfma_f32_16x16x32_bf16 v[32:35], a[56:59], a[128:131], v[32:35]
  ds_read_b128 a[84:87], v1 offset:29696
  v_mfma_f32_16x16x32_bf16 v[36:39], a[60:63], a[128:131], v[36:39]
  s_waitcnt lgkmcnt(3)
  v_mfma_f32_16x16x32_bf16 v[40:43], a[64:67], a[128:131], v[40:43]
  ds_read_b128 a[88:91], v1 offset:30720
  v_mfma_f32_16x16x32_bf16 v[44:47], a[68:71], a[128:131], v[44:47]
  v_mfma_f32_16x16x32_bf16 v[48:51], a[72:75], a[128:131], v[48:51]
  ds_read_b128 a[92:95], v1 offset:31744
  v_mfma_f32_16x16x32_bf16 v[116:119], a[72:75], a[132:135], v[116:119]
  buffer_load_dwordx4 a[172:175], v245, s[24:27], s53 offen offset:3072 sc1
  s_add_u32 s53, s53, 4096
  v_mfma_f32_16x16x32_bf16 v[112:115], a[68:71], a[132:135], v[112:115]
  ds_read_b128 a[96:99], v1 offset:32768
  v_mfma_f32_16x16x32_bf16 v[108:111], a[64:67], a[132:135], v[108:111]
  v_mfma_f32_16x16x32_bf16 v[104:107], a[60:63], a[132:135], v[104:107]
  s_waitcnt vmcnt(8)
  ds_read_b128 a[100:103], v1 offset:33792
  v_mfma_f32_16x16x32_bf16 v[68:71], a[56:59], a[132:135], v[68:71]
  v_mfma_f32_16x16x32_bf16 v[64:67], a[52:55], a[132:135], v[64:67]
  s_barrier
  ds_read_b128 a[104:107], v1 offset:34816
  v_mfma_f32_16x16x32_bf16 v[60:63], a[48:51], a[132:135], v[60:63]
  v_mfma_f32_16x16x32_bf16 v[56:59], a[44:47], a[132:135], v[56:59]
  s_waitcnt vmcnt(11)
  ds_read_b128 a[108:111], v1 offset:35840
  v_mfma_f32_16x16x32_bf16 v[52:55], a[40:43], a[132:135], v[52:55]
  s_waitcnt lgkmcnt(6)
  v_mfma_f32_16x16x32_bf16 v[16:19], a[76:79], a[136:139], v[16:19]
  ds_read_b128 a[40:43], v1 offset:36864
  v_mfma_f32_16x16x32_bf16 v[20:23], a[80:83], a[136:139], v[20:23]
  v_mfma_f32_16x16x32_bf16 v[24:27], a[84:87], a[136:139], v[24:27]
  s_waitcnt lgkmcnt(4)
  ds_read_b128 a[44:47], v1 offset:46080
  v_mfma_f32_16x16x32_bf16 v[28:31], a[88:91], a[136:139], v[28:31]
  v_mfma_f32_16x16x32_bf16 v[32:35], a[92:95], a[136:139], v[32:35]
  ds_read_b128 a[48:51], v1 offset:55296
  v_mfma_f32_16x16x32_bf16 v[36:39], a[96:99], a[136:139], v[36:39]
  s_waitcnt lgkmcnt(3)
  v_mfma_f32_16x16x32_bf16 v[40:43], a[100:103], a[136:139], v[40:43]
  ds_read_b128 a[52:55], v1 offset:64512
  v_mfma_f32_16x16x32_bf16 v[44:47], a[104:107], a[136:139], v[44:47]
  v_mfma_f32_16x16x32_bf16 v[48:51], a[108:111], a[136:139], v[48:51]
  ds_read_b128 a[56:59], v1 offset:37888
  v_mfma_f32_16x16x32_bf16 v[116:119], a[108:111], a[140:143], v[116:119]
  v_mfma_f32_16x16x32_bf16 v[112:115], a[104:107], a[140:143], v[112:115]
  ds_read_b128 a[60:63], v1 offset:47104
  v_mfma_f32_16x16x32_bf16 v[108:111], a[100:103], a[140:143], v[108:111]
  v_mfma_f32_16x16x32_bf16 v[104:107], a[96:99], a[140:143], v[104:107]
  ds_read_b128 a[64:67], v1 offset:56320
  v_mfma_f32_16x16x32_bf16 v[68:71], a[92:95], a[140:143], v[68:71]
  v_mfma_f32_16x16x32_bf16 v[64:67], a[88:91], a[140:143], v[64:67]
  ds_read_b128 a[68:71], v6 offset:0
  v_mfma_f32_16x16x32_bf16 v[60:63], a[84:87], a[140:143], v[60:63]
  v_mfma_f32_16x16x32_bf16 v[56:59], a[80:83], a[140:143], v[56:59]
  ds_read_b128 a[72:75], v1 offset:38912
  v_mfma_f32_16x16x32_bf16 v[52:55], a[76:79], a[140:143], v[52:55]
  s_add_u32 s8, s100, 33423360
  s_addc_u32 s9, s101, 0
  s_and_b32 s9, s9, 0xffff
  s_mov_b32 s10, 7077888
  s_mov_b32 s11, 0x20000
  s_lshl_b32 s21, s48, 2
  s_add_u32 s21, s21, s49
  s_lshl_b32 s6, s21, 2
  s_add_u32 s6, s6, s18
  s_mul_i32 s40, s6, 27648
  s_sub_u32 s6, s47, s18
  s_sub_u32 s6, s6, 1
  s_and_b32 s6, s6, 3
  s_mul_i32 s6, s6, 9216
  s_add_u32 s40, s40, s6
  s_add_u32 s41, s40, 4096
  s_add_u32 s42, s40, 8192
  s_waitcnt vmcnt(0)
  s_cmp_eq_u32 s18, s47
  s_cbranch_scc1 dn_own
  s_waitcnt lgkmcnt(7)
  v_mfma_f32_16x16x32_bf16 v[16:19], a[40:43], a[144:147], v[16:19]
  ds_read_b128 a[76:79], v1 offset:48128
  v_mfma_f32_16x16x32_bf16 v[52:55], a[40:43], a[148:151], v[52:55]
  v_mfma_f32_16x16x32_bf16 v[16:19], a[44:47], a[152:155], v[16:19]
  ds_read_b128 a[80:83], v1 offset:57344
  v_mfma_f32_16x16x32_bf16 v[52:55], a[44:47], a[156:159], v[52:55]
  s_waitcnt lgkmcnt(7)
  v_mfma_f32_16x16x32_bf16 v[16:19], a[48:51], a[160:163], v[16:19]
  ds_read_b128 a[84:87], v6 offset:1024
  v_mfma_f32_16x16x32_bf16 v[52:55], a[48:51], a[164:167], v[52:55]
  v_mfma_f32_16x16x32_bf16 v[16:19], a[52:55], a[168:171], v[16:19]
  ds_read_b128 a[88:91], v1 offset:39936
  v_mfma_f32_16x16x32_bf16 v[52:55], a[52:55], a[172:175], v[52:55]
  s_waitcnt lgkmcnt(7)
  v_mfma_f32_16x16x32_bf16 v[20:23], a[56:59], a[144:147], v[20:23]
  ds_read_b128 a[92:95], v1 offset:49152
  v_mfma_f32_16x16x32_bf16 v[56:59], a[56:59], a[148:151], v[56:59]
  v_mfma_f32_16x16x32_bf16 v[20:23], a[60:63], a[152:155], v[20:23]
  ds_read_b128 a[96:99], v1 offset:58368
  v_cvt_pk_bf16_f32 v200, v16, v17
  v_mfma_f32_16x16x32_bf16 v[56:59], a[60:63], a[156:159], v[56:59]
  s_waitcnt lgkmcnt(7)
  v_cvt_pk_bf16_f32 v202, v52, v53
  v_cvt_pk_bf16_f32 v201, v18, v19
  v_mfma_f32_16x16x32_bf16 v[20:23], a[64:67], a[160:163], v[20:23]
  ds_read_b128 a[100:103], v6 offset:2048
  v_cvt_pk_bf16_f32 v203, v54, v55
  buffer_store_dwordx4 v[200:203], v1, s[8:11], s40 offen offset:0 sc1
  v_mfma_f32_16x16x32_bf16 v[56:59], a[64:67], a[164:167], v[56:59]
  v_mfma_f32_16x16x32_bf16 v[20:23], a[68:71], a[168:171], v[20:23]
  ds_read_b128 a[104:107], v1 offset:40960
  v_mfma_f32_16x16x32_bf16 v[56:59], a[68:71], a[172:175], v[56:59]
  s_waitcnt lgkmcnt(7)
  v_mfma_f32_16x16x32_bf16 v[24:27], a[72:75], a[144:147], v[24:27]
  ds_read_b128 a[108:111], v1 offset:50176
  v_mfma_f32_16x16x32_bf16 v[60:63], a[72:75], a[148:151], v[60:63]
  v_mfma_f32_16x16x32_bf16 v[24:27], a[76:79], a[152:155], v[24:27]
  ds_read_b128 a[40:43], v1 offset:59392
  v_cvt_pk_bf16_f32 v204, v20, v21
  v_mfma_f32_16x16x32_bf16 v[60:63], a[76:79], a[156:159], v[60:63]
  s_waitcnt lgkmcnt(7)
  v_cvt_pk_bf16_f32 v206, v56, v57
  v_cvt_pk_bf16_f32 v205, v22, v23
  v_mfma_f32_16x16x32_bf16 v[24:27], a[80:83], a[160:163], v[24:27]
  ds_read_b128 a[44:47], v6 offset:3072
  v_cvt_pk_bf16_f32 v207, v58, v59
  buffer_store_dwordx4 v[204:207], v1, s[8:11], s40 offen offset:1024 sc1
  v_mfma_f32_16x16x32_bf16 v[60:63], a[80:83], a[164:167], v[60:63]
  v_mfma_f32_16x16x32_bf16 v[24:27], a[84:87], a[168:171], v[24:27]
  ds_read_b128 a[48:51], v1 offset:41984
  v_mfma_f32_16x16x32_bf16 v[60:63], a[84:87], a[172:175], v[60:63]
  s_waitcnt lgkmcnt(7)
  v_mfma_f32_16x16x32_bf16 v[28:31], a[88:91], a[144:147], v[28:31]
  ds_read_b128 a[52:55], v1 offset:51200
  v_mfma_f32_16x16x32_bf16 v[64:67], a[88:91], a[148:151], v[64:67]
  v_mfma_f32_16x16x32_bf16 v[28:31], a[92:95], a[152:155], v[28:31]
  ds_read_b128 a[56:59], v1 offset:60416
  v_cvt_pk_bf16_f32 v208, v24, v25
  v_mfma_f32_16x16x32_bf16 v[64:67], a[92:95], a[156:159], v[64:67]
  s_waitcnt lgkmcnt(7)
  v_cvt_pk_bf16_f32 v210, v60, v61
  v_cvt_pk_bf16_f32 v209, v26, v27
  v_mfma_f32_16x16x32_bf16 v[28:31], a[96:99], a[160:163], v[28:31]
  ds_read_b128 a[60:63], v6 offset:4096
  v_cvt_pk_bf16_f32 v211, v62, v63
  buffer_store_dwordx4 v[208:211], v1, s[8:11], s40 offen offset:2048 sc1
  v_mfma_f32_16x16x32_bf16 v[64:67], a[96:99], a[164:167], v[64:67]
  v_mfma_f32_16x16x32_bf16 v[28:31], a[100:103], a[168:171], v[28:31]
  ds_read_b128 a[64:67], v1 offset:43008
  v_mfma_f32_16x16x32_bf16 v[64:67], a[100:103], a[172:175], v[64:67]
  s_waitcnt lgkmcnt(7)
  v_mfma_f32_16x16x32_bf16 v[32:35], a[104:107], a[144:147], v[32:35]
  ds_read_b128 a[68:71], v1 offset:52224
  v_mfma_f32_16x16x32_bf16 v[68:71], a[104:107], a[148:151], v[68:71]
  v_mfma_f32_16x16x32_bf16 v[32:35], a[108:111], a[152:155], v[32:35]
  ds_read_b128 a[72:75], v1 offset:61440
  v_cvt_pk_bf16_f32 v212, v28, v29
  v_mfma_f32_16x16x32_bf16 v[68:71], a[108:111], a[156:159], v[68:71]
  s_waitcnt lgkmcnt(7)
  v_cvt_pk_bf16_f32 v214, v64, v65
  v_cvt_pk_bf16_f32 v213, v30, v31
  v_mfma_f32_16x16x32_bf16 v[32:35], a[40:43], a[160:163], v[32:35]
  ds_read_b128 a[76:79], v6 offset:5120
  v_cvt_pk_bf16_f32 v215, v66, v67
  buffer_store_dwordx4 v[212:215], v1, s[8:11], s40 offen offset:3072 sc1
  v_mfma_f32_16x16x32_bf16 v[68:71], a[40:43], a[164:167], v[68:71]
  v_mfma_f32_16x16x32_bf16 v[32:35], a[44:47], a[168:171], v[32:35]
  ds_read_b128 a[80:83], v1 offset:44032
  v_mfma_f32_16x16x32_bf16 v[68:71], a[44:47], a[172:175], v[68:71]
  s_waitcnt lgkmcnt(7)
  v_mfma_f32_16x16x32_bf16 v[36:39], a[48:51], a[144:147], v[36:39]
  ds_read_b128 a[84:87], v1 offset:53248
  v_mfma_f32_16x16x32_bf16 v[104:107], a[48:51], a[148:151], v[104:107]
  v_mfma_f32_16x16x32_bf16 v[36:39], a[52:55], a[152:155], v[36:39]
  ds_read_b128 a[88:91], v1 offset:62464
  v_cvt_pk_bf16_f32 v216, v32, v33
  v_mfma_f32_16x16x32_bf16 v[104:107], a[52:55], a[156:159], v[104:107]
  s_waitcnt lgkmcnt(7)
  v_cvt_pk_bf16_f32 v218, v68, v69
  v_cvt_pk_bf16_f32 v217, v34, v35
  v_mfma_f32_16x16x32_bf16 v[36:39], a[56:59], a[160:163], v[36:39]
  ds_read_b128 a[92:95], v6 offset:6144
  v_cvt_pk_bf16_f32 v219, v70, v71
  buffer_store_dwordx4 v[216:219], v1, s[8:11], s41 offen offset:0 sc1
  v_mfma_f32_16x16x32_bf16 v[104:107], a[56:59], a[164:167], v[104:107]
  v_mfma_f32_16x16x32_bf16 v[36:39], a[60:63], a[168:171], v[36:39]
  ds_read_b128 a[96:99], v1 offset:45056
  v_mfma_f32_16x16x32_bf16 v[104:107], a[60:63], a[172:175], v[104:107]
  s_waitcnt lgkmcnt(7)
  v_mfma_f32_16x16x32_bf16 v[40:43], a[64:67], a[144:147], v[40:43]
  ds_read_b128 a[100:103], v1 offset:54272
  v_mfma_f32_16x16x32_bf16 v[108:111], a[64:67], a[148:151], v[108:111]
  v_mfma_f32_16x16x32_bf16 v[40:43], a[68:71], a[152:155], v[40:43]
  ds_read_b128 a[104:107], v1 offset:63488
  v_cvt_pk_bf16_f32 v220, v36, v37
  v_mfma_f32_16x16x32_bf16 v[108:111], a[68:71], a[156:159], v[108:111]
  s_waitcnt lgkmcnt(7)
  v_cvt_pk_bf16_f32 v222, v104, v105
  v_cvt_pk_bf16_f32 v221, v38, v39
  v_mfma_f32_16x16x32_bf16 v[40:43], a[72:75], a[160:163], v[40:43]
  ds_read_b128 a[108:111], v6 offset:7168
  v_cvt_pk_bf16_f32 v223, v106, v107
  buffer_store_dwordx4 v[220:223], v1, s[8:11], s41 offen offset:1024 sc1
  v_mfma_f32_16x16x32_bf16 v[108:111], a[72:75], a[164:167], v[108:111]
  v_mfma_f32_16x16x32_bf16 v[40:43], a[76:79], a[168:171], v[40:43]
  v_mfma_f32_16x16x32_bf16 v[108:111], a[76:79], a[172:175], v[108:111]
  s_waitcnt lgkmcnt(6)
  v_mfma_f32_16x16x32_bf16 v[44:47], a[80:83], a[144:147], v[44:47]
  v_mfma_f32_16x16x32_bf16 v[112:115], a[80:83], a[148:151], v[112:115]
  v_mfma_f32_16x16x32_bf16 v[44:47], a[84:87], a[152:155], v[44:47]
  v_mfma_f32_16x16x32_bf16 v[112:115], a[84:87], a[156:159], v[112:115]
  s_waitcnt lgkmcnt(4)
  v_mfma_f32_16x16x32_bf16 v[44:47], a[88:91], a[160:163], v[44:47]
  v_cvt_pk_bf16_f32 v225, v42, v43
  v_cvt_pk_bf16_f32 v224, v40, v41
  v_mfma_f32_16x16x32_bf16 v[112:115], a[88:91], a[164:167], v[112:115]
  v_cvt_pk_bf16_f32 v226, v108, v109
  v_cvt_pk_bf16_f32 v227, v110, v111
  buffer_store_dwordx4 v[224:227], v1, s[8:11], s41 offen offset:2048 sc1
  v_mfma_f32_16x16x32_bf16 v[44:47], a[92:95], a[168:171], v[44:47]
  v_mfma_f32_16x16x32_bf16 v[112:115], a[92:95], a[172:175], v[112:115]
  s_waitcnt lgkmcnt(2)
  v_mfma_f32_16x16x32_bf16 v[48:51], a[96:99], a[144:147], v[48:51]
  v_mfma_f32_16x16x32_bf16 v[116:119], a[96:99], a[148:151], v[116:119]
  v_mfma_f32_16x16x32_bf16 v[48:51], a[100:103], a[152:155], v[48:51]
  v_mfma_f32_16x16x32_bf16 v[116:119], a[100:103], a[156:159], v[116:119]
  s_waitcnt lgkmcnt(0)
  v_mfma_f32_16x16x32_bf16 v[48:51], a[104:107], a[160:163], v[48:51]
  v_cvt_pk_bf16_f32 v229, v46, v47
  v_cvt_pk_bf16_f32 v228, v44, v45
  v_mfma_f32_16x16x32_bf16 v[116:119], a[104:107], a[164:167], v[116:119]
  v_cvt_pk_bf16_f32 v230, v112, v113
  v_cvt_pk_bf16_f32 v231, v114, v115
  buffer_store_dwordx4 v[228:231], v1, s[8:11], s41 offen offset:3072 sc1
  v_mfma_f32_16x16x32_bf16 v[48:51], a[108:111], a[168:171], v[48:51]
  v_mfma_f32_16x16x32_bf16 v[116:119], a[108:111], a[172:175], v[116:119]
  s_nop 6
  v_cvt_pk_bf16_f32 v232, v48, v49
  v_cvt_pk_bf16_f32 v233, v50, v51
  v_cvt_pk_bf16_f32 v234, v116, v117
  v_cvt_pk_bf16_f32 v235, v118, v119
  buffer_store_dwordx4 v[232:235], v1, s[8:11], s42 offen offset:0 sc1
  s_branch dn_pub
dn_own:
  s_waitcnt lgkmcnt(7)
  v_mfma_f32_16x16x32_bf16 v[16:19], a[40:43], a[144:147], v[16:19]
  ds_read_b128 a[76:79], v1 offset:48128
  v_mfma_f32_16x16x32_bf16 v[52:55], a[40:43], a[148:151], v[52:55]
  v_mfma_f32_16x16x32_bf16 v[16:19], a[44:47], a[152:155], v[16:19]
  ds_read_b128 a[80:83], v1 offset:57344
  v_mfma_f32_16x16x32_bf16 v[52:55], a[44:47], a[156:159], v[52:55]
  s_waitcnt lgkmcnt(7)
  v_mfma_f32_16x16x32_bf16 v[16:19], a[48:51], a[160:163], v[16:19]
  ds_read_b128 a[84:87], v6 offset:1024
  v_mfma_f32_16x16x32_bf16 v[52:55], a[48:51], a[164:167], v[52:55]
  v_mfma_f32_16x16x32_bf16 v[16:19], a[52:55], a[168:171], v[16:19]
  ds_read_b128 a[88:91], v1 offset:39936
  v_mfma_f32_16x16x32_bf16 v[52:55], a[52:55], a[172:175], v[52:55]
  s_waitcnt lgkmcnt(7)
  v_mfma_f32_16x16x32_bf16 v[20:23], a[56:59], a[144:147], v[20:23]
  ds_read_b128 a[92:95], v1 offset:49152
  v_mfma_f32_16x16x32_bf16 v[56:59], a[56:59], a[148:151], v[56:59]
  v_mfma_f32_16x16x32_bf16 v[20:23], a[60:63], a[152:155], v[20:23]
  ds_read_b128 a[96:99], v1 offset:58368
  v_mfma_f32_16x16x32_bf16 v[56:59], a[60:63], a[156:159], v[56:59]
  s_waitcnt lgkmcnt(7)
  ds_write_b128 v6, v[16:19] offset:45056
  ds_write_b128 v6, v[52:55] offset:46080
  v_mfma_f32_16x16x32_bf16 v[20:23], a[64:67], a[160:163], v[20:23]
  ds_read_b128 a[100:103], v6 offset:2048
  v_mfma_f32_16x16x32_bf16 v[56:59], a[64:67], a[164:167], v[56:59]
  v_mfma_f32_16x16x32_bf16 v[20:23], a[68:71], a[168:171], v[20:23]
  ds_read_b128 a[104:107], v1 offset:40960
  v_mfma_f32_16x16x32_bf16 v[56:59], a[68:71], a[172:175], v[56:59]
  s_waitcnt lgkmcnt(9)
  v_mfma_f32_16x16x32_bf16 v[24:27], a[72:75], a[144:147], v[24:27]
  ds_read_b128 a[108:111], v1 offset:50176
  v_mfma_f32_16x16x32_bf16 v[60:63], a[72:75], a[148:151], v[60:63]
  v_mfma_f32_16x16x32_bf16 v[24:27], a[76:79], a[152:155], v[24:27]
  ds_read_b128 a[40:43], v1 offset:59392
  v_mfma_f32_16x16x32_bf16 v[60:63], a[76:79], a[156:159], v[60:63]
  s_waitcnt lgkmcnt(9)
  ds_write_b128 v6, v[20:23] offset:47104
  ds_write_b128 v6, v[56:59] offset:48128
  v_mfma_f32_16x16x32_bf16 v[24:27], a[80:83], a[160:163], v[24:27]
  ds_read_b128 a[44:47], v6 offset:3072
  v_mfma_f32_16x16x32_bf16 v[60:63], a[80:83], a[164:167], v[60:63]
  v_mfma_f32_16x16x32_bf16 v[24:27], a[84:87], a[168:171], v[24:27]
  ds_read_b128 a[48:51], v1 offset:41984
  v_mfma_f32_16x16x32_bf16 v[60:63], a[84:87], a[172:175], v[60:63]
  s_waitcnt lgkmcnt(11)
  v_mfma_f32_16x16x32_bf16 v[28:31], a[88:91], a[144:147], v[28:31]
  ds_read_b128 a[52:55], v1 offset:51200
  v_mfma_f32_16x16x32_bf16 v[64:67], a[88:91], a[148:151], v[64:67]
  v_mfma_f32_16x16x32_bf16 v[28:31], a[92:95], a[152:155], v[28:31]
  ds_read_b128 a[56:59], v1 offset:60416
  v_mfma_f32_16x16x32_bf16 v[64:67], a[92:95], a[156:159], v[64:67]
  s_waitcnt lgkmcnt(9)
  ds_write_b128 v6, v[24:27] offset:49152
  ds_write_b128 v6, v[60:63] offset:50176
  v_mfma_f32_16x16x32_bf16 v[28:31], a[96:99], a[160:163], v[28:31]
  ds_read_b128 a[60:63], v6 offset:4096
  v_mfma_f32_16x16x32_bf16 v[64:67], a[96:99], a[164:167], v[64:67]
  v_mfma_f32_16x16x32_bf16 v[28:31], a[100:103], a[168:171], v[28:31]
  ds_read_b128 a[64:67], v1 offset:43008
  v_mfma_f32_16x16x32_bf16 v[64:67], a[100:103], a[172:175], v[64:67]
  s_waitcnt lgkmcnt(11)
  v_mfma_f32_16x16x32_bf16 v[32:35], a[104:107], a[144:147], v[32:35]
  ds_read_b128 a[68:71], v1 offset:52224
  v_mfma_f32_16x16x32_bf16 v[68:71], a[104:107], a[148:151], v[68:71]
  v_mfma_f32_16x16x32_bf16 v[32:35], a[108:111], a[152:155], v[32:35]
  ds_read_b128 a[72:75], v1 offset:61440
  v_mfma_f32_16x16x32_bf16 v[68:71], a[108:111], a[156:159], v[68:71]
  s_waitcnt lgkmcnt(9)
  ds_write_b128 v6, v[28:31] offset:51200
  ds_write_b128 v6, v[64:67] offset:52224
  v_mfma_f32_16x16x32_bf16 v[32:35], a[40:43], a[160:163], v[32:35]
  ds_read_b128 a[76:79], v6 offset:5120
  v_mfma_f32_16x16x32_bf16 v[68:71], a[40:43], a[164:167], v[68:71]
  v_mfma_f32_16x16x32_bf16 v[32:35], a[44:47], a[168:171], v[32:35]
  ds_read_b128 a[80:83], v1 offset:44032
  v_mfma_f32_16x16x32_bf16 v[68:71], a[44:47], a[172:175], v[68:71]
  s_waitcnt lgkmcnt(11)
  v_mfma_f32_16x16x32_bf16 v[36:39], a[48:51], a[144:147], v[36:39]
  ds_read_b128 a[84:87], v1 offset:53248
  v_mfma_f32_16x16x32_bf16 v[104:107], a[48:51], a[148:151], v[104:107]
  v_mfma_f32_16x16x32_bf16 v[36:39], a[52:55], a[152:155], v[36:39]
  ds_read_b128 a[88:91], v1 offset:62464
  v_mfma_f32_16x16x32_bf16 v[104:107], a[52:55], a[156:159], v[104:107]
  s_waitcnt lgkmcnt(9)
  ds_write_b128 v6, v[32:35] offset:53248
  ds_write_b128 v6, v[68:71] offset:54272
  v_mfma_f32_16x16x32_bf16 v[36:39], a[56:59], a[160:163], v[36:39]
  ds_read_b128 a[92:95], v6 offset:6144
  v_mfma_f32_16x16x32_bf16 v[104:107], a[56:59], a[164:167], v[104:107]
  v_mfma_f32_16x16x32_bf16 v[36:39], a[60:63], a[168:171], v[36:39]
  ds_read_b128 a[96:99], v1 offset:45056
  v_mfma_f32_16x16x32_bf16 v[104:107], a[60:63], a[172:175], v[104:107]
  s_waitcnt lgkmcnt(11)
  v_mfma_f32_16x16x32_bf16 v[40:43], a[64:67], a[144:147], v[40:43]
  ds_read_b128 a[100:103], v1 offset:54272
  v_mfma_f32_16x16x32_bf16 v[108:111], a[64:67], a[148:151], v[108:111]
  v_mfma_f32_16x16x32_bf16 v[40:43], a[68:71], a[152:155], v[40:43]
  ds_read_b128 a[104:107], v1 offset:63488
  v_mfma_f32_16x16x32_bf16 v[108:111], a[68:71], a[156:159], v[108:111]
  s_waitcnt lgkmcnt(9)
  ds_write_b128 v6, v[36:39] offset:55296
  ds_write_b128 v6, v[104:107] offset:56320
  v_mfma_f32_16x16x32_bf16 v[40:43], a[72:75], a[160:163], v[40:43]
  ds_read_b128 a[108:111], v6 offset:7168
  v_mfma_f32_16x16x32_bf16 v[108:111], a[72:75], a[164:167], v[108:111]
  v_mfma_f32_16x16x32_bf16 v[40:43], a[76:79], a[168:171], v[40:43]
  v_mfma_f32_16x16x32_bf16 v[108:111], a[76:79], a[172:175], v[108:111]
  s_waitcnt lgkmcnt(10)
  v_mfma_f32_16x16x32_bf16 v[44:47], a[80:83], a[144:147], v[44:47]
  v_mfma_f32_16x16x32_bf16 v[112:115], a[80:83], a[148:151], v[112:115]
  v_mfma_f32_16x16x32_bf16 v[44:47], a[84:87], a[152:155], v[44:47]
  v_mfma_f32_16x16x32_bf16 v[112:115], a[84:87], a[156:159], v[112:115]
  s_waitcnt lgkmcnt(6)
  v_mfma_f32_16x16x32_bf16 v[44:47], a[88:91], a[160:163], v[44:47]
  ds_write_b128 v6, v[40:43] offset:57344
  ds_write_b128 v6, v[108:111] offset:58368
  v_mfma_f32_16x16x32_bf16 v[112:115], a[88:91], a[164:167], v[112:115]
  v_mfma_f32_16x16x32_bf16 v[44:47], a[92:95], a[168:171], v[44:47]
  v_mfma_f32_16x16x32_bf16 v[112:115], a[92:95], a[172:175], v[112:115]
  s_waitcnt lgkmcnt(6)
  v_mfma_f32_16x16x32_bf16 v[48:51], a[96:99], a[144:147], v[48:51]
  v_mfma_f32_16x16x32_bf16 v[116:119], a[96:99], a[148:151], v[116:119]
  v_mfma_f32_16x16x32_bf16 v[48:51], a[100:103], a[152:155], v[48:51]
  v_mfma_f32_16x16x32_bf16 v[116:119], a[100:103], a[156:159], v[116:119]
  s_waitcnt lgkmcnt(2)
  v_mfma_f32_16x16x32_bf16 v[48:51], a[104:107], a[160:163], v[48:51]
  ds_write_b128 v6, v[44:47] offset:59392
  ds_write_b128 v6, v[112:115] offset:60416
  v_mfma_f32_16x16x32_bf16 v[116:119], a[104:107], a[164:167], v[116:119]
  v_mfma_f32_16x16x32_bf16 v[48:51], a[108:111], a[168:171], v[48:51]
  v_mfma_f32_16x16x32_bf16 v[116:119], a[108:111], a[172:175], v[116:119]
  s_nop 6
  ds_write_b128 v6, v[48:51] offset:61440
  ds_write_b128 v6, v[116:119] offset:62464
dn_pub:
  s_lshl_b32 s46, s21, 9
  s_add_u32 s46, s46, s59
  s_add_u32 s46, s46, 131072
  s_lshl_b32 s58, s47, 7
  s_add_u32 s58, s58, s46
  s_waitcnt lgkmcnt(0)
  s_waitcnt vmcnt(0)
  s_barrier
  s_cmp_lg_u32 s18, 0
  s_cbranch_scc1 dx_sg
  s_mov_b64 exec, 1
  buffer_store_dword v253, v252, s[96:99], s58 offen sc1
  s_mov_b64 exec, -1
dx_sg:
  s_lshr_b32 s7, s2, 3
  s_mul_i32 s6, s7, 43
  s_lshr_b32 s6, s6, 8
  s_mul_i32 s6, s6, 6
  s_sub_u32 s7, s7, s6
  s_and_b32 s6, s2, 1
  s_mul_i32 s6, s6, 6
  s_add_u32 s6, s6, s7
  s_mul_i32 s6, s6, 165888
  s_add_u32 s6, s6, 47579136
  s_add_u32 s12, s4, s6
  s_addc_u32 s13, s5, 0
  s_and_b32 s13, s13, 0xffff
  s_mov_b32 s15, 0x20000
  s_cmp_lt_u32 s2, 192
  s_cselect_b32 s14, 165888, 0
  s_lshl_b32 s20, s18, 10
  s_cmp_lg_u32 s54, 0
  s_cselect_b32 s14, 0, s14
  s_cbranch_scc1 dn_noq
  s_add_u32 m0, s20, 0
  s_nop 0
  buffer_load_dwordx4 v1, s[12:15], m0 offen sc1 lds
  s_add_u32 m0, s20, 4096
  s_nop 0
  buffer_load_dwordx4 v1, s[12:15], m0 offen sc1 lds
  s_add_u32 m0, s20, 8192
  s_nop 0
  buffer_load_dwordx4 v1, s[12:15], m0 offen sc1 lds
  s_add_u32 m0, s20, 12288
  s_nop 0
  buffer_load_dwordx4 v1, s[12:15], m0 offen sc1 lds
  s_add_u32 m0, s20, 16384
  s_nop 0
  buffer_load_dwordx4 v1, s[12:15], m0 offen sc1 lds
  s_add_u32 m0, s20, 20480
  s_nop 0
  buffer_load_dwordx4 v1, s[12:15], m0 offen sc1 lds
  s_add_u32 m0, s20, 24576
  s_nop 0
  buffer_load_dwordx4 v1, s[12:15], m0 offen sc1 lds
  s_add_u32 m0, s20, 28672
  s_nop 0
  buffer_load_dwordx4 v1, s[12:15], m0 offen sc1 lds
  s_add_u32 m0, s20, 32768
  s_nop 0
  buffer_load_dwordx4 v1, s[12:15], m0 offen sc1 lds
  s_add_u32 m0, s20, 36864
  s_nop 0
  buffer_load_dwordx4 v1, s[12:15], m0 offen sc1 lds
  s_add_u32 m0, s20, 40960
  s_nop 0
  buffer_load_dwordx4 v1, s[12:15], m0 offen sc1 lds
  s_add_u32 m0, s20, 45056
  s_nop 0
  buffer_load_dwordx4 v1, s[12:15], m0 offen sc1 lds
  s_add_u32 m0, s20, 49152
  s_nop 0
  buffer_load_dwordx4 v1, s[12:15], m0 offen sc1 lds
  s_add_u32 m0, s20, 53248
  s_nop 0
  buffer_load_dwordx4 v1, s[12:15], m0 offen sc1 lds
dn_noq:
  s_add_u32 s24, s100, 2359296
  s_addc_u32 s25, s101, 0
  s_and_b32 s25, s25, 0xffff
  s_mov_b32 s26, 2359296
  s_mov_b32 s27, 0x20000
  v_and_b32 v10, 15, v254
  v_bfe_u32 v12, v254, 4, 1
  v_lshrrev_b32 v13, 5, v254
  v_mul_u32_u24 v14, 18432, v12
  v_lshl_add_u32 v16, v13, 8, v14
  v_lshl_add_u32 v16, v10, 4, v16
  s_lshl_b32 s30, s48, 3
  s_lshl_b32 s6, s47, 1
  s_add_u32 s30, s30, s6
  s_mul_i32 s31, s30, 18432
  s_mul_i32 s32, s49, 9
  s_add_u32 s32, s32, s18
  s_lshl_b32 s33, s32, 9
  s_add_u32 s33, s33, s31
  s_add_u32 s34, s33, 4096
  buffer_load_dwordx4 v[176:179], v16, s[24:27], s33 offen sc1
  buffer_load_dwordx4 v[180:183], v16, s[24:27], s33 offen offset:2048 sc1
  buffer_load_dwordx4 v[184:187], v16, s[24:27], s34 offen sc1
  s_lshl_b32 s6, s18, 11
  s_add_u32 s6, s6, 110592
  v_add_u32 v6, s6, v1
  ds_read_b128 v[32:35], v6 offset:0
  ds_read_b128 v[36:39], v6 offset:1024
  ds_read_b128 v[40:43], v6 offset:8192
  ds_read_b128 v[44:47], v6 offset:9216
  ds_read_b128 v[48:51], v6 offset:16384
  ds_read_b128 v[52:55], v6 offset:17408
  s_cmp_eq_u32 s54, 1
  s_cselect_b32 s44, 16, 256
  s_cselect_b32 s45, 1152, 16
  s_cselect_b32 s36, s56, s100
  s_cselect_b32 s37, s57, s101
  s_cselect_b32 s6, 0, 0
  s_cselect_b32 s42, 0, 262144
  s_add_u32 s36, s36, s6
  s_addc_u32 s37, s37, 0
  s_and_b32 s37, s37, 0xffff
  s_mov_b32 s38, 2359296
  s_mov_b32 s39, 0x20000
  s_add_u32 s40, s100, 14155776
  s_addc_u32 s41, s101, 0
  s_and_b32 s41, s41, 0xffff
  s_mov_b32 s43, 0x20000
  v_mul_lo_u32 v17, v10, s45
  v_mul_lo_u32 v15, v13, s44
  v_add3_u32 v17, v17, v15, v14
  s_lshl_b32 s6, s44, 1
  s_mul_i32 s16, s32, s6
  s_add_u32 s16, s16, s31
  s_lshl_b32 s6, s44, 3
  s_add_u32 s17, s16, s6
  s_add_u32 s19, s17, s6
  v_lshlrev_b32 v18, 4, v10
  v_lshl_add_u32 v18, v12, 11, v18
  s_lshl_b32 s51, s30, 11
  s_lshl_b32 s6, s49, 9
  s_add_u32 s51, s51, s6
  s_lshr_b32 s6, s18, 1
  s_lshl_b32 s6, s6, 8
  s_add_u32 s51, s51, s6
  s_and_b32 s6, s18, 1
  s_lshl_b32 s6, s6, 3
  s_add_u32 s51, s51, s6
  s_lshl_b32 s6, s21, 2
  s_add_u32 s6, s6, s47
  s_mul_i32 s33, s6, 27648
  s_lshl_b32 s7, s18, 10
  s_add_u32 s33, s33, s7
  s_add_u32 s34, s33, 9216
  s_add_u32 s35, s33, 18432
  s_lshl_b32 s58, s48, 4
  s_lshl_b32 s7, s49, 2
  s_add_u32 s58, s58, s7
  s_add_u32 s58, s58, s47
  s_lshl_b32 s58, s58, 7
  s_add_u32 s58, s58, s59
  s_add_u32 s58, s58, 163840
  v_add_u32 v7, 4096, v1
  v_add_u32 v8, 8192, v1
  v_mov_b32 v20, 0
  v_mov_b32 v21, 0
  v_mov_b32 v22, 0xffff0000
  v_mov_b32 v23, 0x3f803f80
  s_waitcnt lgkmcnt(0)
  v_min_u32 v255, 2, v254
  s_add_u32 s6, s47, 1
  v_add_u32 v255, s6, v255
  v_and_b32 v255, 3, v255
  v_lshlrev_b32 v255, 7, v255
  s_cmp_lg_u32 s18, 0
  s_cbranch_scc1 dx_wn
  s_mov_b32 s3, 150000
dx_wl:
  buffer_load_dword v249, v255, s[96:99], s46 offen sc1
  s_waitcnt vmcnt(0)
  v_cmp_ne_u32 vcc, v253, v249
  s_nop 1
  s_cmp_eq_u64 vcc, 0
  s_cbranch_scc1 dx_wd
  s_sub_u32 s3, s3, 1
  s_cmp_lg_u32 s3, 0
  s_cbranch_scc1 dx_wl
dx_wn:
  s_waitcnt vmcnt(0)
dx_wd:
  s_barrier
  s_cmp_lg_u32 s18, 0
  s_cbranch_scc1 dn_l2
  buffer_load_dwordx4 v[212:215], v8, s[8:11], s33 offen sc1
  buffer_load_dwordx4 v[216:219], v8, s[8:11], s34 offen sc1
  buffer_load_dwordx4 v[220:223], v8, s[8:11], s35 offen sc1
dn_l2:
  buffer_load_dwordx4 v[188:191], v1, s[8:11], s33 offen sc1
  buffer_load_dwordx4 v[192:195], v1, s[8:11], s34 offen sc1
  buffer_load_dwordx4 v[196:199], v1, s[8:11], s35 offen sc1
  buffer_load_dwordx4 v[200:203], v7, s[8:11], s33 offen sc1
  buffer_load_dwordx4 v[204:207], v7, s[8:11], s34 offen sc1
  buffer_load_dwordx4 v[208:211], v7, s[8:11], s35 offen sc1
  s_cmp_lg_u32 s18, 0
  s_cbranch_scc1 dn_f2
  s_waitcnt vmcnt(6)
  v_lshlrev_b32 v64, 16, v212
  v_and_b32 v65, v22, v212
  v_lshlrev_b32 v66, 16, v213
  v_and_b32 v67, v22, v213
  v_lshlrev_b32 v68, 16, v214
  v_and_b32 v69, v22, v214
  v_lshlrev_b32 v70, 16, v215
  v_and_b32 v71, v22, v215
  v_pk_add_f32 v[48:49], v[48:49], v[64:65]
  v_pk_add_f32 v[50:51], v[50:51], v[66:67]
  v_pk_add_f32 v[52:53], v[52:53], v[68:69]
  v_pk_add_f32 v[54:55], v[54:55], v[70:71]
  v_lshlrev_b32 v64, 16, v216
  v_and_b32 v65, v22, v216
  v_lshlrev_b32 v66, 16, v217
  v_and_b32 v67, v22, v217
  v_lshlrev_b32 v68, 16, v218
  v_and_b32 v69, v22, v218
  v_lshlrev_b32 v70, 16, v219
  v_and_b32 v71, v22, v219
  v_pk_add_f32 v[48:49], v[48:49], v[64:65]
  v_pk_add_f32 v[50:51], v[50:51], v[66:67]
  v_pk_add_f32 v[52:53], v[52:53], v[68:69]
  v_pk_add_f32 v[54:55], v[54:55], v[70:71]
  v_lshlrev_b32 v64, 16, v220
  v_and_b32 v65, v22, v220
  v_lshlrev_b32 v66, 16, v221
  v_and_b32 v67, v22, v221
  v_lshlrev_b32 v68, 16, v222
  v_and_b32 v69, v22, v222
  v_lshlrev_b32 v70, 16, v223
  v_and_b32 v71, v22, v223
  v_pk_add_f32 v[48:49], v[48:49], v[64:65]
  v_pk_add_f32 v[50:51], v[50:51], v[66:67]
  v_pk_add_f32 v[52:53], v[52:53], v[68:69]
  v_pk_add_f32 v[54:55], v[54:55], v[70:71]
  v_lshlrev_b32 v64, 16, v184
  v_and_b32 v65, v22, v184
  v_lshlrev_b32 v66, 16, v185
  v_and_b32 v67, v22, v185
  v_lshlrev_b32 v68, 16, v186
  v_and_b32 v69, v22, v186
  v_lshlrev_b32 v70, 16, v187
  v_and_b32 v71, v22, v187
  v_permlane16_swap_b32 v48, v52
  v_permlane16_swap_b32 v49, v53
  v_permlane16_swap_b32 v50, v54
  v_permlane16_swap_b32 v51, v55
  v_pk_add_f32 v[48:49], v[48:49], v[64:65]
  v_pk_add_f32 v[50:51], v[50:51], v[66:67]
  v_pk_add_f32 v[52:53], v[52:53], v[68:69]
  v_pk_add_f32 v[54:55], v[54:55], v[70:71]
  v_cvt_pk_bf16_f32 v80, v48, v49
  v_cvt_pk_bf16_f32 v81, v50, v51
  v_cvt_pk_bf16_f32 v82, v52, v53
  v_cvt_pk_bf16_f32 v83, v54, v55
  s_cmp_eq_u32 s54, 0
  s_cbranch_scc1 dn_s2
  buffer_store_dwordx4 v[80:83], v17, s[36:39], s19 offen
  s_branch dn_t2
dn_s2:
  buffer_store_dwordx4 v[80:83], v17, s[36:39], s19 offen sc1
dn_t2:
  v_dot2c_f32_bf16 v20, v80, v23
  v_dot2c_f32_bf16 v21, v80, v80
  v_dot2c_f32_bf16 v20, v81, v23
  v_dot2c_f32_bf16 v21, v81, v81
  v_dot2c_f32_bf16 v20, v82, v23
  v_dot2c_f32_bf16 v21, v82, v82
  v_dot2c_f32_bf16 v20, v83, v23
  v_dot2c_f32_bf16 v21, v83, v83
dn_f2:
  s_waitcnt vmcnt(3)
  v_lshlrev_b32 v64, 16, v188
  v_and_b32 v65, v22, v188
  v_lshlrev_b32 v66, 16, v189
  v_and_b32 v67, v22, v189
  v_lshlrev_b32 v68, 16, v190
  v_and_b32 v69, v22, v190
  v_lshlrev_b32 v70, 16, v191
  v_and_b32 v71, v22, v191
  v_pk_add_f32 v[32:33], v[32:33], v[64:65]
  v_pk_add_f32 v[34:35], v[34:35], v[66:67]
  v_pk_add_f32 v[36:37], v[36:37], v[68:69]
  v_pk_add_f32 v[38:39], v[38:39], v[70:71]
  v_lshlrev_b32 v64, 16, v192
  v_and_b32 v65, v22, v192
  v_lshlrev_b32 v66, 16, v193
  v_and_b32 v67, v22, v193
  v_lshlrev_b32 v68, 16, v194
  v_and_b32 v69, v22, v194
  v_lshlrev_b32 v70, 16, v195
  v_and_b32 v71, v22, v195
  v_pk_add_f32 v[32:33], v[32:33], v[64:65]
  v_pk_add_f32 v[34:35], v[34:35], v[66:67]
  v_pk_add_f32 v[36:37], v[36:37], v[68:69]
  v_pk_add_f32 v[38:39], v[38:39], v[70:71]
  v_lshlrev_b32 v64, 16, v196
  v_and_b32 v65, v22, v196
  v_lshlrev_b32 v66, 16, v197
  v_and_b32 v67, v22, v197
  v_lshlrev_b32 v68, 16, v198
  v_and_b32 v69, v22, v198
  v_lshlrev_b32 v70, 16, v199
  v_and_b32 v71, v22, v199
  v_pk_add_f32 v[32:33], v[32:33], v[64:65]
  v_pk_add_f32 v[34:35], v[34:35], v[66:67]
  v_pk_add_f32 v[36:37], v[36:37], v[68:69]
  v_pk_add_f32 v[38:39], v[38:39], v[70:71]
  v_lshlrev_b32 v64, 16, v176
  v_and_b32 v65, v22, v176
  v_lshlrev_b32 v66, 16, v177
  v_and_b32 v67, v22, v177
  v_lshlrev_b32 v68, 16, v178
  v_and_b32 v69, v22, v178
  v_lshlrev_b32 v70, 16, v179
  v_and_b32 v71, v22, v179
  v_permlane16_swap_b32 v32, v36
  v_permlane16_swap_b32 v33, v37
  v_permlane16_swap_b32 v34, v38
  v_permlane16_swap_b32 v35, v39
  v_pk_add_f32 v[32:33], v[32:33], v[64:65]
  v_pk_add_f32 v[34:35], v[34:35], v[66:67]
  v_pk_add_f32 v[36:37], v[36:37], v[68:69]
  v_pk_add_f32 v[38:39], v[38:39], v[70:71]
  v_cvt_pk_bf16_f32 v72, v32, v33
  v_cvt_pk_bf16_f32 v73, v34, v35
  v_cvt_pk_bf16_f32 v74, v36, v37
  v_cvt_pk_bf16_f32 v75, v38, v39
  s_cmp_eq_u32 s54, 0
  s_cbranch_scc1 dn_s0
  buffer_store_dwordx4 v[72:75], v17, s[36:39], s16 offen
  s_branch dn_t0
dn_s0:
  buffer_store_dwordx4 v[72:75], v17, s[36:39], s16 offen sc1
dn_t0:
  v_dot2c_f32_bf16 v20, v72, v23
  v_dot2c_f32_bf16 v21, v72, v72
  v_dot2c_f32_bf16 v20, v73, v23
  v_dot2c_f32_bf16 v21, v73, v73
  v_dot2c_f32_bf16 v20, v74, v23
  v_dot2c_f32_bf16 v21, v74, v74
  v_dot2c_f32_bf16 v20, v75, v23
  v_dot2c_f32_bf16 v21, v75, v75
  s_waitcnt vmcnt(1)
  v_lshlrev_b32 v64, 16, v200
  v_and_b32 v65, v22, v200
  v_lshlrev_b32 v66, 16, v201
  v_and_b32 v67, v22, v201
  v_lshlrev_b32 v68, 16, v202
  v_and_b32 v69, v22, v202
  v_lshlrev_b32 v70, 16, v203
  v_and_b32 v71, v22, v203
  v_pk_add_f32 v[40:41], v[40:41], v[64:65]
  v_pk_add_f32 v[42:43], v[42:43], v[66:67]
  v_pk_add_f32 v[44:45], v[44:45], v[68:69]
  v_pk_add_f32 v[46:47], v[46:47], v[70:71]
  v_lshlrev_b32 v64, 16, v204
  v_and_b32 v65, v22, v204
  v_lshlrev_b32 v66, 16, v205
  v_and_b32 v67, v22, v205
  v_lshlrev_b32 v68, 16, v206
  v_and_b32 v69, v22, v206
  v_lshlrev_b32 v70, 16, v207
  v_and_b32 v71, v22, v207
  v_pk_add_f32 v[40:41], v[40:41], v[64:65]
  v_pk_add_f32 v[42:43], v[42:43], v[66:67]
  v_pk_add_f32 v[44:45], v[44:45], v[68:69]
  v_pk_add_f32 v[46:47], v[46:47], v[70:71]
  v_lshlrev_b32 v64, 16, v208
  v_and_b32 v65, v22, v208
  v_lshlrev_b32 v66, 16, v209
  v_and_b32 v67, v22, v209
  v_lshlrev_b32 v68, 16, v210
  v_and_b32 v69, v22, v210
  v_lshlrev_b32 v70, 16, v211
  v_and_b32 v71, v22, v211
  v_pk_add_f32 v[40:41], v[40:41], v[64:65]
  v_pk_add_f32 v[42:43], v[42:43], v[66:67]
  v_pk_add_f32 v[44:45], v[44:45], v[68:69]
  v_pk_add_f32 v[46:47], v[46:47], v[70:71]
  v_lshlrev_b32 v64, 16, v180
  v_and_b32 v65, v22, v180
  v_lshlrev_b32 v66, 16, v181
  v_and_b32 v67, v22, v181
  v_lshlrev_b32 v68, 16, v182
  v_and_b32 v69, v22, v182
  v_lshlrev_b32 v70, 16, v183
  v_and_b32 v71, v22, v183
  v_permlane16_swap_b32 v40, v44
  v_permlane16_swap_b32 v41, v45
  v_permlane16_swap_b32 v42, v46
  v_permlane16_swap_b32 v43, v47
  v_pk_add_f32 v[40:41], v[40:41], v[64:65]
  v_pk_add_f32 v[42:43], v[42:43], v[66:67]
  v_pk_add_f32 v[44:45], v[44:45], v[68:69]
  v_pk_add_f32 v[46:47], v[46:47], v[70:71]
  v_cvt_pk_bf16_f32 v76, v40, v41
  v_cvt_pk_bf16_f32 v77, v42, v43
  v_cvt_pk_bf16_f32 v78, v44, v45
  v_cvt_pk_bf16_f32 v79, v46, v47
  s_cmp_eq_u32 s54, 0
  s_cbranch_scc1 dn_s1
  buffer_store_dwordx4 v[76:79], v17, s[36:39], s17 offen
  s_branch dn_t1
dn_s1:
  buffer_store_dwordx4 v[76:79], v17, s[36:39], s17 offen sc1
dn_t1:
  v_dot2c_f32_bf16 v20, v76, v23
  v_dot2c_f32_bf16 v21, v76, v76
  v_dot2c_f32_bf16 v20, v77, v23
  v_dot2c_f32_bf16 v21, v77, v77
  v_dot2c_f32_bf16 v20, v78, v23
  v_dot2c_f32_bf16 v21, v78, v78
  v_dot2c_f32_bf16 v20, v79, v23
  v_dot2c_f32_bf16 v21, v79, v79
  s_nop 1
  v_mov_b32 v24, v20
  v_mov_b32 v25, v21
  s_nop 0
  v_permlane32_swap_b32 v20, v24
  v_permlane32_swap_b32 v21, v25
  v_add_f32 v20, v20, v24
  v_add_f32 v21, v21, v25
  s_mov_b32 exec_hi, 0
  buffer_store_dwordx2 v[20:21], v18, s[40:43], s51 offen sc1
  s_mov_b32 exec_hi, -1
  s_cmp_eq_u32 s54, 0
  s_cbranch_scc0 mega_fin
  s_mov_b32 s54, 1
  s_mov_b32 s59, 262144
  s_branch q2_main
pkf_slow:
  s_mov_b32 s3, 150000
pkf_wl:
  buffer_load_dword v247, v246, s[96:99], s89 offen sc1
  s_waitcnt vmcnt(0)
  v_cmp_ne_u32 vcc, v253, v247
  s_nop 1
  s_cmp_eq_u64 vcc, 0
  s_cbranch_scc1 pkf_ok
  s_sub_u32 s3, s3, 1
  s_cmp_lg_u32 s3, 0
  s_cbranch_scc1 pkf_wl
  s_branch pkf_ok
fa_slow:
  s_mov_b32 s3, 150000
fa_wl:
  buffer_load_dword v247, v246, s[96:99], s50 offen sc1
  s_waitcnt vmcnt(0)
  v_cmp_ne_u32 vcc, v253, v247
  s_nop 1
  s_cmp_eq_u64 vcc, 0
  s_cbranch_scc1 fa_ok
  s_sub_u32 s3, s3, 1
  s_cmp_lg_u32 s3, 0
  s_cbranch_scc1 fa_wl
  s_branch fa_ok
fb_slow:
  s_mov_b32 s3, 150000
fb_wl:
  buffer_load_dword v247, v246, s[96:99], s51 offen sc1
  s_waitcnt vmcnt(0)
  v_cmp_ne_u32 vcc, v253, v247
  s_nop 1
  s_cmp_eq_u64 vcc, 0
  s_cbranch_scc1 fb_ok
  s_sub_u32 s3, s3, 1
  s_cmp_lg_u32 s3, 0
  s_cbranch_scc1 fb_wl
  s_branch fb_ok
at_redo:
  s_mov_b32 s29, 1
  v_mov_b32 v112, 0
  v_mov_b32 v113, 0
  v_mov_b32 v114, 0
  v_mov_b32 v115, 0
  v_mov_b32 v116, 0
  v_mov_b32 v117, 0
  v_mov_b32 v118, 0
  v_mov_b32 v119, 0
  v_mov_b32 v120, 0
  v_mov_b32 v121, 0
  v_mov_b32 v122, 0
  v_mov_b32 v123, 0
  v_mov_b32 v124, 0
  v_mov_b32 v125, 0
  v_mov_b32 v126, 0
  v_mov_b32 v127, 0
  v_mov_b32 v128, 0
  v_mov_b32 v129, 0
  v_mov_b32 v130, 0
  v_mov_b32 v131, 0
  v_mov_b32 v132, 0
  v_mov_b32 v133, 0
  v_mov_b32 v134, 0
  v_mov_b32 v135, 0
  v_mov_b32 v136, 0
  v_mov_b32 v137, 0
  v_mov_b32 v138, 0
  v_mov_b32 v139, 0
  v_mov_b32 v140, 0
  v_mov_b32 v141, 0
  v_mov_b32 v142, 0
  v_mov_b32 v143, 0
  v_mov_b32 v144, 0
  v_mov_b32 v145, 0
  v_mov_b32 v146, 0
  v_mov_b32 v147, 0
  v_mov_b32 v148, 0
  v_mov_b32 v149, 0
  v_mov_b32 v150, 0
  v_mov_b32 v151, 0
  v_mov_b32 v152, 0
  v_mov_b32 v153, 0
  v_mov_b32 v154, 0
  v_mov_b32 v155, 0
  v_mov_b32 v156, 0
  v_mov_b32 v157, 0
  v_mov_b32 v158, 0
  v_mov_b32 v159, 0
  v_mov_b32 v216, 0xf149f2ca
  v_mov_b32 v217, 0xf149f2ca
  v_mov_b32 v218, 0xf149f2ca
  v_mov_b32 v219, 0xf149f2ca
at_p1:
  v_mov_b32 v2, v6
  v_mov_b32 v3, v5
  s_cmp_eq_u32 s17, 0
  s_cbranch_scc1 at_p1_q0
  ds_read_b128 v[32:35], v2
  ds_read_b128 v[36:39], v2 offset:1024
  s_waitcnt lgkmcnt(0)
  v_mfma_f32_16x16x32_bf16 v[48:51], v[32:35], v[16:19], v[160:163]
  v_mfma_f32_16x16x32_bf16 v[64:67], v[36:39], v[16:19], 0
  v_mfma_f32_16x16x32_bf16 v[68:71], v[36:39], v[20:23], v[160:163]
  ds_read_b128 v[32:35], v2 offset:3072
  ds_read_b128 v[36:39], v2 offset:4096
  s_nop 5
  v_max3_f32 v216, v216, v48, v49
  v_max3_f32 v216, v216, v50, v51
  s_waitcnt lgkmcnt(1)
  v_mfma_f32_16x16x32_bf16 v[48:51], v[32:35], v[16:19], 0
  v_mfma_f32_16x16x32_bf16 v[52:55], v[32:35], v[20:23], 0
  v_mfma_f32_16x16x32_bf16 v[56:59], v[32:35], v[24:27], v[160:163]
  ds_read_b128 v[32:35], v2 offset:6144
  v_max3_f32 v216, v216, v64, v65
  v_max3_f32 v216, v216, v66, v67
  s_waitcnt lgkmcnt(1)
  v_mfma_f32_16x16x32_bf16 v[64:67], v[36:39], v[16:19], 0
  v_max3_f32 v217, v217, v68, v69
  v_max3_f32 v217, v217, v70, v71
  v_mfma_f32_16x16x32_bf16 v[68:71], v[36:39], v[20:23], 0
  v_mfma_f32_16x16x32_bf16 v[72:75], v[36:39], v[24:27], 0
  v_mfma_f32_16x16x32_bf16 v[76:79], v[36:39], v[28:31], v[160:163]
  ds_read_b128 v[36:39], v2 offset:7168
  v_add_u32 v2, 3072, v2
  v_max3_f32 v216, v216, v48, v49
  v_max3_f32 v216, v216, v50, v51
  s_waitcnt lgkmcnt(1)
  v_mfma_f32_16x16x32_bf16 v[48:51], v[32:35], v[16:19], 0
  v_max3_f32 v217, v217, v52, v53
  v_max3_f32 v217, v217, v54, v55
  v_mfma_f32_16x16x32_bf16 v[52:55], v[32:35], v[20:23], 0
  v_max3_f32 v218, v218, v56, v57
  v_max3_f32 v218, v218, v58, v59
  v_mfma_f32_16x16x32_bf16 v[56:59], v[32:35], v[24:27], 0
  v_mfma_f32_16x16x32_bf16 v[60:63], v[32:35], v[28:31], 0
  ds_read_b128 v[32:35], v2 offset:6144
  v_max3_f32 v216, v216, v64, v65
  v_max3_f32 v216, v216, v66, v67
  s_waitcnt lgkmcnt(1)
  v_mfma_f32_16x16x32_bf16 v[64:67], v[36:39], v[16:19], 0
  v_max3_f32 v217, v217, v68, v69
  v_max3_f32 v217, v217, v70, v71
  v_mfma_f32_16x16x32_bf16 v[68:71], v[36:39], v[20:23], 0
  v_max3_f32 v218, v218, v72, v73
  v_max3_f32 v218, v218, v74, v75
  v_mfma_f32_16x16x32_bf16 v[72:75], v[36:39], v[24:27], 0
  v_max3_f32 v219, v219, v76, v77
  v_max3_f32 v219, v219, v78, v79
  v_mfma_f32_16x16x32_bf16 v[76:79], v[36:39], v[28:31], 0
  ds_read_b128 v[36:39], v2 offset:7168
  v_add_u32 v2, 3072, v2
  s_mov_b32 s34, 5
  s_branch at_p1_loop
at_p1_q0:
  s_cmp_eq_u32 s18, 0
  s_cbranch_scc0 at_p1_q0b
  ds_read_b128 v[32:35], v2
  ds_read_b128 v[36:39], v2 offset:1024
  s_waitcnt lgkmcnt(0)
  v_mfma_f32_16x16x32_bf16 v[48:51], v[32:35], v[16:19], v[164:167]
  v_mfma_f32_16x16x32_bf16 v[52:55], v[32:35], v[20:23], 0
  v_mfma_f32_16x16x32_bf16 v[56:59], v[32:35], v[24:27], 0
  v_mfma_f32_16x16x32_bf16 v[60:63], v[32:35], v[28:31], 0
  v_mfma_f32_16x16x32_bf16 v[68:71], v[36:39], v[20:23], v[164:167]
  v_mfma_f32_16x16x32_bf16 v[72:75], v[36:39], v[24:27], 0
  v_mfma_f32_16x16x32_bf16 v[76:79], v[36:39], v[28:31], 0
  ds_read_b128 v[32:35], v2 offset:3072
  ds_read_b128 v[36:39], v2 offset:4096
  s_nop 5
  s_branch at_p1_8
at_p1_q0b:
  ds_read_b128 v[32:35], v2
  ds_read_b128 v[36:39], v2 offset:1024
  s_waitcnt lgkmcnt(0)
  v_mfma_f32_16x16x32_bf16 v[48:51], v[32:35], v[16:19], 0
  v_mfma_f32_16x16x32_bf16 v[52:55], v[32:35], v[20:23], 0
  v_mfma_f32_16x16x32_bf16 v[56:59], v[32:35], v[24:27], 0
  v_mfma_f32_16x16x32_bf16 v[60:63], v[32:35], v[28:31], 0
  v_mfma_f32_16x16x32_bf16 v[64:67], v[36:39], v[16:19], 0
  v_mfma_f32_16x16x32_bf16 v[68:71], v[36:39], v[20:23], 0
  v_mfma_f32_16x16x32_bf16 v[72:75], v[36:39], v[24:27], 0
  v_mfma_f32_16x16x32_bf16 v[76:79], v[36:39], v[28:31], 0
  ds_read_b128 v[32:35], v2 offset:3072
  ds_read_b128 v[36:39], v2 offset:4096
  s_nop 5
  s_lshl_b32 s34, s18, 1
  s_sub_u32 s34, s34, 1
at_p1_loop:
  v_max3_f32 v216, v216, v48, v49
  v_max3_f32 v216, v216, v50, v51
  s_waitcnt lgkmcnt(1)
  v_mfma_f32_16x16x32_bf16 v[48:51], v[32:35], v[16:19], 0
  v_max3_f32 v217, v217, v52, v53
  v_max3_f32 v217, v217, v54, v55
  v_mfma_f32_16x16x32_bf16 v[52:55], v[32:35], v[20:23], 0
  v_max3_f32 v218, v218, v56, v57
  v_max3_f32 v218, v218, v58, v59
  v_mfma_f32_16x16x32_bf16 v[56:59], v[32:35], v[24:27], 0
  v_max3_f32 v219, v219, v60, v61
  v_max3_f32 v219, v219, v62, v63
  v_mfma_f32_16x16x32_bf16 v[60:63], v[32:35], v[28:31], 0
  ds_read_b128 v[32:35], v2 offset:6144
  v_max3_f32 v216, v216, v64, v65
  v_max3_f32 v216, v216, v66, v67
  s_waitcnt lgkmcnt(1)
  v_mfma_f32_16x16x32_bf16 v[64:67], v[36:39], v[16:19], 0
  v_max3_f32 v217, v217, v68, v69
  v_max3_f32 v217, v217, v70, v71
  v_mfma_f32_16x16x32_bf16 v[68:71], v[36:39], v[20:23], 0
  v_max3_f32 v218, v218, v72, v73
  v_max3_f32 v218, v218, v74, v75
  v_mfma_f32_16x16x32_bf16 v[72:75], v[36:39], v[24:27], 0
  v_max3_f32 v219, v219, v76, v77
  v_max3_f32 v219, v219, v78, v79
  v_mfma_f32_16x16x32_bf16 v[76:79], v[36:39], v[28:31], 0
  ds_read_b128 v[36:39], v2 offset:7168
  v_add_u32 v2, 3072, v2
  s_sub_u32 s34, s34, 1
  s_cmp_lg_u32 s34, 0
  s_cbranch_scc1 at_p1_loop
  v_max3_f32 v216, v216, v48, v49
  v_max3_f32 v216, v216, v50, v51
  s_waitcnt lgkmcnt(1)
  v_mfma_f32_16x16x32_bf16 v[48:51], v[32:35], v[16:19], v[164:167]
  v_max3_f32 v217, v217, v52, v53
  v_max3_f32 v217, v217, v54, v55
  v_mfma_f32_16x16x32_bf16 v[52:55], v[32:35], v[20:23], 0
  v_max3_f32 v218, v218, v56, v57
  v_max3_f32 v218, v218, v58, v59
  v_mfma_f32_16x16x32_bf16 v[56:59], v[32:35], v[24:27], 0
  v_max3_f32 v219, v219, v60, v61
  v_max3_f32 v219, v219, v62, v63
  v_mfma_f32_16x16x32_bf16 v[60:63], v[32:35], v[28:31], 0
  ds_read_b128 v[32:35], v2 offset:6144
  v_max3_f32 v216, v216, v64, v65
  v_max3_f32 v216, v216, v66, v67
  s_waitcnt lgkmcnt(1)
  v_max3_f32 v217, v217, v68, v69
  v_max3_f32 v217, v217, v70, v71
  v_mfma_f32_16x16x32_bf16 v[68:71], v[36:39], v[20:23], v[164:167]
  v_max3_f32 v218, v218, v72, v73
  v_max3_f32 v218, v218, v74, v75
  v_mfma_f32_16x16x32_bf16 v[72:75], v[36:39], v[24:27], 0
  v_max3_f32 v219, v219, v76, v77
  v_max3_f32 v219, v219, v78, v79
  v_mfma_f32_16x16x32_bf16 v[76:79], v[36:39], v[28:31], 0
  ds_read_b128 v[36:39], v2 offset:7168
  v_add_u32 v2, 3072, v2
at_p1_8:
  v_max3_f32 v216, v216, v48, v49
  v_max3_f32 v216, v216, v50, v51
  s_waitcnt lgkmcnt(1)
  v_max3_f32 v217, v217, v52, v53
  v_max3_f32 v217, v217, v54, v55
  v_max3_f32 v218, v218, v56, v57
  v_max3_f32 v218, v218, v58, v59
  v_mfma_f32_16x16x32_bf16 v[56:59], v[32:35], v[24:27], v[164:167]
  v_max3_f32 v219, v219, v60, v61
  v_max3_f32 v219, v219, v62, v63
  v_mfma_f32_16x16x32_bf16 v[60:63], v[32:35], v[28:31], 0
  ds_read_b128 v[32:35], v2 offset:6144
  s_waitcnt lgkmcnt(1)
  v_max3_f32 v217, v217, v68, v69
  v_max3_f32 v217, v217, v70, v71
  v_max3_f32 v218, v218, v72, v73
  v_max3_f32 v218, v218, v74, v75
  v_max3_f32 v219, v219, v76, v77
  v_max3_f32 v219, v219, v78, v79
  v_mfma_f32_16x16x32_bf16 v[76:79], v[36:39], v[28:31], v[164:167]
  ds_read_b128 v[36:39], v2 offset:7168
  v_add_u32 v2, 3072, v2
  v_max3_f32 v218, v218, v56, v57
  v_max3_f32 v218, v218, v58, v59
  v_max3_f32 v219, v219, v60, v61
  v_max3_f32 v219, v219, v62, v63
  s_nop 1
  v_max3_f32 v219, v219, v76, v77
  v_max3_f32 v219, v219, v78, v79
  s_waitcnt lgkmcnt(0)
  v_mov_b32 v220, v216
  v_mov_b32 v221, v217
  v_mov_b32 v222, v218
  v_mov_b32 v223, v219
  v_permlane16_swap_b32 v216, v220
  v_permlane16_swap_b32 v217, v221
  v_permlane16_swap_b32 v218, v222
  v_permlane16_swap_b32 v219, v223
  v_max_f32 v216, v216, v220
  v_max_f32 v217, v217, v221
  v_max_f32 v218, v218, v222
  v_max_f32 v219, v219, v223
  v_mov_b32 v220, v216
  v_mov_b32 v221, v217
  v_mov_b32 v222, v218
  v_mov_b32 v223, v219
  v_permlane32_swap_b32 v216, v220
  v_permlane32_swap_b32 v217, v221
  v_permlane32_swap_b32 v218, v222
  v_permlane32_swap_b32 v219, v223
  v_max_f32 v216, v216, v220
  v_max_f32 v217, v217, v221
  v_max_f32 v218, v218, v222
  v_max_f32 v219, v219, v223
  v_sub_f32 v168, 0, v216
  v_sub_f32 v184, v160, v216
  v_sub_f32 v200, v164, v216
  v_sub_f32 v169, 0, v216
  v_sub_f32 v185, v161, v216
  v_sub_f32 v201, v165, v216
  v_sub_f32 v170, 0, v216
  v_sub_f32 v186, v162, v216
  v_sub_f32 v202, v166, v216
  v_sub_f32 v171, 0, v216
  v_sub_f32 v187, v163, v216
  v_sub_f32 v203, v167, v216
  v_sub_f32 v172, 0, v217
  v_sub_f32 v188, v160, v217
  v_sub_f32 v204, v164, v217
  v_sub_f32 v173, 0, v217
  v_sub_f32 v189, v161, v217
  v_sub_f32 v205, v165, v217
  v_sub_f32 v174, 0, v217
  v_sub_f32 v190, v162, v217
  v_sub_f32 v206, v166, v217
  v_sub_f32 v175, 0, v217
  v_sub_f32 v191, v163, v217
  v_sub_f32 v207, v167, v217
  v_sub_f32 v176, 0, v218
  v_sub_f32 v192, v160, v218
  v_sub_f32 v208, v164, v218
  v_sub_f32 v177, 0, v218
  v_sub_f32 v193, v161, v218
  v_sub_f32 v209, v165, v218
  v_sub_f32 v178, 0, v218
  v_sub_f32 v194, v162, v218
  v_sub_f32 v210, v166, v218
  v_sub_f32 v179, 0, v218
  v_sub_f32 v195, v163, v218
  v_sub_f32 v211, v167, v218
  v_sub_f32 v180, 0, v219
  v_sub_f32 v196, v160, v219
  v_sub_f32 v212, v164, v219
  v_sub_f32 v181, 0, v219
  v_sub_f32 v197, v161, v219
  v_sub_f32 v213, v165, v219
  v_sub_f32 v182, 0, v219
  v_sub_f32 v198, v162, v219
  v_sub_f32 v214, v166, v219
  v_sub_f32 v183, 0, v219
  v_sub_f32 v199, v163, v219
  v_sub_f32 v215, v167, v219
  s_branch at_p2
mega_fin:
  s_or_b32 s3, s2, s18
  s_cmp_lg_u32 s3, 0
  s_cbranch_scc1 mega_end
  s_add_u32 s3, s93, 1
  v_mov_b32 v251, s3
  s_mov_b32 s3, 593920
  s_mov_b64 exec, 1
  buffer_store_dword v251, v252, s[96:99], s3 offen sc1
mega_end:
mega_exit:
  s_endpgm
code_end:
  s_endpgm
.section .rodata,"a"
.p2align 6
.amdhsa_kernel interleave_layers__sliding_block__swiglu_ffn__prompt_kernel
  .amdhsa_next_free_vgpr 512
  .amdhsa_next_free_sgpr 102
  .amdhsa_accum_offset 256
  .amdhsa_group_segment_fixed_size 0
  .amdhsa_kernarg_size 80
  .amdhsa_user_sgpr_count 2
  .amdhsa_user_sgpr_kernarg_segment_ptr 1
  .amdhsa_system_sgpr_workgroup_id_x 1
  .amdhsa_float_denorm_mode_32 3
.end_amdhsa_kernel
.text
```
